```python
import torch

def _softmax(x, axis=-1):
    return torch.softmax(x, dim=axis)

def _gelu(x):
    return torch.nn.functional.gelu(x, approximate='tanh')

def _silu(x):
    return torch.nn.functional.silu(x)

def _sigmoid(x):
    return torch.sigmoid(x)

def _layernorm(x, axis=-1, eps=1e-05):
    m = x.mean(dim=axis, keepdim=True)
    v = x.var(dim=axis, keepdim=True, unbiased=False)
    return (x - m) / torch.sqrt(v + eps)

def _scatter_add(tgt, idx, src, axis=0):
    return tgt.clone().index_add_(axis, idx, src)

def _segment_sum(src, seg, n):
    out = torch.zeros((n,) + src.shape[1:], dtype=src.dtype)
    return out.index_add_(0, seg, src)

def _pad(x, pw):
    flat = tuple((v for pair in reversed(pw) for v in pair))
    return torch.nn.functional.pad(x, flat)
kernel_name = 'sequential_preLN__memory_aug_recurrent_mem_tr__glu_gated_swiglu__prompt'

def setup_inputs():

    _w = lambda a: (lambda t: t.to(torch.bfloat16) if t.is_floating_point() else t)(torch.as_tensor(a))

    def _A_setup():
        B, S, Dm = (1, 2048, 640)
        H, Dh = (32, 128)
        M, seg = (8, 32)
        seg = min(seg, S)
        S = S // seg * seg
        return {'x': _w((lambda *s: torch.randn(*s, dtype=torch.bfloat16) * 0.05)(B, S, Dm)), 'mem0': _w((lambda *s: torch.randn(*s, dtype=torch.bfloat16) * 0.2)(B, M, Dm)), 'Wq': _w((lambda *s: torch.randn(*s, dtype=torch.bfloat16) * 1.6)(Dm, H, Dh) * Dm ** (-0.5)), 'Wk': _w((lambda *s: torch.randn(*s, dtype=torch.bfloat16) * 1.6)(Dm, H, Dh) * Dm ** (-0.5)), 'Wv': _w((lambda *s: torch.randn(*s, dtype=torch.bfloat16) * 0.2)(Dm, H, Dh) * Dm ** (-0.5)), 'Wo': _w((lambda *s: torch.randn(*s, dtype=torch.bfloat16) * 0.2)(H, Dh, Dm) * (H * Dh) ** (-0.5)), 'seg_len': seg}
    _A_in = _A_setup()

    def _B_setup():
        B, S, D, F = (1, 2048, 640, 1728)
        return {'x': _w((lambda *s: torch.randn(*s, dtype=torch.bfloat16) * 0.05)(B, S, D)), 'w1': _w((lambda *s: torch.randn(*s, dtype=torch.bfloat16) * 0.2)(D, F) * (2.0 / D) ** 0.5), 'w3': _w((lambda *s: torch.randn(*s, dtype=torch.bfloat16) * 0.2)(D, F) * (2.0 / D) ** 0.5), 'w2': _w((lambda *s: torch.randn(*s, dtype=torch.bfloat16) * 0.2)(F, D) * (2.0 / F) ** 0.5)}
    _B_in = _B_setup()
    return {'A_x': _A_in['x'], 'A_mem0': _A_in['mem0'], 'A_Wq': _A_in['Wq'], 'A_Wk': _A_in['Wk'], 'A_Wv': _A_in['Wv'], 'A_Wo': _A_in['Wo'], 'A_seg_len': _A_in['seg_len'], 'B_x': _B_in['x'], 'B_w1': _B_in['w1'], 'B_w3': _B_in['w3'], 'B_w2': _B_in['w2']}

def reference(A_x, A_mem0, A_Wq, A_Wk, A_Wv, A_Wo, A_seg_len, B_x, B_w1, B_w3, B_w2):

    def _A_ref(x, mem0, Wq, Wk, Wv, Wo, seg_len):
        B, S, Dm = x.shape
        H, Dh = (Wq.shape[1], Wq.shape[2])
        M = mem0.shape[1]
        scale = Dh ** (-0.5)
        n_seg = S // seg_len
        L = M + seg_len
        idx = torch.arange(L)
        mask = (idx[:, None] < M) | (idx[:, None] >= idx[None, :])
        mem = mem0
        outs = []
        for s in range(n_seg):
            xs = x[:, s * seg_len:(s + 1) * seg_len, :].clone()
            h = torch.concatenate([mem, xs], axis=1)
            q = torch.einsum('btd,dhe->bhte', h, Wq)
            k = torch.einsum('btd,dhe->bhte', h, Wk)
            v = torch.einsum('btd,dhe->bhte', h, Wv)
            scores = torch.einsum('bhqe,bhke->bhqk', q, k) * scale
            scores = torch.where(mask[None, None], scores, -1000000000.0)
            p = _softmax(scores, axis=-1)
            o = torch.einsum('bhqk,bhke->bhqe', p, v)
            o = torch.einsum('bhte,hed->btd', o, Wo)
            mem = o[:, :M, :].clone()
            outs.append(o[:, M:, :])
        return torch.concatenate(outs, axis=1)

    def _B_ref(x, w1, w3, w2):
        gate = torch.einsum('bsd,df->bsf', x, w1)
        up = torch.einsum('bsd,df->bsf', x, w3)
        h = _silu(gate) * up
        out = torch.einsum('bsf,fd->bsd', h, w2)
        return out
    x = A_x
    h = x + _A_ref(_layernorm(x, axis=-1), A_mem0, A_Wq, A_Wk, A_Wv, A_Wo, A_seg_len)
    h2 = h + _B_ref(_layernorm(h, axis=-1), B_w1, B_w3, B_w2)
    return h2
```

```asm
; @launch kernel=prep_kernel grid=(1373,1,1) block=(256,1,1) lds=0
; @launch kernel=gemm1_kernel grid=(240,1,1) block=(256,1,1) lds=131072
; @launch kernel=rec_kernel grid=(256,1,1) block=(256,1,1) lds=131072
; @launch kernel=tail_kernel grid=(584,1,1) block=(256,1,1) lds=81920
; @launch kernel=up_kernel grid=(432,1,1) block=(256,1,1) lds=81920
; @launch kernel=down_kernel grid=(160,1,1) block=(256,1,1) lds=98304
.amdgcn_target "amdgcn-amd-amdhsa--gfx950"
.text
.globl prep_kernel
.p2align 8
.type prep_kernel,@function
prep_kernel:
    s_load_dwordx2 s[4:5], s[0:1], 104
    v_lshrrev_b32 v1, 6, v0
    v_and_b32 v2, 63, v0
    v_readfirstlane_b32 s3, v1
    s_lshl_b32 s6, s2, 2
    s_add_u32 s6, s6, s3
    s_cmp_ge_u32 s6, 4608
    s_cbranch_scc1 MISC_2
    s_cmp_ge_u32 s6, 2560
    s_cbranch_scc1 LN_1
    s_cmp_ge_u32 s6, 2560
    s_cbranch_scc1 END_3
    s_cmp_ge_u32 s6, 640
    s_cbranch_scc1 PSEG_5
    s_load_dwordx2 s[8:9], s[0:1], 16
    s_sub_u32 s7, s6, 0
    s_mov_b32 s10, 8192
    s_mov_b32 s14, 5242880
    s_mul_hi_u32 s11, s7, 0x1999999a
    s_mul_i32 s12, s11, 10
    s_sub_u32 s12, s7, s12
    s_mul_i32 s13, s11, 81920
    s_lshl_b32 s16, s12, 12
    s_add_u32 s13, s13, s16
    s_add_u32 s13, s13, 0x0
    s_mov_b32 s17, 40960
    s_mul_i32 s15, s12, 524288
    s_lshl_b32 s16, s11, 7
    s_add_u32 s15, s15, s16
    s_branch PGO_4
PSEG_5:
    s_cmp_ge_u32 s6, 1280
    s_cbranch_scc1 PSEG_6
    s_load_dwordx2 s[8:9], s[0:1], 24
    s_sub_u32 s7, s6, 640
    s_mov_b32 s10, 8192
    s_mov_b32 s14, 5242880
    s_mul_hi_u32 s11, s7, 0x1999999a
    s_mul_i32 s12, s11, 10
    s_sub_u32 s12, s7, s12
    s_mul_i32 s13, s11, 81920
    s_lshl_b32 s16, s12, 12
    s_add_u32 s13, s13, s16
    s_add_u32 s13, s13, 0x500000
    s_mov_b32 s17, 40960
    s_mul_i32 s15, s12, 524288
    s_lshl_b32 s16, s11, 7
    s_add_u32 s15, s15, s16
    s_branch PGO_4
PSEG_6:
    s_cmp_ge_u32 s6, 1920
    s_cbranch_scc1 PSEG_7
    s_load_dwordx2 s[8:9], s[0:1], 32
    s_sub_u32 s7, s6, 1280
    s_mov_b32 s10, 8192
    s_mov_b32 s14, 5242880
    s_mul_hi_u32 s11, s7, 0x1999999a
    s_mul_i32 s12, s11, 10
    s_sub_u32 s12, s7, s12
    s_mul_i32 s13, s11, 81920
    s_lshl_b32 s16, s12, 12
    s_add_u32 s13, s13, s16
    s_add_u32 s13, s13, 0xa00000
    s_mov_b32 s17, 40960
    s_mul_i32 s15, s12, 524288
    s_lshl_b32 s16, s11, 7
    s_add_u32 s15, s15, s16
    s_branch PGO_4
PSEG_7:
    s_cmp_ge_u32 s6, 2560
    s_cbranch_scc1 PSEG_8
    s_load_dwordx2 s[8:9], s[0:1], 40
    s_sub_u32 s7, s6, 1920
    s_mov_b32 s10, 1280
    s_mov_b32 s14, 5242880
    s_mul_hi_u32 s11, s7, 0x80000001
    s_mul_i32 s12, s11, 2
    s_sub_u32 s12, s7, s12
    s_mul_hi_u32 s18, s11, 0x1999999a
    s_mul_i32 s16, s18, 10
    s_sub_u32 s19, s11, s16
    s_mul_i32 s13, s18, 163840
    s_mul_i32 s16, s19, 16384
    s_add_u32 s13, s13, s16
    s_lshl_b32 s16, s12, 12
    s_add_u32 s13, s13, s16
    s_add_u32 s13, s13, 0xf00000
    s_mov_b32 s17, 8192
    s_lshl_b32 s15, s18, 1
    s_add_u32 s15, s15, s12
    s_mul_i32 s15, s15, 81920
    s_lshl_b32 s16, s19, 7
    s_add_u32 s15, s15, s16
    s_branch PGO_4
PSEG_8:
PGO_4:
    s_waitcnt lgkmcnt(0)
    s_mov_b32 s20, s8
    s_and_b32 s21, s9, 0xffff
    s_mov_b32 s22, s14
    s_mov_b32 s23, 0x00020000
    s_mov_b32 s24, s4
    s_and_b32 s25, s5, 0xffff
    s_mov_b32 s26, 0x10000000
    s_mov_b32 s27, 0x00020000
    v_and_b32 v3, 31, v2
    v_lshrrev_b32 v4, 5, v2
    v_mul_lo_u32 v5, v4, s10
    v_lshlrev_b32 v5, 2, v5
    v_lshl_add_u32 v5, v3, 2, v5
    v_lshrrev_b32 v6, 4, v3
    v_mul_lo_u32 v6, v6, s17
    v_lshlrev_b32 v7, 1, v3
    v_and_b32 v7, 31, v7
    v_lshl_add_u32 v7, v4, 5, v7
    v_lshl_add_u32 v6, v7, 4, v6
    s_mul_i32 s16, s10, 0
    s_add_u32 s16, s16, s15
    buffer_load_dword v16, v5, s[20:23], s16 offen
    s_mul_i32 s16, s10, 1
    s_add_u32 s16, s16, s15
    buffer_load_dword v17, v5, s[20:23], s16 offen
    s_mul_i32 s16, s10, 2
    s_add_u32 s16, s16, s15
    buffer_load_dword v18, v5, s[20:23], s16 offen
    s_mul_i32 s16, s10, 3
    s_add_u32 s16, s16, s15
    buffer_load_dword v19, v5, s[20:23], s16 offen
    s_mul_i32 s16, s10, 8
    s_add_u32 s16, s16, s15
    buffer_load_dword v20, v5, s[20:23], s16 offen
    s_mul_i32 s16, s10, 9
    s_add_u32 s16, s16, s15
    buffer_load_dword v21, v5, s[20:23], s16 offen
    s_mul_i32 s16, s10, 10
    s_add_u32 s16, s16, s15
    buffer_load_dword v22, v5, s[20:23], s16 offen
    s_mul_i32 s16, s10, 11
    s_add_u32 s16, s16, s15
    buffer_load_dword v23, v5, s[20:23], s16 offen
    s_mul_i32 s16, s10, 16
    s_add_u32 s16, s16, s15
    buffer_load_dword v24, v5, s[20:23], s16 offen
    s_mul_i32 s16, s10, 17
    s_add_u32 s16, s16, s15
    buffer_load_dword v25, v5, s[20:23], s16 offen
    s_mul_i32 s16, s10, 18
    s_add_u32 s16, s16, s15
    buffer_load_dword v26, v5, s[20:23], s16 offen
    s_mul_i32 s16, s10, 19
    s_add_u32 s16, s16, s15
    buffer_load_dword v27, v5, s[20:23], s16 offen
    s_mul_i32 s16, s10, 24
    s_add_u32 s16, s16, s15
    buffer_load_dword v28, v5, s[20:23], s16 offen
    s_mul_i32 s16, s10, 25
    s_add_u32 s16, s16, s15
    buffer_load_dword v29, v5, s[20:23], s16 offen
    s_mul_i32 s16, s10, 26
    s_add_u32 s16, s16, s15
    buffer_load_dword v30, v5, s[20:23], s16 offen
    s_mul_i32 s16, s10, 27
    s_add_u32 s16, s16, s15
    buffer_load_dword v31, v5, s[20:23], s16 offen
    s_mul_i32 s16, s10, 32
    s_add_u32 s16, s16, s15
    buffer_load_dword v32, v5, s[20:23], s16 offen
    s_mul_i32 s16, s10, 33
    s_add_u32 s16, s16, s15
    buffer_load_dword v33, v5, s[20:23], s16 offen
    s_mul_i32 s16, s10, 34
    s_add_u32 s16, s16, s15
    buffer_load_dword v34, v5, s[20:23], s16 offen
    s_mul_i32 s16, s10, 35
    s_add_u32 s16, s16, s15
    buffer_load_dword v35, v5, s[20:23], s16 offen
    s_mul_i32 s16, s10, 40
    s_add_u32 s16, s16, s15
    buffer_load_dword v36, v5, s[20:23], s16 offen
    s_mul_i32 s16, s10, 41
    s_add_u32 s16, s16, s15
    buffer_load_dword v37, v5, s[20:23], s16 offen
    s_mul_i32 s16, s10, 42
    s_add_u32 s16, s16, s15
    buffer_load_dword v38, v5, s[20:23], s16 offen
    s_mul_i32 s16, s10, 43
    s_add_u32 s16, s16, s15
    buffer_load_dword v39, v5, s[20:23], s16 offen
    s_mul_i32 s16, s10, 48
    s_add_u32 s16, s16, s15
    buffer_load_dword v40, v5, s[20:23], s16 offen
    s_mul_i32 s16, s10, 49
    s_add_u32 s16, s16, s15
    buffer_load_dword v41, v5, s[20:23], s16 offen
    s_mul_i32 s16, s10, 50
    s_add_u32 s16, s16, s15
    buffer_load_dword v42, v5, s[20:23], s16 offen
    s_mul_i32 s16, s10, 51
    s_add_u32 s16, s16, s15
    buffer_load_dword v43, v5, s[20:23], s16 offen
    s_mul_i32 s16, s10, 56
    s_add_u32 s16, s16, s15
    buffer_load_dword v44, v5, s[20:23], s16 offen
    s_mul_i32 s16, s10, 57
    s_add_u32 s16, s16, s15
    buffer_load_dword v45, v5, s[20:23], s16 offen
    s_mul_i32 s16, s10, 58
    s_add_u32 s16, s16, s15
    buffer_load_dword v46, v5, s[20:23], s16 offen
    s_mul_i32 s16, s10, 59
    s_add_u32 s16, s16, s15
    buffer_load_dword v47, v5, s[20:23], s16 offen
    s_mov_b32 s30, 0x05040100
    s_mov_b32 s31, 0x07060302
    s_waitcnt vmcnt(24)
    v_perm_b32 v48, v17, v16, s30
    v_perm_b32 v52, v17, v16, s31
    v_perm_b32 v49, v19, v18, s30
    v_perm_b32 v53, v19, v18, s31
    v_perm_b32 v50, v21, v20, s30
    v_perm_b32 v54, v21, v20, s31
    v_perm_b32 v51, v23, v22, s30
    v_perm_b32 v55, v23, v22, s31
    s_add_u32 s16, s13, 0
    buffer_store_dwordx4 v[48:51], v6, s[24:27], s16 offen
    buffer_store_dwordx4 v[52:55], v6, s[24:27], s16 offen offset:16
    s_nop 1
    s_waitcnt vmcnt(18)
    v_perm_b32 v48, v25, v24, s30
    v_perm_b32 v52, v25, v24, s31
    v_perm_b32 v49, v27, v26, s30
    v_perm_b32 v53, v27, v26, s31
    v_perm_b32 v50, v29, v28, s30
    v_perm_b32 v54, v29, v28, s31
    v_perm_b32 v51, v31, v30, s30
    v_perm_b32 v55, v31, v30, s31
    s_add_u32 s16, s13, 1024
    buffer_store_dwordx4 v[48:51], v6, s[24:27], s16 offen
    buffer_store_dwordx4 v[52:55], v6, s[24:27], s16 offen offset:16
    s_nop 1
    s_waitcnt vmcnt(12)
    v_perm_b32 v48, v33, v32, s30
    v_perm_b32 v52, v33, v32, s31
    v_perm_b32 v49, v35, v34, s30
    v_perm_b32 v53, v35, v34, s31
    v_perm_b32 v50, v37, v36, s30
    v_perm_b32 v54, v37, v36, s31
    v_perm_b32 v51, v39, v38, s30
    v_perm_b32 v55, v39, v38, s31
    s_add_u32 s16, s13, 2048
    buffer_store_dwordx4 v[48:51], v6, s[24:27], s16 offen
    buffer_store_dwordx4 v[52:55], v6, s[24:27], s16 offen offset:16
    s_nop 1
    s_waitcnt vmcnt(6)
    v_perm_b32 v48, v41, v40, s30
    v_perm_b32 v52, v41, v40, s31
    v_perm_b32 v49, v43, v42, s30
    v_perm_b32 v53, v43, v42, s31
    v_perm_b32 v50, v45, v44, s30
    v_perm_b32 v54, v45, v44, s31
    v_perm_b32 v51, v47, v46, s30
    v_perm_b32 v55, v47, v46, s31
    s_add_u32 s16, s13, 3072
    buffer_store_dwordx4 v[48:51], v6, s[24:27], s16 offen
    buffer_store_dwordx4 v[52:55], v6, s[24:27], s16 offen offset:16
    s_nop 1
    s_branch END_3
LN_1:
    s_load_dwordx2 s[8:9], s[0:1], 0
    s_sub_u32 s7, s6, 2560
    s_waitcnt lgkmcnt(0)
    s_mov_b32 s20, s8
    s_and_b32 s21, s9, 0xffff
    s_mov_b32 s22, 0x280000
    s_mov_b32 s23, 0x00020000
    s_mov_b32 s24, s4
    s_and_b32 s25, s5, 0xffff
    s_mov_b32 s26, 0x10000000
    s_mov_b32 s27, 0x00020000
    v_cmp_gt_u32 vcc, 40, v2
    s_mul_i32 s44, s7, 1280
    v_lshlrev_b32 v3, 5, v2
    v_mov_b32 v8, 0
    v_mov_b32 v9, 0
    v_mov_b32 v10, 0
    v_mov_b32 v11, 0
    v_mov_b32 v12, 0
    v_mov_b32 v13, 0
    v_mov_b32 v14, 0
    v_mov_b32 v15, 0
    s_and_saveexec_b64 s[46:47], vcc
    buffer_load_dwordx4 v[8:11], v3, s[20:23], s44 offen
    buffer_load_dwordx4 v[12:15], v3, s[20:23], s44 offen offset:16
    s_mov_b64 exec, s[46:47]
    s_waitcnt vmcnt(0)
    v_lshlrev_b32 v16, 16, v8
    v_and_b32 v17, 0xffff0000, v8
    v_lshlrev_b32 v18, 16, v9
    v_and_b32 v19, 0xffff0000, v9
    v_lshlrev_b32 v20, 16, v10
    v_and_b32 v21, 0xffff0000, v10
    v_lshlrev_b32 v22, 16, v11
    v_and_b32 v23, 0xffff0000, v11
    v_lshlrev_b32 v24, 16, v12
    v_and_b32 v25, 0xffff0000, v12
    v_lshlrev_b32 v26, 16, v13
    v_and_b32 v27, 0xffff0000, v13
    v_lshlrev_b32 v28, 16, v14
    v_and_b32 v29, 0xffff0000, v14
    v_lshlrev_b32 v30, 16, v15
    v_and_b32 v31, 0xffff0000, v15
    v_add_f32 v32, v16, v17
    v_add_f32 v32, v32, v18
    v_add_f32 v32, v32, v19
    v_add_f32 v32, v32, v20
    v_add_f32 v32, v32, v21
    v_add_f32 v32, v32, v22
    v_add_f32 v32, v32, v23
    v_add_f32 v32, v32, v24
    v_add_f32 v32, v32, v25
    v_add_f32 v32, v32, v26
    v_add_f32 v32, v32, v27
    v_add_f32 v32, v32, v28
    v_add_f32 v32, v32, v29
    v_add_f32 v32, v32, v30
    v_add_f32 v32, v32, v31
    s_nop 1
    v_add_f32_dpp v32, v32, v32 row_ror:1 row_mask:0xf bank_mask:0xf
    s_nop 1
    v_add_f32_dpp v32, v32, v32 row_ror:2 row_mask:0xf bank_mask:0xf
    s_nop 1
    v_add_f32_dpp v32, v32, v32 row_ror:4 row_mask:0xf bank_mask:0xf
    s_nop 1
    v_add_f32_dpp v32, v32, v32 row_ror:8 row_mask:0xf bank_mask:0xf
    s_nop 1
    v_readlane_b32 s40, v32, 0
    v_readlane_b32 s41, v32, 16
    v_readlane_b32 s42, v32, 32
    v_readlane_b32 s43, v32, 48
    s_nop 1
    v_mov_b32 v32, s40
    v_add_f32 v32, s41, v32
    v_add_f32 v32, s42, v32
    v_add_f32 v32, s43, v32
    v_mul_f32 v32, 0x3acccccd, v32
    v_sub_f32 v33, v16, v32
    v_mul_f32 v34, v33, v33
    v_sub_f32 v33, v17, v32
    v_fmac_f32 v34, v33, v33
    v_sub_f32 v33, v18, v32
    v_fmac_f32 v34, v33, v33
    v_sub_f32 v33, v19, v32
    v_fmac_f32 v34, v33, v33
    v_sub_f32 v33, v20, v32
    v_fmac_f32 v34, v33, v33
    v_sub_f32 v33, v21, v32
    v_fmac_f32 v34, v33, v33
    v_sub_f32 v33, v22, v32
    v_fmac_f32 v34, v33, v33
    v_sub_f32 v33, v23, v32
    v_fmac_f32 v34, v33, v33
    v_sub_f32 v33, v24, v32
    v_fmac_f32 v34, v33, v33
    v_sub_f32 v33, v25, v32
    v_fmac_f32 v34, v33, v33
    v_sub_f32 v33, v26, v32
    v_fmac_f32 v34, v33, v33
    v_sub_f32 v33, v27, v32
    v_fmac_f32 v34, v33, v33
    v_sub_f32 v33, v28, v32
    v_fmac_f32 v34, v33, v33
    v_sub_f32 v33, v29, v32
    v_fmac_f32 v34, v33, v33
    v_sub_f32 v33, v30, v32
    v_fmac_f32 v34, v33, v33
    v_sub_f32 v33, v31, v32
    v_fmac_f32 v34, v33, v33
    v_cmp_gt_u32 vcc, 40, v2
    s_nop 1
    v_cndmask_b32 v34, 0, v34, vcc
    s_nop 1
    v_add_f32_dpp v34, v34, v34 row_ror:1 row_mask:0xf bank_mask:0xf
    s_nop 1
    v_add_f32_dpp v34, v34, v34 row_ror:2 row_mask:0xf bank_mask:0xf
    s_nop 1
    v_add_f32_dpp v34, v34, v34 row_ror:4 row_mask:0xf bank_mask:0xf
    s_nop 1
    v_add_f32_dpp v34, v34, v34 row_ror:8 row_mask:0xf bank_mask:0xf
    s_nop 1
    v_readlane_b32 s40, v34, 0
    v_readlane_b32 s41, v34, 16
    v_readlane_b32 s42, v34, 32
    v_readlane_b32 s43, v34, 48
    s_nop 1
    v_mov_b32 v34, s40
    v_add_f32 v34, s41, v34
    v_add_f32 v34, s42, v34
    v_add_f32 v34, s43, v34
    v_mul_f32 v34, 0x3acccccd, v34
    v_cvt_pk_bf16_f32 v34, v34, v34
    v_lshlrev_b32 v34, 16, v34
    v_add_f32 v34, 0x3727c5ac, v34
    v_cvt_pk_bf16_f32 v34, v34, v34
    v_lshlrev_b32 v34, 16, v34
    v_sqrt_f32 v34, v34
    s_nop 0
    v_cvt_pk_bf16_f32 v34, v34, v34
    v_lshlrev_b32 v34, 16, v34
    v_rcp_f32 v35, v34
    v_cvt_pk_bf16_f32 v32, v32, v32
    v_lshlrev_b32 v32, 16, v32
    v_sub_f32 v16, v16, v32
    v_sub_f32 v17, v17, v32
    v_sub_f32 v18, v18, v32
    v_sub_f32 v19, v19, v32
    v_sub_f32 v20, v20, v32
    v_sub_f32 v21, v21, v32
    v_sub_f32 v22, v22, v32
    v_sub_f32 v23, v23, v32
    v_sub_f32 v24, v24, v32
    v_sub_f32 v25, v25, v32
    v_sub_f32 v26, v26, v32
    v_sub_f32 v27, v27, v32
    v_sub_f32 v28, v28, v32
    v_sub_f32 v29, v29, v32
    v_sub_f32 v30, v30, v32
    v_sub_f32 v31, v31, v32
    v_cvt_pk_bf16_f32 v36, v16, v17
    v_lshlrev_b32 v16, 16, v36
    v_and_b32 v17, 0xffff0000, v36
    v_cvt_pk_bf16_f32 v36, v18, v19
    v_lshlrev_b32 v18, 16, v36
    v_and_b32 v19, 0xffff0000, v36
    v_cvt_pk_bf16_f32 v36, v20, v21
    v_lshlrev_b32 v20, 16, v36
    v_and_b32 v21, 0xffff0000, v36
    v_cvt_pk_bf16_f32 v36, v22, v23
    v_lshlrev_b32 v22, 16, v36
    v_and_b32 v23, 0xffff0000, v36
    v_cvt_pk_bf16_f32 v36, v24, v25
    v_lshlrev_b32 v24, 16, v36
    v_and_b32 v25, 0xffff0000, v36
    v_cvt_pk_bf16_f32 v36, v26, v27
    v_lshlrev_b32 v26, 16, v36
    v_and_b32 v27, 0xffff0000, v36
    v_cvt_pk_bf16_f32 v36, v28, v29
    v_lshlrev_b32 v28, 16, v36
    v_and_b32 v29, 0xffff0000, v36
    v_cvt_pk_bf16_f32 v36, v30, v31
    v_lshlrev_b32 v30, 16, v36
    v_and_b32 v31, 0xffff0000, v36
    v_mul_f32 v36, v16, v35
    v_fma_f32 v37, -v36, v34, v16
    v_fma_f32 v16, v37, v35, v36
    v_mul_f32 v36, v17, v35
    v_fma_f32 v37, -v36, v34, v17
    v_fma_f32 v17, v37, v35, v36
    v_mul_f32 v36, v18, v35
    v_fma_f32 v37, -v36, v34, v18
    v_fma_f32 v18, v37, v35, v36
    v_mul_f32 v36, v19, v35
    v_fma_f32 v37, -v36, v34, v19
    v_fma_f32 v19, v37, v35, v36
    v_mul_f32 v36, v20, v35
    v_fma_f32 v37, -v36, v34, v20
    v_fma_f32 v20, v37, v35, v36
    v_mul_f32 v36, v21, v35
    v_fma_f32 v37, -v36, v34, v21
    v_fma_f32 v21, v37, v35, v36
    v_mul_f32 v36, v22, v35
    v_fma_f32 v37, -v36, v34, v22
    v_fma_f32 v22, v37, v35, v36
    v_mul_f32 v36, v23, v35
    v_fma_f32 v37, -v36, v34, v23
    v_fma_f32 v23, v37, v35, v36
    v_mul_f32 v36, v24, v35
    v_fma_f32 v37, -v36, v34, v24
    v_fma_f32 v24, v37, v35, v36
    v_mul_f32 v36, v25, v35
    v_fma_f32 v37, -v36, v34, v25
    v_fma_f32 v25, v37, v35, v36
    v_mul_f32 v36, v26, v35
    v_fma_f32 v37, -v36, v34, v26
    v_fma_f32 v26, v37, v35, v36
    v_mul_f32 v36, v27, v35
    v_fma_f32 v37, -v36, v34, v27
    v_fma_f32 v27, v37, v35, v36
    v_mul_f32 v36, v28, v35
    v_fma_f32 v37, -v36, v34, v28
    v_fma_f32 v28, v37, v35, v36
    v_mul_f32 v36, v29, v35
    v_fma_f32 v37, -v36, v34, v29
    v_fma_f32 v29, v37, v35, v36
    v_mul_f32 v36, v30, v35
    v_fma_f32 v37, -v36, v34, v30
    v_fma_f32 v30, v37, v35, v36
    v_mul_f32 v36, v31, v35
    v_fma_f32 v37, -v36, v34, v31
    v_fma_f32 v31, v37, v35, v36
    v_cvt_pk_bf16_f32 v40, v16, v17
    v_cvt_pk_bf16_f32 v41, v18, v19
    v_cvt_pk_bf16_f32 v42, v24, v25
    v_cvt_pk_bf16_f32 v43, v26, v27
    v_cvt_pk_bf16_f32 v44, v20, v21
    v_cvt_pk_bf16_f32 v45, v22, v23
    v_cvt_pk_bf16_f32 v46, v28, v29
    v_cvt_pk_bf16_f32 v47, v30, v31
    s_lshr_b32 s44, s7, 5
    s_mul_i32 s44, s44, 40960
    s_and_b32 s45, s7, 31
    s_lshl_b32 s45, s45, 4
    s_add_u32 s44, s44, s45
    s_add_u32 s44, s44, 0x1a54000
    v_lshlrev_b32 v3, 10, v2
    v_cmp_gt_u32 vcc, 40, v2
    s_and_saveexec_b64 s[46:47], vcc
    buffer_store_dwordx4 v[40:43], v3, s[24:27], s44 offen
    buffer_store_dwordx4 v[44:47], v3, s[24:27], s44 offen offset:512
    s_mov_b64 exec, s[46:47]
    s_branch END_3
MISC_2:
    s_sub_u32 s7, s6, 4608
    s_cmp_ge_u32 s7, 10
    s_cbranch_scc1 SENT_9
    s_load_dwordx2 s[8:9], s[0:1], 8
    s_lshl_b32 s7, s7, 6
    v_add_u32 v3, s7, v2
    v_lshrrev_b32 v4, 3, v3
    v_and_b32 v5, 7, v3
    v_mul_u32_u24 v5, 1280, v5
    v_lshrrev_b32 v6, 1, v4
    v_lshl_add_u32 v5, v6, 5, v5
    v_and_b32 v6, 1, v4
    v_lshl_add_u32 v5, v6, 3, v5
    s_waitcnt lgkmcnt(0)
    s_mov_b32 s20, s8
    s_and_b32 s21, s9, 0xffff
    s_mov_b32 s22, 0x2800
    s_mov_b32 s23, 0x00020000
    s_mov_b32 s24, s4
    s_and_b32 s25, s5, 0xffff
    s_mov_b32 s26, 0x10000000
    s_mov_b32 s27, 0x00020000
    buffer_load_dwordx2 v[8:9], v5, s[20:23], 0 offen
    buffer_load_dwordx2 v[10:11], v5, s[20:23], 0 offen offset:16
    v_lshlrev_b32 v3, 4, v3
    s_mov_b32 s16, 0xa5d4000
    s_waitcnt vmcnt(0)
    s_add_u32 s17, s16, 0
    buffer_store_dwordx4 v[8:11], v3, s[24:27], s17 offen
    s_add_u32 s17, s16, 10240
    buffer_store_dwordx4 v[8:11], v3, s[24:27], s17 offen
    s_add_u32 s17, s16, 20480
    buffer_store_dwordx4 v[8:11], v3, s[24:27], s17 offen
    s_add_u32 s17, s16, 30720
    buffer_store_dwordx4 v[8:11], v3, s[24:27], s17 offen
    s_branch END_3
SENT_9:
    s_sub_u32 s7, s7, 10
    s_cmp_ge_u32 s7, 231
    s_cbranch_scc1 WVT_10
    s_lshl_b32 s16, s7, 12
    s_add_u32 s17, s16, 0xa5de000
    s_add_u32 s18, s16, 0xa818000
    s_cmp_ge_u32 s7, 70
    s_cselect_b32 s16, s18, s17
    s_cmp_eq_u32 s7, 230
    s_cselect_b32 s16, 0xad5e000, s16
    s_waitcnt lgkmcnt(0)
    s_mov_b32 s24, s4
    s_and_b32 s25, s5, 0xffff
    s_mov_b32 s26, 0x10000000
    s_mov_b32 s27, 0x00020000
    v_mov_b32 v8, -1
    v_mov_b32 v9, -1
    v_mov_b32 v10, -1
    v_mov_b32 v11, -1
    v_lshlrev_b32 v3, 4, v2
    buffer_store_dwordx4 v[8:11], v3, s[24:27], s16 offen offset:0
    buffer_store_dwordx4 v[8:11], v3, s[24:27], s16 offen offset:1024
    buffer_store_dwordx4 v[8:11], v3, s[24:27], s16 offen offset:2048
    buffer_store_dwordx4 v[8:11], v3, s[24:27], s16 offen offset:3072
    s_branch END_3
WVT_10:
    s_sub_u32 s7, s7, 231
    s_cmp_ge_u32 s7, 640
    s_cbranch_scc1 END_3
    s_load_dwordx2 s[8:9], s[0:1], 32
    s_mul_hi_u32 s10, s7, 0xccccccd
    s_mul_i32 s11, s10, 20
    s_sub_u32 s11, s7, s11
    v_lshrrev_b32 v3, 4, v2
    v_and_b32 v4, 15, v2
    v_lshlrev_b32 v5, 13, v3
    v_lshl_add_u32 v5, v4, 4, v5
    s_lshl_b32 s12, s11, 18
    s_lshl_b32 s13, s10, 8
    s_add_u32 s12, s12, s13
    v_lshrrev_b32 v6, 1, v4
    v_lshlrev_b32 v6, 10, v6
    v_lshl_add_u32 v6, v3, 4, v6
    v_and_b32 v7, 1, v4
    v_lshl_add_u32 v6, v7, 3, v6
    s_lshl_b32 s14, s7, 13
    s_add_u32 s14, s14, 0xceaf000
    s_waitcnt lgkmcnt(0)
    s_mov_b32 s20, s8
    s_and_b32 s21, s9, 0xffff
    s_mov_b32 s22, 0x500000
    s_mov_b32 s23, 0x00020000
    s_mov_b32 s24, s4
    s_and_b32 s25, s5, 0xffff
    s_mov_b32 s26, 0x10000000
    s_mov_b32 s27, 0x00020000
    s_add_u32 s15, s12, 0
    buffer_load_dwordx4 v[16:19], v5, s[20:23], s15 offen
    s_add_u32 s15, s12, 32768
    buffer_load_dwordx4 v[20:23], v5, s[20:23], s15 offen
    s_add_u32 s15, s12, 65536
    buffer_load_dwordx4 v[24:27], v5, s[20:23], s15 offen
    s_add_u32 s15, s12, 98304
    buffer_load_dwordx4 v[28:31], v5, s[20:23], s15 offen
    s_add_u32 s15, s12, 131072
    buffer_load_dwordx4 v[32:35], v5, s[20:23], s15 offen
    s_add_u32 s15, s12, 163840
    buffer_load_dwordx4 v[36:39], v5, s[20:23], s15 offen
    s_add_u32 s15, s12, 196608
    buffer_load_dwordx4 v[40:43], v5, s[20:23], s15 offen
    s_add_u32 s15, s12, 229376
    buffer_load_dwordx4 v[44:47], v5, s[20:23], s15 offen
    s_waitcnt vmcnt(7)
    buffer_store_dwordx2 v[16:17], v6, s[24:27], s14 offen offset:0
    buffer_store_dwordx2 v[18:19], v6, s[24:27], s14 offen offset:512
    s_waitcnt vmcnt(8)
    buffer_store_dwordx2 v[20:21], v6, s[24:27], s14 offen offset:64
    buffer_store_dwordx2 v[22:23], v6, s[24:27], s14 offen offset:576
    s_waitcnt vmcnt(9)
    buffer_store_dwordx2 v[24:25], v6, s[24:27], s14 offen offset:128
    buffer_store_dwordx2 v[26:27], v6, s[24:27], s14 offen offset:640
    s_waitcnt vmcnt(10)
    buffer_store_dwordx2 v[28:29], v6, s[24:27], s14 offen offset:192
    buffer_store_dwordx2 v[30:31], v6, s[24:27], s14 offen offset:704
    s_waitcnt vmcnt(11)
    buffer_store_dwordx2 v[32:33], v6, s[24:27], s14 offen offset:256
    buffer_store_dwordx2 v[34:35], v6, s[24:27], s14 offen offset:768
    s_waitcnt vmcnt(12)
    buffer_store_dwordx2 v[36:37], v6, s[24:27], s14 offen offset:320
    buffer_store_dwordx2 v[38:39], v6, s[24:27], s14 offen offset:832
    s_waitcnt vmcnt(13)
    buffer_store_dwordx2 v[40:41], v6, s[24:27], s14 offen offset:384
    buffer_store_dwordx2 v[42:43], v6, s[24:27], s14 offen offset:896
    s_waitcnt vmcnt(14)
    buffer_store_dwordx2 v[44:45], v6, s[24:27], s14 offen offset:448
    buffer_store_dwordx2 v[46:47], v6, s[24:27], s14 offen offset:960
END_3:
    s_endpgm
.globl gemm1_kernel
.p2align 8
.type gemm1_kernel,@function
gemm1_kernel:
    s_load_dwordx2 s[4:5], s[0:1], 104
    v_lshrrev_b32 v1, 6, v0
    v_and_b32 v2, 63, v0
    v_readfirstlane_b32 s3, v1
    v_lshlrev_b32 v16, 4, v2
    s_cmp_ge_u32 s2, 240
    s_cbranch_scc1 END_11
    s_waitcnt lgkmcnt(0)
    s_mov_b32 s24, s4
    s_and_b32 s25, s5, 0xffff
    s_mov_b32 s26, 0x10000000
    s_mov_b32 s27, 0x00020000
    s_mov_b32 s99, 1
    s_and_b32 s97, s2, 3
    s_lshr_b32 s98, s2, 2
    s_and_b32 s98, s98, 1
    s_lshr_b32 s6, s2, 3
    s_lshl_b32 s6, s6, 3
    s_sub_u32 s7, s2, 128
    s_and_b32 s9, s7, 1
    s_lshr_b32 s7, s7, 1
    s_lshl_b32 s7, s7, 3
    s_add_u32 s7, s7, 256
    s_add_u32 s8, s2, 224
    s_cmp_lt_u32 s2, 160
    s_cselect_b32 s7, s7, s8
    s_cselect_b32 s99, 1, 0
    s_cmp_lt_u32 s2, 128
    s_cselect_b32 s98, s98, s9
    s_cselect_b32 s2, s6, s7
    s_cmp_ge_u32 s2, 384
    s_cbranch_scc1 G3_13
    s_sub_u32 s6, s2, 128
    s_cmp_lt_u32 s2, 128
    s_cselect_b32 s6, s2, s6
    s_mov_b32 s7, 0x0
    s_mov_b32 s10, 0xa00000
    s_cselect_b32 s7, s10, s7
    s_lshr_b32 s11, s6, 3
    s_and_b32 s12, s6, 7
    s_mul_i32 s13, s11, 327680
    s_add_u32 s60, s7, s13
    s_lshl_b32 s12, s12, 3
    s_lshl_b32 s13, s98, 2
    s_add_u32 s12, s12, s13
    s_mul_i32 s13, s12, 40960
    s_add_u32 s61, s13, 0x1a54000
    v_accvgpr_write_b32 a0, 0
    v_accvgpr_write_b32 a1, 0
    v_accvgpr_write_b32 a2, 0
    v_accvgpr_write_b32 a3, 0
    v_accvgpr_write_b32 a4, 0
    v_accvgpr_write_b32 a5, 0
    v_accvgpr_write_b32 a6, 0
    v_accvgpr_write_b32 a7, 0
    v_accvgpr_write_b32 a8, 0
    v_accvgpr_write_b32 a9, 0
    v_accvgpr_write_b32 a10, 0
    v_accvgpr_write_b32 a11, 0
    v_accvgpr_write_b32 a12, 0
    v_accvgpr_write_b32 a13, 0
    v_accvgpr_write_b32 a14, 0
    v_accvgpr_write_b32 a15, 0
    v_accvgpr_write_b32 a16, 0
    v_accvgpr_write_b32 a17, 0
    v_accvgpr_write_b32 a18, 0
    v_accvgpr_write_b32 a19, 0
    v_accvgpr_write_b32 a20, 0
    v_accvgpr_write_b32 a21, 0
    v_accvgpr_write_b32 a22, 0
    v_accvgpr_write_b32 a23, 0
    v_accvgpr_write_b32 a24, 0
    v_accvgpr_write_b32 a25, 0
    v_accvgpr_write_b32 a26, 0
    v_accvgpr_write_b32 a27, 0
    v_accvgpr_write_b32 a28, 0
    v_accvgpr_write_b32 a29, 0
    v_accvgpr_write_b32 a30, 0
    v_accvgpr_write_b32 a31, 0
    v_accvgpr_write_b32 a32, 0
    v_accvgpr_write_b32 a33, 0
    v_accvgpr_write_b32 a34, 0
    v_accvgpr_write_b32 a35, 0
    v_accvgpr_write_b32 a36, 0
    v_accvgpr_write_b32 a37, 0
    v_accvgpr_write_b32 a38, 0
    v_accvgpr_write_b32 a39, 0
    v_accvgpr_write_b32 a40, 0
    v_accvgpr_write_b32 a41, 0
    v_accvgpr_write_b32 a42, 0
    v_accvgpr_write_b32 a43, 0
    v_accvgpr_write_b32 a44, 0
    v_accvgpr_write_b32 a45, 0
    v_accvgpr_write_b32 a46, 0
    v_accvgpr_write_b32 a47, 0
    v_accvgpr_write_b32 a48, 0
    v_accvgpr_write_b32 a49, 0
    v_accvgpr_write_b32 a50, 0
    v_accvgpr_write_b32 a51, 0
    v_accvgpr_write_b32 a52, 0
    v_accvgpr_write_b32 a53, 0
    v_accvgpr_write_b32 a54, 0
    v_accvgpr_write_b32 a55, 0
    v_accvgpr_write_b32 a56, 0
    v_accvgpr_write_b32 a57, 0
    v_accvgpr_write_b32 a58, 0
    v_accvgpr_write_b32 a59, 0
    v_accvgpr_write_b32 a60, 0
    v_accvgpr_write_b32 a61, 0
    v_accvgpr_write_b32 a62, 0
    v_accvgpr_write_b32 a63, 0
    v_accvgpr_write_b32 a64, 0
    v_accvgpr_write_b32 a65, 0
    v_accvgpr_write_b32 a66, 0
    v_accvgpr_write_b32 a67, 0
    v_accvgpr_write_b32 a68, 0
    v_accvgpr_write_b32 a69, 0
    v_accvgpr_write_b32 a70, 0
    v_accvgpr_write_b32 a71, 0
    v_accvgpr_write_b32 a72, 0
    v_accvgpr_write_b32 a73, 0
    v_accvgpr_write_b32 a74, 0
    v_accvgpr_write_b32 a75, 0
    v_accvgpr_write_b32 a76, 0
    v_accvgpr_write_b32 a77, 0
    v_accvgpr_write_b32 a78, 0
    v_accvgpr_write_b32 a79, 0
    v_accvgpr_write_b32 a80, 0
    v_accvgpr_write_b32 a81, 0
    v_accvgpr_write_b32 a82, 0
    v_accvgpr_write_b32 a83, 0
    v_accvgpr_write_b32 a84, 0
    v_accvgpr_write_b32 a85, 0
    v_accvgpr_write_b32 a86, 0
    v_accvgpr_write_b32 a87, 0
    v_accvgpr_write_b32 a88, 0
    v_accvgpr_write_b32 a89, 0
    v_accvgpr_write_b32 a90, 0
    v_accvgpr_write_b32 a91, 0
    v_accvgpr_write_b32 a92, 0
    v_accvgpr_write_b32 a93, 0
    v_accvgpr_write_b32 a94, 0
    v_accvgpr_write_b32 a95, 0
    v_accvgpr_write_b32 a96, 0
    v_accvgpr_write_b32 a97, 0
    v_accvgpr_write_b32 a98, 0
    v_accvgpr_write_b32 a99, 0
    v_accvgpr_write_b32 a100, 0
    v_accvgpr_write_b32 a101, 0
    v_accvgpr_write_b32 a102, 0
    v_accvgpr_write_b32 a103, 0
    v_accvgpr_write_b32 a104, 0
    v_accvgpr_write_b32 a105, 0
    v_accvgpr_write_b32 a106, 0
    v_accvgpr_write_b32 a107, 0
    v_accvgpr_write_b32 a108, 0
    v_accvgpr_write_b32 a109, 0
    v_accvgpr_write_b32 a110, 0
    v_accvgpr_write_b32 a111, 0
    v_accvgpr_write_b32 a112, 0
    v_accvgpr_write_b32 a113, 0
    v_accvgpr_write_b32 a114, 0
    v_accvgpr_write_b32 a115, 0
    v_accvgpr_write_b32 a116, 0
    v_accvgpr_write_b32 a117, 0
    v_accvgpr_write_b32 a118, 0
    v_accvgpr_write_b32 a119, 0
    v_accvgpr_write_b32 a120, 0
    v_accvgpr_write_b32 a121, 0
    v_accvgpr_write_b32 a122, 0
    v_accvgpr_write_b32 a123, 0
    v_accvgpr_write_b32 a124, 0
    v_accvgpr_write_b32 a125, 0
    v_accvgpr_write_b32 a126, 0
    v_accvgpr_write_b32 a127, 0
    s_lshr_b32 s50, s3, 1
    s_and_b32 s51, s3, 1
    s_mul_i32 s50, s50, 8192
    s_mul_i32 s51, s51, 4096
    s_add_u32 s51, s51, 16384
    v_add_u32 v15, s51, v16
    v_add_u32 v14, s50, v16
    s_mul_i32 s52, s3, 6
    s_add_u32 s54, s52, 0
    s_lshr_b32 s55, s54, 1
    s_and_b32 s56, s54, 1
    s_lshl_b32 s56, s56, 10
    s_mul_i32 s57, s55, 40960
    s_add_u32 s57, s57, s60
    s_sub_u32 s58, s55, 8
    s_mul_i32 s58, s58, 40960
    s_add_u32 s58, s58, s61
    s_cmp_lt_u32 s55, 8
    s_cselect_b32 s57, s57, s58
    s_add_u32 s80, s57, s56
    s_add_u32 s54, s52, 1
    s_lshr_b32 s55, s54, 1
    s_and_b32 s56, s54, 1
    s_lshl_b32 s56, s56, 10
    s_mul_i32 s57, s55, 40960
    s_add_u32 s57, s57, s60
    s_sub_u32 s58, s55, 8
    s_mul_i32 s58, s58, 40960
    s_add_u32 s58, s58, s61
    s_cmp_lt_u32 s55, 8
    s_cselect_b32 s57, s57, s58
    s_add_u32 s81, s57, s56
    s_add_u32 s54, s52, 2
    s_lshr_b32 s55, s54, 1
    s_and_b32 s56, s54, 1
    s_lshl_b32 s56, s56, 10
    s_mul_i32 s57, s55, 40960
    s_add_u32 s57, s57, s60
    s_sub_u32 s58, s55, 8
    s_mul_i32 s58, s58, 40960
    s_add_u32 s58, s58, s61
    s_cmp_lt_u32 s55, 8
    s_cselect_b32 s57, s57, s58
    s_add_u32 s82, s57, s56
    s_add_u32 s54, s52, 3
    s_lshr_b32 s55, s54, 1
    s_and_b32 s56, s54, 1
    s_lshl_b32 s56, s56, 10
    s_mul_i32 s57, s55, 40960
    s_add_u32 s57, s57, s60
    s_sub_u32 s58, s55, 8
    s_mul_i32 s58, s58, 40960
    s_add_u32 s58, s58, s61
    s_cmp_lt_u32 s55, 8
    s_cselect_b32 s57, s57, s58
    s_add_u32 s83, s57, s56
    s_add_u32 s54, s52, 4
    s_lshr_b32 s55, s54, 1
    s_and_b32 s56, s54, 1
    s_lshl_b32 s56, s56, 10
    s_mul_i32 s57, s55, 40960
    s_add_u32 s57, s57, s60
    s_sub_u32 s58, s55, 8
    s_mul_i32 s58, s58, 40960
    s_add_u32 s58, s58, s61
    s_cmp_lt_u32 s55, 8
    s_cselect_b32 s57, s57, s58
    s_add_u32 s84, s57, s56
    s_add_u32 s54, s52, 5
    s_lshr_b32 s55, s54, 1
    s_and_b32 s56, s54, 1
    s_lshl_b32 s56, s56, 10
    s_mul_i32 s57, s55, 40960
    s_add_u32 s57, s57, s60
    s_sub_u32 s58, s55, 8
    s_mul_i32 s58, s58, 40960
    s_add_u32 s58, s58, s61
    s_cmp_lt_u32 s55, 8
    s_cselect_b32 s57, s57, s58
    s_add_u32 s85, s57, s56
    s_lshl_b32 s52, s52, 10
    s_mov_b32 s53, 0
    s_add_u32 s54, s53, s52
    s_mov_b32 m0, s54
    s_add_u32 s54, s54, 1024
    buffer_load_dwordx4 v16, s[24:27], s80 offen lds
    s_add_u32 s80, s80, 2048
    s_mov_b32 m0, s54
    s_add_u32 s54, s54, 1024
    buffer_load_dwordx4 v16, s[24:27], s81 offen lds
    s_add_u32 s81, s81, 2048
    s_mov_b32 m0, s54
    s_add_u32 s54, s54, 1024
    buffer_load_dwordx4 v16, s[24:27], s82 offen lds
    s_add_u32 s82, s82, 2048
    s_mov_b32 m0, s54
    s_add_u32 s54, s54, 1024
    buffer_load_dwordx4 v16, s[24:27], s83 offen lds
    s_add_u32 s83, s83, 2048
    s_mov_b32 m0, s54
    s_add_u32 s54, s54, 1024
    buffer_load_dwordx4 v16, s[24:27], s84 offen lds
    s_add_u32 s84, s84, 2048
    s_mov_b32 m0, s54
    s_add_u32 s54, s54, 1024
    buffer_load_dwordx4 v16, s[24:27], s85 offen lds
    s_add_u32 s85, s85, 2048
    s_add_u32 s53, s53, 24576
    s_cmp_ge_u32 s53, 98304
    s_cselect_b32 s53, 0, s53
    s_add_u32 s54, s53, s52
    s_mov_b32 m0, s54
    s_add_u32 s54, s54, 1024
    buffer_load_dwordx4 v16, s[24:27], s80 offen lds
    s_add_u32 s80, s80, 2048
    s_mov_b32 m0, s54
    s_add_u32 s54, s54, 1024
    buffer_load_dwordx4 v16, s[24:27], s81 offen lds
    s_add_u32 s81, s81, 2048
    s_mov_b32 m0, s54
    s_add_u32 s54, s54, 1024
    buffer_load_dwordx4 v16, s[24:27], s82 offen lds
    s_add_u32 s82, s82, 2048
    s_mov_b32 m0, s54
    s_add_u32 s54, s54, 1024
    buffer_load_dwordx4 v16, s[24:27], s83 offen lds
    s_add_u32 s83, s83, 2048
    s_mov_b32 m0, s54
    s_add_u32 s54, s54, 1024
    buffer_load_dwordx4 v16, s[24:27], s84 offen lds
    s_add_u32 s84, s84, 2048
    s_mov_b32 m0, s54
    s_add_u32 s54, s54, 1024
    buffer_load_dwordx4 v16, s[24:27], s85 offen lds
    s_add_u32 s85, s85, 2048
    s_add_u32 s53, s53, 24576
    s_cmp_ge_u32 s53, 98304
    s_cselect_b32 s53, 0, s53
    s_add_u32 s54, s53, s52
    s_mov_b32 m0, s54
    s_add_u32 s54, s54, 1024
    buffer_load_dwordx4 v16, s[24:27], s80 offen lds
    s_add_u32 s80, s80, 2048
    s_mov_b32 m0, s54
    s_add_u32 s54, s54, 1024
    buffer_load_dwordx4 v16, s[24:27], s81 offen lds
    s_add_u32 s81, s81, 2048
    s_mov_b32 m0, s54
    s_add_u32 s54, s54, 1024
    buffer_load_dwordx4 v16, s[24:27], s82 offen lds
    s_add_u32 s82, s82, 2048
    s_mov_b32 m0, s54
    s_add_u32 s54, s54, 1024
    buffer_load_dwordx4 v16, s[24:27], s83 offen lds
    s_add_u32 s83, s83, 2048
    s_mov_b32 m0, s54
    s_add_u32 s54, s54, 1024
    buffer_load_dwordx4 v16, s[24:27], s84 offen lds
    s_add_u32 s84, s84, 2048
    s_mov_b32 m0, s54
    s_add_u32 s54, s54, 1024
    buffer_load_dwordx4 v16, s[24:27], s85 offen lds
    s_add_u32 s85, s85, 2048
    s_add_u32 s53, s53, 24576
    s_cmp_ge_u32 s53, 98304
    s_cselect_b32 s53, 0, s53
    s_waitcnt vmcnt(12)
    s_barrier
    ds_read_b128 v[64:67], v14 offset:0
    ds_read_b128 v[68:71], v14 offset:2048
    ds_read_b128 v[72:75], v14 offset:4096
    ds_read_b128 v[76:79], v14 offset:6144
    ds_read_b128 v[80:83], v15 offset:0
    ds_read_b128 v[84:87], v15 offset:2048
    s_mov_b32 s59, 0
    s_mov_b32 s49, 0
    s_mov_b32 s47, 24576
GL_15:
    ds_read_b128 v[96:99], v14 offset:1024
    ds_read_b128 v[100:103], v14 offset:3072
    ds_read_b128 v[104:107], v14 offset:5120
    ds_read_b128 v[108:111], v14 offset:7168
    ds_read_b128 v[112:115], v15 offset:1024
    ds_read_b128 v[116:119], v15 offset:3072
    s_waitcnt lgkmcnt(6)
    v_mfma_f32_32x32x16_bf16 a[0:15], v[64:67], v[80:83], a[0:15]
    v_mfma_f32_32x32x16_bf16 a[16:31], v[64:67], v[84:87], a[16:31]
    v_mfma_f32_32x32x16_bf16 a[32:47], v[68:71], v[80:83], a[32:47]
    v_mfma_f32_32x32x16_bf16 a[48:63], v[68:71], v[84:87], a[48:63]
    v_mfma_f32_32x32x16_bf16 a[64:79], v[72:75], v[80:83], a[64:79]
    v_mfma_f32_32x32x16_bf16 a[80:95], v[72:75], v[84:87], a[80:95]
    v_mfma_f32_32x32x16_bf16 a[96:111], v[76:79], v[80:83], a[96:111]
    v_mfma_f32_32x32x16_bf16 a[112:127], v[76:79], v[84:87], a[112:127]
    s_add_u32 s49, s49, 24576
    s_cmp_ge_u32 s49, 98304
    s_cselect_b32 s48, 4294893568, s47
    s_cselect_b32 s49, 0, s49
    v_add_u32 v14, s48, v14
    v_add_u32 v15, s48, v15
    s_cmp_ge_u32 s59, 17
    s_cbranch_scc1 GL_16
    s_waitcnt vmcnt(6)
    s_barrier
    s_waitcnt lgkmcnt(0)
    ds_read_b128 v[64:67], v14 offset:0
    ds_read_b128 v[68:71], v14 offset:2048
    ds_read_b128 v[72:75], v14 offset:4096
    ds_read_b128 v[76:79], v14 offset:6144
    ds_read_b128 v[80:83], v15 offset:0
    ds_read_b128 v[84:87], v15 offset:2048
    s_add_u32 s54, s53, s52
    v_mfma_f32_32x32x16_bf16 a[0:15], v[96:99], v[112:115], a[0:15]
    v_mfma_f32_32x32x16_bf16 a[16:31], v[96:99], v[116:119], a[16:31]
    s_mov_b32 m0, s54
    s_add_u32 s54, s54, 1024
    buffer_load_dwordx4 v16, s[24:27], s80 offen lds
    s_add_u32 s80, s80, 2048
    v_mfma_f32_32x32x16_bf16 a[32:47], v[100:103], v[112:115], a[32:47]
    s_mov_b32 m0, s54
    s_add_u32 s54, s54, 1024
    buffer_load_dwordx4 v16, s[24:27], s81 offen lds
    s_add_u32 s81, s81, 2048
    v_mfma_f32_32x32x16_bf16 a[48:63], v[100:103], v[116:119], a[48:63]
    s_mov_b32 m0, s54
    s_add_u32 s54, s54, 1024
    buffer_load_dwordx4 v16, s[24:27], s82 offen lds
    s_add_u32 s82, s82, 2048
    v_mfma_f32_32x32x16_bf16 a[64:79], v[104:107], v[112:115], a[64:79]
    v_mfma_f32_32x32x16_bf16 a[80:95], v[104:107], v[116:119], a[80:95]
    s_mov_b32 m0, s54
    s_add_u32 s54, s54, 1024
    buffer_load_dwordx4 v16, s[24:27], s83 offen lds
    s_add_u32 s83, s83, 2048
    v_mfma_f32_32x32x16_bf16 a[96:111], v[108:111], v[112:115], a[96:111]
    s_mov_b32 m0, s54
    s_add_u32 s54, s54, 1024
    buffer_load_dwordx4 v16, s[24:27], s84 offen lds
    s_add_u32 s84, s84, 2048
    v_mfma_f32_32x32x16_bf16 a[112:127], v[108:111], v[116:119], a[112:127]
    s_mov_b32 m0, s54
    s_add_u32 s54, s54, 1024
    buffer_load_dwordx4 v16, s[24:27], s85 offen lds
    s_add_u32 s85, s85, 2048
    s_add_u32 s53, s53, 24576
    s_cmp_ge_u32 s53, 98304
    s_cselect_b32 s53, 0, s53
    s_branch GL_18
GL_16:
    s_cmp_lg_u32 s59, 17
    s_cbranch_scc1 GK_20
    s_waitcnt vmcnt(6)
    s_branch GL_17
GK_20:
    s_waitcnt vmcnt(0)
GL_17:
    s_barrier
    s_waitcnt lgkmcnt(0)
    ds_read_b128 v[64:67], v14 offset:0
    ds_read_b128 v[68:71], v14 offset:2048
    ds_read_b128 v[72:75], v14 offset:4096
    ds_read_b128 v[76:79], v14 offset:6144
    ds_read_b128 v[80:83], v15 offset:0
    ds_read_b128 v[84:87], v15 offset:2048
    v_mfma_f32_32x32x16_bf16 a[0:15], v[96:99], v[112:115], a[0:15]
    v_mfma_f32_32x32x16_bf16 a[16:31], v[96:99], v[116:119], a[16:31]
    v_mfma_f32_32x32x16_bf16 a[32:47], v[100:103], v[112:115], a[32:47]
    v_mfma_f32_32x32x16_bf16 a[48:63], v[100:103], v[116:119], a[48:63]
    v_mfma_f32_32x32x16_bf16 a[64:79], v[104:107], v[112:115], a[64:79]
    v_mfma_f32_32x32x16_bf16 a[80:95], v[104:107], v[116:119], a[80:95]
    v_mfma_f32_32x32x16_bf16 a[96:111], v[108:111], v[112:115], a[96:111]
    v_mfma_f32_32x32x16_bf16 a[112:127], v[108:111], v[116:119], a[112:127]
GL_18:
    s_add_u32 s59, s59, 1
    s_cmp_lt_u32 s59, 20
    s_cbranch_scc1 GL_15
    s_waitcnt lgkmcnt(0)
    s_nop 15
    s_lshr_b32 s14, s3, 1
    s_and_b32 s15, s3, 1
    s_lshl_b32 s16, s11, 1
    s_add_u32 s16, s16, s14
    s_mul_i32 s15, s15, 2
    s_add_u32 s17, s12, s15
    s_cmp_ge_u32 s2, 128
    s_cbranch_scc1 QKE_14
    v_accvgpr_read_b32 v32, a0
    v_accvgpr_read_b32 v33, a1
    v_accvgpr_read_b32 v34, a2
    v_accvgpr_read_b32 v35, a3
    v_accvgpr_read_b32 v36, a4
    v_accvgpr_read_b32 v37, a5
    v_accvgpr_read_b32 v38, a6
    v_accvgpr_read_b32 v39, a7
    v_cvt_pk_bf16_f32 v128, v32, v33
    v_cvt_pk_bf16_f32 v129, v34, v35
    v_cvt_pk_bf16_f32 v130, v36, v37
    v_cvt_pk_bf16_f32 v131, v38, v39
    v_accvgpr_read_b32 v40, a8
    v_accvgpr_read_b32 v41, a9
    v_accvgpr_read_b32 v42, a10
    v_accvgpr_read_b32 v43, a11
    v_accvgpr_read_b32 v44, a12
    v_accvgpr_read_b32 v45, a13
    v_accvgpr_read_b32 v46, a14
    v_accvgpr_read_b32 v47, a15
    v_cvt_pk_bf16_f32 v132, v40, v41
    v_cvt_pk_bf16_f32 v133, v42, v43
    v_cvt_pk_bf16_f32 v134, v44, v45
    v_cvt_pk_bf16_f32 v135, v46, v47
    v_accvgpr_read_b32 v32, a16
    v_accvgpr_read_b32 v33, a17
    v_accvgpr_read_b32 v34, a18
    v_accvgpr_read_b32 v35, a19
    v_accvgpr_read_b32 v36, a20
    v_accvgpr_read_b32 v37, a21
    v_accvgpr_read_b32 v38, a22
    v_accvgpr_read_b32 v39, a23
    v_cvt_pk_bf16_f32 v160, v32, v33
    v_cvt_pk_bf16_f32 v161, v34, v35
    v_cvt_pk_bf16_f32 v162, v36, v37
    v_cvt_pk_bf16_f32 v163, v38, v39
    v_accvgpr_read_b32 v40, a24
    v_accvgpr_read_b32 v41, a25
    v_accvgpr_read_b32 v42, a26
    v_accvgpr_read_b32 v43, a27
    v_accvgpr_read_b32 v44, a28
    v_accvgpr_read_b32 v45, a29
    v_accvgpr_read_b32 v46, a30
    v_accvgpr_read_b32 v47, a31
    v_cvt_pk_bf16_f32 v164, v40, v41
    v_cvt_pk_bf16_f32 v165, v42, v43
    v_cvt_pk_bf16_f32 v166, v44, v45
    v_cvt_pk_bf16_f32 v167, v46, v47
    v_accvgpr_read_b32 v32, a32
    v_accvgpr_read_b32 v33, a33
    v_accvgpr_read_b32 v34, a34
    v_accvgpr_read_b32 v35, a35
    v_accvgpr_read_b32 v36, a36
    v_accvgpr_read_b32 v37, a37
    v_accvgpr_read_b32 v38, a38
    v_accvgpr_read_b32 v39, a39
    v_cvt_pk_bf16_f32 v136, v32, v33
    v_cvt_pk_bf16_f32 v137, v34, v35
    v_cvt_pk_bf16_f32 v138, v36, v37
    v_cvt_pk_bf16_f32 v139, v38, v39
    v_accvgpr_read_b32 v40, a40
    v_accvgpr_read_b32 v41, a41
    v_accvgpr_read_b32 v42, a42
    v_accvgpr_read_b32 v43, a43
    v_accvgpr_read_b32 v44, a44
    v_accvgpr_read_b32 v45, a45
    v_accvgpr_read_b32 v46, a46
    v_accvgpr_read_b32 v47, a47
    v_cvt_pk_bf16_f32 v140, v40, v41
    v_cvt_pk_bf16_f32 v141, v42, v43
    v_cvt_pk_bf16_f32 v142, v44, v45
    v_cvt_pk_bf16_f32 v143, v46, v47
    v_accvgpr_read_b32 v32, a48
    v_accvgpr_read_b32 v33, a49
    v_accvgpr_read_b32 v34, a50
    v_accvgpr_read_b32 v35, a51
    v_accvgpr_read_b32 v36, a52
    v_accvgpr_read_b32 v37, a53
    v_accvgpr_read_b32 v38, a54
    v_accvgpr_read_b32 v39, a55
    v_cvt_pk_bf16_f32 v168, v32, v33
    v_cvt_pk_bf16_f32 v169, v34, v35
    v_cvt_pk_bf16_f32 v170, v36, v37
    v_cvt_pk_bf16_f32 v171, v38, v39
    v_accvgpr_read_b32 v40, a56
    v_accvgpr_read_b32 v41, a57
    v_accvgpr_read_b32 v42, a58
    v_accvgpr_read_b32 v43, a59
    v_accvgpr_read_b32 v44, a60
    v_accvgpr_read_b32 v45, a61
    v_accvgpr_read_b32 v46, a62
    v_accvgpr_read_b32 v47, a63
    v_cvt_pk_bf16_f32 v172, v40, v41
    v_cvt_pk_bf16_f32 v173, v42, v43
    v_cvt_pk_bf16_f32 v174, v44, v45
    v_cvt_pk_bf16_f32 v175, v46, v47
    v_accvgpr_read_b32 v32, a64
    v_accvgpr_read_b32 v33, a65
    v_accvgpr_read_b32 v34, a66
    v_accvgpr_read_b32 v35, a67
    v_accvgpr_read_b32 v36, a68
    v_accvgpr_read_b32 v37, a69
    v_accvgpr_read_b32 v38, a70
    v_accvgpr_read_b32 v39, a71
    v_cvt_pk_bf16_f32 v144, v32, v33
    v_cvt_pk_bf16_f32 v145, v34, v35
    v_cvt_pk_bf16_f32 v146, v36, v37
    v_cvt_pk_bf16_f32 v147, v38, v39
    v_accvgpr_read_b32 v40, a72
    v_accvgpr_read_b32 v41, a73
    v_accvgpr_read_b32 v42, a74
    v_accvgpr_read_b32 v43, a75
    v_accvgpr_read_b32 v44, a76
    v_accvgpr_read_b32 v45, a77
    v_accvgpr_read_b32 v46, a78
    v_accvgpr_read_b32 v47, a79
    v_cvt_pk_bf16_f32 v148, v40, v41
    v_cvt_pk_bf16_f32 v149, v42, v43
    v_cvt_pk_bf16_f32 v150, v44, v45
    v_cvt_pk_bf16_f32 v151, v46, v47
    v_accvgpr_read_b32 v32, a80
    v_accvgpr_read_b32 v33, a81
    v_accvgpr_read_b32 v34, a82
    v_accvgpr_read_b32 v35, a83
    v_accvgpr_read_b32 v36, a84
    v_accvgpr_read_b32 v37, a85
    v_accvgpr_read_b32 v38, a86
    v_accvgpr_read_b32 v39, a87
    v_cvt_pk_bf16_f32 v176, v32, v33
    v_cvt_pk_bf16_f32 v177, v34, v35
    v_cvt_pk_bf16_f32 v178, v36, v37
    v_cvt_pk_bf16_f32 v179, v38, v39
    v_accvgpr_read_b32 v40, a88
    v_accvgpr_read_b32 v41, a89
    v_accvgpr_read_b32 v42, a90
    v_accvgpr_read_b32 v43, a91
    v_accvgpr_read_b32 v44, a92
    v_accvgpr_read_b32 v45, a93
    v_accvgpr_read_b32 v46, a94
    v_accvgpr_read_b32 v47, a95
    v_cvt_pk_bf16_f32 v180, v40, v41
    v_cvt_pk_bf16_f32 v181, v42, v43
    v_cvt_pk_bf16_f32 v182, v44, v45
    v_cvt_pk_bf16_f32 v183, v46, v47
    v_accvgpr_read_b32 v32, a96
    v_accvgpr_read_b32 v33, a97
    v_accvgpr_read_b32 v34, a98
    v_accvgpr_read_b32 v35, a99
    v_accvgpr_read_b32 v36, a100
    v_accvgpr_read_b32 v37, a101
    v_accvgpr_read_b32 v38, a102
    v_accvgpr_read_b32 v39, a103
    v_cvt_pk_bf16_f32 v152, v32, v33
    v_cvt_pk_bf16_f32 v153, v34, v35
    v_cvt_pk_bf16_f32 v154, v36, v37
    v_cvt_pk_bf16_f32 v155, v38, v39
    v_accvgpr_read_b32 v40, a104
    v_accvgpr_read_b32 v41, a105
    v_accvgpr_read_b32 v42, a106
    v_accvgpr_read_b32 v43, a107
    v_accvgpr_read_b32 v44, a108
    v_accvgpr_read_b32 v45, a109
    v_accvgpr_read_b32 v46, a110
    v_accvgpr_read_b32 v47, a111
    v_cvt_pk_bf16_f32 v156, v40, v41
    v_cvt_pk_bf16_f32 v157, v42, v43
    v_cvt_pk_bf16_f32 v158, v44, v45
    v_cvt_pk_bf16_f32 v159, v46, v47
    v_accvgpr_read_b32 v32, a112
    v_accvgpr_read_b32 v33, a113
    v_accvgpr_read_b32 v34, a114
    v_accvgpr_read_b32 v35, a115
    v_accvgpr_read_b32 v36, a116
    v_accvgpr_read_b32 v37, a117
    v_accvgpr_read_b32 v38, a118
    v_accvgpr_read_b32 v39, a119
    v_cvt_pk_bf16_f32 v184, v32, v33
    v_cvt_pk_bf16_f32 v185, v34, v35
    v_cvt_pk_bf16_f32 v186, v36, v37
    v_cvt_pk_bf16_f32 v187, v38, v39
    v_accvgpr_read_b32 v40, a120
    v_accvgpr_read_b32 v41, a121
    v_accvgpr_read_b32 v42, a122
    v_accvgpr_read_b32 v43, a123
    v_accvgpr_read_b32 v44, a124
    v_accvgpr_read_b32 v45, a125
    v_accvgpr_read_b32 v46, a126
    v_accvgpr_read_b32 v47, a127
    v_cvt_pk_bf16_f32 v188, v40, v41
    v_cvt_pk_bf16_f32 v189, v42, v43
    v_cvt_pk_bf16_f32 v190, v44, v45
    v_cvt_pk_bf16_f32 v191, v46, v47
    s_mul_i32 s62, s16, 163840
    s_add_u32 s62, s62, 0xf00000
    s_mul_i32 s63, s17, 1310720
    s_mul_i32 s13, s16, 40960
    s_add_u32 s63, s63, s13
    s_add_u32 s63, s63, 0x3cd4000
    s_mul_i32 s13, s97, 40960
    s_add_u32 s62, s62, s13
    s_mul_i32 s13, s97, 10240
    s_add_u32 s63, s63, s13
    v_add_u32 v17, 0x1000, v16
    buffer_load_dwordx4 a[128:131], v16, s[24:27], s62 offen offset:0
    buffer_load_dwordx4 a[132:135], v16, s[24:27], s62 offen offset:1024
    buffer_load_dwordx4 a[136:139], v16, s[24:27], s62 offen offset:2048
    buffer_load_dwordx4 a[140:143], v16, s[24:27], s62 offen offset:3072
    buffer_load_dwordx4 a[144:147], v17, s[24:27], s62 offen offset:0
    buffer_load_dwordx4 a[148:151], v17, s[24:27], s62 offen offset:1024
    buffer_load_dwordx4 a[152:155], v17, s[24:27], s62 offen offset:2048
    buffer_load_dwordx4 a[156:159], v17, s[24:27], s62 offen offset:3072
    s_add_u32 s62, s62, 8192
    buffer_load_dwordx4 a[160:163], v16, s[24:27], s62 offen offset:0
    buffer_load_dwordx4 a[164:167], v16, s[24:27], s62 offen offset:1024
    buffer_load_dwordx4 a[168:171], v16, s[24:27], s62 offen offset:2048
    buffer_load_dwordx4 a[172:175], v16, s[24:27], s62 offen offset:3072
    buffer_load_dwordx4 a[176:179], v17, s[24:27], s62 offen offset:0
    buffer_load_dwordx4 a[180:183], v17, s[24:27], s62 offen offset:1024
    buffer_load_dwordx4 a[184:187], v17, s[24:27], s62 offen offset:2048
    buffer_load_dwordx4 a[188:191], v17, s[24:27], s62 offen offset:3072
    s_add_u32 s62, s62, 8192
    buffer_load_dwordx4 a[192:195], v16, s[24:27], s62 offen offset:0
    buffer_load_dwordx4 a[196:199], v16, s[24:27], s62 offen offset:1024
    buffer_load_dwordx4 a[200:203], v16, s[24:27], s62 offen offset:2048
    buffer_load_dwordx4 a[204:207], v16, s[24:27], s62 offen offset:3072
    buffer_load_dwordx4 a[208:211], v17, s[24:27], s62 offen offset:0
    buffer_load_dwordx4 a[212:215], v17, s[24:27], s62 offen offset:1024
    buffer_load_dwordx4 a[216:219], v17, s[24:27], s62 offen offset:2048
    buffer_load_dwordx4 a[220:223], v17, s[24:27], s62 offen offset:3072
    s_add_u32 s62, s62, 8192
    buffer_load_dwordx4 a[224:227], v16, s[24:27], s62 offen offset:0
    buffer_load_dwordx4 a[228:231], v16, s[24:27], s62 offen offset:1024
    buffer_load_dwordx4 a[232:235], v16, s[24:27], s62 offen offset:2048
    buffer_load_dwordx4 a[236:239], v16, s[24:27], s62 offen offset:3072
    buffer_load_dwordx4 a[240:243], v17, s[24:27], s62 offen offset:0
    buffer_load_dwordx4 a[244:247], v17, s[24:27], s62 offen offset:1024
    buffer_load_dwordx4 a[248:251], v17, s[24:27], s62 offen offset:2048
    buffer_load_dwordx4 a[252:255], v17, s[24:27], s62 offen offset:3072
    s_add_u32 s62, s62, 8192
    s_waitcnt vmcnt(24)
    v_mfma_f32_32x32x16_bf16 a[0:15], v[128:131], a[128:131], 0
    v_mfma_f32_32x32x16_bf16 a[16:31], v[160:163], a[128:131], 0
    v_mfma_f32_32x32x16_bf16 a[0:15], v[132:135], a[132:135], a[0:15]
    v_mfma_f32_32x32x16_bf16 a[16:31], v[164:167], a[132:135], a[16:31]
    v_mfma_f32_32x32x16_bf16 a[0:15], v[136:139], a[136:139], a[0:15]
    v_mfma_f32_32x32x16_bf16 a[16:31], v[168:171], a[136:139], a[16:31]
    v_mfma_f32_32x32x16_bf16 a[0:15], v[140:143], a[140:143], a[0:15]
    v_mfma_f32_32x32x16_bf16 a[16:31], v[172:175], a[140:143], a[16:31]
    v_mfma_f32_32x32x16_bf16 a[0:15], v[144:147], a[144:147], a[0:15]
    v_mfma_f32_32x32x16_bf16 a[16:31], v[176:179], a[144:147], a[16:31]
    v_mfma_f32_32x32x16_bf16 a[0:15], v[148:151], a[148:151], a[0:15]
    v_mfma_f32_32x32x16_bf16 a[16:31], v[180:183], a[148:151], a[16:31]
    v_mfma_f32_32x32x16_bf16 a[0:15], v[152:155], a[152:155], a[0:15]
    v_mfma_f32_32x32x16_bf16 a[16:31], v[184:187], a[152:155], a[16:31]
    v_mfma_f32_32x32x16_bf16 a[0:15], v[156:159], a[156:159], a[0:15]
    v_mfma_f32_32x32x16_bf16 a[16:31], v[188:191], a[156:159], a[16:31]
    buffer_load_dwordx4 a[128:131], v16, s[24:27], s62 offen offset:0
    buffer_load_dwordx4 a[132:135], v16, s[24:27], s62 offen offset:1024
    buffer_load_dwordx4 a[136:139], v16, s[24:27], s62 offen offset:2048
    buffer_load_dwordx4 a[140:143], v16, s[24:27], s62 offen offset:3072
    buffer_load_dwordx4 a[144:147], v17, s[24:27], s62 offen offset:0
    buffer_load_dwordx4 a[148:151], v17, s[24:27], s62 offen offset:1024
    buffer_load_dwordx4 a[152:155], v17, s[24:27], s62 offen offset:2048
    buffer_load_dwordx4 a[156:159], v17, s[24:27], s62 offen offset:3072
    s_add_u32 s62, s62, 8192
    s_waitcnt vmcnt(24)
    v_mfma_f32_32x32x16_bf16 a[64:79], v[128:131], a[160:163], 0
    s_nop 15
    v_accvgpr_read_b32 v32, a0
    v_accvgpr_read_b32 v33, a1
    v_accvgpr_read_b32 v34, a2
    v_mfma_f32_32x32x16_bf16 a[80:95], v[160:163], a[160:163], 0
    v_accvgpr_read_b32 v35, a3
    v_accvgpr_read_b32 v36, a4
    v_accvgpr_read_b32 v37, a5
    v_accvgpr_read_b32 v38, a6
    v_mfma_f32_32x32x16_bf16 a[64:79], v[132:135], a[164:167], a[64:79]
    v_accvgpr_read_b32 v39, a7
    v_cvt_pk_bf16_f32 v40, v32, v33
    v_cvt_pk_bf16_f32 v41, v34, v35
    v_cvt_pk_bf16_f32 v42, v36, v37
    v_mfma_f32_32x32x16_bf16 a[80:95], v[164:167], a[164:167], a[80:95]
    v_cvt_pk_bf16_f32 v43, v38, v39
    s_add_u32 s56, s63, 0
    buffer_store_dwordx4 v[40:43], v16, s[24:27], s56 offen
    v_accvgpr_read_b32 v44, a8
    v_mfma_f32_32x32x16_bf16 a[64:79], v[136:139], a[168:171], a[64:79]
    v_accvgpr_read_b32 v45, a9
    v_accvgpr_read_b32 v46, a10
    v_accvgpr_read_b32 v47, a11
    v_accvgpr_read_b32 v48, a12
    v_mfma_f32_32x32x16_bf16 a[80:95], v[168:171], a[168:171], a[80:95]
    v_accvgpr_read_b32 v49, a13
    v_accvgpr_read_b32 v50, a14
    v_accvgpr_read_b32 v51, a15
    v_cvt_pk_bf16_f32 v52, v44, v45
    v_mfma_f32_32x32x16_bf16 a[64:79], v[140:143], a[172:175], a[64:79]
    v_cvt_pk_bf16_f32 v53, v46, v47
    v_cvt_pk_bf16_f32 v54, v48, v49
    v_cvt_pk_bf16_f32 v55, v50, v51
    s_add_u32 s56, s63, 1024
    v_mfma_f32_32x32x16_bf16 a[80:95], v[172:175], a[172:175], a[80:95]
    buffer_store_dwordx4 v[52:55], v16, s[24:27], s56 offen
    v_accvgpr_read_b32 v32, a16
    v_accvgpr_read_b32 v33, a17
    v_accvgpr_read_b32 v34, a18
    v_mfma_f32_32x32x16_bf16 a[64:79], v[144:147], a[176:179], a[64:79]
    v_accvgpr_read_b32 v35, a19
    v_accvgpr_read_b32 v36, a20
    v_accvgpr_read_b32 v37, a21
    v_accvgpr_read_b32 v38, a22
    v_mfma_f32_32x32x16_bf16 a[80:95], v[176:179], a[176:179], a[80:95]
    v_accvgpr_read_b32 v39, a23
    v_cvt_pk_bf16_f32 v40, v32, v33
    v_cvt_pk_bf16_f32 v41, v34, v35
    v_cvt_pk_bf16_f32 v42, v36, v37
    v_mfma_f32_32x32x16_bf16 a[64:79], v[148:151], a[180:183], a[64:79]
    v_cvt_pk_bf16_f32 v43, v38, v39
    s_add_u32 s56, s63, 1310720
    buffer_store_dwordx4 v[40:43], v16, s[24:27], s56 offen
    v_accvgpr_read_b32 v44, a24
    v_mfma_f32_32x32x16_bf16 a[80:95], v[180:183], a[180:183], a[80:95]
    v_accvgpr_read_b32 v45, a25
    v_accvgpr_read_b32 v46, a26
    v_accvgpr_read_b32 v47, a27
    v_accvgpr_read_b32 v48, a28
    v_mfma_f32_32x32x16_bf16 a[64:79], v[152:155], a[184:187], a[64:79]
    v_accvgpr_read_b32 v49, a29
    v_accvgpr_read_b32 v50, a30
    v_accvgpr_read_b32 v51, a31
    v_cvt_pk_bf16_f32 v52, v44, v45
    v_mfma_f32_32x32x16_bf16 a[80:95], v[184:187], a[184:187], a[80:95]
    v_cvt_pk_bf16_f32 v53, v46, v47
    v_cvt_pk_bf16_f32 v54, v48, v49
    v_cvt_pk_bf16_f32 v55, v50, v51
    s_add_u32 s56, s63, 1311744
    v_mfma_f32_32x32x16_bf16 a[64:79], v[156:159], a[188:191], a[64:79]
    buffer_store_dwordx4 v[52:55], v16, s[24:27], s56 offen
    s_add_u32 s63, s63, 2048
    v_mfma_f32_32x32x16_bf16 a[80:95], v[188:191], a[188:191], a[80:95]
    s_waitcnt vmcnt(20)
    v_mfma_f32_32x32x16_bf16 a[0:15], v[128:131], a[192:195], 0
    s_nop 15
    v_accvgpr_read_b32 v32, a64
    v_accvgpr_read_b32 v33, a65
    v_accvgpr_read_b32 v34, a66
    v_mfma_f32_32x32x16_bf16 a[16:31], v[160:163], a[192:195], 0
    v_accvgpr_read_b32 v35, a67
    v_accvgpr_read_b32 v36, a68
    v_accvgpr_read_b32 v37, a69
    v_accvgpr_read_b32 v38, a70
    v_mfma_f32_32x32x16_bf16 a[0:15], v[132:135], a[196:199], a[0:15]
    v_accvgpr_read_b32 v39, a71
    v_cvt_pk_bf16_f32 v40, v32, v33
    v_cvt_pk_bf16_f32 v41, v34, v35
    v_cvt_pk_bf16_f32 v42, v36, v37
    v_mfma_f32_32x32x16_bf16 a[16:31], v[164:167], a[196:199], a[16:31]
    v_cvt_pk_bf16_f32 v43, v38, v39
    s_add_u32 s56, s63, 0
    buffer_store_dwordx4 v[40:43], v16, s[24:27], s56 offen
    v_accvgpr_read_b32 v44, a72
    v_mfma_f32_32x32x16_bf16 a[0:15], v[136:139], a[200:203], a[0:15]
    v_accvgpr_read_b32 v45, a73
    v_accvgpr_read_b32 v46, a74
    v_accvgpr_read_b32 v47, a75
    v_accvgpr_read_b32 v48, a76
    v_mfma_f32_32x32x16_bf16 a[16:31], v[168:171], a[200:203], a[16:31]
    v_accvgpr_read_b32 v49, a77
    v_accvgpr_read_b32 v50, a78
    v_accvgpr_read_b32 v51, a79
    v_cvt_pk_bf16_f32 v52, v44, v45
    v_mfma_f32_32x32x16_bf16 a[0:15], v[140:143], a[204:207], a[0:15]
    v_cvt_pk_bf16_f32 v53, v46, v47
    v_cvt_pk_bf16_f32 v54, v48, v49
    v_cvt_pk_bf16_f32 v55, v50, v51
    s_add_u32 s56, s63, 1024
    v_mfma_f32_32x32x16_bf16 a[16:31], v[172:175], a[204:207], a[16:31]
    buffer_store_dwordx4 v[52:55], v16, s[24:27], s56 offen
    v_accvgpr_read_b32 v32, a80
    v_accvgpr_read_b32 v33, a81
    v_accvgpr_read_b32 v34, a82
    v_mfma_f32_32x32x16_bf16 a[0:15], v[144:147], a[208:211], a[0:15]
    v_accvgpr_read_b32 v35, a83
    v_accvgpr_read_b32 v36, a84
    v_accvgpr_read_b32 v37, a85
    v_accvgpr_read_b32 v38, a86
    v_mfma_f32_32x32x16_bf16 a[16:31], v[176:179], a[208:211], a[16:31]
    v_accvgpr_read_b32 v39, a87
    v_cvt_pk_bf16_f32 v40, v32, v33
    v_cvt_pk_bf16_f32 v41, v34, v35
    v_cvt_pk_bf16_f32 v42, v36, v37
    v_mfma_f32_32x32x16_bf16 a[0:15], v[148:151], a[212:215], a[0:15]
    v_cvt_pk_bf16_f32 v43, v38, v39
    s_add_u32 s56, s63, 1310720
    buffer_store_dwordx4 v[40:43], v16, s[24:27], s56 offen
    v_accvgpr_read_b32 v44, a88
    v_mfma_f32_32x32x16_bf16 a[16:31], v[180:183], a[212:215], a[16:31]
    v_accvgpr_read_b32 v45, a89
    v_accvgpr_read_b32 v46, a90
    v_accvgpr_read_b32 v47, a91
    v_accvgpr_read_b32 v48, a92
    v_mfma_f32_32x32x16_bf16 a[0:15], v[152:155], a[216:219], a[0:15]
    v_accvgpr_read_b32 v49, a93
    v_accvgpr_read_b32 v50, a94
    v_accvgpr_read_b32 v51, a95
    v_cvt_pk_bf16_f32 v52, v44, v45
    v_mfma_f32_32x32x16_bf16 a[16:31], v[184:187], a[216:219], a[16:31]
    v_cvt_pk_bf16_f32 v53, v46, v47
    v_cvt_pk_bf16_f32 v54, v48, v49
    v_cvt_pk_bf16_f32 v55, v50, v51
    s_add_u32 s56, s63, 1311744
    v_mfma_f32_32x32x16_bf16 a[0:15], v[156:159], a[220:223], a[0:15]
    buffer_store_dwordx4 v[52:55], v16, s[24:27], s56 offen
    s_add_u32 s63, s63, 2048
    v_mfma_f32_32x32x16_bf16 a[16:31], v[188:191], a[220:223], a[16:31]
    s_waitcnt vmcnt(16)
    v_mfma_f32_32x32x16_bf16 a[64:79], v[128:131], a[224:227], 0
    s_nop 15
    v_accvgpr_read_b32 v32, a0
    v_accvgpr_read_b32 v33, a1
    v_accvgpr_read_b32 v34, a2
    v_mfma_f32_32x32x16_bf16 a[80:95], v[160:163], a[224:227], 0
    v_accvgpr_read_b32 v35, a3
    v_accvgpr_read_b32 v36, a4
    v_accvgpr_read_b32 v37, a5
    v_accvgpr_read_b32 v38, a6
    v_mfma_f32_32x32x16_bf16 a[64:79], v[132:135], a[228:231], a[64:79]
    v_accvgpr_read_b32 v39, a7
    v_cvt_pk_bf16_f32 v40, v32, v33
    v_cvt_pk_bf16_f32 v41, v34, v35
    v_cvt_pk_bf16_f32 v42, v36, v37
    v_mfma_f32_32x32x16_bf16 a[80:95], v[164:167], a[228:231], a[80:95]
    v_cvt_pk_bf16_f32 v43, v38, v39
    s_add_u32 s56, s63, 0
    buffer_store_dwordx4 v[40:43], v16, s[24:27], s56 offen
    v_accvgpr_read_b32 v44, a8
    v_mfma_f32_32x32x16_bf16 a[64:79], v[136:139], a[232:235], a[64:79]
    v_accvgpr_read_b32 v45, a9
    v_accvgpr_read_b32 v46, a10
    v_accvgpr_read_b32 v47, a11
    v_accvgpr_read_b32 v48, a12
    v_mfma_f32_32x32x16_bf16 a[80:95], v[168:171], a[232:235], a[80:95]
    v_accvgpr_read_b32 v49, a13
    v_accvgpr_read_b32 v50, a14
    v_accvgpr_read_b32 v51, a15
    v_cvt_pk_bf16_f32 v52, v44, v45
    v_mfma_f32_32x32x16_bf16 a[64:79], v[140:143], a[236:239], a[64:79]
    v_cvt_pk_bf16_f32 v53, v46, v47
    v_cvt_pk_bf16_f32 v54, v48, v49
    v_cvt_pk_bf16_f32 v55, v50, v51
    s_add_u32 s56, s63, 1024
    v_mfma_f32_32x32x16_bf16 a[80:95], v[172:175], a[236:239], a[80:95]
    buffer_store_dwordx4 v[52:55], v16, s[24:27], s56 offen
    v_accvgpr_read_b32 v32, a16
    v_accvgpr_read_b32 v33, a17
    v_accvgpr_read_b32 v34, a18
    v_mfma_f32_32x32x16_bf16 a[64:79], v[144:147], a[240:243], a[64:79]
    v_accvgpr_read_b32 v35, a19
    v_accvgpr_read_b32 v36, a20
    v_accvgpr_read_b32 v37, a21
    v_accvgpr_read_b32 v38, a22
    v_mfma_f32_32x32x16_bf16 a[80:95], v[176:179], a[240:243], a[80:95]
    v_accvgpr_read_b32 v39, a23
    v_cvt_pk_bf16_f32 v40, v32, v33
    v_cvt_pk_bf16_f32 v41, v34, v35
    v_cvt_pk_bf16_f32 v42, v36, v37
    v_mfma_f32_32x32x16_bf16 a[64:79], v[148:151], a[244:247], a[64:79]
    v_cvt_pk_bf16_f32 v43, v38, v39
    s_add_u32 s56, s63, 1310720
    buffer_store_dwordx4 v[40:43], v16, s[24:27], s56 offen
    v_accvgpr_read_b32 v44, a24
    v_mfma_f32_32x32x16_bf16 a[80:95], v[180:183], a[244:247], a[80:95]
    v_accvgpr_read_b32 v45, a25
    v_accvgpr_read_b32 v46, a26
    v_accvgpr_read_b32 v47, a27
    v_accvgpr_read_b32 v48, a28
    v_mfma_f32_32x32x16_bf16 a[64:79], v[152:155], a[248:251], a[64:79]
    v_accvgpr_read_b32 v49, a29
    v_accvgpr_read_b32 v50, a30
    v_accvgpr_read_b32 v51, a31
    v_cvt_pk_bf16_f32 v52, v44, v45
    v_mfma_f32_32x32x16_bf16 a[80:95], v[184:187], a[248:251], a[80:95]
    v_cvt_pk_bf16_f32 v53, v46, v47
    v_cvt_pk_bf16_f32 v54, v48, v49
    v_cvt_pk_bf16_f32 v55, v50, v51
    s_add_u32 s56, s63, 1311744
    v_mfma_f32_32x32x16_bf16 a[64:79], v[156:159], a[252:255], a[64:79]
    buffer_store_dwordx4 v[52:55], v16, s[24:27], s56 offen
    s_add_u32 s63, s63, 2048
    v_mfma_f32_32x32x16_bf16 a[80:95], v[188:191], a[252:255], a[80:95]
    s_waitcnt vmcnt(12)
    v_mfma_f32_32x32x16_bf16 a[0:15], v[128:131], a[128:131], 0
    s_nop 15
    v_accvgpr_read_b32 v32, a64
    v_accvgpr_read_b32 v33, a65
    v_accvgpr_read_b32 v34, a66
    v_mfma_f32_32x32x16_bf16 a[16:31], v[160:163], a[128:131], 0
    v_accvgpr_read_b32 v35, a67
    v_accvgpr_read_b32 v36, a68
    v_accvgpr_read_b32 v37, a69
    v_accvgpr_read_b32 v38, a70
    v_mfma_f32_32x32x16_bf16 a[0:15], v[132:135], a[132:135], a[0:15]
    v_accvgpr_read_b32 v39, a71
    v_cvt_pk_bf16_f32 v40, v32, v33
    v_cvt_pk_bf16_f32 v41, v34, v35
    v_cvt_pk_bf16_f32 v42, v36, v37
    v_mfma_f32_32x32x16_bf16 a[16:31], v[164:167], a[132:135], a[16:31]
    v_cvt_pk_bf16_f32 v43, v38, v39
    s_add_u32 s56, s63, 0
    buffer_store_dwordx4 v[40:43], v16, s[24:27], s56 offen
    v_accvgpr_read_b32 v44, a72
    v_mfma_f32_32x32x16_bf16 a[0:15], v[136:139], a[136:139], a[0:15]
    v_accvgpr_read_b32 v45, a73
    v_accvgpr_read_b32 v46, a74
    v_accvgpr_read_b32 v47, a75
    v_accvgpr_read_b32 v48, a76
    v_mfma_f32_32x32x16_bf16 a[16:31], v[168:171], a[136:139], a[16:31]
    v_accvgpr_read_b32 v49, a77
    v_accvgpr_read_b32 v50, a78
    v_accvgpr_read_b32 v51, a79
    v_cvt_pk_bf16_f32 v52, v44, v45
    v_mfma_f32_32x32x16_bf16 a[0:15], v[140:143], a[140:143], a[0:15]
    v_cvt_pk_bf16_f32 v53, v46, v47
    v_cvt_pk_bf16_f32 v54, v48, v49
    v_cvt_pk_bf16_f32 v55, v50, v51
    s_add_u32 s56, s63, 1024
    v_mfma_f32_32x32x16_bf16 a[16:31], v[172:175], a[140:143], a[16:31]
    buffer_store_dwordx4 v[52:55], v16, s[24:27], s56 offen
    v_accvgpr_read_b32 v32, a80
    v_accvgpr_read_b32 v33, a81
    v_accvgpr_read_b32 v34, a82
    v_mfma_f32_32x32x16_bf16 a[0:15], v[144:147], a[144:147], a[0:15]
    v_accvgpr_read_b32 v35, a83
    v_accvgpr_read_b32 v36, a84
    v_accvgpr_read_b32 v37, a85
    v_accvgpr_read_b32 v38, a86
    v_mfma_f32_32x32x16_bf16 a[16:31], v[176:179], a[144:147], a[16:31]
    v_accvgpr_read_b32 v39, a87
    v_cvt_pk_bf16_f32 v40, v32, v33
    v_cvt_pk_bf16_f32 v41, v34, v35
    v_cvt_pk_bf16_f32 v42, v36, v37
    v_mfma_f32_32x32x16_bf16 a[0:15], v[148:151], a[148:151], a[0:15]
    v_cvt_pk_bf16_f32 v43, v38, v39
    s_add_u32 s56, s63, 1310720
    buffer_store_dwordx4 v[40:43], v16, s[24:27], s56 offen
    v_accvgpr_read_b32 v44, a88
    v_mfma_f32_32x32x16_bf16 a[16:31], v[180:183], a[148:151], a[16:31]
    v_accvgpr_read_b32 v45, a89
    v_accvgpr_read_b32 v46, a90
    v_accvgpr_read_b32 v47, a91
    v_accvgpr_read_b32 v48, a92
    v_mfma_f32_32x32x16_bf16 a[0:15], v[152:155], a[152:155], a[0:15]
    v_accvgpr_read_b32 v49, a93
    v_accvgpr_read_b32 v50, a94
    v_accvgpr_read_b32 v51, a95
    v_cvt_pk_bf16_f32 v52, v44, v45
    v_mfma_f32_32x32x16_bf16 a[16:31], v[184:187], a[152:155], a[16:31]
    v_cvt_pk_bf16_f32 v53, v46, v47
    v_cvt_pk_bf16_f32 v54, v48, v49
    v_cvt_pk_bf16_f32 v55, v50, v51
    s_add_u32 s56, s63, 1311744
    v_mfma_f32_32x32x16_bf16 a[0:15], v[156:159], a[156:159], a[0:15]
    buffer_store_dwordx4 v[52:55], v16, s[24:27], s56 offen
    s_add_u32 s63, s63, 2048
    v_mfma_f32_32x32x16_bf16 a[16:31], v[188:191], a[156:159], a[16:31]
    s_nop 15
    v_accvgpr_read_b32 v32, a0
    v_accvgpr_read_b32 v33, a1
    v_accvgpr_read_b32 v34, a2
    v_accvgpr_read_b32 v35, a3
    v_accvgpr_read_b32 v36, a4
    v_accvgpr_read_b32 v37, a5
    v_accvgpr_read_b32 v38, a6
    v_accvgpr_read_b32 v39, a7
    v_cvt_pk_bf16_f32 v40, v32, v33
    v_cvt_pk_bf16_f32 v41, v34, v35
    v_cvt_pk_bf16_f32 v42, v36, v37
    v_cvt_pk_bf16_f32 v43, v38, v39
    s_add_u32 s56, s63, 0
    buffer_store_dwordx4 v[40:43], v16, s[24:27], s56 offen
    v_accvgpr_read_b32 v44, a8
    v_accvgpr_read_b32 v45, a9
    v_accvgpr_read_b32 v46, a10
    v_accvgpr_read_b32 v47, a11
    v_accvgpr_read_b32 v48, a12
    v_accvgpr_read_b32 v49, a13
    v_accvgpr_read_b32 v50, a14
    v_accvgpr_read_b32 v51, a15
    v_cvt_pk_bf16_f32 v52, v44, v45
    v_cvt_pk_bf16_f32 v53, v46, v47
    v_cvt_pk_bf16_f32 v54, v48, v49
    v_cvt_pk_bf16_f32 v55, v50, v51
    s_add_u32 s56, s63, 1024
    buffer_store_dwordx4 v[52:55], v16, s[24:27], s56 offen
    v_accvgpr_read_b32 v32, a16
    v_accvgpr_read_b32 v33, a17
    v_accvgpr_read_b32 v34, a18
    v_accvgpr_read_b32 v35, a19
    v_accvgpr_read_b32 v36, a20
    v_accvgpr_read_b32 v37, a21
    v_accvgpr_read_b32 v38, a22
    v_accvgpr_read_b32 v39, a23
    v_cvt_pk_bf16_f32 v40, v32, v33
    v_cvt_pk_bf16_f32 v41, v34, v35
    v_cvt_pk_bf16_f32 v42, v36, v37
    v_cvt_pk_bf16_f32 v43, v38, v39
    s_add_u32 s56, s63, 1310720
    buffer_store_dwordx4 v[40:43], v16, s[24:27], s56 offen
    v_accvgpr_read_b32 v44, a24
    v_accvgpr_read_b32 v45, a25
    v_accvgpr_read_b32 v46, a26
    v_accvgpr_read_b32 v47, a27
    v_accvgpr_read_b32 v48, a28
    v_accvgpr_read_b32 v49, a29
    v_accvgpr_read_b32 v50, a30
    v_accvgpr_read_b32 v51, a31
    v_cvt_pk_bf16_f32 v52, v44, v45
    v_cvt_pk_bf16_f32 v53, v46, v47
    v_cvt_pk_bf16_f32 v54, v48, v49
    v_cvt_pk_bf16_f32 v55, v50, v51
    s_add_u32 s56, s63, 1311744
    buffer_store_dwordx4 v[52:55], v16, s[24:27], s56 offen
    s_add_u32 s63, s63, 2048
    s_branch KT_12
QKE_14:
    s_lshl_b32 s63, s16, 19
    s_lshl_b32 s13, s17, 13
    s_add_u32 s63, s63, s13
    s_add_u32 s63, s63, 0x1cd4000
    v_accvgpr_read_b32 v32, a0
    v_accvgpr_read_b32 v33, a1
    v_accvgpr_read_b32 v34, a2
    v_accvgpr_read_b32 v35, a3
    v_accvgpr_read_b32 v36, a4
    v_accvgpr_read_b32 v37, a5
    v_accvgpr_read_b32 v38, a6
    v_accvgpr_read_b32 v39, a7
    v_cvt_pk_bf16_f32 v40, v32, v33
    v_cvt_pk_bf16_f32 v41, v34, v35
    v_cvt_pk_bf16_f32 v42, v36, v37
    v_cvt_pk_bf16_f32 v43, v38, v39
    s_add_u32 s56, s63, 0
    buffer_store_dwordx4 v[40:43], v16, s[24:27], s56 offen
    v_accvgpr_read_b32 v44, a8
    v_accvgpr_read_b32 v45, a9
    v_accvgpr_read_b32 v46, a10
    v_accvgpr_read_b32 v47, a11
    v_accvgpr_read_b32 v48, a12
    v_accvgpr_read_b32 v49, a13
    v_accvgpr_read_b32 v50, a14
    v_accvgpr_read_b32 v51, a15
    v_cvt_pk_bf16_f32 v52, v44, v45
    v_cvt_pk_bf16_f32 v53, v46, v47
    v_cvt_pk_bf16_f32 v54, v48, v49
    v_cvt_pk_bf16_f32 v55, v50, v51
    s_add_u32 s56, s63, 1024
    buffer_store_dwordx4 v[52:55], v16, s[24:27], s56 offen
    v_accvgpr_read_b32 v32, a32
    v_accvgpr_read_b32 v33, a33
    v_accvgpr_read_b32 v34, a34
    v_accvgpr_read_b32 v35, a35
    v_accvgpr_read_b32 v36, a36
    v_accvgpr_read_b32 v37, a37
    v_accvgpr_read_b32 v38, a38
    v_accvgpr_read_b32 v39, a39
    v_cvt_pk_bf16_f32 v40, v32, v33
    v_cvt_pk_bf16_f32 v41, v34, v35
    v_cvt_pk_bf16_f32 v42, v36, v37
    v_cvt_pk_bf16_f32 v43, v38, v39
    s_add_u32 s56, s63, 2048
    buffer_store_dwordx4 v[40:43], v16, s[24:27], s56 offen
    v_accvgpr_read_b32 v44, a40
    v_accvgpr_read_b32 v45, a41
    v_accvgpr_read_b32 v46, a42
    v_accvgpr_read_b32 v47, a43
    v_accvgpr_read_b32 v48, a44
    v_accvgpr_read_b32 v49, a45
    v_accvgpr_read_b32 v50, a46
    v_accvgpr_read_b32 v51, a47
    v_cvt_pk_bf16_f32 v52, v44, v45
    v_cvt_pk_bf16_f32 v53, v46, v47
    v_cvt_pk_bf16_f32 v54, v48, v49
    v_cvt_pk_bf16_f32 v55, v50, v51
    s_add_u32 s56, s63, 3072
    buffer_store_dwordx4 v[52:55], v16, s[24:27], s56 offen
    v_accvgpr_read_b32 v32, a64
    v_accvgpr_read_b32 v33, a65
    v_accvgpr_read_b32 v34, a66
    v_accvgpr_read_b32 v35, a67
    v_accvgpr_read_b32 v36, a68
    v_accvgpr_read_b32 v37, a69
    v_accvgpr_read_b32 v38, a70
    v_accvgpr_read_b32 v39, a71
    v_cvt_pk_bf16_f32 v40, v32, v33
    v_cvt_pk_bf16_f32 v41, v34, v35
    v_cvt_pk_bf16_f32 v42, v36, v37
    v_cvt_pk_bf16_f32 v43, v38, v39
    s_add_u32 s56, s63, 4096
    buffer_store_dwordx4 v[40:43], v16, s[24:27], s56 offen
    v_accvgpr_read_b32 v44, a72
    v_accvgpr_read_b32 v45, a73
    v_accvgpr_read_b32 v46, a74
    v_accvgpr_read_b32 v47, a75
    v_accvgpr_read_b32 v48, a76
    v_accvgpr_read_b32 v49, a77
    v_accvgpr_read_b32 v50, a78
    v_accvgpr_read_b32 v51, a79
    v_cvt_pk_bf16_f32 v52, v44, v45
    v_cvt_pk_bf16_f32 v53, v46, v47
    v_cvt_pk_bf16_f32 v54, v48, v49
    v_cvt_pk_bf16_f32 v55, v50, v51
    s_add_u32 s56, s63, 5120
    buffer_store_dwordx4 v[52:55], v16, s[24:27], s56 offen
    v_accvgpr_read_b32 v32, a96
    v_accvgpr_read_b32 v33, a97
    v_accvgpr_read_b32 v34, a98
    v_accvgpr_read_b32 v35, a99
    v_accvgpr_read_b32 v36, a100
    v_accvgpr_read_b32 v37, a101
    v_accvgpr_read_b32 v38, a102
    v_accvgpr_read_b32 v39, a103
    v_cvt_pk_bf16_f32 v40, v32, v33
    v_cvt_pk_bf16_f32 v41, v34, v35
    v_cvt_pk_bf16_f32 v42, v36, v37
    v_cvt_pk_bf16_f32 v43, v38, v39
    s_add_u32 s56, s63, 6144
    buffer_store_dwordx4 v[40:43], v16, s[24:27], s56 offen
    v_accvgpr_read_b32 v44, a104
    v_accvgpr_read_b32 v45, a105
    v_accvgpr_read_b32 v46, a106
    v_accvgpr_read_b32 v47, a107
    v_accvgpr_read_b32 v48, a108
    v_accvgpr_read_b32 v49, a109
    v_accvgpr_read_b32 v50, a110
    v_accvgpr_read_b32 v51, a111
    v_cvt_pk_bf16_f32 v52, v44, v45
    v_cvt_pk_bf16_f32 v53, v46, v47
    v_cvt_pk_bf16_f32 v54, v48, v49
    v_cvt_pk_bf16_f32 v55, v50, v51
    s_add_u32 s56, s63, 7168
    buffer_store_dwordx4 v[52:55], v16, s[24:27], s56 offen
    v_accvgpr_read_b32 v32, a16
    v_accvgpr_read_b32 v33, a17
    v_accvgpr_read_b32 v34, a18
    v_accvgpr_read_b32 v35, a19
    v_accvgpr_read_b32 v36, a20
    v_accvgpr_read_b32 v37, a21
    v_accvgpr_read_b32 v38, a22
    v_accvgpr_read_b32 v39, a23
    v_cvt_pk_bf16_f32 v40, v32, v33
    v_cvt_pk_bf16_f32 v41, v34, v35
    v_cvt_pk_bf16_f32 v42, v36, v37
    v_cvt_pk_bf16_f32 v43, v38, v39
    s_add_u32 s56, s63, 8192
    buffer_store_dwordx4 v[40:43], v16, s[24:27], s56 offen
    v_accvgpr_read_b32 v44, a24
    v_accvgpr_read_b32 v45, a25
    v_accvgpr_read_b32 v46, a26
    v_accvgpr_read_b32 v47, a27
    v_accvgpr_read_b32 v48, a28
    v_accvgpr_read_b32 v49, a29
    v_accvgpr_read_b32 v50, a30
    v_accvgpr_read_b32 v51, a31
    v_cvt_pk_bf16_f32 v52, v44, v45
    v_cvt_pk_bf16_f32 v53, v46, v47
    v_cvt_pk_bf16_f32 v54, v48, v49
    v_cvt_pk_bf16_f32 v55, v50, v51
    s_add_u32 s56, s63, 9216
    buffer_store_dwordx4 v[52:55], v16, s[24:27], s56 offen
    v_accvgpr_read_b32 v32, a48
    v_accvgpr_read_b32 v33, a49
    v_accvgpr_read_b32 v34, a50
    v_accvgpr_read_b32 v35, a51
    v_accvgpr_read_b32 v36, a52
    v_accvgpr_read_b32 v37, a53
    v_accvgpr_read_b32 v38, a54
    v_accvgpr_read_b32 v39, a55
    v_cvt_pk_bf16_f32 v40, v32, v33
    v_cvt_pk_bf16_f32 v41, v34, v35
    v_cvt_pk_bf16_f32 v42, v36, v37
    v_cvt_pk_bf16_f32 v43, v38, v39
    s_add_u32 s56, s63, 10240
    buffer_store_dwordx4 v[40:43], v16, s[24:27], s56 offen
    v_accvgpr_read_b32 v44, a56
    v_accvgpr_read_b32 v45, a57
    v_accvgpr_read_b32 v46, a58
    v_accvgpr_read_b32 v47, a59
    v_accvgpr_read_b32 v48, a60
    v_accvgpr_read_b32 v49, a61
    v_accvgpr_read_b32 v50, a62
    v_accvgpr_read_b32 v51, a63
    v_cvt_pk_bf16_f32 v52, v44, v45
    v_cvt_pk_bf16_f32 v53, v46, v47
    v_cvt_pk_bf16_f32 v54, v48, v49
    v_cvt_pk_bf16_f32 v55, v50, v51
    s_add_u32 s56, s63, 11264
    buffer_store_dwordx4 v[52:55], v16, s[24:27], s56 offen
    v_accvgpr_read_b32 v32, a80
    v_accvgpr_read_b32 v33, a81
    v_accvgpr_read_b32 v34, a82
    v_accvgpr_read_b32 v35, a83
    v_accvgpr_read_b32 v36, a84
    v_accvgpr_read_b32 v37, a85
    v_accvgpr_read_b32 v38, a86
    v_accvgpr_read_b32 v39, a87
    v_cvt_pk_bf16_f32 v40, v32, v33
    v_cvt_pk_bf16_f32 v41, v34, v35
    v_cvt_pk_bf16_f32 v42, v36, v37
    v_cvt_pk_bf16_f32 v43, v38, v39
    s_add_u32 s56, s63, 12288
    buffer_store_dwordx4 v[40:43], v16, s[24:27], s56 offen
    v_accvgpr_read_b32 v44, a88
    v_accvgpr_read_b32 v45, a89
    v_accvgpr_read_b32 v46, a90
    v_accvgpr_read_b32 v47, a91
    v_accvgpr_read_b32 v48, a92
    v_accvgpr_read_b32 v49, a93
    v_accvgpr_read_b32 v50, a94
    v_accvgpr_read_b32 v51, a95
    v_cvt_pk_bf16_f32 v52, v44, v45
    v_cvt_pk_bf16_f32 v53, v46, v47
    v_cvt_pk_bf16_f32 v54, v48, v49
    v_cvt_pk_bf16_f32 v55, v50, v51
    s_add_u32 s56, s63, 13312
    buffer_store_dwordx4 v[52:55], v16, s[24:27], s56 offen
    v_accvgpr_read_b32 v32, a112
    v_accvgpr_read_b32 v33, a113
    v_accvgpr_read_b32 v34, a114
    v_accvgpr_read_b32 v35, a115
    v_accvgpr_read_b32 v36, a116
    v_accvgpr_read_b32 v37, a117
    v_accvgpr_read_b32 v38, a118
    v_accvgpr_read_b32 v39, a119
    v_cvt_pk_bf16_f32 v40, v32, v33
    v_cvt_pk_bf16_f32 v41, v34, v35
    v_cvt_pk_bf16_f32 v42, v36, v37
    v_cvt_pk_bf16_f32 v43, v38, v39
    s_add_u32 s56, s63, 14336
    buffer_store_dwordx4 v[40:43], v16, s[24:27], s56 offen
    v_accvgpr_read_b32 v44, a120
    v_accvgpr_read_b32 v45, a121
    v_accvgpr_read_b32 v46, a122
    v_accvgpr_read_b32 v47, a123
    v_accvgpr_read_b32 v48, a124
    v_accvgpr_read_b32 v49, a125
    v_accvgpr_read_b32 v50, a126
    v_accvgpr_read_b32 v51, a127
    v_cvt_pk_bf16_f32 v52, v44, v45
    v_cvt_pk_bf16_f32 v53, v46, v47
    v_cvt_pk_bf16_f32 v54, v48, v49
    v_cvt_pk_bf16_f32 v55, v50, v51
    s_add_u32 s56, s63, 15360
    buffer_store_dwordx4 v[52:55], v16, s[24:27], s56 offen
    s_branch KT_12
G3_13:
    s_sub_u32 s6, s2, 384
    s_and_b32 s15, s6, 7
    s_mul_i32 s15, s15, 20
    s_lshr_b32 s6, s6, 3
    s_add_u32 s6, s6, s15
    s_mul_hi_u32 s16, s6, 0x33333334
    s_mul_i32 s13, s16, 5
    s_sub_u32 s17, s6, s13
    s_mul_i32 s13, s16, 20
    s_lshl_b32 s14, s17, 2
    s_add_u32 s13, s13, s14
    s_lshl_b32 s13, s13, 13
    s_add_u32 s13, s13, 0xceaf000
    v_add_u32 v17, 0x1000, v16
    s_add_u32 s14, s13, 0
    buffer_load_dwordx4 v[128:131], v16, s[24:27], s14 offen offset:0
    buffer_load_dwordx4 v[132:135], v16, s[24:27], s14 offen offset:1024
    buffer_load_dwordx4 v[136:139], v16, s[24:27], s14 offen offset:2048
    buffer_load_dwordx4 v[140:143], v16, s[24:27], s14 offen offset:3072
    buffer_load_dwordx4 v[144:147], v17, s[24:27], s14 offen offset:0
    buffer_load_dwordx4 v[148:151], v17, s[24:27], s14 offen offset:1024
    buffer_load_dwordx4 v[152:155], v17, s[24:27], s14 offen offset:2048
    buffer_load_dwordx4 v[156:159], v17, s[24:27], s14 offen offset:3072
    s_add_u32 s14, s13, 8192
    buffer_load_dwordx4 v[160:163], v16, s[24:27], s14 offen offset:0
    buffer_load_dwordx4 v[164:167], v16, s[24:27], s14 offen offset:1024
    buffer_load_dwordx4 v[168:171], v16, s[24:27], s14 offen offset:2048
    buffer_load_dwordx4 v[172:175], v16, s[24:27], s14 offen offset:3072
    buffer_load_dwordx4 v[176:179], v17, s[24:27], s14 offen offset:0
    buffer_load_dwordx4 v[180:183], v17, s[24:27], s14 offen offset:1024
    buffer_load_dwordx4 v[184:187], v17, s[24:27], s14 offen offset:2048
    buffer_load_dwordx4 v[188:191], v17, s[24:27], s14 offen offset:3072
    s_add_u32 s14, s13, 16384
    buffer_load_dwordx4 v[192:195], v16, s[24:27], s14 offen offset:0
    buffer_load_dwordx4 v[196:199], v16, s[24:27], s14 offen offset:1024
    buffer_load_dwordx4 v[200:203], v16, s[24:27], s14 offen offset:2048
    buffer_load_dwordx4 v[204:207], v16, s[24:27], s14 offen offset:3072
    buffer_load_dwordx4 v[208:211], v17, s[24:27], s14 offen offset:0
    buffer_load_dwordx4 v[212:215], v17, s[24:27], s14 offen offset:1024
    buffer_load_dwordx4 v[216:219], v17, s[24:27], s14 offen offset:2048
    buffer_load_dwordx4 v[220:223], v17, s[24:27], s14 offen offset:3072
    s_add_u32 s14, s13, 24576
    buffer_load_dwordx4 v[224:227], v16, s[24:27], s14 offen offset:0
    buffer_load_dwordx4 v[228:231], v16, s[24:27], s14 offen offset:1024
    buffer_load_dwordx4 v[232:235], v16, s[24:27], s14 offen offset:2048
    buffer_load_dwordx4 v[236:239], v16, s[24:27], s14 offen offset:3072
    buffer_load_dwordx4 v[240:243], v17, s[24:27], s14 offen offset:0
    buffer_load_dwordx4 v[244:247], v17, s[24:27], s14 offen offset:1024
    buffer_load_dwordx4 v[248:251], v17, s[24:27], s14 offen offset:2048
    buffer_load_dwordx4 v[252:255], v17, s[24:27], s14 offen offset:3072
    s_mul_i32 s18, s3, 5
    s_mul_i32 s62, s16, 20
    s_add_u32 s62, s62, s18
    s_mul_i32 s63, s62, 40960
    s_lshl_b32 s62, s62, 13
    s_add_u32 s62, s62, 0xf00000
    s_lshl_b32 s13, s17, 13
    s_add_u32 s63, s63, s13
    s_add_u32 s63, s63, 0x8cd4000
    v_add_u32 v17, 0x1000, v16
    buffer_load_dwordx4 a[128:131], v16, s[24:27], s62 offen offset:0
    buffer_load_dwordx4 a[132:135], v16, s[24:27], s62 offen offset:1024
    buffer_load_dwordx4 a[136:139], v16, s[24:27], s62 offen offset:2048
    buffer_load_dwordx4 a[140:143], v16, s[24:27], s62 offen offset:3072
    buffer_load_dwordx4 a[144:147], v17, s[24:27], s62 offen offset:0
    buffer_load_dwordx4 a[148:151], v17, s[24:27], s62 offen offset:1024
    buffer_load_dwordx4 a[152:155], v17, s[24:27], s62 offen offset:2048
    buffer_load_dwordx4 a[156:159], v17, s[24:27], s62 offen offset:3072
    s_add_u32 s62, s62, 8192
    buffer_load_dwordx4 a[160:163], v16, s[24:27], s62 offen offset:0
    buffer_load_dwordx4 a[164:167], v16, s[24:27], s62 offen offset:1024
    buffer_load_dwordx4 a[168:171], v16, s[24:27], s62 offen offset:2048
    buffer_load_dwordx4 a[172:175], v16, s[24:27], s62 offen offset:3072
    buffer_load_dwordx4 a[176:179], v17, s[24:27], s62 offen offset:0
    buffer_load_dwordx4 a[180:183], v17, s[24:27], s62 offen offset:1024
    buffer_load_dwordx4 a[184:187], v17, s[24:27], s62 offen offset:2048
    buffer_load_dwordx4 a[188:191], v17, s[24:27], s62 offen offset:3072
    s_add_u32 s62, s62, 8192
    buffer_load_dwordx4 a[192:195], v16, s[24:27], s62 offen offset:0
    buffer_load_dwordx4 a[196:199], v16, s[24:27], s62 offen offset:1024
    buffer_load_dwordx4 a[200:203], v16, s[24:27], s62 offen offset:2048
    buffer_load_dwordx4 a[204:207], v16, s[24:27], s62 offen offset:3072
    buffer_load_dwordx4 a[208:211], v17, s[24:27], s62 offen offset:0
    buffer_load_dwordx4 a[212:215], v17, s[24:27], s62 offen offset:1024
    buffer_load_dwordx4 a[216:219], v17, s[24:27], s62 offen offset:2048
    buffer_load_dwordx4 a[220:223], v17, s[24:27], s62 offen offset:3072
    s_add_u32 s62, s62, 8192
    buffer_load_dwordx4 a[224:227], v16, s[24:27], s62 offen offset:0
    buffer_load_dwordx4 a[228:231], v16, s[24:27], s62 offen offset:1024
    buffer_load_dwordx4 a[232:235], v16, s[24:27], s62 offen offset:2048
    buffer_load_dwordx4 a[236:239], v16, s[24:27], s62 offen offset:3072
    buffer_load_dwordx4 a[240:243], v17, s[24:27], s62 offen offset:0
    buffer_load_dwordx4 a[244:247], v17, s[24:27], s62 offen offset:1024
    buffer_load_dwordx4 a[248:251], v17, s[24:27], s62 offen offset:2048
    buffer_load_dwordx4 a[252:255], v17, s[24:27], s62 offen offset:3072
    s_add_u32 s62, s62, 8192
    s_waitcnt vmcnt(24)
    v_mfma_f32_32x32x16_bf16 a[0:15], v[128:131], a[128:131], 0
    v_mfma_f32_32x32x16_bf16 a[16:31], v[160:163], a[128:131], 0
    v_mfma_f32_32x32x16_bf16 a[32:47], v[192:195], a[128:131], 0
    v_mfma_f32_32x32x16_bf16 a[48:63], v[224:227], a[128:131], 0
    v_mfma_f32_32x32x16_bf16 a[0:15], v[132:135], a[132:135], a[0:15]
    v_mfma_f32_32x32x16_bf16 a[16:31], v[164:167], a[132:135], a[16:31]
    v_mfma_f32_32x32x16_bf16 a[32:47], v[196:199], a[132:135], a[32:47]
    v_mfma_f32_32x32x16_bf16 a[48:63], v[228:231], a[132:135], a[48:63]
    v_mfma_f32_32x32x16_bf16 a[0:15], v[136:139], a[136:139], a[0:15]
    v_mfma_f32_32x32x16_bf16 a[16:31], v[168:171], a[136:139], a[16:31]
    v_mfma_f32_32x32x16_bf16 a[32:47], v[200:203], a[136:139], a[32:47]
    v_mfma_f32_32x32x16_bf16 a[48:63], v[232:235], a[136:139], a[48:63]
    v_mfma_f32_32x32x16_bf16 a[0:15], v[140:143], a[140:143], a[0:15]
    v_mfma_f32_32x32x16_bf16 a[16:31], v[172:175], a[140:143], a[16:31]
    v_mfma_f32_32x32x16_bf16 a[32:47], v[204:207], a[140:143], a[32:47]
    v_mfma_f32_32x32x16_bf16 a[48:63], v[236:239], a[140:143], a[48:63]
    v_mfma_f32_32x32x16_bf16 a[0:15], v[144:147], a[144:147], a[0:15]
    v_mfma_f32_32x32x16_bf16 a[16:31], v[176:179], a[144:147], a[16:31]
    v_mfma_f32_32x32x16_bf16 a[32:47], v[208:211], a[144:147], a[32:47]
    v_mfma_f32_32x32x16_bf16 a[48:63], v[240:243], a[144:147], a[48:63]
    v_mfma_f32_32x32x16_bf16 a[0:15], v[148:151], a[148:151], a[0:15]
    v_mfma_f32_32x32x16_bf16 a[16:31], v[180:183], a[148:151], a[16:31]
    v_mfma_f32_32x32x16_bf16 a[32:47], v[212:215], a[148:151], a[32:47]
    v_mfma_f32_32x32x16_bf16 a[48:63], v[244:247], a[148:151], a[48:63]
    v_mfma_f32_32x32x16_bf16 a[0:15], v[152:155], a[152:155], a[0:15]
    v_mfma_f32_32x32x16_bf16 a[16:31], v[184:187], a[152:155], a[16:31]
    v_mfma_f32_32x32x16_bf16 a[32:47], v[216:219], a[152:155], a[32:47]
    v_mfma_f32_32x32x16_bf16 a[48:63], v[248:251], a[152:155], a[48:63]
    v_mfma_f32_32x32x16_bf16 a[0:15], v[156:159], a[156:159], a[0:15]
    v_mfma_f32_32x32x16_bf16 a[16:31], v[188:191], a[156:159], a[16:31]
    v_mfma_f32_32x32x16_bf16 a[32:47], v[220:223], a[156:159], a[32:47]
    v_mfma_f32_32x32x16_bf16 a[48:63], v[252:255], a[156:159], a[48:63]
    buffer_load_dwordx4 a[128:131], v16, s[24:27], s62 offen offset:0
    buffer_load_dwordx4 a[132:135], v16, s[24:27], s62 offen offset:1024
    buffer_load_dwordx4 a[136:139], v16, s[24:27], s62 offen offset:2048
    buffer_load_dwordx4 a[140:143], v16, s[24:27], s62 offen offset:3072
    buffer_load_dwordx4 a[144:147], v17, s[24:27], s62 offen offset:0
    buffer_load_dwordx4 a[148:151], v17, s[24:27], s62 offen offset:1024
    buffer_load_dwordx4 a[152:155], v17, s[24:27], s62 offen offset:2048
    buffer_load_dwordx4 a[156:159], v17, s[24:27], s62 offen offset:3072
    s_add_u32 s62, s62, 8192
    s_waitcnt vmcnt(24)
    v_mfma_f32_32x32x16_bf16 a[64:79], v[128:131], a[160:163], 0
    s_nop 15
    v_accvgpr_read_b32 v32, a0
    v_accvgpr_read_b32 v33, a1
    v_accvgpr_read_b32 v34, a2
    v_mfma_f32_32x32x16_bf16 a[80:95], v[160:163], a[160:163], 0
    v_accvgpr_read_b32 v35, a3
    v_accvgpr_read_b32 v36, a4
    v_accvgpr_read_b32 v37, a5
    v_accvgpr_read_b32 v38, a6
    v_mfma_f32_32x32x16_bf16 a[96:111], v[192:195], a[160:163], 0
    v_accvgpr_read_b32 v39, a7
    v_cvt_pk_bf16_f32 v40, v32, v33
    v_cvt_pk_bf16_f32 v41, v34, v35
    v_cvt_pk_bf16_f32 v42, v36, v37
    v_mfma_f32_32x32x16_bf16 a[112:127], v[224:227], a[160:163], 0
    v_cvt_pk_bf16_f32 v43, v38, v39
    s_add_u32 s56, s63, 0
    buffer_store_dwordx4 v[40:43], v16, s[24:27], s56 offen
    v_accvgpr_read_b32 v44, a8
    v_mfma_f32_32x32x16_bf16 a[64:79], v[132:135], a[164:167], a[64:79]
    v_accvgpr_read_b32 v45, a9
    v_accvgpr_read_b32 v46, a10
    v_accvgpr_read_b32 v47, a11
    v_accvgpr_read_b32 v48, a12
    v_mfma_f32_32x32x16_bf16 a[80:95], v[164:167], a[164:167], a[80:95]
    v_accvgpr_read_b32 v49, a13
    v_accvgpr_read_b32 v50, a14
    v_accvgpr_read_b32 v51, a15
    v_cvt_pk_bf16_f32 v52, v44, v45
    v_mfma_f32_32x32x16_bf16 a[96:111], v[196:199], a[164:167], a[96:111]
    v_cvt_pk_bf16_f32 v53, v46, v47
    v_cvt_pk_bf16_f32 v54, v48, v49
    v_cvt_pk_bf16_f32 v55, v50, v51
    s_add_u32 s56, s63, 1024
    v_mfma_f32_32x32x16_bf16 a[112:127], v[228:231], a[164:167], a[112:127]
    buffer_store_dwordx4 v[52:55], v16, s[24:27], s56 offen
    v_accvgpr_read_b32 v32, a16
    v_accvgpr_read_b32 v33, a17
    v_accvgpr_read_b32 v34, a18
    v_mfma_f32_32x32x16_bf16 a[64:79], v[136:139], a[168:171], a[64:79]
    v_accvgpr_read_b32 v35, a19
    v_accvgpr_read_b32 v36, a20
    v_accvgpr_read_b32 v37, a21
    v_accvgpr_read_b32 v38, a22
    v_mfma_f32_32x32x16_bf16 a[80:95], v[168:171], a[168:171], a[80:95]
    v_accvgpr_read_b32 v39, a23
    v_cvt_pk_bf16_f32 v40, v32, v33
    v_cvt_pk_bf16_f32 v41, v34, v35
    v_cvt_pk_bf16_f32 v42, v36, v37
    v_mfma_f32_32x32x16_bf16 a[96:111], v[200:203], a[168:171], a[96:111]
    v_cvt_pk_bf16_f32 v43, v38, v39
    s_add_u32 s56, s63, 2048
    buffer_store_dwordx4 v[40:43], v16, s[24:27], s56 offen
    v_accvgpr_read_b32 v44, a24
    v_mfma_f32_32x32x16_bf16 a[112:127], v[232:235], a[168:171], a[112:127]
    v_accvgpr_read_b32 v45, a25
    v_accvgpr_read_b32 v46, a26
    v_accvgpr_read_b32 v47, a27
    v_accvgpr_read_b32 v48, a28
    v_mfma_f32_32x32x16_bf16 a[64:79], v[140:143], a[172:175], a[64:79]
    v_accvgpr_read_b32 v49, a29
    v_accvgpr_read_b32 v50, a30
    v_accvgpr_read_b32 v51, a31
    v_cvt_pk_bf16_f32 v52, v44, v45
    v_mfma_f32_32x32x16_bf16 a[80:95], v[172:175], a[172:175], a[80:95]
    v_cvt_pk_bf16_f32 v53, v46, v47
    v_cvt_pk_bf16_f32 v54, v48, v49
    v_cvt_pk_bf16_f32 v55, v50, v51
    s_add_u32 s56, s63, 3072
    v_mfma_f32_32x32x16_bf16 a[96:111], v[204:207], a[172:175], a[96:111]
    buffer_store_dwordx4 v[52:55], v16, s[24:27], s56 offen
    v_accvgpr_read_b32 v32, a32
    v_accvgpr_read_b32 v33, a33
    v_accvgpr_read_b32 v34, a34
    v_mfma_f32_32x32x16_bf16 a[112:127], v[236:239], a[172:175], a[112:127]
    v_accvgpr_read_b32 v35, a35
    v_accvgpr_read_b32 v36, a36
    v_accvgpr_read_b32 v37, a37
    v_accvgpr_read_b32 v38, a38
    v_mfma_f32_32x32x16_bf16 a[64:79], v[144:147], a[176:179], a[64:79]
    v_accvgpr_read_b32 v39, a39
    v_cvt_pk_bf16_f32 v40, v32, v33
    v_cvt_pk_bf16_f32 v41, v34, v35
    v_cvt_pk_bf16_f32 v42, v36, v37
    v_mfma_f32_32x32x16_bf16 a[80:95], v[176:179], a[176:179], a[80:95]
    v_cvt_pk_bf16_f32 v43, v38, v39
    s_add_u32 s56, s63, 4096
    buffer_store_dwordx4 v[40:43], v16, s[24:27], s56 offen
    v_accvgpr_read_b32 v44, a40
    v_mfma_f32_32x32x16_bf16 a[96:111], v[208:211], a[176:179], a[96:111]
    v_accvgpr_read_b32 v45, a41
    v_accvgpr_read_b32 v46, a42
    v_accvgpr_read_b32 v47, a43
    v_accvgpr_read_b32 v48, a44
    v_mfma_f32_32x32x16_bf16 a[112:127], v[240:243], a[176:179], a[112:127]
    v_accvgpr_read_b32 v49, a45
    v_accvgpr_read_b32 v50, a46
    v_accvgpr_read_b32 v51, a47
    v_cvt_pk_bf16_f32 v52, v44, v45
    v_mfma_f32_32x32x16_bf16 a[64:79], v[148:151], a[180:183], a[64:79]
    v_cvt_pk_bf16_f32 v53, v46, v47
    v_cvt_pk_bf16_f32 v54, v48, v49
    v_cvt_pk_bf16_f32 v55, v50, v51
    s_add_u32 s56, s63, 5120
    v_mfma_f32_32x32x16_bf16 a[80:95], v[180:183], a[180:183], a[80:95]
    buffer_store_dwordx4 v[52:55], v16, s[24:27], s56 offen
    v_accvgpr_read_b32 v32, a48
    v_accvgpr_read_b32 v33, a49
    v_accvgpr_read_b32 v34, a50
    v_mfma_f32_32x32x16_bf16 a[96:111], v[212:215], a[180:183], a[96:111]
    v_accvgpr_read_b32 v35, a51
    v_accvgpr_read_b32 v36, a52
    v_accvgpr_read_b32 v37, a53
    v_accvgpr_read_b32 v38, a54
    v_mfma_f32_32x32x16_bf16 a[112:127], v[244:247], a[180:183], a[112:127]
    v_accvgpr_read_b32 v39, a55
    v_cvt_pk_bf16_f32 v40, v32, v33
    v_cvt_pk_bf16_f32 v41, v34, v35
    v_cvt_pk_bf16_f32 v42, v36, v37
    v_mfma_f32_32x32x16_bf16 a[64:79], v[152:155], a[184:187], a[64:79]
    v_cvt_pk_bf16_f32 v43, v38, v39
    s_add_u32 s56, s63, 6144
    buffer_store_dwordx4 v[40:43], v16, s[24:27], s56 offen
    v_accvgpr_read_b32 v44, a56
    v_mfma_f32_32x32x16_bf16 a[80:95], v[184:187], a[184:187], a[80:95]
    v_accvgpr_read_b32 v45, a57
    v_accvgpr_read_b32 v46, a58
    v_accvgpr_read_b32 v47, a59
    v_accvgpr_read_b32 v48, a60
    v_mfma_f32_32x32x16_bf16 a[96:111], v[216:219], a[184:187], a[96:111]
    v_accvgpr_read_b32 v49, a61
    v_accvgpr_read_b32 v50, a62
    v_accvgpr_read_b32 v51, a63
    v_cvt_pk_bf16_f32 v52, v44, v45
    v_mfma_f32_32x32x16_bf16 a[112:127], v[248:251], a[184:187], a[112:127]
    v_cvt_pk_bf16_f32 v53, v46, v47
    v_cvt_pk_bf16_f32 v54, v48, v49
    v_cvt_pk_bf16_f32 v55, v50, v51
    s_add_u32 s56, s63, 7168
    v_mfma_f32_32x32x16_bf16 a[64:79], v[156:159], a[188:191], a[64:79]
    buffer_store_dwordx4 v[52:55], v16, s[24:27], s56 offen
    s_add_u32 s63, s63, 40960
    v_mfma_f32_32x32x16_bf16 a[80:95], v[188:191], a[188:191], a[80:95]
    v_mfma_f32_32x32x16_bf16 a[96:111], v[220:223], a[188:191], a[96:111]
    v_mfma_f32_32x32x16_bf16 a[112:127], v[252:255], a[188:191], a[112:127]
    s_waitcnt vmcnt(24)
    v_mfma_f32_32x32x16_bf16 a[0:15], v[128:131], a[192:195], 0
    s_nop 15
    v_accvgpr_read_b32 v32, a64
    v_accvgpr_read_b32 v33, a65
    v_accvgpr_read_b32 v34, a66
    v_mfma_f32_32x32x16_bf16 a[16:31], v[160:163], a[192:195], 0
    v_accvgpr_read_b32 v35, a67
    v_accvgpr_read_b32 v36, a68
    v_accvgpr_read_b32 v37, a69
    v_accvgpr_read_b32 v38, a70
    v_mfma_f32_32x32x16_bf16 a[32:47], v[192:195], a[192:195], 0
    v_accvgpr_read_b32 v39, a71
    v_cvt_pk_bf16_f32 v40, v32, v33
    v_cvt_pk_bf16_f32 v41, v34, v35
    v_cvt_pk_bf16_f32 v42, v36, v37
    v_mfma_f32_32x32x16_bf16 a[48:63], v[224:227], a[192:195], 0
    v_cvt_pk_bf16_f32 v43, v38, v39
    s_add_u32 s56, s63, 0
    buffer_store_dwordx4 v[40:43], v16, s[24:27], s56 offen
    v_accvgpr_read_b32 v44, a72
    v_mfma_f32_32x32x16_bf16 a[0:15], v[132:135], a[196:199], a[0:15]
    v_accvgpr_read_b32 v45, a73
    v_accvgpr_read_b32 v46, a74
    v_accvgpr_read_b32 v47, a75
    v_accvgpr_read_b32 v48, a76
    v_mfma_f32_32x32x16_bf16 a[16:31], v[164:167], a[196:199], a[16:31]
    v_accvgpr_read_b32 v49, a77
    v_accvgpr_read_b32 v50, a78
    v_accvgpr_read_b32 v51, a79
    v_cvt_pk_bf16_f32 v52, v44, v45
    v_mfma_f32_32x32x16_bf16 a[32:47], v[196:199], a[196:199], a[32:47]
    v_cvt_pk_bf16_f32 v53, v46, v47
    v_cvt_pk_bf16_f32 v54, v48, v49
    v_cvt_pk_bf16_f32 v55, v50, v51
    s_add_u32 s56, s63, 1024
    v_mfma_f32_32x32x16_bf16 a[48:63], v[228:231], a[196:199], a[48:63]
    buffer_store_dwordx4 v[52:55], v16, s[24:27], s56 offen
    v_accvgpr_read_b32 v32, a80
    v_accvgpr_read_b32 v33, a81
    v_accvgpr_read_b32 v34, a82
    v_mfma_f32_32x32x16_bf16 a[0:15], v[136:139], a[200:203], a[0:15]
    v_accvgpr_read_b32 v35, a83
    v_accvgpr_read_b32 v36, a84
    v_accvgpr_read_b32 v37, a85
    v_accvgpr_read_b32 v38, a86
    v_mfma_f32_32x32x16_bf16 a[16:31], v[168:171], a[200:203], a[16:31]
    v_accvgpr_read_b32 v39, a87
    v_cvt_pk_bf16_f32 v40, v32, v33
    v_cvt_pk_bf16_f32 v41, v34, v35
    v_cvt_pk_bf16_f32 v42, v36, v37
    v_mfma_f32_32x32x16_bf16 a[32:47], v[200:203], a[200:203], a[32:47]
    v_cvt_pk_bf16_f32 v43, v38, v39
    s_add_u32 s56, s63, 2048
    buffer_store_dwordx4 v[40:43], v16, s[24:27], s56 offen
    v_accvgpr_read_b32 v44, a88
    v_mfma_f32_32x32x16_bf16 a[48:63], v[232:235], a[200:203], a[48:63]
    v_accvgpr_read_b32 v45, a89
    v_accvgpr_read_b32 v46, a90
    v_accvgpr_read_b32 v47, a91
    v_accvgpr_read_b32 v48, a92
    v_mfma_f32_32x32x16_bf16 a[0:15], v[140:143], a[204:207], a[0:15]
    v_accvgpr_read_b32 v49, a93
    v_accvgpr_read_b32 v50, a94
    v_accvgpr_read_b32 v51, a95
    v_cvt_pk_bf16_f32 v52, v44, v45
    v_mfma_f32_32x32x16_bf16 a[16:31], v[172:175], a[204:207], a[16:31]
    v_cvt_pk_bf16_f32 v53, v46, v47
    v_cvt_pk_bf16_f32 v54, v48, v49
    v_cvt_pk_bf16_f32 v55, v50, v51
    s_add_u32 s56, s63, 3072
    v_mfma_f32_32x32x16_bf16 a[32:47], v[204:207], a[204:207], a[32:47]
    buffer_store_dwordx4 v[52:55], v16, s[24:27], s56 offen
    v_accvgpr_read_b32 v32, a96
    v_accvgpr_read_b32 v33, a97
    v_accvgpr_read_b32 v34, a98
    v_mfma_f32_32x32x16_bf16 a[48:63], v[236:239], a[204:207], a[48:63]
    v_accvgpr_read_b32 v35, a99
    v_accvgpr_read_b32 v36, a100
    v_accvgpr_read_b32 v37, a101
    v_accvgpr_read_b32 v38, a102
    v_mfma_f32_32x32x16_bf16 a[0:15], v[144:147], a[208:211], a[0:15]
    v_accvgpr_read_b32 v39, a103
    v_cvt_pk_bf16_f32 v40, v32, v33
    v_cvt_pk_bf16_f32 v41, v34, v35
    v_cvt_pk_bf16_f32 v42, v36, v37
    v_mfma_f32_32x32x16_bf16 a[16:31], v[176:179], a[208:211], a[16:31]
    v_cvt_pk_bf16_f32 v43, v38, v39
    s_add_u32 s56, s63, 4096
    buffer_store_dwordx4 v[40:43], v16, s[24:27], s56 offen
    v_accvgpr_read_b32 v44, a104
    v_mfma_f32_32x32x16_bf16 a[32:47], v[208:211], a[208:211], a[32:47]
    v_accvgpr_read_b32 v45, a105
    v_accvgpr_read_b32 v46, a106
    v_accvgpr_read_b32 v47, a107
    v_accvgpr_read_b32 v48, a108
    v_mfma_f32_32x32x16_bf16 a[48:63], v[240:243], a[208:211], a[48:63]
    v_accvgpr_read_b32 v49, a109
    v_accvgpr_read_b32 v50, a110
    v_accvgpr_read_b32 v51, a111
    v_cvt_pk_bf16_f32 v52, v44, v45
    v_mfma_f32_32x32x16_bf16 a[0:15], v[148:151], a[212:215], a[0:15]
    v_cvt_pk_bf16_f32 v53, v46, v47
    v_cvt_pk_bf16_f32 v54, v48, v49
    v_cvt_pk_bf16_f32 v55, v50, v51
    s_add_u32 s56, s63, 5120
    v_mfma_f32_32x32x16_bf16 a[16:31], v[180:183], a[212:215], a[16:31]
    buffer_store_dwordx4 v[52:55], v16, s[24:27], s56 offen
    v_accvgpr_read_b32 v32, a112
    v_accvgpr_read_b32 v33, a113
    v_accvgpr_read_b32 v34, a114
    v_mfma_f32_32x32x16_bf16 a[32:47], v[212:215], a[212:215], a[32:47]
    v_accvgpr_read_b32 v35, a115
    v_accvgpr_read_b32 v36, a116
    v_accvgpr_read_b32 v37, a117
    v_accvgpr_read_b32 v38, a118
    v_mfma_f32_32x32x16_bf16 a[48:63], v[244:247], a[212:215], a[48:63]
    v_accvgpr_read_b32 v39, a119
    v_cvt_pk_bf16_f32 v40, v32, v33
    v_cvt_pk_bf16_f32 v41, v34, v35
    v_cvt_pk_bf16_f32 v42, v36, v37
    v_mfma_f32_32x32x16_bf16 a[0:15], v[152:155], a[216:219], a[0:15]
    v_cvt_pk_bf16_f32 v43, v38, v39
    s_add_u32 s56, s63, 6144
    buffer_store_dwordx4 v[40:43], v16, s[24:27], s56 offen
    v_accvgpr_read_b32 v44, a120
    v_mfma_f32_32x32x16_bf16 a[16:31], v[184:187], a[216:219], a[16:31]
    v_accvgpr_read_b32 v45, a121
    v_accvgpr_read_b32 v46, a122
    v_accvgpr_read_b32 v47, a123
    v_accvgpr_read_b32 v48, a124
    v_mfma_f32_32x32x16_bf16 a[32:47], v[216:219], a[216:219], a[32:47]
    v_accvgpr_read_b32 v49, a125
    v_accvgpr_read_b32 v50, a126
    v_accvgpr_read_b32 v51, a127
    v_cvt_pk_bf16_f32 v52, v44, v45
    v_mfma_f32_32x32x16_bf16 a[48:63], v[248:251], a[216:219], a[48:63]
    v_cvt_pk_bf16_f32 v53, v46, v47
    v_cvt_pk_bf16_f32 v54, v48, v49
    v_cvt_pk_bf16_f32 v55, v50, v51
    s_add_u32 s56, s63, 7168
    v_mfma_f32_32x32x16_bf16 a[0:15], v[156:159], a[220:223], a[0:15]
    buffer_store_dwordx4 v[52:55], v16, s[24:27], s56 offen
    s_add_u32 s63, s63, 40960
    v_mfma_f32_32x32x16_bf16 a[16:31], v[188:191], a[220:223], a[16:31]
    v_mfma_f32_32x32x16_bf16 a[32:47], v[220:223], a[220:223], a[32:47]
    v_mfma_f32_32x32x16_bf16 a[48:63], v[252:255], a[220:223], a[48:63]
    s_waitcnt vmcnt(24)
    v_mfma_f32_32x32x16_bf16 a[64:79], v[128:131], a[224:227], 0
    s_nop 15
    v_accvgpr_read_b32 v32, a0
    v_accvgpr_read_b32 v33, a1
    v_accvgpr_read_b32 v34, a2
    v_mfma_f32_32x32x16_bf16 a[80:95], v[160:163], a[224:227], 0
    v_accvgpr_read_b32 v35, a3
    v_accvgpr_read_b32 v36, a4
    v_accvgpr_read_b32 v37, a5
    v_accvgpr_read_b32 v38, a6
    v_mfma_f32_32x32x16_bf16 a[96:111], v[192:195], a[224:227], 0
    v_accvgpr_read_b32 v39, a7
    v_cvt_pk_bf16_f32 v40, v32, v33
    v_cvt_pk_bf16_f32 v41, v34, v35
    v_cvt_pk_bf16_f32 v42, v36, v37
    v_mfma_f32_32x32x16_bf16 a[112:127], v[224:227], a[224:227], 0
    v_cvt_pk_bf16_f32 v43, v38, v39
    s_add_u32 s56, s63, 0
    buffer_store_dwordx4 v[40:43], v16, s[24:27], s56 offen
    v_accvgpr_read_b32 v44, a8
    v_mfma_f32_32x32x16_bf16 a[64:79], v[132:135], a[228:231], a[64:79]
    v_accvgpr_read_b32 v45, a9
    v_accvgpr_read_b32 v46, a10
    v_accvgpr_read_b32 v47, a11
    v_accvgpr_read_b32 v48, a12
    v_mfma_f32_32x32x16_bf16 a[80:95], v[164:167], a[228:231], a[80:95]
    v_accvgpr_read_b32 v49, a13
    v_accvgpr_read_b32 v50, a14
    v_accvgpr_read_b32 v51, a15
    v_cvt_pk_bf16_f32 v52, v44, v45
    v_mfma_f32_32x32x16_bf16 a[96:111], v[196:199], a[228:231], a[96:111]
    v_cvt_pk_bf16_f32 v53, v46, v47
    v_cvt_pk_bf16_f32 v54, v48, v49
    v_cvt_pk_bf16_f32 v55, v50, v51
    s_add_u32 s56, s63, 1024
    v_mfma_f32_32x32x16_bf16 a[112:127], v[228:231], a[228:231], a[112:127]
    buffer_store_dwordx4 v[52:55], v16, s[24:27], s56 offen
    v_accvgpr_read_b32 v32, a16
    v_accvgpr_read_b32 v33, a17
    v_accvgpr_read_b32 v34, a18
    v_mfma_f32_32x32x16_bf16 a[64:79], v[136:139], a[232:235], a[64:79]
    v_accvgpr_read_b32 v35, a19
    v_accvgpr_read_b32 v36, a20
    v_accvgpr_read_b32 v37, a21
    v_accvgpr_read_b32 v38, a22
    v_mfma_f32_32x32x16_bf16 a[80:95], v[168:171], a[232:235], a[80:95]
    v_accvgpr_read_b32 v39, a23
    v_cvt_pk_bf16_f32 v40, v32, v33
    v_cvt_pk_bf16_f32 v41, v34, v35
    v_cvt_pk_bf16_f32 v42, v36, v37
    v_mfma_f32_32x32x16_bf16 a[96:111], v[200:203], a[232:235], a[96:111]
    v_cvt_pk_bf16_f32 v43, v38, v39
    s_add_u32 s56, s63, 2048
    buffer_store_dwordx4 v[40:43], v16, s[24:27], s56 offen
    v_accvgpr_read_b32 v44, a24
    v_mfma_f32_32x32x16_bf16 a[112:127], v[232:235], a[232:235], a[112:127]
    v_accvgpr_read_b32 v45, a25
    v_accvgpr_read_b32 v46, a26
    v_accvgpr_read_b32 v47, a27
    v_accvgpr_read_b32 v48, a28
    v_mfma_f32_32x32x16_bf16 a[64:79], v[140:143], a[236:239], a[64:79]
    v_accvgpr_read_b32 v49, a29
    v_accvgpr_read_b32 v50, a30
    v_accvgpr_read_b32 v51, a31
    v_cvt_pk_bf16_f32 v52, v44, v45
    v_mfma_f32_32x32x16_bf16 a[80:95], v[172:175], a[236:239], a[80:95]
    v_cvt_pk_bf16_f32 v53, v46, v47
    v_cvt_pk_bf16_f32 v54, v48, v49
    v_cvt_pk_bf16_f32 v55, v50, v51
    s_add_u32 s56, s63, 3072
    v_mfma_f32_32x32x16_bf16 a[96:111], v[204:207], a[236:239], a[96:111]
    buffer_store_dwordx4 v[52:55], v16, s[24:27], s56 offen
    v_accvgpr_read_b32 v32, a32
    v_accvgpr_read_b32 v33, a33
    v_accvgpr_read_b32 v34, a34
    v_mfma_f32_32x32x16_bf16 a[112:127], v[236:239], a[236:239], a[112:127]
    v_accvgpr_read_b32 v35, a35
    v_accvgpr_read_b32 v36, a36
    v_accvgpr_read_b32 v37, a37
    v_accvgpr_read_b32 v38, a38
    v_mfma_f32_32x32x16_bf16 a[64:79], v[144:147], a[240:243], a[64:79]
    v_accvgpr_read_b32 v39, a39
    v_cvt_pk_bf16_f32 v40, v32, v33
    v_cvt_pk_bf16_f32 v41, v34, v35
    v_cvt_pk_bf16_f32 v42, v36, v37
    v_mfma_f32_32x32x16_bf16 a[80:95], v[176:179], a[240:243], a[80:95]
    v_cvt_pk_bf16_f32 v43, v38, v39
    s_add_u32 s56, s63, 4096
    buffer_store_dwordx4 v[40:43], v16, s[24:27], s56 offen
    v_accvgpr_read_b32 v44, a40
    v_mfma_f32_32x32x16_bf16 a[96:111], v[208:211], a[240:243], a[96:111]
    v_accvgpr_read_b32 v45, a41
    v_accvgpr_read_b32 v46, a42
    v_accvgpr_read_b32 v47, a43
    v_accvgpr_read_b32 v48, a44
    v_mfma_f32_32x32x16_bf16 a[112:127], v[240:243], a[240:243], a[112:127]
    v_accvgpr_read_b32 v49, a45
    v_accvgpr_read_b32 v50, a46
    v_accvgpr_read_b32 v51, a47
    v_cvt_pk_bf16_f32 v52, v44, v45
    v_mfma_f32_32x32x16_bf16 a[64:79], v[148:151], a[244:247], a[64:79]
    v_cvt_pk_bf16_f32 v53, v46, v47
    v_cvt_pk_bf16_f32 v54, v48, v49
    v_cvt_pk_bf16_f32 v55, v50, v51
    s_add_u32 s56, s63, 5120
    v_mfma_f32_32x32x16_bf16 a[80:95], v[180:183], a[244:247], a[80:95]
    buffer_store_dwordx4 v[52:55], v16, s[24:27], s56 offen
    v_accvgpr_read_b32 v32, a48
    v_accvgpr_read_b32 v33, a49
    v_accvgpr_read_b32 v34, a50
    v_mfma_f32_32x32x16_bf16 a[96:111], v[212:215], a[244:247], a[96:111]
    v_accvgpr_read_b32 v35, a51
    v_accvgpr_read_b32 v36, a52
    v_accvgpr_read_b32 v37, a53
    v_accvgpr_read_b32 v38, a54
    v_mfma_f32_32x32x16_bf16 a[112:127], v[244:247], a[244:247], a[112:127]
    v_accvgpr_read_b32 v39, a55
    v_cvt_pk_bf16_f32 v40, v32, v33
    v_cvt_pk_bf16_f32 v41, v34, v35
    v_cvt_pk_bf16_f32 v42, v36, v37
    v_mfma_f32_32x32x16_bf16 a[64:79], v[152:155], a[248:251], a[64:79]
    v_cvt_pk_bf16_f32 v43, v38, v39
    s_add_u32 s56, s63, 6144
    buffer_store_dwordx4 v[40:43], v16, s[24:27], s56 offen
    v_accvgpr_read_b32 v44, a56
    v_mfma_f32_32x32x16_bf16 a[80:95], v[184:187], a[248:251], a[80:95]
    v_accvgpr_read_b32 v45, a57
    v_accvgpr_read_b32 v46, a58
    v_accvgpr_read_b32 v47, a59
    v_accvgpr_read_b32 v48, a60
    v_mfma_f32_32x32x16_bf16 a[96:111], v[216:219], a[248:251], a[96:111]
    v_accvgpr_read_b32 v49, a61
    v_accvgpr_read_b32 v50, a62
    v_accvgpr_read_b32 v51, a63
    v_cvt_pk_bf16_f32 v52, v44, v45
    v_mfma_f32_32x32x16_bf16 a[112:127], v[248:251], a[248:251], a[112:127]
    v_cvt_pk_bf16_f32 v53, v46, v47
    v_cvt_pk_bf16_f32 v54, v48, v49
    v_cvt_pk_bf16_f32 v55, v50, v51
    s_add_u32 s56, s63, 7168
    v_mfma_f32_32x32x16_bf16 a[64:79], v[156:159], a[252:255], a[64:79]
    buffer_store_dwordx4 v[52:55], v16, s[24:27], s56 offen
    s_add_u32 s63, s63, 40960
    v_mfma_f32_32x32x16_bf16 a[80:95], v[188:191], a[252:255], a[80:95]
    v_mfma_f32_32x32x16_bf16 a[96:111], v[220:223], a[252:255], a[96:111]
    v_mfma_f32_32x32x16_bf16 a[112:127], v[252:255], a[252:255], a[112:127]
    s_waitcnt vmcnt(24)
    v_mfma_f32_32x32x16_bf16 a[0:15], v[128:131], a[128:131], 0
    s_nop 15
    v_accvgpr_read_b32 v32, a64
    v_accvgpr_read_b32 v33, a65
    v_accvgpr_read_b32 v34, a66
    v_mfma_f32_32x32x16_bf16 a[16:31], v[160:163], a[128:131], 0
    v_accvgpr_read_b32 v35, a67
    v_accvgpr_read_b32 v36, a68
    v_accvgpr_read_b32 v37, a69
    v_accvgpr_read_b32 v38, a70
    v_mfma_f32_32x32x16_bf16 a[32:47], v[192:195], a[128:131], 0
    v_accvgpr_read_b32 v39, a71
    v_cvt_pk_bf16_f32 v40, v32, v33
    v_cvt_pk_bf16_f32 v41, v34, v35
    v_cvt_pk_bf16_f32 v42, v36, v37
    v_mfma_f32_32x32x16_bf16 a[48:63], v[224:227], a[128:131], 0
    v_cvt_pk_bf16_f32 v43, v38, v39
    s_add_u32 s56, s63, 0
    buffer_store_dwordx4 v[40:43], v16, s[24:27], s56 offen
    v_accvgpr_read_b32 v44, a72
    v_mfma_f32_32x32x16_bf16 a[0:15], v[132:135], a[132:135], a[0:15]
    v_accvgpr_read_b32 v45, a73
    v_accvgpr_read_b32 v46, a74
    v_accvgpr_read_b32 v47, a75
    v_accvgpr_read_b32 v48, a76
    v_mfma_f32_32x32x16_bf16 a[16:31], v[164:167], a[132:135], a[16:31]
    v_accvgpr_read_b32 v49, a77
    v_accvgpr_read_b32 v50, a78
    v_accvgpr_read_b32 v51, a79
    v_cvt_pk_bf16_f32 v52, v44, v45
    v_mfma_f32_32x32x16_bf16 a[32:47], v[196:199], a[132:135], a[32:47]
    v_cvt_pk_bf16_f32 v53, v46, v47
    v_cvt_pk_bf16_f32 v54, v48, v49
    v_cvt_pk_bf16_f32 v55, v50, v51
    s_add_u32 s56, s63, 1024
    v_mfma_f32_32x32x16_bf16 a[48:63], v[228:231], a[132:135], a[48:63]
    buffer_store_dwordx4 v[52:55], v16, s[24:27], s56 offen
    v_accvgpr_read_b32 v32, a80
    v_accvgpr_read_b32 v33, a81
    v_accvgpr_read_b32 v34, a82
    v_mfma_f32_32x32x16_bf16 a[0:15], v[136:139], a[136:139], a[0:15]
    v_accvgpr_read_b32 v35, a83
    v_accvgpr_read_b32 v36, a84
    v_accvgpr_read_b32 v37, a85
    v_accvgpr_read_b32 v38, a86
    v_mfma_f32_32x32x16_bf16 a[16:31], v[168:171], a[136:139], a[16:31]
    v_accvgpr_read_b32 v39, a87
    v_cvt_pk_bf16_f32 v40, v32, v33
    v_cvt_pk_bf16_f32 v41, v34, v35
    v_cvt_pk_bf16_f32 v42, v36, v37
    v_mfma_f32_32x32x16_bf16 a[32:47], v[200:203], a[136:139], a[32:47]
    v_cvt_pk_bf16_f32 v43, v38, v39
    s_add_u32 s56, s63, 2048
    buffer_store_dwordx4 v[40:43], v16, s[24:27], s56 offen
    v_accvgpr_read_b32 v44, a88
    v_mfma_f32_32x32x16_bf16 a[48:63], v[232:235], a[136:139], a[48:63]
    v_accvgpr_read_b32 v45, a89
    v_accvgpr_read_b32 v46, a90
    v_accvgpr_read_b32 v47, a91
    v_accvgpr_read_b32 v48, a92
    v_mfma_f32_32x32x16_bf16 a[0:15], v[140:143], a[140:143], a[0:15]
    v_accvgpr_read_b32 v49, a93
    v_accvgpr_read_b32 v50, a94
    v_accvgpr_read_b32 v51, a95
    v_cvt_pk_bf16_f32 v52, v44, v45
    v_mfma_f32_32x32x16_bf16 a[16:31], v[172:175], a[140:143], a[16:31]
    v_cvt_pk_bf16_f32 v53, v46, v47
    v_cvt_pk_bf16_f32 v54, v48, v49
    v_cvt_pk_bf16_f32 v55, v50, v51
    s_add_u32 s56, s63, 3072
    v_mfma_f32_32x32x16_bf16 a[32:47], v[204:207], a[140:143], a[32:47]
    buffer_store_dwordx4 v[52:55], v16, s[24:27], s56 offen
    v_accvgpr_read_b32 v32, a96
    v_accvgpr_read_b32 v33, a97
    v_accvgpr_read_b32 v34, a98
    v_mfma_f32_32x32x16_bf16 a[48:63], v[236:239], a[140:143], a[48:63]
    v_accvgpr_read_b32 v35, a99
    v_accvgpr_read_b32 v36, a100
    v_accvgpr_read_b32 v37, a101
    v_accvgpr_read_b32 v38, a102
    v_mfma_f32_32x32x16_bf16 a[0:15], v[144:147], a[144:147], a[0:15]
    v_accvgpr_read_b32 v39, a103
    v_cvt_pk_bf16_f32 v40, v32, v33
    v_cvt_pk_bf16_f32 v41, v34, v35
    v_cvt_pk_bf16_f32 v42, v36, v37
    v_mfma_f32_32x32x16_bf16 a[16:31], v[176:179], a[144:147], a[16:31]
    v_cvt_pk_bf16_f32 v43, v38, v39
    s_add_u32 s56, s63, 4096
    buffer_store_dwordx4 v[40:43], v16, s[24:27], s56 offen
    v_accvgpr_read_b32 v44, a104
    v_mfma_f32_32x32x16_bf16 a[32:47], v[208:211], a[144:147], a[32:47]
    v_accvgpr_read_b32 v45, a105
    v_accvgpr_read_b32 v46, a106
    v_accvgpr_read_b32 v47, a107
    v_accvgpr_read_b32 v48, a108
    v_mfma_f32_32x32x16_bf16 a[48:63], v[240:243], a[144:147], a[48:63]
    v_accvgpr_read_b32 v49, a109
    v_accvgpr_read_b32 v50, a110
    v_accvgpr_read_b32 v51, a111
    v_cvt_pk_bf16_f32 v52, v44, v45
    v_mfma_f32_32x32x16_bf16 a[0:15], v[148:151], a[148:151], a[0:15]
    v_cvt_pk_bf16_f32 v53, v46, v47
    v_cvt_pk_bf16_f32 v54, v48, v49
    v_cvt_pk_bf16_f32 v55, v50, v51
    s_add_u32 s56, s63, 5120
    v_mfma_f32_32x32x16_bf16 a[16:31], v[180:183], a[148:151], a[16:31]
    buffer_store_dwordx4 v[52:55], v16, s[24:27], s56 offen
    v_accvgpr_read_b32 v32, a112
    v_accvgpr_read_b32 v33, a113
    v_accvgpr_read_b32 v34, a114
    v_mfma_f32_32x32x16_bf16 a[32:47], v[212:215], a[148:151], a[32:47]
    v_accvgpr_read_b32 v35, a115
    v_accvgpr_read_b32 v36, a116
    v_accvgpr_read_b32 v37, a117
    v_accvgpr_read_b32 v38, a118
    v_mfma_f32_32x32x16_bf16 a[48:63], v[244:247], a[148:151], a[48:63]
    v_accvgpr_read_b32 v39, a119
    v_cvt_pk_bf16_f32 v40, v32, v33
    v_cvt_pk_bf16_f32 v41, v34, v35
    v_cvt_pk_bf16_f32 v42, v36, v37
    v_mfma_f32_32x32x16_bf16 a[0:15], v[152:155], a[152:155], a[0:15]
    v_cvt_pk_bf16_f32 v43, v38, v39
    s_add_u32 s56, s63, 6144
    buffer_store_dwordx4 v[40:43], v16, s[24:27], s56 offen
    v_accvgpr_read_b32 v44, a120
    v_mfma_f32_32x32x16_bf16 a[16:31], v[184:187], a[152:155], a[16:31]
    v_accvgpr_read_b32 v45, a121
    v_accvgpr_read_b32 v46, a122
    v_accvgpr_read_b32 v47, a123
    v_accvgpr_read_b32 v48, a124
    v_mfma_f32_32x32x16_bf16 a[32:47], v[216:219], a[152:155], a[32:47]
    v_accvgpr_read_b32 v49, a125
    v_accvgpr_read_b32 v50, a126
    v_accvgpr_read_b32 v51, a127
    v_cvt_pk_bf16_f32 v52, v44, v45
    v_mfma_f32_32x32x16_bf16 a[48:63], v[248:251], a[152:155], a[48:63]
    v_cvt_pk_bf16_f32 v53, v46, v47
    v_cvt_pk_bf16_f32 v54, v48, v49
    v_cvt_pk_bf16_f32 v55, v50, v51
    s_add_u32 s56, s63, 7168
    v_mfma_f32_32x32x16_bf16 a[0:15], v[156:159], a[156:159], a[0:15]
    buffer_store_dwordx4 v[52:55], v16, s[24:27], s56 offen
    s_add_u32 s63, s63, 40960
    v_mfma_f32_32x32x16_bf16 a[16:31], v[188:191], a[156:159], a[16:31]
    v_mfma_f32_32x32x16_bf16 a[32:47], v[220:223], a[156:159], a[32:47]
    v_mfma_f32_32x32x16_bf16 a[48:63], v[252:255], a[156:159], a[48:63]
    s_nop 15
    v_accvgpr_read_b32 v32, a0
    v_accvgpr_read_b32 v33, a1
    v_accvgpr_read_b32 v34, a2
    v_accvgpr_read_b32 v35, a3
    v_accvgpr_read_b32 v36, a4
    v_accvgpr_read_b32 v37, a5
    v_accvgpr_read_b32 v38, a6
    v_accvgpr_read_b32 v39, a7
    v_cvt_pk_bf16_f32 v40, v32, v33
    v_cvt_pk_bf16_f32 v41, v34, v35
    v_cvt_pk_bf16_f32 v42, v36, v37
    v_cvt_pk_bf16_f32 v43, v38, v39
    s_add_u32 s56, s63, 0
    buffer_store_dwordx4 v[40:43], v16, s[24:27], s56 offen
    v_accvgpr_read_b32 v44, a8
    v_accvgpr_read_b32 v45, a9
    v_accvgpr_read_b32 v46, a10
    v_accvgpr_read_b32 v47, a11
    v_accvgpr_read_b32 v48, a12
    v_accvgpr_read_b32 v49, a13
    v_accvgpr_read_b32 v50, a14
    v_accvgpr_read_b32 v51, a15
    v_cvt_pk_bf16_f32 v52, v44, v45
    v_cvt_pk_bf16_f32 v53, v46, v47
    v_cvt_pk_bf16_f32 v54, v48, v49
    v_cvt_pk_bf16_f32 v55, v50, v51
    s_add_u32 s56, s63, 1024
    buffer_store_dwordx4 v[52:55], v16, s[24:27], s56 offen
    v_accvgpr_read_b32 v32, a16
    v_accvgpr_read_b32 v33, a17
    v_accvgpr_read_b32 v34, a18
    v_accvgpr_read_b32 v35, a19
    v_accvgpr_read_b32 v36, a20
    v_accvgpr_read_b32 v37, a21
    v_accvgpr_read_b32 v38, a22
    v_accvgpr_read_b32 v39, a23
    v_cvt_pk_bf16_f32 v40, v32, v33
    v_cvt_pk_bf16_f32 v41, v34, v35
    v_cvt_pk_bf16_f32 v42, v36, v37
    v_cvt_pk_bf16_f32 v43, v38, v39
    s_add_u32 s56, s63, 2048
    buffer_store_dwordx4 v[40:43], v16, s[24:27], s56 offen
    v_accvgpr_read_b32 v44, a24
    v_accvgpr_read_b32 v45, a25
    v_accvgpr_read_b32 v46, a26
    v_accvgpr_read_b32 v47, a27
    v_accvgpr_read_b32 v48, a28
    v_accvgpr_read_b32 v49, a29
    v_accvgpr_read_b32 v50, a30
    v_accvgpr_read_b32 v51, a31
    v_cvt_pk_bf16_f32 v52, v44, v45
    v_cvt_pk_bf16_f32 v53, v46, v47
    v_cvt_pk_bf16_f32 v54, v48, v49
    v_cvt_pk_bf16_f32 v55, v50, v51
    s_add_u32 s56, s63, 3072
    buffer_store_dwordx4 v[52:55], v16, s[24:27], s56 offen
    v_accvgpr_read_b32 v32, a32
    v_accvgpr_read_b32 v33, a33
    v_accvgpr_read_b32 v34, a34
    v_accvgpr_read_b32 v35, a35
    v_accvgpr_read_b32 v36, a36
    v_accvgpr_read_b32 v37, a37
    v_accvgpr_read_b32 v38, a38
    v_accvgpr_read_b32 v39, a39
    v_cvt_pk_bf16_f32 v40, v32, v33
    v_cvt_pk_bf16_f32 v41, v34, v35
    v_cvt_pk_bf16_f32 v42, v36, v37
    v_cvt_pk_bf16_f32 v43, v38, v39
    s_add_u32 s56, s63, 4096
    buffer_store_dwordx4 v[40:43], v16, s[24:27], s56 offen
    v_accvgpr_read_b32 v44, a40
    v_accvgpr_read_b32 v45, a41
    v_accvgpr_read_b32 v46, a42
    v_accvgpr_read_b32 v47, a43
    v_accvgpr_read_b32 v48, a44
    v_accvgpr_read_b32 v49, a45
    v_accvgpr_read_b32 v50, a46
    v_accvgpr_read_b32 v51, a47
    v_cvt_pk_bf16_f32 v52, v44, v45
    v_cvt_pk_bf16_f32 v53, v46, v47
    v_cvt_pk_bf16_f32 v54, v48, v49
    v_cvt_pk_bf16_f32 v55, v50, v51
    s_add_u32 s56, s63, 5120
    buffer_store_dwordx4 v[52:55], v16, s[24:27], s56 offen
    v_accvgpr_read_b32 v32, a48
    v_accvgpr_read_b32 v33, a49
    v_accvgpr_read_b32 v34, a50
    v_accvgpr_read_b32 v35, a51
    v_accvgpr_read_b32 v36, a52
    v_accvgpr_read_b32 v37, a53
    v_accvgpr_read_b32 v38, a54
    v_accvgpr_read_b32 v39, a55
    v_cvt_pk_bf16_f32 v40, v32, v33
    v_cvt_pk_bf16_f32 v41, v34, v35
    v_cvt_pk_bf16_f32 v42, v36, v37
    v_cvt_pk_bf16_f32 v43, v38, v39
    s_add_u32 s56, s63, 6144
    buffer_store_dwordx4 v[40:43], v16, s[24:27], s56 offen
    v_accvgpr_read_b32 v44, a56
    v_accvgpr_read_b32 v45, a57
    v_accvgpr_read_b32 v46, a58
    v_accvgpr_read_b32 v47, a59
    v_accvgpr_read_b32 v48, a60
    v_accvgpr_read_b32 v49, a61
    v_accvgpr_read_b32 v50, a62
    v_accvgpr_read_b32 v51, a63
    v_cvt_pk_bf16_f32 v52, v44, v45
    v_cvt_pk_bf16_f32 v53, v46, v47
    v_cvt_pk_bf16_f32 v54, v48, v49
    v_cvt_pk_bf16_f32 v55, v50, v51
    s_add_u32 s56, s63, 7168
    buffer_store_dwordx4 v[52:55], v16, s[24:27], s56 offen
    s_add_u32 s63, s63, 40960
    s_branch KT_12
KT_12:
    s_cmp_lg_u32 s99, 0
    s_cbranch_scc1 END_11
    s_mov_b32 s99, 1
    s_add_u32 s2, s2, 80
    s_waitcnt vmcnt(0)
    s_branch G3_13
END_11:
    s_endpgm
.globl rec_kernel
.p2align 8
.type rec_kernel,@function
rec_kernel:
    s_load_dwordx2 s[4:5], s[0:1], 104
    v_lshrrev_b32 v1, 6, v0
    v_and_b32 v2, 63, v0
    v_readfirstlane_b32 s3, v1
    s_mov_b32 s36, 0
    s_cmp_ge_u32 s2, 256
    s_cbranch_scc1 END_22
    s_waitcnt lgkmcnt(0)
    s_mov_b32 s24, s4
    s_and_b32 s25, s5, 0xffff
    s_mov_b32 s26, 0x10000000
    s_mov_b32 s27, 0x00020000
    s_cmp_ge_u32 s2, 112
    s_cbranch_scc1 BG_23
    v_and_b32 v144, 31, v2
    v_lshlrev_b32 v144, 2, v144
    v_and_b32 v3, 15, v2
    v_lshrrev_b32 v4, 4, v2
    v_and_b32 v5, 7, v2
    v_mov_b32 v31, 0x7fc07fc0
    v_mov_b32 v30, 0
    s_mul_i32 s6, s3, 160
    v_add_u32 v10, s6, v2
    v_add_u32 v11, 64, v10
    v_and_b32 v12, 31, v2
    v_add_u32 v12, s6, v12
    v_add_u32 v12, 0x80, v12
    v_lshlrev_b32 v10, 4, v10
    v_lshlrev_b32 v11, 4, v11
    v_lshlrev_b32 v12, 4, v12
    v_lshlrev_b32 v14, 7, v4
    v_lshl_add_u32 v14, v5, 4, v14
    s_and_b32 s37, s2, 3
    s_mov_b32 s20, 0xa5d4000
    s_mov_b32 s21, 0
    s_cmp_ge_u32 s2, 32
    s_cbranch_scc1 COL_21
    v_bfe_u32 v6, v3, 2, 1
    v_lshlrev_b32 v6, 3, v6
    v_bfe_u32 v7, v3, 3, 1
    v_lshl_add_u32 v6, v7, 2, v6
    v_and_b32 v7, 3, v3
    v_add_u32 v6, v6, v7
    v_and_b32 v7, 1, v4
    v_lshl_add_u32 v6, v7, 5, v6
    v_lshlrev_b32 v6, 4, v6
    v_lshrrev_b32 v7, 1, v4
    v_lshl_add_u32 v181, v7, 10, v6
    s_lshl_b32 s7, s2, 2
    s_add_u32 s7, s7, s3
    s_mul_i32 s7, s7, 40960
    s_add_u32 s7, s7, 0x0
    s_add_u32 s8, s7, 0
    buffer_load_dwordx4 a[0:3], v181, s[24:27], s8 offen
    s_add_u32 s8, s7, 2048
    buffer_load_dwordx4 a[4:7], v181, s[24:27], s8 offen
    s_add_u32 s8, s7, 4096
    buffer_load_dwordx4 a[8:11], v181, s[24:27], s8 offen
    s_add_u32 s8, s7, 6144
    buffer_load_dwordx4 a[12:15], v181, s[24:27], s8 offen
    s_add_u32 s8, s7, 8192
    buffer_load_dwordx4 a[16:19], v181, s[24:27], s8 offen
    s_add_u32 s8, s7, 10240
    buffer_load_dwordx4 a[20:23], v181, s[24:27], s8 offen
    s_add_u32 s8, s7, 12288
    buffer_load_dwordx4 a[24:27], v181, s[24:27], s8 offen
    s_add_u32 s8, s7, 14336
    buffer_load_dwordx4 a[28:31], v181, s[24:27], s8 offen
    s_add_u32 s8, s7, 16384
    buffer_load_dwordx4 a[32:35], v181, s[24:27], s8 offen
    s_add_u32 s8, s7, 18432
    buffer_load_dwordx4 a[36:39], v181, s[24:27], s8 offen
    s_add_u32 s8, s7, 20480
    buffer_load_dwordx4 a[40:43], v181, s[24:27], s8 offen
    s_add_u32 s8, s7, 22528
    buffer_load_dwordx4 a[44:47], v181, s[24:27], s8 offen
    s_add_u32 s8, s7, 24576
    buffer_load_dwordx4 a[48:51], v181, s[24:27], s8 offen
    s_add_u32 s8, s7, 26624
    buffer_load_dwordx4 a[52:55], v181, s[24:27], s8 offen
    s_add_u32 s8, s7, 28672
    buffer_load_dwordx4 a[56:59], v181, s[24:27], s8 offen
    s_add_u32 s8, s7, 30720
    buffer_load_dwordx4 a[60:63], v181, s[24:27], s8 offen
    s_add_u32 s8, s7, 32768
    buffer_load_dwordx4 a[64:67], v181, s[24:27], s8 offen
    s_add_u32 s8, s7, 34816
    buffer_load_dwordx4 a[68:71], v181, s[24:27], s8 offen
    s_add_u32 s8, s7, 36864
    buffer_load_dwordx4 a[72:75], v181, s[24:27], s8 offen
    s_add_u32 s8, s7, 38912
    buffer_load_dwordx4 a[76:79], v181, s[24:27], s8 offen
    s_add_u32 s8, s7, 256
    buffer_load_dwordx4 a[80:83], v181, s[24:27], s8 offen
    s_add_u32 s8, s7, 2304
    buffer_load_dwordx4 a[84:87], v181, s[24:27], s8 offen
    s_add_u32 s8, s7, 4352
    buffer_load_dwordx4 a[88:91], v181, s[24:27], s8 offen
    s_add_u32 s8, s7, 6400
    buffer_load_dwordx4 a[92:95], v181, s[24:27], s8 offen
    s_add_u32 s8, s7, 8448
    buffer_load_dwordx4 a[96:99], v181, s[24:27], s8 offen
    s_add_u32 s8, s7, 10496
    buffer_load_dwordx4 a[100:103], v181, s[24:27], s8 offen
    s_add_u32 s8, s7, 12544
    buffer_load_dwordx4 a[104:107], v181, s[24:27], s8 offen
    s_add_u32 s8, s7, 14592
    buffer_load_dwordx4 a[108:111], v181, s[24:27], s8 offen
    s_add_u32 s8, s7, 16640
    buffer_load_dwordx4 a[112:115], v181, s[24:27], s8 offen
    s_add_u32 s8, s7, 18688
    buffer_load_dwordx4 a[116:119], v181, s[24:27], s8 offen
    s_add_u32 s8, s7, 20736
    buffer_load_dwordx4 a[120:123], v181, s[24:27], s8 offen
    s_add_u32 s8, s7, 22784
    buffer_load_dwordx4 a[124:127], v181, s[24:27], s8 offen
    s_add_u32 s8, s7, 24832
    buffer_load_dwordx4 a[128:131], v181, s[24:27], s8 offen
    s_add_u32 s8, s7, 26880
    buffer_load_dwordx4 a[132:135], v181, s[24:27], s8 offen
    s_add_u32 s8, s7, 28928
    buffer_load_dwordx4 a[136:139], v181, s[24:27], s8 offen
    s_add_u32 s8, s7, 30976
    buffer_load_dwordx4 a[140:143], v181, s[24:27], s8 offen
    s_add_u32 s8, s7, 33024
    buffer_load_dwordx4 a[144:147], v181, s[24:27], s8 offen
    s_add_u32 s8, s7, 35072
    buffer_load_dwordx4 a[148:151], v181, s[24:27], s8 offen
    s_add_u32 s8, s7, 37120
    buffer_load_dwordx4 a[152:155], v181, s[24:27], s8 offen
    s_add_u32 s8, s7, 39168
    buffer_load_dwordx4 a[156:159], v181, s[24:27], s8 offen
    s_add_u32 s8, s7, 5242880
    buffer_load_dwordx4 a[160:163], v181, s[24:27], s8 offen
    s_add_u32 s8, s7, 5244928
    buffer_load_dwordx4 a[164:167], v181, s[24:27], s8 offen
    s_add_u32 s8, s7, 5246976
    buffer_load_dwordx4 a[168:171], v181, s[24:27], s8 offen
    s_add_u32 s8, s7, 5249024
    buffer_load_dwordx4 a[172:175], v181, s[24:27], s8 offen
    s_add_u32 s8, s7, 5251072
    buffer_load_dwordx4 a[176:179], v181, s[24:27], s8 offen
    s_add_u32 s8, s7, 5253120
    buffer_load_dwordx4 a[180:183], v181, s[24:27], s8 offen
    s_add_u32 s8, s7, 5255168
    buffer_load_dwordx4 a[184:187], v181, s[24:27], s8 offen
    s_add_u32 s8, s7, 5257216
    buffer_load_dwordx4 a[188:191], v181, s[24:27], s8 offen
    s_add_u32 s8, s7, 5259264
    buffer_load_dwordx4 a[192:195], v181, s[24:27], s8 offen
    s_add_u32 s8, s7, 5261312
    buffer_load_dwordx4 a[196:199], v181, s[24:27], s8 offen
    s_add_u32 s8, s7, 5263360
    buffer_load_dwordx4 a[200:203], v181, s[24:27], s8 offen
    s_add_u32 s8, s7, 5265408
    buffer_load_dwordx4 a[204:207], v181, s[24:27], s8 offen
    s_add_u32 s8, s7, 5267456
    buffer_load_dwordx4 a[208:211], v181, s[24:27], s8 offen
    s_add_u32 s8, s7, 5269504
    buffer_load_dwordx4 a[212:215], v181, s[24:27], s8 offen
    s_add_u32 s8, s7, 5271552
    buffer_load_dwordx4 a[216:219], v181, s[24:27], s8 offen
    s_add_u32 s8, s7, 5273600
    buffer_load_dwordx4 a[220:223], v181, s[24:27], s8 offen
    s_add_u32 s8, s7, 5275648
    buffer_load_dwordx4 a[224:227], v181, s[24:27], s8 offen
    s_add_u32 s8, s7, 5277696
    buffer_load_dwordx4 a[228:231], v181, s[24:27], s8 offen
    s_add_u32 s8, s7, 5279744
    buffer_load_dwordx4 a[232:235], v181, s[24:27], s8 offen
    s_add_u32 s8, s7, 5281792
    buffer_load_dwordx4 a[236:239], v181, s[24:27], s8 offen
    s_add_u32 s8, s7, 5243136
    buffer_load_dwordx4 a[240:243], v181, s[24:27], s8 offen
    s_add_u32 s8, s7, 5245184
    buffer_load_dwordx4 a[244:247], v181, s[24:27], s8 offen
    s_add_u32 s8, s7, 5247232
    buffer_load_dwordx4 a[248:251], v181, s[24:27], s8 offen
    s_add_u32 s8, s7, 5249280
    buffer_load_dwordx4 a[252:255], v181, s[24:27], s8 offen
    s_add_u32 s8, s7, 5251328
    buffer_load_dwordx4 v[192:195], v181, s[24:27], s8 offen
    s_add_u32 s8, s7, 5253376
    buffer_load_dwordx4 v[196:199], v181, s[24:27], s8 offen
    s_add_u32 s8, s7, 5255424
    buffer_load_dwordx4 v[200:203], v181, s[24:27], s8 offen
    s_add_u32 s8, s7, 5257472
    buffer_load_dwordx4 v[204:207], v181, s[24:27], s8 offen
    s_add_u32 s8, s7, 5259520
    buffer_load_dwordx4 v[208:211], v181, s[24:27], s8 offen
    s_add_u32 s8, s7, 5261568
    buffer_load_dwordx4 v[212:215], v181, s[24:27], s8 offen
    s_add_u32 s8, s7, 5263616
    buffer_load_dwordx4 v[216:219], v181, s[24:27], s8 offen
    s_add_u32 s8, s7, 5265664
    buffer_load_dwordx4 v[220:223], v181, s[24:27], s8 offen
    s_add_u32 s8, s7, 5267712
    buffer_load_dwordx4 v[224:227], v181, s[24:27], s8 offen
    s_add_u32 s8, s7, 5269760
    buffer_load_dwordx4 v[228:231], v181, s[24:27], s8 offen
    s_add_u32 s8, s7, 5271808
    buffer_load_dwordx4 v[232:235], v181, s[24:27], s8 offen
    s_add_u32 s8, s7, 5273856
    buffer_load_dwordx4 v[236:239], v181, s[24:27], s8 offen
    s_add_u32 s8, s7, 5275904
    buffer_load_dwordx4 v[240:243], v181, s[24:27], s8 offen
    s_add_u32 s8, s7, 5277952
    buffer_load_dwordx4 v[244:247], v181, s[24:27], s8 offen
    s_add_u32 s8, s7, 5280000
    buffer_load_dwordx4 v[248:251], v181, s[24:27], s8 offen
    s_add_u32 s8, s7, 5282048
    buffer_load_dwordx4 v[252:255], v181, s[24:27], s8 offen
    v_lshrrev_b32 v6, 3, v3
    v_lshlrev_b32 v6, 4, v6
    v_add_u32 v6, v6, v5
    v_and_b32 v7, 1, v4
    v_lshl_add_u32 v6, v7, 5, v6
    v_lshlrev_b32 v6, 4, v6
    v_lshrrev_b32 v7, 1, v4
    v_lshl_add_u32 v6, v7, 10, v6
    v_add_u32 v182, 0x1000, v6
    s_lshl_b32 s9, s2, 19
    s_add_u32 s22, s9, 0x2cd4000
    v_lshlrev_b32 v15, 7, v4
    v_lshl_add_u32 v15, v3, 4, v15
    s_lshl_b32 s23, s2, 11
    s_add_u32 s23, s23, 0xad5f000
    s_mul_i32 s28, s2, 640
    s_add_u32 s28, s28, 0xa85e000
    v_lshlrev_b32 v16, 4, v3
    v_lshl_add_u32 v16, v4, 3, v16
    v_add_u32 v16, 0x200, v16
    v_lshlrev_b32 v179, 8, v4
    v_lshl_add_u32 v179, v5, 4, v179
    v_lshrrev_b32 v7, 3, v3
    v_lshl_add_u32 v179, v7, 2, v179
    v_mov_b32 v178, 0x44444444
    v_mov_b32 v7, 0xeeeeeeee
    v_cmp_lt_u32 vcc, 7, v3
    v_cndmask_b32 v178, v178, v7, vcc
    v_lshlrev_b32 v17, 2, v4
    v_mul_u32_u24 v17, 272, v17
    v_lshl_add_u32 v17, v3, 1, v17
    s_lshl_b32 s8, s3, 6
    v_add_u32 v17, s8, v17
    v_add_u32 v17, 0x2800, v17
    v_mul_u32_u24 v18, 272, v5
    v_lshl_add_u32 v18, v4, 4, v18
    v_add_u32 v18, 0x2800, v18
    v_cmp_gt_u32 s[30:31], 8, v3
    v_cmp_gt_u32 s[32:33], 2, v4
    s_and_b64 s[32:33], s[32:33], s[30:31]
    buffer_load_dwordx4 v[146:149], v6, s[24:27], s22 offen offset:0 sc1
    buffer_load_dwordx4 v[150:153], v6, s[24:27], s22 offen offset:128 sc1
    buffer_load_dwordx4 v[154:157], v6, s[24:27], s22 offen offset:2048 sc1
    buffer_load_dwordx4 v[158:161], v6, s[24:27], s22 offen offset:2176 sc1
    buffer_load_dwordx4 v[162:165], v182, s[24:27], s22 offen offset:0 sc1
    buffer_load_dwordx4 v[166:169], v182, s[24:27], s22 offen offset:128 sc1
    buffer_load_dwordx4 v[170:173], v182, s[24:27], s22 offen offset:2048 sc1
    buffer_load_dwordx4 v[174:177], v182, s[24:27], s22 offen offset:2176 sc1
    s_waitcnt vmcnt(0)
HL_24:
    s_mul_i32 s40, s37, 10240
    s_add_u32 s40, s40, s20
    buffer_load_dwordx4 v[96:99], v10, s[24:27], s40 offen sc1
    buffer_load_dwordx4 v[100:103], v11, s[24:27], s40 offen sc1
    buffer_load_dwordx4 v[104:107], v12, s[24:27], s40 offen sc1
QL_27:
    s_waitcnt vmcnt(0)
    v_max3_u32 v44, v96, v97, v98
    v_max3_u32 v45, v99, v100, v101
    v_max3_u32 v46, v102, v103, v104
    v_max3_u32 v47, v105, v106, v107
    v_max3_u32 v44, v44, v45, v46
    v_max_u32 v44, v44, v47
    v_cmp_eq_u32 vcc, -1, v44
    s_cbranch_vccz QD_29
    buffer_load_dwordx4 v[96:99], v10, s[24:27], s40 offen sc1
    buffer_load_dwordx4 v[100:103], v11, s[24:27], s40 offen sc1
    buffer_load_dwordx4 v[104:107], v12, s[24:27], s40 offen sc1
    s_add_u32 s36, s36, 1
    s_cmp_gt_u32 s36, 0x100000
    s_cbranch_scc1 END_22
    s_branch QL_27
QD_29:
    ds_write_b128 v10, v[96:99]
    ds_write_b128 v11, v[100:103]
    ds_write_b128 v12, v[104:107]
QE_28:
    s_waitcnt lgkmcnt(0)
    s_barrier
    v_mov_b32 v48, 0
    v_mov_b32 v49, 0
    v_mov_b32 v50, 0
    v_mov_b32 v51, 0
    v_mov_b32 v52, 0
    v_mov_b32 v53, 0
    v_mov_b32 v54, 0
    v_mov_b32 v55, 0
    v_mov_b32 v56, 0
    v_mov_b32 v57, 0
    v_mov_b32 v58, 0
    v_mov_b32 v59, 0
    v_mov_b32 v60, 0
    v_mov_b32 v61, 0
    v_mov_b32 v62, 0
    v_mov_b32 v63, 0
    v_mov_b32 v180, v179
    ds_read2_b32 v[64:65], v180 offset0:0 offset1:2
    ds_read2_b32 v[66:67], v180 offset0:32 offset1:34
    v_add_u32 v180, 1024, v179
    ds_read2_b32 v[68:69], v180 offset0:0 offset1:2
    ds_read2_b32 v[70:71], v180 offset0:32 offset1:34
    v_add_u32 v180, 2048, v179
    ds_read2_b32 v[72:73], v180 offset0:0 offset1:2
    ds_read2_b32 v[74:75], v180 offset0:32 offset1:34
    v_add_u32 v180, 3072, v179
    ds_read2_b32 v[76:77], v180 offset0:0 offset1:2
    ds_read2_b32 v[78:79], v180 offset0:32 offset1:34
    s_waitcnt lgkmcnt(6)
    v_smfmac_f32_16x16x64_bf16 v[48:51], v[64:67], a[0:7], v178
    v_smfmac_f32_16x16x64_bf16 v[52:55], v[64:67], a[80:87], v178
    v_smfmac_f32_16x16x64_bf16 v[56:59], v[64:67], a[160:167], v178
    v_smfmac_f32_16x16x64_bf16 v[60:63], v[64:67], a[240:247], v178
    v_add_u32 v180, 4096, v179
    ds_read2_b32 v[64:65], v180 offset0:0 offset1:2
    ds_read2_b32 v[66:67], v180 offset0:32 offset1:34
    s_waitcnt lgkmcnt(6)
    v_smfmac_f32_16x16x64_bf16 v[48:51], v[68:71], a[8:15], v178
    v_smfmac_f32_16x16x64_bf16 v[52:55], v[68:71], a[88:95], v178
    v_smfmac_f32_16x16x64_bf16 v[56:59], v[68:71], a[168:175], v178
    v_smfmac_f32_16x16x64_bf16 v[60:63], v[68:71], a[248:255], v178
    v_add_u32 v180, 5120, v179
    ds_read2_b32 v[68:69], v180 offset0:0 offset1:2
    ds_read2_b32 v[70:71], v180 offset0:32 offset1:34
    s_waitcnt lgkmcnt(6)
    v_smfmac_f32_16x16x64_bf16 v[48:51], v[72:75], a[16:23], v178
    v_smfmac_f32_16x16x64_bf16 v[52:55], v[72:75], a[96:103], v178
    v_smfmac_f32_16x16x64_bf16 v[56:59], v[72:75], a[176:183], v178
    v_smfmac_f32_16x16x64_bf16 v[60:63], v[72:75], v[192:199], v178
    v_add_u32 v180, 6144, v179
    ds_read2_b32 v[72:73], v180 offset0:0 offset1:2
    ds_read2_b32 v[74:75], v180 offset0:32 offset1:34
    s_waitcnt lgkmcnt(6)
    v_smfmac_f32_16x16x64_bf16 v[48:51], v[76:79], a[24:31], v178
    v_smfmac_f32_16x16x64_bf16 v[52:55], v[76:79], a[104:111], v178
    v_smfmac_f32_16x16x64_bf16 v[56:59], v[76:79], a[184:191], v178
    v_smfmac_f32_16x16x64_bf16 v[60:63], v[76:79], v[200:207], v178
    v_add_u32 v180, 7168, v179
    ds_read2_b32 v[76:77], v180 offset0:0 offset1:2
    ds_read2_b32 v[78:79], v180 offset0:32 offset1:34
    s_waitcnt lgkmcnt(6)
    v_smfmac_f32_16x16x64_bf16 v[48:51], v[64:67], a[32:39], v178
    v_smfmac_f32_16x16x64_bf16 v[52:55], v[64:67], a[112:119], v178
    v_smfmac_f32_16x16x64_bf16 v[56:59], v[64:67], a[192:199], v178
    v_smfmac_f32_16x16x64_bf16 v[60:63], v[64:67], v[208:215], v178
    v_add_u32 v180, 8192, v179
    ds_read2_b32 v[64:65], v180 offset0:0 offset1:2
    ds_read2_b32 v[66:67], v180 offset0:32 offset1:34
    s_waitcnt lgkmcnt(6)
    v_smfmac_f32_16x16x64_bf16 v[48:51], v[68:71], a[40:47], v178
    v_smfmac_f32_16x16x64_bf16 v[52:55], v[68:71], a[120:127], v178
    v_smfmac_f32_16x16x64_bf16 v[56:59], v[68:71], a[200:207], v178
    v_smfmac_f32_16x16x64_bf16 v[60:63], v[68:71], v[216:223], v178
    v_add_u32 v180, 9216, v179
    ds_read2_b32 v[68:69], v180 offset0:0 offset1:2
    ds_read2_b32 v[70:71], v180 offset0:32 offset1:34
    s_waitcnt lgkmcnt(6)
    v_smfmac_f32_16x16x64_bf16 v[48:51], v[72:75], a[48:55], v178
    v_smfmac_f32_16x16x64_bf16 v[52:55], v[72:75], a[128:135], v178
    v_smfmac_f32_16x16x64_bf16 v[56:59], v[72:75], a[208:215], v178
    v_smfmac_f32_16x16x64_bf16 v[60:63], v[72:75], v[224:231], v178
    s_waitcnt lgkmcnt(4)
    v_smfmac_f32_16x16x64_bf16 v[48:51], v[76:79], a[56:63], v178
    v_smfmac_f32_16x16x64_bf16 v[52:55], v[76:79], a[136:143], v178
    v_smfmac_f32_16x16x64_bf16 v[56:59], v[76:79], a[216:223], v178
    v_smfmac_f32_16x16x64_bf16 v[60:63], v[76:79], v[232:239], v178
    s_waitcnt lgkmcnt(2)
    v_smfmac_f32_16x16x64_bf16 v[48:51], v[64:67], a[64:71], v178
    v_smfmac_f32_16x16x64_bf16 v[52:55], v[64:67], a[144:151], v178
    v_smfmac_f32_16x16x64_bf16 v[56:59], v[64:67], a[224:231], v178
    v_smfmac_f32_16x16x64_bf16 v[60:63], v[64:67], v[240:247], v178
    s_waitcnt lgkmcnt(0)
    v_smfmac_f32_16x16x64_bf16 v[48:51], v[68:71], a[72:79], v178
    v_smfmac_f32_16x16x64_bf16 v[52:55], v[68:71], a[152:159], v178
    v_smfmac_f32_16x16x64_bf16 v[56:59], v[68:71], a[232:239], v178
    v_smfmac_f32_16x16x64_bf16 v[60:63], v[68:71], v[248:255], v178
    s_nop 7
    s_nop 4
    v_permlane32_swap_b32 v48, v56
    v_permlane32_swap_b32 v49, v57
    v_permlane32_swap_b32 v50, v58
    v_permlane32_swap_b32 v51, v59
    v_permlane32_swap_b32 v52, v60
    v_permlane32_swap_b32 v53, v61
    v_permlane32_swap_b32 v54, v62
    v_permlane32_swap_b32 v55, v63
    s_nop 1
    v_add_f32 v48, v48, v56
    v_add_f32 v49, v49, v57
    v_add_f32 v50, v50, v58
    v_add_f32 v51, v51, v59
    v_add_f32 v52, v52, v60
    v_add_f32 v53, v53, v61
    v_add_f32 v54, v54, v62
    v_add_f32 v55, v55, v63
    v_cvt_pk_bf16_f32 v56, v48, v49
    v_cvt_pk_bf16_f32 v57, v50, v51
    v_cvt_pk_bf16_f32 v58, v52, v53
    v_cvt_pk_bf16_f32 v59, v54, v55
    ds_write_b16 v17, v56 offset:0
    ds_write_b16_d16_hi v17, v56 offset:272
    ds_write_b16 v17, v57 offset:544
    ds_write_b16_d16_hi v17, v57 offset:816
    ds_write_b16 v17, v58 offset:32
    ds_write_b16_d16_hi v17, v58 offset:304
    ds_write_b16 v17, v59 offset:576
    ds_write_b16_d16_hi v17, v59 offset:848
    s_waitcnt lgkmcnt(0)
    s_barrier
    s_cmp_gt_u32 s3, 1
    s_cbranch_scc1 HN_25
    s_cmp_eq_u32 s3, 0
    s_cbranch_scc1 HW_26
    ds_read_b128 v[80:83], v18 offset:2176
    ds_read_b128 v[84:87], v18 offset:2240
    ds_read_b128 v[88:91], v18 offset:2304
    ds_read_b128 v[92:95], v18 offset:2368
    s_waitcnt lgkmcnt(0)
    s_mov_b64 exec, s[30:31]
    buffer_store_dwordx4 v[80:83], v15, s[24:27], s23 offen offset:0 sc1
    buffer_store_dwordx4 v[84:87], v15, s[24:27], s23 offen offset:512 sc1
    buffer_store_dwordx4 v[88:91], v15, s[24:27], s23 offen offset:1024 sc1
    buffer_store_dwordx4 v[92:95], v15, s[24:27], s23 offen offset:1536 sc1
    s_cmp_lg_u32 s2, 0
    s_cbranch_scc1 HNP_30
    s_lshl_b32 s8, s21, 2
    s_add_u32 s8, s8, 0xad5e600
    s_mov_b64 exec, 1
    buffer_store_dword v30, v30, s[24:27], s8 offen sc1
HNP_30:
    s_mov_b64 exec, -1
    s_cmp_eq_u32 s21, 63
    s_cbranch_scc1 END_22
    s_branch HN_25
HW_26:
    s_cmp_eq_u32 s21, 63
    s_cbranch_scc1 END_22
    ds_read_b128 v[64:67], v18 offset:0
    ds_read_b128 v[80:83], v18 offset:2176
    ds_read_b128 v[68:71], v18 offset:64
    ds_read_b128 v[84:87], v18 offset:2240
    ds_read_b128 v[72:75], v18 offset:128
    ds_read_b128 v[88:91], v18 offset:2304
    ds_read_b128 v[76:79], v18 offset:192
    ds_read_b128 v[92:95], v18 offset:2368
    s_waitcnt vmcnt(0)
    s_waitcnt lgkmcnt(6)
    v_mfma_f32_16x16x32_bf16 v[100:103], v[146:149], v[64:67], 0
    v_mfma_f32_16x16x32_bf16 v[104:107], v[150:153], v[64:67], 0
    v_mfma_f32_16x16x32_bf16 v[96:99], v[80:83], v[64:67], 0
    s_waitcnt lgkmcnt(4)
    v_mfma_f32_16x16x32_bf16 v[100:103], v[154:157], v[68:71], v[100:103]
    v_mfma_f32_16x16x32_bf16 v[104:107], v[158:161], v[68:71], v[104:107]
    v_mfma_f32_16x16x32_bf16 v[96:99], v[84:87], v[68:71], v[96:99]
    s_waitcnt lgkmcnt(2)
    v_mfma_f32_16x16x32_bf16 v[100:103], v[162:165], v[72:75], v[100:103]
    v_mfma_f32_16x16x32_bf16 v[104:107], v[166:169], v[72:75], v[104:107]
    v_mfma_f32_16x16x32_bf16 v[96:99], v[88:91], v[72:75], v[96:99]
    s_waitcnt lgkmcnt(0)
    v_mfma_f32_16x16x32_bf16 v[100:103], v[170:173], v[76:79], v[100:103]
    v_mfma_f32_16x16x32_bf16 v[104:107], v[174:177], v[76:79], v[104:107]
    v_mfma_f32_16x16x32_bf16 v[96:99], v[92:95], v[76:79], v[96:99]
    s_add_u32 s22, s22, 8192
    s_mov_b32 s10, 0x3e0293ee
    s_mov_b32 s11, 0x3e0293ee
    s_nop 7
    s_nop 2
    v_max3_f32 v44, v96, v97, v98
    v_max3_f32 v45, v99, v100, v101
    v_max3_f32 v46, v102, v103, v104
    v_max3_f32 v47, v105, v106, v107
    v_max3_f32 v44, v44, v45, v46
    v_max_f32 v44, v44, v47
    v_mov_b32 v45, v44
    s_nop 1
    v_permlane32_swap_b32 v45, v44
    s_nop 1
    v_max_f32 v44, v44, v45
    v_mov_b32 v45, v44
    s_nop 1
    v_permlane16_swap_b32 v45, v44
    s_nop 1
    v_max_f32 v44, v44, v45
    v_mul_f32 v44, s10, v44
    v_mov_b32 v45, v44
    v_pk_fma_f32 v[96:97], v[96:97], s[10:11], v[44:45] neg_lo:[0,0,1] neg_hi:[0,0,1]
    v_pk_fma_f32 v[98:99], v[98:99], s[10:11], v[44:45] neg_lo:[0,0,1] neg_hi:[0,0,1]
    v_pk_fma_f32 v[100:101], v[100:101], s[10:11], v[44:45] neg_lo:[0,0,1] neg_hi:[0,0,1]
    v_pk_fma_f32 v[102:103], v[102:103], s[10:11], v[44:45] neg_lo:[0,0,1] neg_hi:[0,0,1]
    v_pk_fma_f32 v[104:105], v[104:105], s[10:11], v[44:45] neg_lo:[0,0,1] neg_hi:[0,0,1]
    v_pk_fma_f32 v[106:107], v[106:107], s[10:11], v[44:45] neg_lo:[0,0,1] neg_hi:[0,0,1]
    v_exp_f32 v96, v96
    v_exp_f32 v97, v97
    v_exp_f32 v98, v98
    v_exp_f32 v99, v99
    v_exp_f32 v100, v100
    v_exp_f32 v101, v101
    v_exp_f32 v102, v102
    v_exp_f32 v103, v103
    v_exp_f32 v104, v104
    v_exp_f32 v105, v105
    v_exp_f32 v106, v106
    v_exp_f32 v107, v107
    v_cmp_gt_u32 vcc, 2, v4
    v_pk_add_f32 v[46:47], v[100:101], v[102:103]
    v_pk_add_f32 v[44:45], v[96:97], v[98:99]
    v_pk_add_f32 v[108:109], v[104:105], v[106:107]
    v_add_f32 v44, v44, v45
    v_pk_add_f32 v[46:47], v[46:47], v[108:109]
    v_cndmask_b32 v44, 0, v44, vcc
    v_add_f32 v45, v46, v47
    v_add_f32 v45, v45, v44
    v_mov_b32 v46, v45
    s_nop 1
    v_permlane32_swap_b32 v46, v45
    s_nop 1
    v_add_f32 v45, v45, v46
    v_mov_b32 v46, v45
    s_nop 1
    v_permlane16_swap_b32 v46, v45
    s_nop 1
    v_add_f32 v45, v45, v46
    v_rcp_f32 v44, v45
    s_nop 0
    v_mov_b32 v45, v44
    v_pk_mul_f32 v[96:97], v[96:97], v[44:45]
    v_pk_mul_f32 v[98:99], v[98:99], v[44:45]
    v_pk_mul_f32 v[100:101], v[100:101], v[44:45]
    v_pk_mul_f32 v[102:103], v[102:103], v[44:45]
    v_pk_mul_f32 v[104:105], v[104:105], v[44:45]
    v_pk_mul_f32 v[106:107], v[106:107], v[44:45]
    v_cvt_pk_bf16_f32 v108, v96, v97
    v_cvt_pk_bf16_f32 v109, v98, v99
    v_cvt_pk_bf16_f32 v110, v100, v101
    v_cvt_pk_bf16_f32 v111, v102, v103
    v_cvt_pk_bf16_f32 v112, v104, v105
    v_cvt_pk_bf16_f32 v113, v106, v107
    v_min_u32 v108, -2, v108
    v_min_u32 v109, -2, v109
    v_min_u32 v110, -2, v110
    v_min_u32 v111, -2, v111
    v_min_u32 v112, -2, v112
    v_min_u32 v113, -2, v113
    s_mov_b64 exec, s[30:31]
    s_add_u32 s8, s28, 0
    buffer_store_dwordx4 v[110:113], v15, s[24:27], s8 offen sc1
    s_add_u32 s8, s28, 20480
    buffer_store_dwordx4 v[110:113], v15, s[24:27], s8 offen sc1
    s_add_u32 s8, s28, 40960
    buffer_store_dwordx4 v[110:113], v15, s[24:27], s8 offen sc1
    s_add_u32 s8, s28, 61440
    buffer_store_dwordx4 v[110:113], v15, s[24:27], s8 offen sc1
    s_mov_b64 exec, s[32:33]
    s_add_u32 s8, s28, 0
    buffer_store_dwordx2 v[108:109], v16, s[24:27], s8 offen sc1
    s_add_u32 s8, s28, 20480
    buffer_store_dwordx2 v[108:109], v16, s[24:27], s8 offen sc1
    s_add_u32 s8, s28, 40960
    buffer_store_dwordx2 v[108:109], v16, s[24:27], s8 offen sc1
    s_add_u32 s8, s28, 61440
    buffer_store_dwordx2 v[108:109], v16, s[24:27], s8 offen sc1
    s_mov_b64 exec, -1
    buffer_load_dwordx4 v[146:149], v6, s[24:27], s22 offen offset:0 sc1
    buffer_load_dwordx4 v[150:153], v6, s[24:27], s22 offen offset:128 sc1
    buffer_load_dwordx4 v[154:157], v6, s[24:27], s22 offen offset:2048 sc1
    buffer_load_dwordx4 v[158:161], v6, s[24:27], s22 offen offset:2176 sc1
    buffer_load_dwordx4 v[162:165], v182, s[24:27], s22 offen offset:0 sc1
    buffer_load_dwordx4 v[166:169], v182, s[24:27], s22 offen offset:128 sc1
    buffer_load_dwordx4 v[170:173], v182, s[24:27], s22 offen offset:2048 sc1
    buffer_load_dwordx4 v[174:177], v182, s[24:27], s22 offen offset:2176 sc1
HN_25:
    s_cmp_eq_u32 s21, 63
    s_cbranch_scc1 END_22
    s_add_u32 s20, s20, 40960
    s_add_u32 s21, s21, 1
    s_add_u32 s23, s23, 65536
    s_add_u32 s28, s28, 81920
    s_add_u32 s38, s21, 1
    s_and_b32 s39, s38, 7
    s_cmp_lg_u32 s39, 0
    s_cbranch_scc1 FS_31
    s_cmp_ge_u32 s38, 64
    s_cbranch_scc1 FS_31
    s_lshl_b32 s38, s38, 4
    s_add_u32 s38, s38, 0xad5e000
FP_32:
    buffer_load_dword v145, v144, s[24:27], s38 offen sc1
    s_waitcnt vmcnt(0)
    v_cmp_eq_u32 vcc, -1, v145
    s_add_u32 s36, s36, 1
    s_cmp_gt_u32 s36, 0x400000
    s_cbranch_scc1 END_22
    s_cbranch_vccz FS_31
    s_sleep 8
    s_branch FP_32
FS_31:
    s_sleep 46
    s_branch HL_24
COL_21:
    s_sub_u32 s6, s2, 32
    s_lshr_b32 s7, s6, 2
    s_lshr_b32 s8, s6, 1
    s_and_b32 s8, s8, 1
    s_lshl_b32 s8, s8, 4
    s_and_b32 s9, s6, 1
    s_lshl_b32 s9, s9, 2
    s_add_u32 s8, s8, s9
    v_and_b32 v6, 3, v2
    v_bfe_u32 v7, v2, 2, 1
    v_lshl_add_u32 v6, v7, 3, v6
    v_add_u32 v6, s8, v6
    v_mov_b32 v19, v6
    v_and_b32 v7, 1, v4
    v_lshl_add_u32 v6, v7, 5, v6
    v_lshlrev_b32 v6, 4, v6
    v_lshrrev_b32 v7, 1, v4
    v_lshl_add_u32 v6, v7, 10, v6
    v_lshrrev_b32 v8, 3, v3
    v_mul_u32_u24 v9, 819200, v8
    v_add_u32 v9, v9, v6
    v_mul_u32_u24 v20, 40960, v8
    v_add_u32 v20, v20, v6
    s_lshl_b32 s9, s3, 3
    s_mul_i32 s9, s9, 20
    s_add_u32 s9, s9, s7
    s_mul_i32 s10, s9, 40960
    s_add_u32 s10, s10, 0x8cd4000
    s_add_u32 s8, s10, 0
    buffer_load_dwordx4 a[0:3], v9, s[24:27], s8 offen
    s_add_u32 s8, s10, 2048
    buffer_load_dwordx4 a[4:7], v9, s[24:27], s8 offen
    s_add_u32 s8, s10, 4096
    buffer_load_dwordx4 a[8:11], v9, s[24:27], s8 offen
    s_add_u32 s8, s10, 6144
    buffer_load_dwordx4 a[12:15], v9, s[24:27], s8 offen
    s_add_u32 s8, s10, 8192
    buffer_load_dwordx4 a[16:19], v9, s[24:27], s8 offen
    s_add_u32 s8, s10, 10240
    buffer_load_dwordx4 a[20:23], v9, s[24:27], s8 offen
    s_add_u32 s8, s10, 12288
    buffer_load_dwordx4 a[24:27], v9, s[24:27], s8 offen
    s_add_u32 s8, s10, 14336
    buffer_load_dwordx4 a[28:31], v9, s[24:27], s8 offen
    s_add_u32 s8, s10, 16384
    buffer_load_dwordx4 a[32:35], v9, s[24:27], s8 offen
    s_add_u32 s8, s10, 18432
    buffer_load_dwordx4 a[36:39], v9, s[24:27], s8 offen
    s_add_u32 s8, s10, 20480
    buffer_load_dwordx4 a[40:43], v9, s[24:27], s8 offen
    s_add_u32 s8, s10, 22528
    buffer_load_dwordx4 a[44:47], v9, s[24:27], s8 offen
    s_add_u32 s8, s10, 24576
    buffer_load_dwordx4 a[48:51], v9, s[24:27], s8 offen
    s_add_u32 s8, s10, 26624
    buffer_load_dwordx4 a[52:55], v9, s[24:27], s8 offen
    s_add_u32 s8, s10, 28672
    buffer_load_dwordx4 a[56:59], v9, s[24:27], s8 offen
    s_add_u32 s8, s10, 30720
    buffer_load_dwordx4 a[60:63], v9, s[24:27], s8 offen
    s_add_u32 s8, s10, 32768
    buffer_load_dwordx4 a[64:67], v9, s[24:27], s8 offen
    s_add_u32 s8, s10, 34816
    buffer_load_dwordx4 a[68:71], v9, s[24:27], s8 offen
    s_add_u32 s8, s10, 36864
    buffer_load_dwordx4 a[72:75], v9, s[24:27], s8 offen
    s_add_u32 s8, s10, 38912
    buffer_load_dwordx4 a[76:79], v9, s[24:27], s8 offen
    s_add_u32 s8, s10, 1638400
    buffer_load_dwordx4 a[80:83], v9, s[24:27], s8 offen
    s_add_u32 s8, s10, 1640448
    buffer_load_dwordx4 a[84:87], v9, s[24:27], s8 offen
    s_add_u32 s8, s10, 1642496
    buffer_load_dwordx4 a[88:91], v9, s[24:27], s8 offen
    s_add_u32 s8, s10, 1644544
    buffer_load_dwordx4 a[92:95], v9, s[24:27], s8 offen
    s_add_u32 s8, s10, 1646592
    buffer_load_dwordx4 a[96:99], v9, s[24:27], s8 offen
    s_add_u32 s8, s10, 1648640
    buffer_load_dwordx4 a[100:103], v9, s[24:27], s8 offen
    s_add_u32 s8, s10, 1650688
    buffer_load_dwordx4 a[104:107], v9, s[24:27], s8 offen
    s_add_u32 s8, s10, 1652736
    buffer_load_dwordx4 a[108:111], v9, s[24:27], s8 offen
    s_add_u32 s8, s10, 1654784
    buffer_load_dwordx4 a[112:115], v9, s[24:27], s8 offen
    s_add_u32 s8, s10, 1656832
    buffer_load_dwordx4 a[116:119], v9, s[24:27], s8 offen
    s_add_u32 s8, s10, 1658880
    buffer_load_dwordx4 a[120:123], v9, s[24:27], s8 offen
    s_add_u32 s8, s10, 1660928
    buffer_load_dwordx4 a[124:127], v9, s[24:27], s8 offen
    s_add_u32 s8, s10, 1662976
    buffer_load_dwordx4 a[128:131], v9, s[24:27], s8 offen
    s_add_u32 s8, s10, 1665024
    buffer_load_dwordx4 a[132:135], v9, s[24:27], s8 offen
    s_add_u32 s8, s10, 1667072
    buffer_load_dwordx4 a[136:139], v9, s[24:27], s8 offen
    s_add_u32 s8, s10, 1669120
    buffer_load_dwordx4 a[140:143], v9, s[24:27], s8 offen
    s_add_u32 s8, s10, 1671168
    buffer_load_dwordx4 a[144:147], v9, s[24:27], s8 offen
    s_add_u32 s8, s10, 1673216
    buffer_load_dwordx4 a[148:151], v9, s[24:27], s8 offen
    s_add_u32 s8, s10, 1675264
    buffer_load_dwordx4 a[152:155], v9, s[24:27], s8 offen
    s_add_u32 s8, s10, 1677312
    buffer_load_dwordx4 a[156:159], v9, s[24:27], s8 offen
    s_add_u32 s8, s10, 3276800
    buffer_load_dwordx4 a[160:163], v9, s[24:27], s8 offen
    s_add_u32 s8, s10, 3278848
    buffer_load_dwordx4 a[164:167], v9, s[24:27], s8 offen
    s_add_u32 s8, s10, 3280896
    buffer_load_dwordx4 a[168:171], v9, s[24:27], s8 offen
    s_add_u32 s8, s10, 3282944
    buffer_load_dwordx4 a[172:175], v9, s[24:27], s8 offen
    s_add_u32 s8, s10, 3284992
    buffer_load_dwordx4 a[176:179], v9, s[24:27], s8 offen
    s_add_u32 s8, s10, 3287040
    buffer_load_dwordx4 a[180:183], v9, s[24:27], s8 offen
    s_add_u32 s8, s10, 3289088
    buffer_load_dwordx4 a[184:187], v9, s[24:27], s8 offen
    s_add_u32 s8, s10, 3291136
    buffer_load_dwordx4 a[188:191], v9, s[24:27], s8 offen
    s_add_u32 s8, s10, 3293184
    buffer_load_dwordx4 a[192:195], v9, s[24:27], s8 offen
    s_add_u32 s8, s10, 3295232
    buffer_load_dwordx4 a[196:199], v9, s[24:27], s8 offen
    s_add_u32 s8, s10, 3297280
    buffer_load_dwordx4 a[200:203], v9, s[24:27], s8 offen
    s_add_u32 s8, s10, 3299328
    buffer_load_dwordx4 a[204:207], v9, s[24:27], s8 offen
    s_add_u32 s8, s10, 3301376
    buffer_load_dwordx4 a[208:211], v9, s[24:27], s8 offen
    s_add_u32 s8, s10, 3303424
    buffer_load_dwordx4 a[212:215], v9, s[24:27], s8 offen
    s_add_u32 s8, s10, 3305472
    buffer_load_dwordx4 a[216:219], v9, s[24:27], s8 offen
    s_add_u32 s8, s10, 3307520
    buffer_load_dwordx4 a[220:223], v9, s[24:27], s8 offen
    s_add_u32 s8, s10, 3309568
    buffer_load_dwordx4 a[224:227], v9, s[24:27], s8 offen
    s_add_u32 s8, s10, 3311616
    buffer_load_dwordx4 a[228:231], v9, s[24:27], s8 offen
    s_add_u32 s8, s10, 3313664
    buffer_load_dwordx4 a[232:235], v9, s[24:27], s8 offen
    s_add_u32 s8, s10, 3315712
    buffer_load_dwordx4 a[236:239], v9, s[24:27], s8 offen
    s_add_u32 s8, s10, 4915200
    buffer_load_dwordx4 a[240:243], v9, s[24:27], s8 offen
    s_add_u32 s8, s10, 4917248
    buffer_load_dwordx4 a[244:247], v9, s[24:27], s8 offen
    s_add_u32 s8, s10, 4919296
    buffer_load_dwordx4 a[248:251], v9, s[24:27], s8 offen
    s_add_u32 s8, s10, 4921344
    buffer_load_dwordx4 a[252:255], v9, s[24:27], s8 offen
    s_add_u32 s8, s10, 4923392
    buffer_load_dwordx4 v[192:195], v9, s[24:27], s8 offen
    s_add_u32 s8, s10, 4925440
    buffer_load_dwordx4 v[196:199], v9, s[24:27], s8 offen
    s_add_u32 s8, s10, 4927488
    buffer_load_dwordx4 v[200:203], v9, s[24:27], s8 offen
    s_add_u32 s8, s10, 4929536
    buffer_load_dwordx4 v[204:207], v9, s[24:27], s8 offen
    s_add_u32 s8, s10, 4931584
    buffer_load_dwordx4 v[208:211], v9, s[24:27], s8 offen
    s_add_u32 s8, s10, 4933632
    buffer_load_dwordx4 v[212:215], v9, s[24:27], s8 offen
    s_add_u32 s8, s10, 4935680
    buffer_load_dwordx4 v[216:219], v9, s[24:27], s8 offen
    s_add_u32 s8, s10, 4937728
    buffer_load_dwordx4 v[220:223], v9, s[24:27], s8 offen
    s_add_u32 s8, s10, 4939776
    buffer_load_dwordx4 v[224:227], v9, s[24:27], s8 offen
    s_add_u32 s8, s10, 4941824
    buffer_load_dwordx4 v[228:231], v9, s[24:27], s8 offen
    s_add_u32 s8, s10, 4943872
    buffer_load_dwordx4 v[232:235], v9, s[24:27], s8 offen
    s_add_u32 s8, s10, 4945920
    buffer_load_dwordx4 v[236:239], v9, s[24:27], s8 offen
    s_add_u32 s8, s10, 4947968
    buffer_load_dwordx4 v[240:243], v9, s[24:27], s8 offen
    s_add_u32 s8, s10, 4950016
    buffer_load_dwordx4 v[244:247], v9, s[24:27], s8 offen
    s_add_u32 s8, s10, 4952064
    buffer_load_dwordx4 v[248:251], v9, s[24:27], s8 offen
    s_add_u32 s8, s10, 4954112
    buffer_load_dwordx4 v[252:255], v9, s[24:27], s8 offen
    s_lshl_b32 s22, s9, 11
    s_add_u32 s22, s22, 0x3cd4000
    v_mul_u32_u24 v21, 640, v8
    v_lshl_add_u32 v21, v4, 7, v21
    v_lshl_add_u32 v21, v5, 4, v21
    v_lshl_add_u32 v22, v8, 2, v4
    v_mul_u32_u24 v22, 640, v22
    v_lshl_add_u32 v22, v5, 4, v22
    v_add_u32 v22, 0x200, v22
    s_mul_i32 s28, s3, 5120
    s_add_u32 s28, s28, 0xa85e000
    s_lshl_b32 s8, s3, 10
    v_lshlrev_b32 v23, 4, v3
    v_lshl_add_u32 v23, v4, 3, v23
    v_add_u32 v23, s8, v23
    v_add_u32 v23, 0x2800, v23
    v_lshl_add_u32 v24, v8, 2, v4
    v_lshlrev_b32 v24, 7, v24
    v_lshl_add_u32 v24, v5, 4, v24
    v_add_u32 v24, s8, v24
    v_add_u32 v24, 0x2800, v24
    v_mul_u32_u24 v25, 10240, v8
    v_lshl_add_u32 v25, v19, 4, v25
    v_lshl_add_u32 v25, v4, 3, v25
    s_mul_i32 s23, s3, 81920
    s_lshl_b32 s8, s7, 9
    s_add_u32 s23, s23, s8
    s_add_u32 s23, s23, 0xb15f000
    s_lshl_b32 s8, s3, 10
    v_lshlrev_b32 v26, 4, v2
    v_add_u32 v26, s8, v26
    v_add_u32 v26, 0x3800, v26
    v_bfe_u32 v27, v2, 3, 1
    v_lshlrev_b32 v27, 8, v27
    v_lshl_add_u32 v27, v5, 4, v27
    v_add_u32 v27, 0x3800, v27
    v_bfe_u32 v13, v2, 3, 1
    v_lshlrev_b32 v13, 3, v13
    v_lshl_add_u32 v13, v5, 4, v13
    s_lshl_b32 s29, s6, 7
    s_add_u32 s29, s29, 0xa5de000
    v_cmp_gt_u32 s[32:33], 2, v4
    v_cmp_gt_u32 s[34:35], 16, v2
    s_add_u32 s8, s22, 0
    buffer_load_dwordx4 v[80:83], v20, s[24:27], s8 offen sc1
    s_add_u32 s8, s22, 81920
    buffer_load_dwordx4 v[84:87], v20, s[24:27], s8 offen sc1
    s_add_u32 s8, s22, 163840
    buffer_load_dwordx4 v[88:91], v20, s[24:27], s8 offen sc1
    s_add_u32 s8, s22, 245760
    buffer_load_dwordx4 v[92:95], v20, s[24:27], s8 offen sc1
    s_waitcnt vmcnt(0)
CL_33:
    s_mul_i32 s40, s37, 10240
    s_add_u32 s40, s40, s20
PS_37:
    buffer_load_dwordx4 v[32:35], v10, s[24:27], s40 offen sc1
    buffer_load_dwordx4 v[36:39], v11, s[24:27], s40 offen sc1
    buffer_load_dwordx4 v[40:43], v12, s[24:27], s40 offen sc1
    s_waitcnt vmcnt(0)
    v_max3_u32 v44, v32, v33, v34
    v_max3_u32 v45, v35, v36, v37
    v_max3_u32 v46, v38, v39, v40
    v_max3_u32 v47, v41, v42, v43
    v_max3_u32 v44, v44, v45, v46
    v_max_u32 v44, v44, v47
    v_cmp_eq_u32 vcc, -1, v44
    s_add_u32 s36, s36, 1
    s_cmp_gt_u32 s36, 0x400000
    s_cbranch_scc1 END_22
    s_cbranch_vccnz PS_37
PD_38:
    ds_write_b128 v10, v[32:35]
    ds_write_b128 v11, v[36:39]
    ds_write_b128 v12, v[40:43]
    s_waitcnt lgkmcnt(0)
    s_barrier
    ds_read_b128 v[64:67], v14 offset:0
    ds_read_b128 v[68:71], v14 offset:512
    ds_read_b128 v[72:75], v14 offset:1024
    ds_read_b128 v[76:79], v14 offset:1536
    s_waitcnt lgkmcnt(3)
    v_mfma_f32_16x16x32_bf16 v[48:51], v[64:67], a[0:3], 0
    v_mfma_f32_16x16x32_bf16 v[52:55], v[64:67], a[80:83], 0
    v_mfma_f32_16x16x32_bf16 v[56:59], v[64:67], a[160:163], 0
    v_mfma_f32_16x16x32_bf16 v[60:63], v[64:67], a[240:243], 0
    ds_read_b128 v[64:67], v14 offset:2048
    s_waitcnt lgkmcnt(3)
    v_mfma_f32_16x16x32_bf16 v[48:51], v[68:71], a[4:7], v[48:51]
    v_mfma_f32_16x16x32_bf16 v[52:55], v[68:71], a[84:87], v[52:55]
    v_mfma_f32_16x16x32_bf16 v[56:59], v[68:71], a[164:167], v[56:59]
    v_mfma_f32_16x16x32_bf16 v[60:63], v[68:71], a[244:247], v[60:63]
    ds_read_b128 v[68:71], v14 offset:2560
    s_waitcnt lgkmcnt(3)
    v_mfma_f32_16x16x32_bf16 v[48:51], v[72:75], a[8:11], v[48:51]
    v_mfma_f32_16x16x32_bf16 v[52:55], v[72:75], a[88:91], v[52:55]
    v_mfma_f32_16x16x32_bf16 v[56:59], v[72:75], a[168:171], v[56:59]
    v_mfma_f32_16x16x32_bf16 v[60:63], v[72:75], a[248:251], v[60:63]
    ds_read_b128 v[72:75], v14 offset:3072
    s_waitcnt lgkmcnt(3)
    v_mfma_f32_16x16x32_bf16 v[48:51], v[76:79], a[12:15], v[48:51]
    v_mfma_f32_16x16x32_bf16 v[52:55], v[76:79], a[92:95], v[52:55]
    v_mfma_f32_16x16x32_bf16 v[56:59], v[76:79], a[172:175], v[56:59]
    v_mfma_f32_16x16x32_bf16 v[60:63], v[76:79], a[252:255], v[60:63]
    ds_read_b128 v[76:79], v14 offset:3584
    s_waitcnt lgkmcnt(3)
    v_mfma_f32_16x16x32_bf16 v[48:51], v[64:67], a[16:19], v[48:51]
    v_mfma_f32_16x16x32_bf16 v[52:55], v[64:67], a[96:99], v[52:55]
    v_mfma_f32_16x16x32_bf16 v[56:59], v[64:67], a[176:179], v[56:59]
    v_mfma_f32_16x16x32_bf16 v[60:63], v[64:67], v[192:195], v[60:63]
    ds_read_b128 v[64:67], v14 offset:4096
    s_waitcnt lgkmcnt(3)
    v_mfma_f32_16x16x32_bf16 v[48:51], v[68:71], a[20:23], v[48:51]
    v_mfma_f32_16x16x32_bf16 v[52:55], v[68:71], a[100:103], v[52:55]
    v_mfma_f32_16x16x32_bf16 v[56:59], v[68:71], a[180:183], v[56:59]
    v_mfma_f32_16x16x32_bf16 v[60:63], v[68:71], v[196:199], v[60:63]
    ds_read_b128 v[68:71], v14 offset:4608
    s_waitcnt lgkmcnt(3)
    v_mfma_f32_16x16x32_bf16 v[48:51], v[72:75], a[24:27], v[48:51]
    v_mfma_f32_16x16x32_bf16 v[52:55], v[72:75], a[104:107], v[52:55]
    v_mfma_f32_16x16x32_bf16 v[56:59], v[72:75], a[184:187], v[56:59]
    v_mfma_f32_16x16x32_bf16 v[60:63], v[72:75], v[200:203], v[60:63]
    ds_read_b128 v[72:75], v14 offset:5120
    s_waitcnt lgkmcnt(3)
    v_mfma_f32_16x16x32_bf16 v[48:51], v[76:79], a[28:31], v[48:51]
    v_mfma_f32_16x16x32_bf16 v[52:55], v[76:79], a[108:111], v[52:55]
    v_mfma_f32_16x16x32_bf16 v[56:59], v[76:79], a[188:191], v[56:59]
    v_mfma_f32_16x16x32_bf16 v[60:63], v[76:79], v[204:207], v[60:63]
    ds_read_b128 v[76:79], v14 offset:5632
    s_waitcnt lgkmcnt(3)
    v_mfma_f32_16x16x32_bf16 v[48:51], v[64:67], a[32:35], v[48:51]
    v_mfma_f32_16x16x32_bf16 v[52:55], v[64:67], a[112:115], v[52:55]
    v_mfma_f32_16x16x32_bf16 v[56:59], v[64:67], a[192:195], v[56:59]
    v_mfma_f32_16x16x32_bf16 v[60:63], v[64:67], v[208:211], v[60:63]
    ds_read_b128 v[64:67], v14 offset:6144
    s_waitcnt lgkmcnt(3)
    v_mfma_f32_16x16x32_bf16 v[48:51], v[68:71], a[36:39], v[48:51]
    v_mfma_f32_16x16x32_bf16 v[52:55], v[68:71], a[116:119], v[52:55]
    v_mfma_f32_16x16x32_bf16 v[56:59], v[68:71], a[196:199], v[56:59]
    v_mfma_f32_16x16x32_bf16 v[60:63], v[68:71], v[212:215], v[60:63]
    ds_read_b128 v[68:71], v14 offset:6656
    s_waitcnt lgkmcnt(3)
    v_mfma_f32_16x16x32_bf16 v[48:51], v[72:75], a[40:43], v[48:51]
    v_mfma_f32_16x16x32_bf16 v[52:55], v[72:75], a[120:123], v[52:55]
    v_mfma_f32_16x16x32_bf16 v[56:59], v[72:75], a[200:203], v[56:59]
    v_mfma_f32_16x16x32_bf16 v[60:63], v[72:75], v[216:219], v[60:63]
    ds_read_b128 v[72:75], v14 offset:7168
    s_waitcnt lgkmcnt(3)
    v_mfma_f32_16x16x32_bf16 v[48:51], v[76:79], a[44:47], v[48:51]
    v_mfma_f32_16x16x32_bf16 v[52:55], v[76:79], a[124:127], v[52:55]
    v_mfma_f32_16x16x32_bf16 v[56:59], v[76:79], a[204:207], v[56:59]
    v_mfma_f32_16x16x32_bf16 v[60:63], v[76:79], v[220:223], v[60:63]
    ds_read_b128 v[76:79], v14 offset:7680
    s_waitcnt lgkmcnt(3)
    v_mfma_f32_16x16x32_bf16 v[48:51], v[64:67], a[48:51], v[48:51]
    v_mfma_f32_16x16x32_bf16 v[52:55], v[64:67], a[128:131], v[52:55]
    v_mfma_f32_16x16x32_bf16 v[56:59], v[64:67], a[208:211], v[56:59]
    v_mfma_f32_16x16x32_bf16 v[60:63], v[64:67], v[224:227], v[60:63]
    ds_read_b128 v[64:67], v14 offset:8192
    s_waitcnt lgkmcnt(3)
    v_mfma_f32_16x16x32_bf16 v[48:51], v[68:71], a[52:55], v[48:51]
    v_mfma_f32_16x16x32_bf16 v[52:55], v[68:71], a[132:135], v[52:55]
    v_mfma_f32_16x16x32_bf16 v[56:59], v[68:71], a[212:215], v[56:59]
    v_mfma_f32_16x16x32_bf16 v[60:63], v[68:71], v[228:231], v[60:63]
    ds_read_b128 v[68:71], v14 offset:8704
    s_waitcnt lgkmcnt(3)
    v_mfma_f32_16x16x32_bf16 v[48:51], v[72:75], a[56:59], v[48:51]
    v_mfma_f32_16x16x32_bf16 v[52:55], v[72:75], a[136:139], v[52:55]
    v_mfma_f32_16x16x32_bf16 v[56:59], v[72:75], a[216:219], v[56:59]
    v_mfma_f32_16x16x32_bf16 v[60:63], v[72:75], v[232:235], v[60:63]
    ds_read_b128 v[72:75], v14 offset:9216
    s_waitcnt lgkmcnt(3)
    v_mfma_f32_16x16x32_bf16 v[48:51], v[76:79], a[60:63], v[48:51]
    v_mfma_f32_16x16x32_bf16 v[52:55], v[76:79], a[140:143], v[52:55]
    v_mfma_f32_16x16x32_bf16 v[56:59], v[76:79], a[220:223], v[56:59]
    v_mfma_f32_16x16x32_bf16 v[60:63], v[76:79], v[236:239], v[60:63]
    ds_read_b128 v[76:79], v14 offset:9728
    s_waitcnt lgkmcnt(3)
    v_mfma_f32_16x16x32_bf16 v[48:51], v[64:67], a[64:67], v[48:51]
    v_mfma_f32_16x16x32_bf16 v[52:55], v[64:67], a[144:147], v[52:55]
    v_mfma_f32_16x16x32_bf16 v[56:59], v[64:67], a[224:227], v[56:59]
    v_mfma_f32_16x16x32_bf16 v[60:63], v[64:67], v[240:243], v[60:63]
    s_waitcnt lgkmcnt(2)
    v_mfma_f32_16x16x32_bf16 v[48:51], v[68:71], a[68:71], v[48:51]
    v_mfma_f32_16x16x32_bf16 v[52:55], v[68:71], a[148:151], v[52:55]
    v_mfma_f32_16x16x32_bf16 v[56:59], v[68:71], a[228:231], v[56:59]
    v_mfma_f32_16x16x32_bf16 v[60:63], v[68:71], v[244:247], v[60:63]
    s_waitcnt lgkmcnt(1)
    v_mfma_f32_16x16x32_bf16 v[48:51], v[72:75], a[72:75], v[48:51]
    v_mfma_f32_16x16x32_bf16 v[52:55], v[72:75], a[152:155], v[52:55]
    v_mfma_f32_16x16x32_bf16 v[56:59], v[72:75], a[232:235], v[56:59]
    v_mfma_f32_16x16x32_bf16 v[60:63], v[72:75], v[248:251], v[60:63]
    s_waitcnt lgkmcnt(0)
    v_mfma_f32_16x16x32_bf16 v[48:51], v[76:79], a[76:79], v[48:51]
    v_mfma_f32_16x16x32_bf16 v[52:55], v[76:79], a[156:159], v[52:55]
    v_mfma_f32_16x16x32_bf16 v[56:59], v[76:79], a[236:239], v[56:59]
    v_mfma_f32_16x16x32_bf16 v[60:63], v[76:79], v[252:255], v[60:63]
    s_nop 7
    v_cvt_pk_bf16_f32 v96, v48, v49
    v_cvt_pk_bf16_f32 v97, v50, v51
    v_cvt_pk_bf16_f32 v98, v52, v53
    v_cvt_pk_bf16_f32 v99, v54, v55
    v_cvt_pk_bf16_f32 v100, v56, v57
    v_cvt_pk_bf16_f32 v101, v58, v59
    v_cvt_pk_bf16_f32 v102, v60, v61
    v_cvt_pk_bf16_f32 v103, v62, v63
    s_mov_b64 exec, s[32:33]
    ds_write_b64 v23, v[96:97] offset:0
    ds_write_b64 v23, v[98:99] offset:256
    ds_write_b64 v23, v[100:101] offset:512
    ds_write_b64 v23, v[102:103] offset:768
    s_add_u32 s8, s23, 0
    buffer_store_dwordx2 v[96:97], v25, s[24:27], s8 offen sc1
    s_add_u32 s8, s23, 20480
    buffer_store_dwordx2 v[98:99], v25, s[24:27], s8 offen sc1
    s_add_u32 s8, s23, 40960
    buffer_store_dwordx2 v[100:101], v25, s[24:27], s8 offen sc1
    s_add_u32 s8, s23, 61440
    buffer_store_dwordx2 v[102:103], v25, s[24:27], s8 offen sc1
    s_mov_b64 exec, -1
    s_cmp_eq_u32 s21, 63
    s_cbranch_scc1 END_22
    s_waitcnt lgkmcnt(0)
    ds_read_b128 v[104:107], v24
    s_sleep 19
    s_mul_i32 s40, s37, 20480
    s_add_u32 s40, s40, s28
    buffer_load_dwordx4 v[108:111], v21, s[24:27], s40 offen offset:0 sc1
    buffer_load_dwordx4 v[112:115], v21, s[24:27], s40 offen offset:1280 sc1
    buffer_load_dwordx4 v[116:119], v21, s[24:27], s40 offen offset:2560 sc1
    buffer_load_dwordx4 v[120:123], v21, s[24:27], s40 offen offset:3840 sc1
    buffer_load_dwordx4 v[124:127], v22, s[24:27], s40 offen sc1
QL_39:
    s_waitcnt vmcnt(0)
    v_max3_u32 v44, v108, v109, v110
    v_max3_u32 v45, v111, v112, v113
    v_max3_u32 v46, v114, v115, v116
    v_max3_u32 v131, v117, v118, v119
    v_max3_u32 v132, v120, v121, v122
    v_max3_u32 v133, v123, v124, v125
    v_max3_u32 v44, v44, v45, v46
    v_max3_u32 v44, v44, v131, v132
    v_max3_u32 v44, v44, v133, v126
    v_max_u32 v44, v44, v127
    v_cmp_eq_u32 vcc, -1, v44
    s_cbranch_vccz QD_41
    buffer_load_dwordx4 v[108:111], v21, s[24:27], s40 offen offset:0 sc1
    buffer_load_dwordx4 v[112:115], v21, s[24:27], s40 offen offset:1280 sc1
    buffer_load_dwordx4 v[116:119], v21, s[24:27], s40 offen offset:2560 sc1
    buffer_load_dwordx4 v[120:123], v21, s[24:27], s40 offen offset:3840 sc1
    buffer_load_dwordx4 v[124:127], v22, s[24:27], s40 offen sc1
    s_add_u32 s36, s36, 1
    s_cmp_gt_u32 s36, 0x100000
    s_cbranch_scc1 END_22
    s_branch QL_39
QD_41:
    s_waitcnt lgkmcnt(0)
    v_mfma_f32_16x16x32_bf16 v[48:51], v[104:107], v[124:127], 0
    v_mfma_f32_16x16x32_bf16 v[52:55], v[80:83], v[108:111], 0
    v_mfma_f32_16x16x32_bf16 v[48:51], v[84:87], v[112:115], v[48:51]
    v_mfma_f32_16x16x32_bf16 v[52:55], v[88:91], v[116:119], v[52:55]
    v_mfma_f32_16x16x32_bf16 v[48:51], v[92:95], v[120:123], v[48:51]
QE_40:
    s_add_u32 s22, s22, 1310720
    s_nop 6
    v_add_f32 v48, v48, v52
    v_add_f32 v49, v49, v53
    v_add_f32 v50, v50, v54
    v_add_f32 v51, v51, v55
    ds_write_b128 v26, v[48:51]
    s_add_u32 s8, s22, 0
    buffer_load_dwordx4 v[80:83], v20, s[24:27], s8 offen sc1
    s_add_u32 s8, s22, 81920
    buffer_load_dwordx4 v[84:87], v20, s[24:27], s8 offen sc1
    s_add_u32 s8, s22, 163840
    buffer_load_dwordx4 v[88:91], v20, s[24:27], s8 offen sc1
    s_add_u32 s8, s22, 245760
    buffer_load_dwordx4 v[92:95], v20, s[24:27], s8 offen sc1
    s_waitcnt lgkmcnt(0)
    s_barrier
    s_cmp_lg_u32 s3, 0
    s_cbranch_scc1 CN_34
    ds_read_b128 v[64:67], v27 offset:0
    ds_read_b128 v[68:71], v27 offset:640
    ds_read_b128 v[72:75], v27 offset:1024
    ds_read_b128 v[76:79], v27 offset:1664
    ds_read_b128 v[96:99], v27 offset:2048
    ds_read_b128 v[100:103], v27 offset:2688
    ds_read_b128 v[134:137], v27 offset:3072
    ds_read_b128 v[138:141], v27 offset:3712
    s_waitcnt lgkmcnt(0)
    v_pk_add_f32 v[64:65], v[64:65], v[96:97]
    v_pk_add_f32 v[66:67], v[66:67], v[98:99]
    v_pk_add_f32 v[68:69], v[68:69], v[100:101]
    v_pk_add_f32 v[70:71], v[70:71], v[102:103]
    v_pk_add_f32 v[72:73], v[72:73], v[134:135]
    v_pk_add_f32 v[74:75], v[74:75], v[136:137]
    v_pk_add_f32 v[76:77], v[76:77], v[138:139]
    v_pk_add_f32 v[78:79], v[78:79], v[140:141]
    v_pk_add_f32 v[64:65], v[64:65], v[72:73]
    v_pk_add_f32 v[66:67], v[66:67], v[74:75]
    v_pk_add_f32 v[68:69], v[68:69], v[76:77]
    v_pk_add_f32 v[70:71], v[70:71], v[78:79]
    v_pk_add_f32 v[64:65], v[64:65], v[68:69]
    v_pk_add_f32 v[66:67], v[66:67], v[70:71]
    v_cvt_pk_bf16_f32 v142, v64, v65
    v_cvt_pk_bf16_f32 v143, v66, v67
    v_min_u32 v142, -2, v142
    v_min_u32 v143, -2, v143
    s_mov_b64 exec, s[34:35]
    s_add_u32 s8, s29, 0
    buffer_store_dwordx2 v[142:143], v13, s[24:27], s8 offen sc1
    s_add_u32 s8, s29, 10240
    buffer_store_dwordx2 v[142:143], v13, s[24:27], s8 offen sc1
    s_add_u32 s8, s29, 20480
    buffer_store_dwordx2 v[142:143], v13, s[24:27], s8 offen sc1
    s_add_u32 s8, s29, 30720
    buffer_store_dwordx2 v[142:143], v13, s[24:27], s8 offen sc1
    s_mov_b64 exec, -1
CN_34:
    s_add_u32 s20, s20, 40960
    s_add_u32 s21, s21, 1
    s_add_u32 s29, s29, 40960
    s_add_u32 s28, s28, 81920
    s_add_u32 s38, s21, 1
    s_and_b32 s39, s38, 7
    s_cmp_lg_u32 s39, 0
    s_cbranch_scc1 FS_42
    s_cmp_ge_u32 s38, 64
    s_cbranch_scc1 FS_42
    s_lshl_b32 s38, s38, 4
    s_add_u32 s38, s38, 0xad5e000
FP_43:
    buffer_load_dword v145, v144, s[24:27], s38 offen sc1
    s_waitcnt vmcnt(0)
    v_cmp_eq_u32 vcc, -1, v145
    s_add_u32 s36, s36, 1
    s_cmp_gt_u32 s36, 0x400000
    s_cbranch_scc1 END_22
    s_cbranch_vccz FS_42
    s_sleep 8
    s_branch FP_43
FS_42:
    s_sleep 14
    s_add_u32 s23, s23, 327680
    s_branch CL_33
END_22:
    s_endpgm
BG_23:
    v_lshlrev_b32 v16, 4, v2
    s_sub_u32 s96, s2, 112
    s_mov_b32 s68, s96
BGL_45:
    s_cmp_ge_u32 s96, 352
    s_cbranch_scc1 BPOST_48
    s_lshr_b32 s6, s96, 5
    s_add_u32 s6, s6, 1
    s_and_b32 s7, s96, 31
    s_lshl_b32 s8, s7, 3
    s_add_u32 s8, s8, s6
    s_add_u32 s9, s8, 128
    s_cmp_lt_u32 s7, 16
    s_cselect_b32 s8, s8, s9
    s_sub_u32 s6, s96, 224
    s_and_b32 s7, s6, 15
    s_lshr_b32 s6, s6, 4
    s_lshl_b32 s7, s7, 3
    s_add_u32 s7, s7, s6
    s_add_u32 s7, s7, 128
    s_cmp_lt_u32 s96, 224
    s_cselect_b32 s2, s8, s7
    s_cmp_ge_u32 s96, 224
    s_cbranch_scc1 BSI_49
    v_mov_b32 v32, -1
    v_mov_b32 v33, -1
    v_mov_b32 v34, -1
    v_mov_b32 v35, -1
    v_lshlrev_b32 v36, 4, v0
    s_mul_i32 s6, s96, 10240
    s_add_u32 s6, s6, 0xa624000
    buffer_store_dwordx4 v[32:35], v36, s[24:27], s6 offen sc1
    s_add_u32 s7, s6, 4096
    buffer_store_dwordx4 v[32:35], v36, s[24:27], s7 offen sc1
    s_add_u32 s7, s6, 8192
    v_cmp_gt_u32 vcc, 128, v0
    s_mov_b64 exec, vcc
    buffer_store_dwordx4 v[32:35], v36, s[24:27], s7 offen sc1
    s_mov_b64 exec, -1
    s_mul_i32 s6, s96, 20480
    s_add_u32 s6, s6, 0xa8fe000
    buffer_store_dwordx4 v[32:35], v36, s[24:27], s6 offen sc1
    s_add_u32 s6, s6, 4096
    buffer_store_dwordx4 v[32:35], v36, s[24:27], s6 offen sc1
    s_add_u32 s6, s6, 4096
    buffer_store_dwordx4 v[32:35], v36, s[24:27], s6 offen sc1
    s_add_u32 s6, s6, 4096
    buffer_store_dwordx4 v[32:35], v36, s[24:27], s6 offen sc1
    s_add_u32 s6, s6, 4096
    buffer_store_dwordx4 v[32:35], v36, s[24:27], s6 offen sc1
    s_add_u32 s6, s6, 4096
BSI_49:
    s_sub_u32 s6, s2, 128
    s_cmp_lt_u32 s2, 128
    s_cselect_b32 s6, s2, s6
    s_mov_b32 s7, 0x0
    s_mov_b32 s10, 0xa00000
    s_cselect_b32 s7, s10, s7
    s_lshr_b32 s11, s6, 3
    s_and_b32 s12, s6, 7
    s_mul_i32 s13, s11, 327680
    s_add_u32 s60, s7, s13
    s_lshl_b32 s12, s12, 3
    s_mul_i32 s13, s12, 40960
    s_add_u32 s61, s13, 0x1a54000
    v_accvgpr_write_b32 a0, 0
    v_accvgpr_write_b32 a1, 0
    v_accvgpr_write_b32 a2, 0
    v_accvgpr_write_b32 a3, 0
    v_accvgpr_write_b32 a4, 0
    v_accvgpr_write_b32 a5, 0
    v_accvgpr_write_b32 a6, 0
    v_accvgpr_write_b32 a7, 0
    v_accvgpr_write_b32 a8, 0
    v_accvgpr_write_b32 a9, 0
    v_accvgpr_write_b32 a10, 0
    v_accvgpr_write_b32 a11, 0
    v_accvgpr_write_b32 a12, 0
    v_accvgpr_write_b32 a13, 0
    v_accvgpr_write_b32 a14, 0
    v_accvgpr_write_b32 a15, 0
    v_accvgpr_write_b32 a16, 0
    v_accvgpr_write_b32 a17, 0
    v_accvgpr_write_b32 a18, 0
    v_accvgpr_write_b32 a19, 0
    v_accvgpr_write_b32 a20, 0
    v_accvgpr_write_b32 a21, 0
    v_accvgpr_write_b32 a22, 0
    v_accvgpr_write_b32 a23, 0
    v_accvgpr_write_b32 a24, 0
    v_accvgpr_write_b32 a25, 0
    v_accvgpr_write_b32 a26, 0
    v_accvgpr_write_b32 a27, 0
    v_accvgpr_write_b32 a28, 0
    v_accvgpr_write_b32 a29, 0
    v_accvgpr_write_b32 a30, 0
    v_accvgpr_write_b32 a31, 0
    v_accvgpr_write_b32 a32, 0
    v_accvgpr_write_b32 a33, 0
    v_accvgpr_write_b32 a34, 0
    v_accvgpr_write_b32 a35, 0
    v_accvgpr_write_b32 a36, 0
    v_accvgpr_write_b32 a37, 0
    v_accvgpr_write_b32 a38, 0
    v_accvgpr_write_b32 a39, 0
    v_accvgpr_write_b32 a40, 0
    v_accvgpr_write_b32 a41, 0
    v_accvgpr_write_b32 a42, 0
    v_accvgpr_write_b32 a43, 0
    v_accvgpr_write_b32 a44, 0
    v_accvgpr_write_b32 a45, 0
    v_accvgpr_write_b32 a46, 0
    v_accvgpr_write_b32 a47, 0
    v_accvgpr_write_b32 a48, 0
    v_accvgpr_write_b32 a49, 0
    v_accvgpr_write_b32 a50, 0
    v_accvgpr_write_b32 a51, 0
    v_accvgpr_write_b32 a52, 0
    v_accvgpr_write_b32 a53, 0
    v_accvgpr_write_b32 a54, 0
    v_accvgpr_write_b32 a55, 0
    v_accvgpr_write_b32 a56, 0
    v_accvgpr_write_b32 a57, 0
    v_accvgpr_write_b32 a58, 0
    v_accvgpr_write_b32 a59, 0
    v_accvgpr_write_b32 a60, 0
    v_accvgpr_write_b32 a61, 0
    v_accvgpr_write_b32 a62, 0
    v_accvgpr_write_b32 a63, 0
    v_accvgpr_write_b32 a64, 0
    v_accvgpr_write_b32 a65, 0
    v_accvgpr_write_b32 a66, 0
    v_accvgpr_write_b32 a67, 0
    v_accvgpr_write_b32 a68, 0
    v_accvgpr_write_b32 a69, 0
    v_accvgpr_write_b32 a70, 0
    v_accvgpr_write_b32 a71, 0
    v_accvgpr_write_b32 a72, 0
    v_accvgpr_write_b32 a73, 0
    v_accvgpr_write_b32 a74, 0
    v_accvgpr_write_b32 a75, 0
    v_accvgpr_write_b32 a76, 0
    v_accvgpr_write_b32 a77, 0
    v_accvgpr_write_b32 a78, 0
    v_accvgpr_write_b32 a79, 0
    v_accvgpr_write_b32 a80, 0
    v_accvgpr_write_b32 a81, 0
    v_accvgpr_write_b32 a82, 0
    v_accvgpr_write_b32 a83, 0
    v_accvgpr_write_b32 a84, 0
    v_accvgpr_write_b32 a85, 0
    v_accvgpr_write_b32 a86, 0
    v_accvgpr_write_b32 a87, 0
    v_accvgpr_write_b32 a88, 0
    v_accvgpr_write_b32 a89, 0
    v_accvgpr_write_b32 a90, 0
    v_accvgpr_write_b32 a91, 0
    v_accvgpr_write_b32 a92, 0
    v_accvgpr_write_b32 a93, 0
    v_accvgpr_write_b32 a94, 0
    v_accvgpr_write_b32 a95, 0
    v_accvgpr_write_b32 a96, 0
    v_accvgpr_write_b32 a97, 0
    v_accvgpr_write_b32 a98, 0
    v_accvgpr_write_b32 a99, 0
    v_accvgpr_write_b32 a100, 0
    v_accvgpr_write_b32 a101, 0
    v_accvgpr_write_b32 a102, 0
    v_accvgpr_write_b32 a103, 0
    v_accvgpr_write_b32 a104, 0
    v_accvgpr_write_b32 a105, 0
    v_accvgpr_write_b32 a106, 0
    v_accvgpr_write_b32 a107, 0
    v_accvgpr_write_b32 a108, 0
    v_accvgpr_write_b32 a109, 0
    v_accvgpr_write_b32 a110, 0
    v_accvgpr_write_b32 a111, 0
    v_accvgpr_write_b32 a112, 0
    v_accvgpr_write_b32 a113, 0
    v_accvgpr_write_b32 a114, 0
    v_accvgpr_write_b32 a115, 0
    v_accvgpr_write_b32 a116, 0
    v_accvgpr_write_b32 a117, 0
    v_accvgpr_write_b32 a118, 0
    v_accvgpr_write_b32 a119, 0
    v_accvgpr_write_b32 a120, 0
    v_accvgpr_write_b32 a121, 0
    v_accvgpr_write_b32 a122, 0
    v_accvgpr_write_b32 a123, 0
    v_accvgpr_write_b32 a124, 0
    v_accvgpr_write_b32 a125, 0
    v_accvgpr_write_b32 a126, 0
    v_accvgpr_write_b32 a127, 0
    v_accvgpr_write_b32 a128, 0
    v_accvgpr_write_b32 a129, 0
    v_accvgpr_write_b32 a130, 0
    v_accvgpr_write_b32 a131, 0
    v_accvgpr_write_b32 a132, 0
    v_accvgpr_write_b32 a133, 0
    v_accvgpr_write_b32 a134, 0
    v_accvgpr_write_b32 a135, 0
    v_accvgpr_write_b32 a136, 0
    v_accvgpr_write_b32 a137, 0
    v_accvgpr_write_b32 a138, 0
    v_accvgpr_write_b32 a139, 0
    v_accvgpr_write_b32 a140, 0
    v_accvgpr_write_b32 a141, 0
    v_accvgpr_write_b32 a142, 0
    v_accvgpr_write_b32 a143, 0
    v_accvgpr_write_b32 a144, 0
    v_accvgpr_write_b32 a145, 0
    v_accvgpr_write_b32 a146, 0
    v_accvgpr_write_b32 a147, 0
    v_accvgpr_write_b32 a148, 0
    v_accvgpr_write_b32 a149, 0
    v_accvgpr_write_b32 a150, 0
    v_accvgpr_write_b32 a151, 0
    v_accvgpr_write_b32 a152, 0
    v_accvgpr_write_b32 a153, 0
    v_accvgpr_write_b32 a154, 0
    v_accvgpr_write_b32 a155, 0
    v_accvgpr_write_b32 a156, 0
    v_accvgpr_write_b32 a157, 0
    v_accvgpr_write_b32 a158, 0
    v_accvgpr_write_b32 a159, 0
    v_accvgpr_write_b32 a160, 0
    v_accvgpr_write_b32 a161, 0
    v_accvgpr_write_b32 a162, 0
    v_accvgpr_write_b32 a163, 0
    v_accvgpr_write_b32 a164, 0
    v_accvgpr_write_b32 a165, 0
    v_accvgpr_write_b32 a166, 0
    v_accvgpr_write_b32 a167, 0
    v_accvgpr_write_b32 a168, 0
    v_accvgpr_write_b32 a169, 0
    v_accvgpr_write_b32 a170, 0
    v_accvgpr_write_b32 a171, 0
    v_accvgpr_write_b32 a172, 0
    v_accvgpr_write_b32 a173, 0
    v_accvgpr_write_b32 a174, 0
    v_accvgpr_write_b32 a175, 0
    v_accvgpr_write_b32 a176, 0
    v_accvgpr_write_b32 a177, 0
    v_accvgpr_write_b32 a178, 0
    v_accvgpr_write_b32 a179, 0
    v_accvgpr_write_b32 a180, 0
    v_accvgpr_write_b32 a181, 0
    v_accvgpr_write_b32 a182, 0
    v_accvgpr_write_b32 a183, 0
    v_accvgpr_write_b32 a184, 0
    v_accvgpr_write_b32 a185, 0
    v_accvgpr_write_b32 a186, 0
    v_accvgpr_write_b32 a187, 0
    v_accvgpr_write_b32 a188, 0
    v_accvgpr_write_b32 a189, 0
    v_accvgpr_write_b32 a190, 0
    v_accvgpr_write_b32 a191, 0
    v_accvgpr_write_b32 a192, 0
    v_accvgpr_write_b32 a193, 0
    v_accvgpr_write_b32 a194, 0
    v_accvgpr_write_b32 a195, 0
    v_accvgpr_write_b32 a196, 0
    v_accvgpr_write_b32 a197, 0
    v_accvgpr_write_b32 a198, 0
    v_accvgpr_write_b32 a199, 0
    v_accvgpr_write_b32 a200, 0
    v_accvgpr_write_b32 a201, 0
    v_accvgpr_write_b32 a202, 0
    v_accvgpr_write_b32 a203, 0
    v_accvgpr_write_b32 a204, 0
    v_accvgpr_write_b32 a205, 0
    v_accvgpr_write_b32 a206, 0
    v_accvgpr_write_b32 a207, 0
    v_accvgpr_write_b32 a208, 0
    v_accvgpr_write_b32 a209, 0
    v_accvgpr_write_b32 a210, 0
    v_accvgpr_write_b32 a211, 0
    v_accvgpr_write_b32 a212, 0
    v_accvgpr_write_b32 a213, 0
    v_accvgpr_write_b32 a214, 0
    v_accvgpr_write_b32 a215, 0
    v_accvgpr_write_b32 a216, 0
    v_accvgpr_write_b32 a217, 0
    v_accvgpr_write_b32 a218, 0
    v_accvgpr_write_b32 a219, 0
    v_accvgpr_write_b32 a220, 0
    v_accvgpr_write_b32 a221, 0
    v_accvgpr_write_b32 a222, 0
    v_accvgpr_write_b32 a223, 0
    v_accvgpr_write_b32 a224, 0
    v_accvgpr_write_b32 a225, 0
    v_accvgpr_write_b32 a226, 0
    v_accvgpr_write_b32 a227, 0
    v_accvgpr_write_b32 a228, 0
    v_accvgpr_write_b32 a229, 0
    v_accvgpr_write_b32 a230, 0
    v_accvgpr_write_b32 a231, 0
    v_accvgpr_write_b32 a232, 0
    v_accvgpr_write_b32 a233, 0
    v_accvgpr_write_b32 a234, 0
    v_accvgpr_write_b32 a235, 0
    v_accvgpr_write_b32 a236, 0
    v_accvgpr_write_b32 a237, 0
    v_accvgpr_write_b32 a238, 0
    v_accvgpr_write_b32 a239, 0
    v_accvgpr_write_b32 a240, 0
    v_accvgpr_write_b32 a241, 0
    v_accvgpr_write_b32 a242, 0
    v_accvgpr_write_b32 a243, 0
    v_accvgpr_write_b32 a244, 0
    v_accvgpr_write_b32 a245, 0
    v_accvgpr_write_b32 a246, 0
    v_accvgpr_write_b32 a247, 0
    v_accvgpr_write_b32 a248, 0
    v_accvgpr_write_b32 a249, 0
    v_accvgpr_write_b32 a250, 0
    v_accvgpr_write_b32 a251, 0
    v_accvgpr_write_b32 a252, 0
    v_accvgpr_write_b32 a253, 0
    v_accvgpr_write_b32 a254, 0
    v_accvgpr_write_b32 a255, 0
    s_lshr_b32 s50, s3, 1
    s_and_b32 s51, s3, 1
    s_mul_i32 s50, s50, 8192
    s_mul_i32 s51, s51, 8192
    s_add_u32 s51, s51, 16384
    v_add_u32 v15, s51, v16
    v_add_u32 v14, s50, v16
    s_mul_i32 s52, s3, 8
    s_add_u32 s54, s52, 0
    s_lshr_b32 s55, s54, 1
    s_and_b32 s56, s54, 1
    s_lshl_b32 s56, s56, 10
    s_mul_i32 s57, s55, 40960
    s_add_u32 s57, s57, s60
    s_sub_u32 s58, s55, 8
    s_mul_i32 s58, s58, 40960
    s_add_u32 s58, s58, s61
    s_cmp_lt_u32 s55, 8
    s_cselect_b32 s57, s57, s58
    s_add_u32 s80, s57, s56
    s_add_u32 s54, s52, 1
    s_lshr_b32 s55, s54, 1
    s_and_b32 s56, s54, 1
    s_lshl_b32 s56, s56, 10
    s_mul_i32 s57, s55, 40960
    s_add_u32 s57, s57, s60
    s_sub_u32 s58, s55, 8
    s_mul_i32 s58, s58, 40960
    s_add_u32 s58, s58, s61
    s_cmp_lt_u32 s55, 8
    s_cselect_b32 s57, s57, s58
    s_add_u32 s81, s57, s56
    s_add_u32 s54, s52, 2
    s_lshr_b32 s55, s54, 1
    s_and_b32 s56, s54, 1
    s_lshl_b32 s56, s56, 10
    s_mul_i32 s57, s55, 40960
    s_add_u32 s57, s57, s60
    s_sub_u32 s58, s55, 8
    s_mul_i32 s58, s58, 40960
    s_add_u32 s58, s58, s61
    s_cmp_lt_u32 s55, 8
    s_cselect_b32 s57, s57, s58
    s_add_u32 s82, s57, s56
    s_add_u32 s54, s52, 3
    s_lshr_b32 s55, s54, 1
    s_and_b32 s56, s54, 1
    s_lshl_b32 s56, s56, 10
    s_mul_i32 s57, s55, 40960
    s_add_u32 s57, s57, s60
    s_sub_u32 s58, s55, 8
    s_mul_i32 s58, s58, 40960
    s_add_u32 s58, s58, s61
    s_cmp_lt_u32 s55, 8
    s_cselect_b32 s57, s57, s58
    s_add_u32 s83, s57, s56
    s_add_u32 s54, s52, 4
    s_lshr_b32 s55, s54, 1
    s_and_b32 s56, s54, 1
    s_lshl_b32 s56, s56, 10
    s_mul_i32 s57, s55, 40960
    s_add_u32 s57, s57, s60
    s_sub_u32 s58, s55, 8
    s_mul_i32 s58, s58, 40960
    s_add_u32 s58, s58, s61
    s_cmp_lt_u32 s55, 8
    s_cselect_b32 s57, s57, s58
    s_add_u32 s84, s57, s56
    s_add_u32 s54, s52, 5
    s_lshr_b32 s55, s54, 1
    s_and_b32 s56, s54, 1
    s_lshl_b32 s56, s56, 10
    s_mul_i32 s57, s55, 40960
    s_add_u32 s57, s57, s60
    s_sub_u32 s58, s55, 8
    s_mul_i32 s58, s58, 40960
    s_add_u32 s58, s58, s61
    s_cmp_lt_u32 s55, 8
    s_cselect_b32 s57, s57, s58
    s_add_u32 s85, s57, s56
    s_add_u32 s54, s52, 6
    s_lshr_b32 s55, s54, 1
    s_and_b32 s56, s54, 1
    s_lshl_b32 s56, s56, 10
    s_mul_i32 s57, s55, 40960
    s_add_u32 s57, s57, s60
    s_sub_u32 s58, s55, 8
    s_mul_i32 s58, s58, 40960
    s_add_u32 s58, s58, s61
    s_cmp_lt_u32 s55, 8
    s_cselect_b32 s57, s57, s58
    s_add_u32 s86, s57, s56
    s_add_u32 s54, s52, 7
    s_lshr_b32 s55, s54, 1
    s_and_b32 s56, s54, 1
    s_lshl_b32 s56, s56, 10
    s_mul_i32 s57, s55, 40960
    s_add_u32 s57, s57, s60
    s_sub_u32 s58, s55, 8
    s_mul_i32 s58, s58, 40960
    s_add_u32 s58, s58, s61
    s_cmp_lt_u32 s55, 8
    s_cselect_b32 s57, s57, s58
    s_add_u32 s87, s57, s56
    s_lshl_b32 s52, s52, 10
    s_mov_b32 s53, 0
    s_add_u32 s54, s53, s52
    s_mov_b32 m0, s54
    s_add_u32 s54, s54, 1024
    buffer_load_dwordx4 v16, s[24:27], s80 offen lds
    s_add_u32 s80, s80, 2048
    s_mov_b32 m0, s54
    s_add_u32 s54, s54, 1024
    buffer_load_dwordx4 v16, s[24:27], s81 offen lds
    s_add_u32 s81, s81, 2048
    s_mov_b32 m0, s54
    s_add_u32 s54, s54, 1024
    buffer_load_dwordx4 v16, s[24:27], s82 offen lds
    s_add_u32 s82, s82, 2048
    s_mov_b32 m0, s54
    s_add_u32 s54, s54, 1024
    buffer_load_dwordx4 v16, s[24:27], s83 offen lds
    s_add_u32 s83, s83, 2048
    s_mov_b32 m0, s54
    s_add_u32 s54, s54, 1024
    buffer_load_dwordx4 v16, s[24:27], s84 offen lds
    s_add_u32 s84, s84, 2048
    s_mov_b32 m0, s54
    s_add_u32 s54, s54, 1024
    buffer_load_dwordx4 v16, s[24:27], s85 offen lds
    s_add_u32 s85, s85, 2048
    s_mov_b32 m0, s54
    s_add_u32 s54, s54, 1024
    buffer_load_dwordx4 v16, s[24:27], s86 offen lds
    s_add_u32 s86, s86, 2048
    s_mov_b32 m0, s54
    s_add_u32 s54, s54, 1024
    buffer_load_dwordx4 v16, s[24:27], s87 offen lds
    s_add_u32 s87, s87, 2048
    s_add_u32 s53, s53, 32768
    s_cmp_ge_u32 s53, 131072
    s_cselect_b32 s53, 0, s53
    s_add_u32 s54, s53, s52
    s_mov_b32 m0, s54
    s_add_u32 s54, s54, 1024
    buffer_load_dwordx4 v16, s[24:27], s80 offen lds
    s_add_u32 s80, s80, 2048
    s_mov_b32 m0, s54
    s_add_u32 s54, s54, 1024
    buffer_load_dwordx4 v16, s[24:27], s81 offen lds
    s_add_u32 s81, s81, 2048
    s_mov_b32 m0, s54
    s_add_u32 s54, s54, 1024
    buffer_load_dwordx4 v16, s[24:27], s82 offen lds
    s_add_u32 s82, s82, 2048
    s_mov_b32 m0, s54
    s_add_u32 s54, s54, 1024
    buffer_load_dwordx4 v16, s[24:27], s83 offen lds
    s_add_u32 s83, s83, 2048
    s_mov_b32 m0, s54
    s_add_u32 s54, s54, 1024
    buffer_load_dwordx4 v16, s[24:27], s84 offen lds
    s_add_u32 s84, s84, 2048
    s_mov_b32 m0, s54
    s_add_u32 s54, s54, 1024
    buffer_load_dwordx4 v16, s[24:27], s85 offen lds
    s_add_u32 s85, s85, 2048
    s_mov_b32 m0, s54
    s_add_u32 s54, s54, 1024
    buffer_load_dwordx4 v16, s[24:27], s86 offen lds
    s_add_u32 s86, s86, 2048
    s_mov_b32 m0, s54
    s_add_u32 s54, s54, 1024
    buffer_load_dwordx4 v16, s[24:27], s87 offen lds
    s_add_u32 s87, s87, 2048
    s_add_u32 s53, s53, 32768
    s_cmp_ge_u32 s53, 131072
    s_cselect_b32 s53, 0, s53
    s_add_u32 s54, s53, s52
    s_mov_b32 m0, s54
    s_add_u32 s54, s54, 1024
    buffer_load_dwordx4 v16, s[24:27], s80 offen lds
    s_add_u32 s80, s80, 2048
    s_mov_b32 m0, s54
    s_add_u32 s54, s54, 1024
    buffer_load_dwordx4 v16, s[24:27], s81 offen lds
    s_add_u32 s81, s81, 2048
    s_mov_b32 m0, s54
    s_add_u32 s54, s54, 1024
    buffer_load_dwordx4 v16, s[24:27], s82 offen lds
    s_add_u32 s82, s82, 2048
    s_mov_b32 m0, s54
    s_add_u32 s54, s54, 1024
    buffer_load_dwordx4 v16, s[24:27], s83 offen lds
    s_add_u32 s83, s83, 2048
    s_mov_b32 m0, s54
    s_add_u32 s54, s54, 1024
    buffer_load_dwordx4 v16, s[24:27], s84 offen lds
    s_add_u32 s84, s84, 2048
    s_mov_b32 m0, s54
    s_add_u32 s54, s54, 1024
    buffer_load_dwordx4 v16, s[24:27], s85 offen lds
    s_add_u32 s85, s85, 2048
    s_mov_b32 m0, s54
    s_add_u32 s54, s54, 1024
    buffer_load_dwordx4 v16, s[24:27], s86 offen lds
    s_add_u32 s86, s86, 2048
    s_mov_b32 m0, s54
    s_add_u32 s54, s54, 1024
    buffer_load_dwordx4 v16, s[24:27], s87 offen lds
    s_add_u32 s87, s87, 2048
    s_add_u32 s53, s53, 32768
    s_cmp_ge_u32 s53, 131072
    s_cselect_b32 s53, 0, s53
    s_waitcnt vmcnt(16)
    s_barrier
    ds_read_b128 v[64:67], v14 offset:0
    ds_read_b128 v[68:71], v14 offset:2048
    ds_read_b128 v[72:75], v14 offset:4096
    ds_read_b128 v[76:79], v14 offset:6144
    ds_read_b128 v[80:83], v15 offset:0
    ds_read_b128 v[84:87], v15 offset:2048
    ds_read_b128 v[88:91], v15 offset:4096
    ds_read_b128 v[92:95], v15 offset:6144
    s_mov_b32 s59, 0
    s_mov_b32 s49, 0
    s_mov_b32 s47, 32768
GL_51:
    ds_read_b128 v[96:99], v14 offset:1024
    ds_read_b128 v[100:103], v14 offset:3072
    ds_read_b128 v[104:107], v14 offset:5120
    ds_read_b128 v[108:111], v14 offset:7168
    ds_read_b128 v[112:115], v15 offset:1024
    ds_read_b128 v[116:119], v15 offset:3072
    ds_read_b128 v[120:123], v15 offset:5120
    ds_read_b128 v[124:127], v15 offset:7168
    s_waitcnt lgkmcnt(8)
    v_mfma_f32_32x32x16_bf16 a[0:15], v[64:67], v[80:83], a[0:15]
    v_mfma_f32_32x32x16_bf16 a[16:31], v[64:67], v[84:87], a[16:31]
    v_mfma_f32_32x32x16_bf16 a[32:47], v[64:67], v[88:91], a[32:47]
    v_mfma_f32_32x32x16_bf16 a[48:63], v[64:67], v[92:95], a[48:63]
    v_mfma_f32_32x32x16_bf16 a[64:79], v[68:71], v[80:83], a[64:79]
    v_mfma_f32_32x32x16_bf16 a[80:95], v[68:71], v[84:87], a[80:95]
    v_mfma_f32_32x32x16_bf16 a[96:111], v[68:71], v[88:91], a[96:111]
    v_mfma_f32_32x32x16_bf16 a[112:127], v[68:71], v[92:95], a[112:127]
    v_mfma_f32_32x32x16_bf16 a[128:143], v[72:75], v[80:83], a[128:143]
    v_mfma_f32_32x32x16_bf16 a[144:159], v[72:75], v[84:87], a[144:159]
    v_mfma_f32_32x32x16_bf16 a[160:175], v[72:75], v[88:91], a[160:175]
    v_mfma_f32_32x32x16_bf16 a[176:191], v[72:75], v[92:95], a[176:191]
    v_mfma_f32_32x32x16_bf16 a[192:207], v[76:79], v[80:83], a[192:207]
    v_mfma_f32_32x32x16_bf16 a[208:223], v[76:79], v[84:87], a[208:223]
    v_mfma_f32_32x32x16_bf16 a[224:239], v[76:79], v[88:91], a[224:239]
    v_mfma_f32_32x32x16_bf16 a[240:255], v[76:79], v[92:95], a[240:255]
    s_add_u32 s49, s49, 32768
    s_cmp_ge_u32 s49, 131072
    s_cselect_b32 s48, 4294868992, s47
    s_cselect_b32 s49, 0, s49
    v_add_u32 v14, s48, v14
    v_add_u32 v15, s48, v15
    s_cmp_ge_u32 s59, 17
    s_cbranch_scc1 GL_52
    s_waitcnt vmcnt(8)
    s_barrier
    s_waitcnt lgkmcnt(0)
    ds_read_b128 v[64:67], v14 offset:0
    ds_read_b128 v[68:71], v14 offset:2048
    ds_read_b128 v[72:75], v14 offset:4096
    ds_read_b128 v[76:79], v14 offset:6144
    ds_read_b128 v[80:83], v15 offset:0
    ds_read_b128 v[84:87], v15 offset:2048
    ds_read_b128 v[88:91], v15 offset:4096
    ds_read_b128 v[92:95], v15 offset:6144
    s_add_u32 s54, s53, s52
    v_mfma_f32_32x32x16_bf16 a[0:15], v[96:99], v[112:115], a[0:15]
    v_mfma_f32_32x32x16_bf16 a[16:31], v[96:99], v[116:119], a[16:31]
    s_mov_b32 m0, s54
    s_add_u32 s54, s54, 1024
    buffer_load_dwordx4 v16, s[24:27], s80 offen lds
    s_add_u32 s80, s80, 2048
    v_mfma_f32_32x32x16_bf16 a[32:47], v[96:99], v[120:123], a[32:47]
    v_mfma_f32_32x32x16_bf16 a[48:63], v[96:99], v[124:127], a[48:63]
    s_mov_b32 m0, s54
    s_add_u32 s54, s54, 1024
    buffer_load_dwordx4 v16, s[24:27], s81 offen lds
    s_add_u32 s81, s81, 2048
    v_mfma_f32_32x32x16_bf16 a[64:79], v[100:103], v[112:115], a[64:79]
    v_mfma_f32_32x32x16_bf16 a[80:95], v[100:103], v[116:119], a[80:95]
    s_mov_b32 m0, s54
    s_add_u32 s54, s54, 1024
    buffer_load_dwordx4 v16, s[24:27], s82 offen lds
    s_add_u32 s82, s82, 2048
    v_mfma_f32_32x32x16_bf16 a[96:111], v[100:103], v[120:123], a[96:111]
    v_mfma_f32_32x32x16_bf16 a[112:127], v[100:103], v[124:127], a[112:127]
    s_mov_b32 m0, s54
    s_add_u32 s54, s54, 1024
    buffer_load_dwordx4 v16, s[24:27], s83 offen lds
    s_add_u32 s83, s83, 2048
    v_mfma_f32_32x32x16_bf16 a[128:143], v[104:107], v[112:115], a[128:143]
    v_mfma_f32_32x32x16_bf16 a[144:159], v[104:107], v[116:119], a[144:159]
    s_mov_b32 m0, s54
    s_add_u32 s54, s54, 1024
    buffer_load_dwordx4 v16, s[24:27], s84 offen lds
    s_add_u32 s84, s84, 2048
    v_mfma_f32_32x32x16_bf16 a[160:175], v[104:107], v[120:123], a[160:175]
    v_mfma_f32_32x32x16_bf16 a[176:191], v[104:107], v[124:127], a[176:191]
    s_mov_b32 m0, s54
    s_add_u32 s54, s54, 1024
    buffer_load_dwordx4 v16, s[24:27], s85 offen lds
    s_add_u32 s85, s85, 2048
    v_mfma_f32_32x32x16_bf16 a[192:207], v[108:111], v[112:115], a[192:207]
    v_mfma_f32_32x32x16_bf16 a[208:223], v[108:111], v[116:119], a[208:223]
    s_mov_b32 m0, s54
    s_add_u32 s54, s54, 1024
    buffer_load_dwordx4 v16, s[24:27], s86 offen lds
    s_add_u32 s86, s86, 2048
    v_mfma_f32_32x32x16_bf16 a[224:239], v[108:111], v[120:123], a[224:239]
    v_mfma_f32_32x32x16_bf16 a[240:255], v[108:111], v[124:127], a[240:255]
    s_mov_b32 m0, s54
    s_add_u32 s54, s54, 1024
    buffer_load_dwordx4 v16, s[24:27], s87 offen lds
    s_add_u32 s87, s87, 2048
    s_add_u32 s53, s53, 32768
    s_cmp_ge_u32 s53, 131072
    s_cselect_b32 s53, 0, s53
    s_branch GL_54
GL_52:
    s_cmp_lg_u32 s59, 17
    s_cbranch_scc1 GK_56
    s_waitcnt vmcnt(8)
    s_branch GL_53
GK_56:
    s_waitcnt vmcnt(0)
GL_53:
    s_barrier
    s_waitcnt lgkmcnt(0)
    ds_read_b128 v[64:67], v14 offset:0
    ds_read_b128 v[68:71], v14 offset:2048
    ds_read_b128 v[72:75], v14 offset:4096
    ds_read_b128 v[76:79], v14 offset:6144
    ds_read_b128 v[80:83], v15 offset:0
    ds_read_b128 v[84:87], v15 offset:2048
    ds_read_b128 v[88:91], v15 offset:4096
    ds_read_b128 v[92:95], v15 offset:6144
    v_mfma_f32_32x32x16_bf16 a[0:15], v[96:99], v[112:115], a[0:15]
    v_mfma_f32_32x32x16_bf16 a[16:31], v[96:99], v[116:119], a[16:31]
    v_mfma_f32_32x32x16_bf16 a[32:47], v[96:99], v[120:123], a[32:47]
    v_mfma_f32_32x32x16_bf16 a[48:63], v[96:99], v[124:127], a[48:63]
    v_mfma_f32_32x32x16_bf16 a[64:79], v[100:103], v[112:115], a[64:79]
    v_mfma_f32_32x32x16_bf16 a[80:95], v[100:103], v[116:119], a[80:95]
    v_mfma_f32_32x32x16_bf16 a[96:111], v[100:103], v[120:123], a[96:111]
    v_mfma_f32_32x32x16_bf16 a[112:127], v[100:103], v[124:127], a[112:127]
    v_mfma_f32_32x32x16_bf16 a[128:143], v[104:107], v[112:115], a[128:143]
    v_mfma_f32_32x32x16_bf16 a[144:159], v[104:107], v[116:119], a[144:159]
    v_mfma_f32_32x32x16_bf16 a[160:175], v[104:107], v[120:123], a[160:175]
    v_mfma_f32_32x32x16_bf16 a[176:191], v[104:107], v[124:127], a[176:191]
    v_mfma_f32_32x32x16_bf16 a[192:207], v[108:111], v[112:115], a[192:207]
    v_mfma_f32_32x32x16_bf16 a[208:223], v[108:111], v[116:119], a[208:223]
    v_mfma_f32_32x32x16_bf16 a[224:239], v[108:111], v[120:123], a[224:239]
    v_mfma_f32_32x32x16_bf16 a[240:255], v[108:111], v[124:127], a[240:255]
GL_54:
    s_add_u32 s59, s59, 1
    s_cmp_lt_u32 s59, 20
    s_cbranch_scc1 GL_51
    s_waitcnt lgkmcnt(0)
    s_nop 15
    s_lshr_b32 s14, s3, 1
    s_and_b32 s15, s3, 1
    s_lshl_b32 s16, s11, 1
    s_add_u32 s16, s16, s14
    s_mul_i32 s15, s15, 4
    s_add_u32 s17, s12, s15
    s_cmp_ge_u32 s2, 128
    s_cbranch_scc1 QKE_50
    v_accvgpr_read_b32 v32, a0
    v_accvgpr_read_b32 v33, a1
    v_accvgpr_read_b32 v34, a2
    v_accvgpr_read_b32 v35, a3
    v_accvgpr_read_b32 v36, a4
    v_accvgpr_read_b32 v37, a5
    v_accvgpr_read_b32 v38, a6
    v_accvgpr_read_b32 v39, a7
    v_cvt_pk_bf16_f32 v128, v32, v33
    v_cvt_pk_bf16_f32 v129, v34, v35
    v_cvt_pk_bf16_f32 v130, v36, v37
    v_cvt_pk_bf16_f32 v131, v38, v39
    v_accvgpr_read_b32 v40, a8
    v_accvgpr_read_b32 v41, a9
    v_accvgpr_read_b32 v42, a10
    v_accvgpr_read_b32 v43, a11
    v_accvgpr_read_b32 v44, a12
    v_accvgpr_read_b32 v45, a13
    v_accvgpr_read_b32 v46, a14
    v_accvgpr_read_b32 v47, a15
    v_cvt_pk_bf16_f32 v132, v40, v41
    v_cvt_pk_bf16_f32 v133, v42, v43
    v_cvt_pk_bf16_f32 v134, v44, v45
    v_cvt_pk_bf16_f32 v135, v46, v47
    v_accvgpr_read_b32 v32, a16
    v_accvgpr_read_b32 v33, a17
    v_accvgpr_read_b32 v34, a18
    v_accvgpr_read_b32 v35, a19
    v_accvgpr_read_b32 v36, a20
    v_accvgpr_read_b32 v37, a21
    v_accvgpr_read_b32 v38, a22
    v_accvgpr_read_b32 v39, a23
    v_cvt_pk_bf16_f32 v160, v32, v33
    v_cvt_pk_bf16_f32 v161, v34, v35
    v_cvt_pk_bf16_f32 v162, v36, v37
    v_cvt_pk_bf16_f32 v163, v38, v39
    v_accvgpr_read_b32 v40, a24
    v_accvgpr_read_b32 v41, a25
    v_accvgpr_read_b32 v42, a26
    v_accvgpr_read_b32 v43, a27
    v_accvgpr_read_b32 v44, a28
    v_accvgpr_read_b32 v45, a29
    v_accvgpr_read_b32 v46, a30
    v_accvgpr_read_b32 v47, a31
    v_cvt_pk_bf16_f32 v164, v40, v41
    v_cvt_pk_bf16_f32 v165, v42, v43
    v_cvt_pk_bf16_f32 v166, v44, v45
    v_cvt_pk_bf16_f32 v167, v46, v47
    v_accvgpr_read_b32 v32, a32
    v_accvgpr_read_b32 v33, a33
    v_accvgpr_read_b32 v34, a34
    v_accvgpr_read_b32 v35, a35
    v_accvgpr_read_b32 v36, a36
    v_accvgpr_read_b32 v37, a37
    v_accvgpr_read_b32 v38, a38
    v_accvgpr_read_b32 v39, a39
    v_cvt_pk_bf16_f32 v192, v32, v33
    v_cvt_pk_bf16_f32 v193, v34, v35
    v_cvt_pk_bf16_f32 v194, v36, v37
    v_cvt_pk_bf16_f32 v195, v38, v39
    v_accvgpr_read_b32 v40, a40
    v_accvgpr_read_b32 v41, a41
    v_accvgpr_read_b32 v42, a42
    v_accvgpr_read_b32 v43, a43
    v_accvgpr_read_b32 v44, a44
    v_accvgpr_read_b32 v45, a45
    v_accvgpr_read_b32 v46, a46
    v_accvgpr_read_b32 v47, a47
    v_cvt_pk_bf16_f32 v196, v40, v41
    v_cvt_pk_bf16_f32 v197, v42, v43
    v_cvt_pk_bf16_f32 v198, v44, v45
    v_cvt_pk_bf16_f32 v199, v46, v47
    v_accvgpr_read_b32 v32, a48
    v_accvgpr_read_b32 v33, a49
    v_accvgpr_read_b32 v34, a50
    v_accvgpr_read_b32 v35, a51
    v_accvgpr_read_b32 v36, a52
    v_accvgpr_read_b32 v37, a53
    v_accvgpr_read_b32 v38, a54
    v_accvgpr_read_b32 v39, a55
    v_cvt_pk_bf16_f32 v224, v32, v33
    v_cvt_pk_bf16_f32 v225, v34, v35
    v_cvt_pk_bf16_f32 v226, v36, v37
    v_cvt_pk_bf16_f32 v227, v38, v39
    v_accvgpr_read_b32 v40, a56
    v_accvgpr_read_b32 v41, a57
    v_accvgpr_read_b32 v42, a58
    v_accvgpr_read_b32 v43, a59
    v_accvgpr_read_b32 v44, a60
    v_accvgpr_read_b32 v45, a61
    v_accvgpr_read_b32 v46, a62
    v_accvgpr_read_b32 v47, a63
    v_cvt_pk_bf16_f32 v228, v40, v41
    v_cvt_pk_bf16_f32 v229, v42, v43
    v_cvt_pk_bf16_f32 v230, v44, v45
    v_cvt_pk_bf16_f32 v231, v46, v47
    v_accvgpr_read_b32 v32, a64
    v_accvgpr_read_b32 v33, a65
    v_accvgpr_read_b32 v34, a66
    v_accvgpr_read_b32 v35, a67
    v_accvgpr_read_b32 v36, a68
    v_accvgpr_read_b32 v37, a69
    v_accvgpr_read_b32 v38, a70
    v_accvgpr_read_b32 v39, a71
    v_cvt_pk_bf16_f32 v136, v32, v33
    v_cvt_pk_bf16_f32 v137, v34, v35
    v_cvt_pk_bf16_f32 v138, v36, v37
    v_cvt_pk_bf16_f32 v139, v38, v39
    v_accvgpr_read_b32 v40, a72
    v_accvgpr_read_b32 v41, a73
    v_accvgpr_read_b32 v42, a74
    v_accvgpr_read_b32 v43, a75
    v_accvgpr_read_b32 v44, a76
    v_accvgpr_read_b32 v45, a77
    v_accvgpr_read_b32 v46, a78
    v_accvgpr_read_b32 v47, a79
    v_cvt_pk_bf16_f32 v140, v40, v41
    v_cvt_pk_bf16_f32 v141, v42, v43
    v_cvt_pk_bf16_f32 v142, v44, v45
    v_cvt_pk_bf16_f32 v143, v46, v47
    v_accvgpr_read_b32 v32, a80
    v_accvgpr_read_b32 v33, a81
    v_accvgpr_read_b32 v34, a82
    v_accvgpr_read_b32 v35, a83
    v_accvgpr_read_b32 v36, a84
    v_accvgpr_read_b32 v37, a85
    v_accvgpr_read_b32 v38, a86
    v_accvgpr_read_b32 v39, a87
    v_cvt_pk_bf16_f32 v168, v32, v33
    v_cvt_pk_bf16_f32 v169, v34, v35
    v_cvt_pk_bf16_f32 v170, v36, v37
    v_cvt_pk_bf16_f32 v171, v38, v39
    v_accvgpr_read_b32 v40, a88
    v_accvgpr_read_b32 v41, a89
    v_accvgpr_read_b32 v42, a90
    v_accvgpr_read_b32 v43, a91
    v_accvgpr_read_b32 v44, a92
    v_accvgpr_read_b32 v45, a93
    v_accvgpr_read_b32 v46, a94
    v_accvgpr_read_b32 v47, a95
    v_cvt_pk_bf16_f32 v172, v40, v41
    v_cvt_pk_bf16_f32 v173, v42, v43
    v_cvt_pk_bf16_f32 v174, v44, v45
    v_cvt_pk_bf16_f32 v175, v46, v47
    v_accvgpr_read_b32 v32, a96
    v_accvgpr_read_b32 v33, a97
    v_accvgpr_read_b32 v34, a98
    v_accvgpr_read_b32 v35, a99
    v_accvgpr_read_b32 v36, a100
    v_accvgpr_read_b32 v37, a101
    v_accvgpr_read_b32 v38, a102
    v_accvgpr_read_b32 v39, a103
    v_cvt_pk_bf16_f32 v200, v32, v33
    v_cvt_pk_bf16_f32 v201, v34, v35
    v_cvt_pk_bf16_f32 v202, v36, v37
    v_cvt_pk_bf16_f32 v203, v38, v39
    v_accvgpr_read_b32 v40, a104
    v_accvgpr_read_b32 v41, a105
    v_accvgpr_read_b32 v42, a106
    v_accvgpr_read_b32 v43, a107
    v_accvgpr_read_b32 v44, a108
    v_accvgpr_read_b32 v45, a109
    v_accvgpr_read_b32 v46, a110
    v_accvgpr_read_b32 v47, a111
    v_cvt_pk_bf16_f32 v204, v40, v41
    v_cvt_pk_bf16_f32 v205, v42, v43
    v_cvt_pk_bf16_f32 v206, v44, v45
    v_cvt_pk_bf16_f32 v207, v46, v47
    v_accvgpr_read_b32 v32, a112
    v_accvgpr_read_b32 v33, a113
    v_accvgpr_read_b32 v34, a114
    v_accvgpr_read_b32 v35, a115
    v_accvgpr_read_b32 v36, a116
    v_accvgpr_read_b32 v37, a117
    v_accvgpr_read_b32 v38, a118
    v_accvgpr_read_b32 v39, a119
    v_cvt_pk_bf16_f32 v232, v32, v33
    v_cvt_pk_bf16_f32 v233, v34, v35
    v_cvt_pk_bf16_f32 v234, v36, v37
    v_cvt_pk_bf16_f32 v235, v38, v39
    v_accvgpr_read_b32 v40, a120
    v_accvgpr_read_b32 v41, a121
    v_accvgpr_read_b32 v42, a122
    v_accvgpr_read_b32 v43, a123
    v_accvgpr_read_b32 v44, a124
    v_accvgpr_read_b32 v45, a125
    v_accvgpr_read_b32 v46, a126
    v_accvgpr_read_b32 v47, a127
    v_cvt_pk_bf16_f32 v236, v40, v41
    v_cvt_pk_bf16_f32 v237, v42, v43
    v_cvt_pk_bf16_f32 v238, v44, v45
    v_cvt_pk_bf16_f32 v239, v46, v47
    v_accvgpr_read_b32 v32, a128
    v_accvgpr_read_b32 v33, a129
    v_accvgpr_read_b32 v34, a130
    v_accvgpr_read_b32 v35, a131
    v_accvgpr_read_b32 v36, a132
    v_accvgpr_read_b32 v37, a133
    v_accvgpr_read_b32 v38, a134
    v_accvgpr_read_b32 v39, a135
    v_cvt_pk_bf16_f32 v144, v32, v33
    v_cvt_pk_bf16_f32 v145, v34, v35
    v_cvt_pk_bf16_f32 v146, v36, v37
    v_cvt_pk_bf16_f32 v147, v38, v39
    v_accvgpr_read_b32 v40, a136
    v_accvgpr_read_b32 v41, a137
    v_accvgpr_read_b32 v42, a138
    v_accvgpr_read_b32 v43, a139
    v_accvgpr_read_b32 v44, a140
    v_accvgpr_read_b32 v45, a141
    v_accvgpr_read_b32 v46, a142
    v_accvgpr_read_b32 v47, a143
    v_cvt_pk_bf16_f32 v148, v40, v41
    v_cvt_pk_bf16_f32 v149, v42, v43
    v_cvt_pk_bf16_f32 v150, v44, v45
    v_cvt_pk_bf16_f32 v151, v46, v47
    v_accvgpr_read_b32 v32, a144
    v_accvgpr_read_b32 v33, a145
    v_accvgpr_read_b32 v34, a146
    v_accvgpr_read_b32 v35, a147
    v_accvgpr_read_b32 v36, a148
    v_accvgpr_read_b32 v37, a149
    v_accvgpr_read_b32 v38, a150
    v_accvgpr_read_b32 v39, a151
    v_cvt_pk_bf16_f32 v176, v32, v33
    v_cvt_pk_bf16_f32 v177, v34, v35
    v_cvt_pk_bf16_f32 v178, v36, v37
    v_cvt_pk_bf16_f32 v179, v38, v39
    v_accvgpr_read_b32 v40, a152
    v_accvgpr_read_b32 v41, a153
    v_accvgpr_read_b32 v42, a154
    v_accvgpr_read_b32 v43, a155
    v_accvgpr_read_b32 v44, a156
    v_accvgpr_read_b32 v45, a157
    v_accvgpr_read_b32 v46, a158
    v_accvgpr_read_b32 v47, a159
    v_cvt_pk_bf16_f32 v180, v40, v41
    v_cvt_pk_bf16_f32 v181, v42, v43
    v_cvt_pk_bf16_f32 v182, v44, v45
    v_cvt_pk_bf16_f32 v183, v46, v47
    v_accvgpr_read_b32 v32, a160
    v_accvgpr_read_b32 v33, a161
    v_accvgpr_read_b32 v34, a162
    v_accvgpr_read_b32 v35, a163
    v_accvgpr_read_b32 v36, a164
    v_accvgpr_read_b32 v37, a165
    v_accvgpr_read_b32 v38, a166
    v_accvgpr_read_b32 v39, a167
    v_cvt_pk_bf16_f32 v208, v32, v33
    v_cvt_pk_bf16_f32 v209, v34, v35
    v_cvt_pk_bf16_f32 v210, v36, v37
    v_cvt_pk_bf16_f32 v211, v38, v39
    v_accvgpr_read_b32 v40, a168
    v_accvgpr_read_b32 v41, a169
    v_accvgpr_read_b32 v42, a170
    v_accvgpr_read_b32 v43, a171
    v_accvgpr_read_b32 v44, a172
    v_accvgpr_read_b32 v45, a173
    v_accvgpr_read_b32 v46, a174
    v_accvgpr_read_b32 v47, a175
    v_cvt_pk_bf16_f32 v212, v40, v41
    v_cvt_pk_bf16_f32 v213, v42, v43
    v_cvt_pk_bf16_f32 v214, v44, v45
    v_cvt_pk_bf16_f32 v215, v46, v47
    v_accvgpr_read_b32 v32, a176
    v_accvgpr_read_b32 v33, a177
    v_accvgpr_read_b32 v34, a178
    v_accvgpr_read_b32 v35, a179
    v_accvgpr_read_b32 v36, a180
    v_accvgpr_read_b32 v37, a181
    v_accvgpr_read_b32 v38, a182
    v_accvgpr_read_b32 v39, a183
    v_cvt_pk_bf16_f32 v240, v32, v33
    v_cvt_pk_bf16_f32 v241, v34, v35
    v_cvt_pk_bf16_f32 v242, v36, v37
    v_cvt_pk_bf16_f32 v243, v38, v39
    v_accvgpr_read_b32 v40, a184
    v_accvgpr_read_b32 v41, a185
    v_accvgpr_read_b32 v42, a186
    v_accvgpr_read_b32 v43, a187
    v_accvgpr_read_b32 v44, a188
    v_accvgpr_read_b32 v45, a189
    v_accvgpr_read_b32 v46, a190
    v_accvgpr_read_b32 v47, a191
    v_cvt_pk_bf16_f32 v244, v40, v41
    v_cvt_pk_bf16_f32 v245, v42, v43
    v_cvt_pk_bf16_f32 v246, v44, v45
    v_cvt_pk_bf16_f32 v247, v46, v47
    v_accvgpr_read_b32 v32, a192
    v_accvgpr_read_b32 v33, a193
    v_accvgpr_read_b32 v34, a194
    v_accvgpr_read_b32 v35, a195
    v_accvgpr_read_b32 v36, a196
    v_accvgpr_read_b32 v37, a197
    v_accvgpr_read_b32 v38, a198
    v_accvgpr_read_b32 v39, a199
    v_cvt_pk_bf16_f32 v152, v32, v33
    v_cvt_pk_bf16_f32 v153, v34, v35
    v_cvt_pk_bf16_f32 v154, v36, v37
    v_cvt_pk_bf16_f32 v155, v38, v39
    v_accvgpr_read_b32 v40, a200
    v_accvgpr_read_b32 v41, a201
    v_accvgpr_read_b32 v42, a202
    v_accvgpr_read_b32 v43, a203
    v_accvgpr_read_b32 v44, a204
    v_accvgpr_read_b32 v45, a205
    v_accvgpr_read_b32 v46, a206
    v_accvgpr_read_b32 v47, a207
    v_cvt_pk_bf16_f32 v156, v40, v41
    v_cvt_pk_bf16_f32 v157, v42, v43
    v_cvt_pk_bf16_f32 v158, v44, v45
    v_cvt_pk_bf16_f32 v159, v46, v47
    v_accvgpr_read_b32 v32, a208
    v_accvgpr_read_b32 v33, a209
    v_accvgpr_read_b32 v34, a210
    v_accvgpr_read_b32 v35, a211
    v_accvgpr_read_b32 v36, a212
    v_accvgpr_read_b32 v37, a213
    v_accvgpr_read_b32 v38, a214
    v_accvgpr_read_b32 v39, a215
    v_cvt_pk_bf16_f32 v184, v32, v33
    v_cvt_pk_bf16_f32 v185, v34, v35
    v_cvt_pk_bf16_f32 v186, v36, v37
    v_cvt_pk_bf16_f32 v187, v38, v39
    v_accvgpr_read_b32 v40, a216
    v_accvgpr_read_b32 v41, a217
    v_accvgpr_read_b32 v42, a218
    v_accvgpr_read_b32 v43, a219
    v_accvgpr_read_b32 v44, a220
    v_accvgpr_read_b32 v45, a221
    v_accvgpr_read_b32 v46, a222
    v_accvgpr_read_b32 v47, a223
    v_cvt_pk_bf16_f32 v188, v40, v41
    v_cvt_pk_bf16_f32 v189, v42, v43
    v_cvt_pk_bf16_f32 v190, v44, v45
    v_cvt_pk_bf16_f32 v191, v46, v47
    v_accvgpr_read_b32 v32, a224
    v_accvgpr_read_b32 v33, a225
    v_accvgpr_read_b32 v34, a226
    v_accvgpr_read_b32 v35, a227
    v_accvgpr_read_b32 v36, a228
    v_accvgpr_read_b32 v37, a229
    v_accvgpr_read_b32 v38, a230
    v_accvgpr_read_b32 v39, a231
    v_cvt_pk_bf16_f32 v216, v32, v33
    v_cvt_pk_bf16_f32 v217, v34, v35
    v_cvt_pk_bf16_f32 v218, v36, v37
    v_cvt_pk_bf16_f32 v219, v38, v39
    v_accvgpr_read_b32 v40, a232
    v_accvgpr_read_b32 v41, a233
    v_accvgpr_read_b32 v42, a234
    v_accvgpr_read_b32 v43, a235
    v_accvgpr_read_b32 v44, a236
    v_accvgpr_read_b32 v45, a237
    v_accvgpr_read_b32 v46, a238
    v_accvgpr_read_b32 v47, a239
    v_cvt_pk_bf16_f32 v220, v40, v41
    v_cvt_pk_bf16_f32 v221, v42, v43
    v_cvt_pk_bf16_f32 v222, v44, v45
    v_cvt_pk_bf16_f32 v223, v46, v47
    v_accvgpr_read_b32 v32, a240
    v_accvgpr_read_b32 v33, a241
    v_accvgpr_read_b32 v34, a242
    v_accvgpr_read_b32 v35, a243
    v_accvgpr_read_b32 v36, a244
    v_accvgpr_read_b32 v37, a245
    v_accvgpr_read_b32 v38, a246
    v_accvgpr_read_b32 v39, a247
    v_cvt_pk_bf16_f32 v248, v32, v33
    v_cvt_pk_bf16_f32 v249, v34, v35
    v_cvt_pk_bf16_f32 v250, v36, v37
    v_cvt_pk_bf16_f32 v251, v38, v39
    v_accvgpr_read_b32 v40, a248
    v_accvgpr_read_b32 v41, a249
    v_accvgpr_read_b32 v42, a250
    v_accvgpr_read_b32 v43, a251
    v_accvgpr_read_b32 v44, a252
    v_accvgpr_read_b32 v45, a253
    v_accvgpr_read_b32 v46, a254
    v_accvgpr_read_b32 v47, a255
    v_cvt_pk_bf16_f32 v252, v40, v41
    v_cvt_pk_bf16_f32 v253, v42, v43
    v_cvt_pk_bf16_f32 v254, v44, v45
    v_cvt_pk_bf16_f32 v255, v46, v47
    s_mul_i32 s62, s16, 163840
    s_add_u32 s62, s62, 0xf00000
    s_mul_i32 s63, s17, 1310720
    s_mul_i32 s13, s16, 40960
    s_add_u32 s63, s63, s13
    s_add_u32 s63, s63, 0x3cd4000
    v_add_u32 v17, 0x1000, v16
    buffer_load_dwordx4 a[128:131], v16, s[24:27], s62 offen offset:0
    buffer_load_dwordx4 a[132:135], v16, s[24:27], s62 offen offset:1024
    buffer_load_dwordx4 a[136:139], v16, s[24:27], s62 offen offset:2048
    buffer_load_dwordx4 a[140:143], v16, s[24:27], s62 offen offset:3072
    buffer_load_dwordx4 a[144:147], v17, s[24:27], s62 offen offset:0
    buffer_load_dwordx4 a[148:151], v17, s[24:27], s62 offen offset:1024
    buffer_load_dwordx4 a[152:155], v17, s[24:27], s62 offen offset:2048
    buffer_load_dwordx4 a[156:159], v17, s[24:27], s62 offen offset:3072
    s_add_u32 s62, s62, 8192
    buffer_load_dwordx4 a[160:163], v16, s[24:27], s62 offen offset:0
    buffer_load_dwordx4 a[164:167], v16, s[24:27], s62 offen offset:1024
    buffer_load_dwordx4 a[168:171], v16, s[24:27], s62 offen offset:2048
    buffer_load_dwordx4 a[172:175], v16, s[24:27], s62 offen offset:3072
    buffer_load_dwordx4 a[176:179], v17, s[24:27], s62 offen offset:0
    buffer_load_dwordx4 a[180:183], v17, s[24:27], s62 offen offset:1024
    buffer_load_dwordx4 a[184:187], v17, s[24:27], s62 offen offset:2048
    buffer_load_dwordx4 a[188:191], v17, s[24:27], s62 offen offset:3072
    s_add_u32 s62, s62, 8192
    s_waitcnt vmcnt(8)
    v_mfma_f32_32x32x16_bf16 a[0:15], v[128:131], a[128:131], 0
    v_mfma_f32_32x32x16_bf16 a[16:31], v[160:163], a[128:131], 0
    v_mfma_f32_32x32x16_bf16 a[32:47], v[192:195], a[128:131], 0
    v_mfma_f32_32x32x16_bf16 a[48:63], v[224:227], a[128:131], 0
    v_mfma_f32_32x32x16_bf16 a[0:15], v[132:135], a[132:135], a[0:15]
    v_mfma_f32_32x32x16_bf16 a[16:31], v[164:167], a[132:135], a[16:31]
    v_mfma_f32_32x32x16_bf16 a[32:47], v[196:199], a[132:135], a[32:47]
    v_mfma_f32_32x32x16_bf16 a[48:63], v[228:231], a[132:135], a[48:63]
    v_mfma_f32_32x32x16_bf16 a[0:15], v[136:139], a[136:139], a[0:15]
    v_mfma_f32_32x32x16_bf16 a[16:31], v[168:171], a[136:139], a[16:31]
    v_mfma_f32_32x32x16_bf16 a[32:47], v[200:203], a[136:139], a[32:47]
    v_mfma_f32_32x32x16_bf16 a[48:63], v[232:235], a[136:139], a[48:63]
    v_mfma_f32_32x32x16_bf16 a[0:15], v[140:143], a[140:143], a[0:15]
    v_mfma_f32_32x32x16_bf16 a[16:31], v[172:175], a[140:143], a[16:31]
    v_mfma_f32_32x32x16_bf16 a[32:47], v[204:207], a[140:143], a[32:47]
    v_mfma_f32_32x32x16_bf16 a[48:63], v[236:239], a[140:143], a[48:63]
    v_mfma_f32_32x32x16_bf16 a[0:15], v[144:147], a[144:147], a[0:15]
    v_mfma_f32_32x32x16_bf16 a[16:31], v[176:179], a[144:147], a[16:31]
    v_mfma_f32_32x32x16_bf16 a[32:47], v[208:211], a[144:147], a[32:47]
    v_mfma_f32_32x32x16_bf16 a[48:63], v[240:243], a[144:147], a[48:63]
    v_mfma_f32_32x32x16_bf16 a[0:15], v[148:151], a[148:151], a[0:15]
    v_mfma_f32_32x32x16_bf16 a[16:31], v[180:183], a[148:151], a[16:31]
    v_mfma_f32_32x32x16_bf16 a[32:47], v[212:215], a[148:151], a[32:47]
    v_mfma_f32_32x32x16_bf16 a[48:63], v[244:247], a[148:151], a[48:63]
    v_mfma_f32_32x32x16_bf16 a[0:15], v[152:155], a[152:155], a[0:15]
    v_mfma_f32_32x32x16_bf16 a[16:31], v[184:187], a[152:155], a[16:31]
    v_mfma_f32_32x32x16_bf16 a[32:47], v[216:219], a[152:155], a[32:47]
    v_mfma_f32_32x32x16_bf16 a[48:63], v[248:251], a[152:155], a[48:63]
    v_mfma_f32_32x32x16_bf16 a[0:15], v[156:159], a[156:159], a[0:15]
    v_mfma_f32_32x32x16_bf16 a[16:31], v[188:191], a[156:159], a[16:31]
    v_mfma_f32_32x32x16_bf16 a[32:47], v[220:223], a[156:159], a[32:47]
    v_mfma_f32_32x32x16_bf16 a[48:63], v[252:255], a[156:159], a[48:63]
    buffer_load_dwordx4 a[128:131], v16, s[24:27], s62 offen offset:0
    buffer_load_dwordx4 a[132:135], v16, s[24:27], s62 offen offset:1024
    buffer_load_dwordx4 a[136:139], v16, s[24:27], s62 offen offset:2048
    buffer_load_dwordx4 a[140:143], v16, s[24:27], s62 offen offset:3072
    buffer_load_dwordx4 a[144:147], v17, s[24:27], s62 offen offset:0
    buffer_load_dwordx4 a[148:151], v17, s[24:27], s62 offen offset:1024
    buffer_load_dwordx4 a[152:155], v17, s[24:27], s62 offen offset:2048
    buffer_load_dwordx4 a[156:159], v17, s[24:27], s62 offen offset:3072
    s_add_u32 s62, s62, 8192
    s_waitcnt vmcnt(8)
    v_mfma_f32_32x32x16_bf16 a[64:79], v[128:131], a[160:163], 0
    s_nop 15
    v_accvgpr_read_b32 v32, a0
    v_accvgpr_read_b32 v33, a1
    v_accvgpr_read_b32 v34, a2
    v_mfma_f32_32x32x16_bf16 a[80:95], v[160:163], a[160:163], 0
    v_accvgpr_read_b32 v35, a3
    v_accvgpr_read_b32 v36, a4
    v_accvgpr_read_b32 v37, a5
    v_accvgpr_read_b32 v38, a6
    v_mfma_f32_32x32x16_bf16 a[96:111], v[192:195], a[160:163], 0
    v_accvgpr_read_b32 v39, a7
    v_cvt_pk_bf16_f32 v40, v32, v33
    v_cvt_pk_bf16_f32 v41, v34, v35
    v_cvt_pk_bf16_f32 v42, v36, v37
    v_mfma_f32_32x32x16_bf16 a[112:127], v[224:227], a[160:163], 0
    v_cvt_pk_bf16_f32 v43, v38, v39
    s_add_u32 s56, s63, 0
    buffer_store_dwordx4 v[40:43], v16, s[24:27], s56 offen sc1
    v_accvgpr_read_b32 v44, a8
    v_mfma_f32_32x32x16_bf16 a[64:79], v[132:135], a[164:167], a[64:79]
    v_accvgpr_read_b32 v45, a9
    v_accvgpr_read_b32 v46, a10
    v_accvgpr_read_b32 v47, a11
    v_accvgpr_read_b32 v48, a12
    v_mfma_f32_32x32x16_bf16 a[80:95], v[164:167], a[164:167], a[80:95]
    v_accvgpr_read_b32 v49, a13
    v_accvgpr_read_b32 v50, a14
    v_accvgpr_read_b32 v51, a15
    v_cvt_pk_bf16_f32 v52, v44, v45
    v_mfma_f32_32x32x16_bf16 a[96:111], v[196:199], a[164:167], a[96:111]
    v_cvt_pk_bf16_f32 v53, v46, v47
    v_cvt_pk_bf16_f32 v54, v48, v49
    v_cvt_pk_bf16_f32 v55, v50, v51
    s_add_u32 s56, s63, 1024
    v_mfma_f32_32x32x16_bf16 a[112:127], v[228:231], a[164:167], a[112:127]
    buffer_store_dwordx4 v[52:55], v16, s[24:27], s56 offen sc1
    v_accvgpr_read_b32 v32, a16
    v_accvgpr_read_b32 v33, a17
    v_accvgpr_read_b32 v34, a18
    v_mfma_f32_32x32x16_bf16 a[64:79], v[136:139], a[168:171], a[64:79]
    v_accvgpr_read_b32 v35, a19
    v_accvgpr_read_b32 v36, a20
    v_accvgpr_read_b32 v37, a21
    v_accvgpr_read_b32 v38, a22
    v_mfma_f32_32x32x16_bf16 a[80:95], v[168:171], a[168:171], a[80:95]
    v_accvgpr_read_b32 v39, a23
    v_cvt_pk_bf16_f32 v40, v32, v33
    v_cvt_pk_bf16_f32 v41, v34, v35
    v_cvt_pk_bf16_f32 v42, v36, v37
    v_mfma_f32_32x32x16_bf16 a[96:111], v[200:203], a[168:171], a[96:111]
    v_cvt_pk_bf16_f32 v43, v38, v39
    s_add_u32 s56, s63, 1310720
    buffer_store_dwordx4 v[40:43], v16, s[24:27], s56 offen sc1
    v_accvgpr_read_b32 v44, a24
    v_mfma_f32_32x32x16_bf16 a[112:127], v[232:235], a[168:171], a[112:127]
    v_accvgpr_read_b32 v45, a25
    v_accvgpr_read_b32 v46, a26
    v_accvgpr_read_b32 v47, a27
    v_accvgpr_read_b32 v48, a28
    v_mfma_f32_32x32x16_bf16 a[64:79], v[140:143], a[172:175], a[64:79]
    v_accvgpr_read_b32 v49, a29
    v_accvgpr_read_b32 v50, a30
    v_accvgpr_read_b32 v51, a31
    v_cvt_pk_bf16_f32 v52, v44, v45
    v_mfma_f32_32x32x16_bf16 a[80:95], v[172:175], a[172:175], a[80:95]
    v_cvt_pk_bf16_f32 v53, v46, v47
    v_cvt_pk_bf16_f32 v54, v48, v49
    v_cvt_pk_bf16_f32 v55, v50, v51
    s_add_u32 s56, s63, 1311744
    v_mfma_f32_32x32x16_bf16 a[96:111], v[204:207], a[172:175], a[96:111]
    buffer_store_dwordx4 v[52:55], v16, s[24:27], s56 offen sc1
    v_accvgpr_read_b32 v32, a32
    v_accvgpr_read_b32 v33, a33
    v_accvgpr_read_b32 v34, a34
    v_mfma_f32_32x32x16_bf16 a[112:127], v[236:239], a[172:175], a[112:127]
    v_accvgpr_read_b32 v35, a35
    v_accvgpr_read_b32 v36, a36
    v_accvgpr_read_b32 v37, a37
    v_accvgpr_read_b32 v38, a38
    v_mfma_f32_32x32x16_bf16 a[64:79], v[144:147], a[176:179], a[64:79]
    v_accvgpr_read_b32 v39, a39
    v_cvt_pk_bf16_f32 v40, v32, v33
    v_cvt_pk_bf16_f32 v41, v34, v35
    v_cvt_pk_bf16_f32 v42, v36, v37
    v_mfma_f32_32x32x16_bf16 a[80:95], v[176:179], a[176:179], a[80:95]
    v_cvt_pk_bf16_f32 v43, v38, v39
    s_add_u32 s56, s63, 2621440
    buffer_store_dwordx4 v[40:43], v16, s[24:27], s56 offen sc1
    v_accvgpr_read_b32 v44, a40
    v_mfma_f32_32x32x16_bf16 a[96:111], v[208:211], a[176:179], a[96:111]
    v_accvgpr_read_b32 v45, a41
    v_accvgpr_read_b32 v46, a42
    v_accvgpr_read_b32 v47, a43
    v_accvgpr_read_b32 v48, a44
    v_mfma_f32_32x32x16_bf16 a[112:127], v[240:243], a[176:179], a[112:127]
    v_accvgpr_read_b32 v49, a45
    v_accvgpr_read_b32 v50, a46
    v_accvgpr_read_b32 v51, a47
    v_cvt_pk_bf16_f32 v52, v44, v45
    v_mfma_f32_32x32x16_bf16 a[64:79], v[148:151], a[180:183], a[64:79]
    v_cvt_pk_bf16_f32 v53, v46, v47
    v_cvt_pk_bf16_f32 v54, v48, v49
    v_cvt_pk_bf16_f32 v55, v50, v51
    s_add_u32 s56, s63, 2622464
    v_mfma_f32_32x32x16_bf16 a[80:95], v[180:183], a[180:183], a[80:95]
    buffer_store_dwordx4 v[52:55], v16, s[24:27], s56 offen sc1
    v_accvgpr_read_b32 v32, a48
    v_accvgpr_read_b32 v33, a49
    v_accvgpr_read_b32 v34, a50
    v_mfma_f32_32x32x16_bf16 a[96:111], v[212:215], a[180:183], a[96:111]
    v_accvgpr_read_b32 v35, a51
    v_accvgpr_read_b32 v36, a52
    v_accvgpr_read_b32 v37, a53
    v_accvgpr_read_b32 v38, a54
    v_mfma_f32_32x32x16_bf16 a[112:127], v[244:247], a[180:183], a[112:127]
    v_accvgpr_read_b32 v39, a55
    v_cvt_pk_bf16_f32 v40, v32, v33
    v_cvt_pk_bf16_f32 v41, v34, v35
    v_cvt_pk_bf16_f32 v42, v36, v37
    v_mfma_f32_32x32x16_bf16 a[64:79], v[152:155], a[184:187], a[64:79]
    v_cvt_pk_bf16_f32 v43, v38, v39
    s_add_u32 s56, s63, 3932160
    buffer_store_dwordx4 v[40:43], v16, s[24:27], s56 offen sc1
    v_accvgpr_read_b32 v44, a56
    v_mfma_f32_32x32x16_bf16 a[80:95], v[184:187], a[184:187], a[80:95]
    v_accvgpr_read_b32 v45, a57
    v_accvgpr_read_b32 v46, a58
    v_accvgpr_read_b32 v47, a59
    v_accvgpr_read_b32 v48, a60
    v_mfma_f32_32x32x16_bf16 a[96:111], v[216:219], a[184:187], a[96:111]
    v_accvgpr_read_b32 v49, a61
    v_accvgpr_read_b32 v50, a62
    v_accvgpr_read_b32 v51, a63
    v_cvt_pk_bf16_f32 v52, v44, v45
    v_mfma_f32_32x32x16_bf16 a[112:127], v[248:251], a[184:187], a[112:127]
    v_cvt_pk_bf16_f32 v53, v46, v47
    v_cvt_pk_bf16_f32 v54, v48, v49
    v_cvt_pk_bf16_f32 v55, v50, v51
    s_add_u32 s56, s63, 3933184
    v_mfma_f32_32x32x16_bf16 a[64:79], v[156:159], a[188:191], a[64:79]
    buffer_store_dwordx4 v[52:55], v16, s[24:27], s56 offen sc1
    s_add_u32 s63, s63, 2048
    v_mfma_f32_32x32x16_bf16 a[80:95], v[188:191], a[188:191], a[80:95]
    v_mfma_f32_32x32x16_bf16 a[96:111], v[220:223], a[188:191], a[96:111]
    v_mfma_f32_32x32x16_bf16 a[112:127], v[252:255], a[188:191], a[112:127]
    buffer_load_dwordx4 a[160:163], v16, s[24:27], s62 offen offset:0
    buffer_load_dwordx4 a[164:167], v16, s[24:27], s62 offen offset:1024
    buffer_load_dwordx4 a[168:171], v16, s[24:27], s62 offen offset:2048
    buffer_load_dwordx4 a[172:175], v16, s[24:27], s62 offen offset:3072
    buffer_load_dwordx4 a[176:179], v17, s[24:27], s62 offen offset:0
    buffer_load_dwordx4 a[180:183], v17, s[24:27], s62 offen offset:1024
    buffer_load_dwordx4 a[184:187], v17, s[24:27], s62 offen offset:2048
    buffer_load_dwordx4 a[188:191], v17, s[24:27], s62 offen offset:3072
    s_add_u32 s62, s62, 8192
    s_waitcnt vmcnt(8)
    v_mfma_f32_32x32x16_bf16 a[0:15], v[128:131], a[128:131], 0
    s_nop 15
    v_accvgpr_read_b32 v32, a64
    v_accvgpr_read_b32 v33, a65
    v_accvgpr_read_b32 v34, a66
    v_mfma_f32_32x32x16_bf16 a[16:31], v[160:163], a[128:131], 0
    v_accvgpr_read_b32 v35, a67
    v_accvgpr_read_b32 v36, a68
    v_accvgpr_read_b32 v37, a69
    v_accvgpr_read_b32 v38, a70
    v_mfma_f32_32x32x16_bf16 a[32:47], v[192:195], a[128:131], 0
    v_accvgpr_read_b32 v39, a71
    v_cvt_pk_bf16_f32 v40, v32, v33
    v_cvt_pk_bf16_f32 v41, v34, v35
    v_cvt_pk_bf16_f32 v42, v36, v37
    v_mfma_f32_32x32x16_bf16 a[48:63], v[224:227], a[128:131], 0
    v_cvt_pk_bf16_f32 v43, v38, v39
    s_add_u32 s56, s63, 0
    buffer_store_dwordx4 v[40:43], v16, s[24:27], s56 offen sc1
    v_accvgpr_read_b32 v44, a72
    v_mfma_f32_32x32x16_bf16 a[0:15], v[132:135], a[132:135], a[0:15]
    v_accvgpr_read_b32 v45, a73
    v_accvgpr_read_b32 v46, a74
    v_accvgpr_read_b32 v47, a75
    v_accvgpr_read_b32 v48, a76
    v_mfma_f32_32x32x16_bf16 a[16:31], v[164:167], a[132:135], a[16:31]
    v_accvgpr_read_b32 v49, a77
    v_accvgpr_read_b32 v50, a78
    v_accvgpr_read_b32 v51, a79
    v_cvt_pk_bf16_f32 v52, v44, v45
    v_mfma_f32_32x32x16_bf16 a[32:47], v[196:199], a[132:135], a[32:47]
    v_cvt_pk_bf16_f32 v53, v46, v47
    v_cvt_pk_bf16_f32 v54, v48, v49
    v_cvt_pk_bf16_f32 v55, v50, v51
    s_add_u32 s56, s63, 1024
    v_mfma_f32_32x32x16_bf16 a[48:63], v[228:231], a[132:135], a[48:63]
    buffer_store_dwordx4 v[52:55], v16, s[24:27], s56 offen sc1
    v_accvgpr_read_b32 v32, a80
    v_accvgpr_read_b32 v33, a81
    v_accvgpr_read_b32 v34, a82
    v_mfma_f32_32x32x16_bf16 a[0:15], v[136:139], a[136:139], a[0:15]
    v_accvgpr_read_b32 v35, a83
    v_accvgpr_read_b32 v36, a84
    v_accvgpr_read_b32 v37, a85
    v_accvgpr_read_b32 v38, a86
    v_mfma_f32_32x32x16_bf16 a[16:31], v[168:171], a[136:139], a[16:31]
    v_accvgpr_read_b32 v39, a87
    v_cvt_pk_bf16_f32 v40, v32, v33
    v_cvt_pk_bf16_f32 v41, v34, v35
    v_cvt_pk_bf16_f32 v42, v36, v37
    v_mfma_f32_32x32x16_bf16 a[32:47], v[200:203], a[136:139], a[32:47]
    v_cvt_pk_bf16_f32 v43, v38, v39
    s_add_u32 s56, s63, 1310720
    buffer_store_dwordx4 v[40:43], v16, s[24:27], s56 offen sc1
    v_accvgpr_read_b32 v44, a88
    v_mfma_f32_32x32x16_bf16 a[48:63], v[232:235], a[136:139], a[48:63]
    v_accvgpr_read_b32 v45, a89
    v_accvgpr_read_b32 v46, a90
    v_accvgpr_read_b32 v47, a91
    v_accvgpr_read_b32 v48, a92
    v_mfma_f32_32x32x16_bf16 a[0:15], v[140:143], a[140:143], a[0:15]
    v_accvgpr_read_b32 v49, a93
    v_accvgpr_read_b32 v50, a94
    v_accvgpr_read_b32 v51, a95
    v_cvt_pk_bf16_f32 v52, v44, v45
    v_mfma_f32_32x32x16_bf16 a[16:31], v[172:175], a[140:143], a[16:31]
    v_cvt_pk_bf16_f32 v53, v46, v47
    v_cvt_pk_bf16_f32 v54, v48, v49
    v_cvt_pk_bf16_f32 v55, v50, v51
    s_add_u32 s56, s63, 1311744
    v_mfma_f32_32x32x16_bf16 a[32:47], v[204:207], a[140:143], a[32:47]
    buffer_store_dwordx4 v[52:55], v16, s[24:27], s56 offen sc1
    v_accvgpr_read_b32 v32, a96
    v_accvgpr_read_b32 v33, a97
    v_accvgpr_read_b32 v34, a98
    v_mfma_f32_32x32x16_bf16 a[48:63], v[236:239], a[140:143], a[48:63]
    v_accvgpr_read_b32 v35, a99
    v_accvgpr_read_b32 v36, a100
    v_accvgpr_read_b32 v37, a101
    v_accvgpr_read_b32 v38, a102
    v_mfma_f32_32x32x16_bf16 a[0:15], v[144:147], a[144:147], a[0:15]
    v_accvgpr_read_b32 v39, a103
    v_cvt_pk_bf16_f32 v40, v32, v33
    v_cvt_pk_bf16_f32 v41, v34, v35
    v_cvt_pk_bf16_f32 v42, v36, v37
    v_mfma_f32_32x32x16_bf16 a[16:31], v[176:179], a[144:147], a[16:31]
    v_cvt_pk_bf16_f32 v43, v38, v39
    s_add_u32 s56, s63, 2621440
    buffer_store_dwordx4 v[40:43], v16, s[24:27], s56 offen sc1
    v_accvgpr_read_b32 v44, a104
    v_mfma_f32_32x32x16_bf16 a[32:47], v[208:211], a[144:147], a[32:47]
    v_accvgpr_read_b32 v45, a105
    v_accvgpr_read_b32 v46, a106
    v_accvgpr_read_b32 v47, a107
    v_accvgpr_read_b32 v48, a108
    v_mfma_f32_32x32x16_bf16 a[48:63], v[240:243], a[144:147], a[48:63]
    v_accvgpr_read_b32 v49, a109
    v_accvgpr_read_b32 v50, a110
    v_accvgpr_read_b32 v51, a111
    v_cvt_pk_bf16_f32 v52, v44, v45
    v_mfma_f32_32x32x16_bf16 a[0:15], v[148:151], a[148:151], a[0:15]
    v_cvt_pk_bf16_f32 v53, v46, v47
    v_cvt_pk_bf16_f32 v54, v48, v49
    v_cvt_pk_bf16_f32 v55, v50, v51
    s_add_u32 s56, s63, 2622464
    v_mfma_f32_32x32x16_bf16 a[16:31], v[180:183], a[148:151], a[16:31]
    buffer_store_dwordx4 v[52:55], v16, s[24:27], s56 offen sc1
    v_accvgpr_read_b32 v32, a112
    v_accvgpr_read_b32 v33, a113
    v_accvgpr_read_b32 v34, a114
    v_mfma_f32_32x32x16_bf16 a[32:47], v[212:215], a[148:151], a[32:47]
    v_accvgpr_read_b32 v35, a115
    v_accvgpr_read_b32 v36, a116
    v_accvgpr_read_b32 v37, a117
    v_accvgpr_read_b32 v38, a118
    v_mfma_f32_32x32x16_bf16 a[48:63], v[244:247], a[148:151], a[48:63]
    v_accvgpr_read_b32 v39, a119
    v_cvt_pk_bf16_f32 v40, v32, v33
    v_cvt_pk_bf16_f32 v41, v34, v35
    v_cvt_pk_bf16_f32 v42, v36, v37
    v_mfma_f32_32x32x16_bf16 a[0:15], v[152:155], a[152:155], a[0:15]
    v_cvt_pk_bf16_f32 v43, v38, v39
    s_add_u32 s56, s63, 3932160
    buffer_store_dwordx4 v[40:43], v16, s[24:27], s56 offen sc1
    v_accvgpr_read_b32 v44, a120
    v_mfma_f32_32x32x16_bf16 a[16:31], v[184:187], a[152:155], a[16:31]
    v_accvgpr_read_b32 v45, a121
    v_accvgpr_read_b32 v46, a122
    v_accvgpr_read_b32 v47, a123
    v_accvgpr_read_b32 v48, a124
    v_mfma_f32_32x32x16_bf16 a[32:47], v[216:219], a[152:155], a[32:47]
    v_accvgpr_read_b32 v49, a125
    v_accvgpr_read_b32 v50, a126
    v_accvgpr_read_b32 v51, a127
    v_cvt_pk_bf16_f32 v52, v44, v45
    v_mfma_f32_32x32x16_bf16 a[48:63], v[248:251], a[152:155], a[48:63]
    v_cvt_pk_bf16_f32 v53, v46, v47
    v_cvt_pk_bf16_f32 v54, v48, v49
    v_cvt_pk_bf16_f32 v55, v50, v51
    s_add_u32 s56, s63, 3933184
    v_mfma_f32_32x32x16_bf16 a[0:15], v[156:159], a[156:159], a[0:15]
    buffer_store_dwordx4 v[52:55], v16, s[24:27], s56 offen sc1
    s_add_u32 s63, s63, 2048
    v_mfma_f32_32x32x16_bf16 a[16:31], v[188:191], a[156:159], a[16:31]
    v_mfma_f32_32x32x16_bf16 a[32:47], v[220:223], a[156:159], a[32:47]
    v_mfma_f32_32x32x16_bf16 a[48:63], v[252:255], a[156:159], a[48:63]
    buffer_load_dwordx4 a[128:131], v16, s[24:27], s62 offen offset:0
    buffer_load_dwordx4 a[132:135], v16, s[24:27], s62 offen offset:1024
    buffer_load_dwordx4 a[136:139], v16, s[24:27], s62 offen offset:2048
    buffer_load_dwordx4 a[140:143], v16, s[24:27], s62 offen offset:3072
    buffer_load_dwordx4 a[144:147], v17, s[24:27], s62 offen offset:0
    buffer_load_dwordx4 a[148:151], v17, s[24:27], s62 offen offset:1024
    buffer_load_dwordx4 a[152:155], v17, s[24:27], s62 offen offset:2048
    buffer_load_dwordx4 a[156:159], v17, s[24:27], s62 offen offset:3072
    s_add_u32 s62, s62, 8192
    s_waitcnt vmcnt(8)
    v_mfma_f32_32x32x16_bf16 a[64:79], v[128:131], a[160:163], 0
    s_nop 15
    v_accvgpr_read_b32 v32, a0
    v_accvgpr_read_b32 v33, a1
    v_accvgpr_read_b32 v34, a2
    v_mfma_f32_32x32x16_bf16 a[80:95], v[160:163], a[160:163], 0
    v_accvgpr_read_b32 v35, a3
    v_accvgpr_read_b32 v36, a4
    v_accvgpr_read_b32 v37, a5
    v_accvgpr_read_b32 v38, a6
    v_mfma_f32_32x32x16_bf16 a[96:111], v[192:195], a[160:163], 0
    v_accvgpr_read_b32 v39, a7
    v_cvt_pk_bf16_f32 v40, v32, v33
    v_cvt_pk_bf16_f32 v41, v34, v35
    v_cvt_pk_bf16_f32 v42, v36, v37
    v_mfma_f32_32x32x16_bf16 a[112:127], v[224:227], a[160:163], 0
    v_cvt_pk_bf16_f32 v43, v38, v39
    s_add_u32 s56, s63, 0
    buffer_store_dwordx4 v[40:43], v16, s[24:27], s56 offen sc1
    v_accvgpr_read_b32 v44, a8
    v_mfma_f32_32x32x16_bf16 a[64:79], v[132:135], a[164:167], a[64:79]
    v_accvgpr_read_b32 v45, a9
    v_accvgpr_read_b32 v46, a10
    v_accvgpr_read_b32 v47, a11
    v_accvgpr_read_b32 v48, a12
    v_mfma_f32_32x32x16_bf16 a[80:95], v[164:167], a[164:167], a[80:95]
    v_accvgpr_read_b32 v49, a13
    v_accvgpr_read_b32 v50, a14
    v_accvgpr_read_b32 v51, a15
    v_cvt_pk_bf16_f32 v52, v44, v45
    v_mfma_f32_32x32x16_bf16 a[96:111], v[196:199], a[164:167], a[96:111]
    v_cvt_pk_bf16_f32 v53, v46, v47
    v_cvt_pk_bf16_f32 v54, v48, v49
    v_cvt_pk_bf16_f32 v55, v50, v51
    s_add_u32 s56, s63, 1024
    v_mfma_f32_32x32x16_bf16 a[112:127], v[228:231], a[164:167], a[112:127]
    buffer_store_dwordx4 v[52:55], v16, s[24:27], s56 offen sc1
    v_accvgpr_read_b32 v32, a16
    v_accvgpr_read_b32 v33, a17
    v_accvgpr_read_b32 v34, a18
    v_mfma_f32_32x32x16_bf16 a[64:79], v[136:139], a[168:171], a[64:79]
    v_accvgpr_read_b32 v35, a19
    v_accvgpr_read_b32 v36, a20
    v_accvgpr_read_b32 v37, a21
    v_accvgpr_read_b32 v38, a22
    v_mfma_f32_32x32x16_bf16 a[80:95], v[168:171], a[168:171], a[80:95]
    v_accvgpr_read_b32 v39, a23
    v_cvt_pk_bf16_f32 v40, v32, v33
    v_cvt_pk_bf16_f32 v41, v34, v35
    v_cvt_pk_bf16_f32 v42, v36, v37
    v_mfma_f32_32x32x16_bf16 a[96:111], v[200:203], a[168:171], a[96:111]
    v_cvt_pk_bf16_f32 v43, v38, v39
    s_add_u32 s56, s63, 1310720
    buffer_store_dwordx4 v[40:43], v16, s[24:27], s56 offen sc1
    v_accvgpr_read_b32 v44, a24
    v_mfma_f32_32x32x16_bf16 a[112:127], v[232:235], a[168:171], a[112:127]
    v_accvgpr_read_b32 v45, a25
    v_accvgpr_read_b32 v46, a26
    v_accvgpr_read_b32 v47, a27
    v_accvgpr_read_b32 v48, a28
    v_mfma_f32_32x32x16_bf16 a[64:79], v[140:143], a[172:175], a[64:79]
    v_accvgpr_read_b32 v49, a29
    v_accvgpr_read_b32 v50, a30
    v_accvgpr_read_b32 v51, a31
    v_cvt_pk_bf16_f32 v52, v44, v45
    v_mfma_f32_32x32x16_bf16 a[80:95], v[172:175], a[172:175], a[80:95]
    v_cvt_pk_bf16_f32 v53, v46, v47
    v_cvt_pk_bf16_f32 v54, v48, v49
    v_cvt_pk_bf16_f32 v55, v50, v51
    s_add_u32 s56, s63, 1311744
    v_mfma_f32_32x32x16_bf16 a[96:111], v[204:207], a[172:175], a[96:111]
    buffer_store_dwordx4 v[52:55], v16, s[24:27], s56 offen sc1
    v_accvgpr_read_b32 v32, a32
    v_accvgpr_read_b32 v33, a33
    v_accvgpr_read_b32 v34, a34
    v_mfma_f32_32x32x16_bf16 a[112:127], v[236:239], a[172:175], a[112:127]
    v_accvgpr_read_b32 v35, a35
    v_accvgpr_read_b32 v36, a36
    v_accvgpr_read_b32 v37, a37
    v_accvgpr_read_b32 v38, a38
    v_mfma_f32_32x32x16_bf16 a[64:79], v[144:147], a[176:179], a[64:79]
    v_accvgpr_read_b32 v39, a39
    v_cvt_pk_bf16_f32 v40, v32, v33
    v_cvt_pk_bf16_f32 v41, v34, v35
    v_cvt_pk_bf16_f32 v42, v36, v37
    v_mfma_f32_32x32x16_bf16 a[80:95], v[176:179], a[176:179], a[80:95]
    v_cvt_pk_bf16_f32 v43, v38, v39
    s_add_u32 s56, s63, 2621440
    buffer_store_dwordx4 v[40:43], v16, s[24:27], s56 offen sc1
    v_accvgpr_read_b32 v44, a40
    v_mfma_f32_32x32x16_bf16 a[96:111], v[208:211], a[176:179], a[96:111]
    v_accvgpr_read_b32 v45, a41
    v_accvgpr_read_b32 v46, a42
    v_accvgpr_read_b32 v47, a43
    v_accvgpr_read_b32 v48, a44
    v_mfma_f32_32x32x16_bf16 a[112:127], v[240:243], a[176:179], a[112:127]
    v_accvgpr_read_b32 v49, a45
    v_accvgpr_read_b32 v50, a46
    v_accvgpr_read_b32 v51, a47
    v_cvt_pk_bf16_f32 v52, v44, v45
    v_mfma_f32_32x32x16_bf16 a[64:79], v[148:151], a[180:183], a[64:79]
    v_cvt_pk_bf16_f32 v53, v46, v47
    v_cvt_pk_bf16_f32 v54, v48, v49
    v_cvt_pk_bf16_f32 v55, v50, v51
    s_add_u32 s56, s63, 2622464
    v_mfma_f32_32x32x16_bf16 a[80:95], v[180:183], a[180:183], a[80:95]
    buffer_store_dwordx4 v[52:55], v16, s[24:27], s56 offen sc1
    v_accvgpr_read_b32 v32, a48
    v_accvgpr_read_b32 v33, a49
    v_accvgpr_read_b32 v34, a50
    v_mfma_f32_32x32x16_bf16 a[96:111], v[212:215], a[180:183], a[96:111]
    v_accvgpr_read_b32 v35, a51
    v_accvgpr_read_b32 v36, a52
    v_accvgpr_read_b32 v37, a53
    v_accvgpr_read_b32 v38, a54
    v_mfma_f32_32x32x16_bf16 a[112:127], v[244:247], a[180:183], a[112:127]
    v_accvgpr_read_b32 v39, a55
    v_cvt_pk_bf16_f32 v40, v32, v33
    v_cvt_pk_bf16_f32 v41, v34, v35
    v_cvt_pk_bf16_f32 v42, v36, v37
    v_mfma_f32_32x32x16_bf16 a[64:79], v[152:155], a[184:187], a[64:79]
    v_cvt_pk_bf16_f32 v43, v38, v39
    s_add_u32 s56, s63, 3932160
    buffer_store_dwordx4 v[40:43], v16, s[24:27], s56 offen sc1
    v_accvgpr_read_b32 v44, a56
    v_mfma_f32_32x32x16_bf16 a[80:95], v[184:187], a[184:187], a[80:95]
    v_accvgpr_read_b32 v45, a57
    v_accvgpr_read_b32 v46, a58
    v_accvgpr_read_b32 v47, a59
    v_accvgpr_read_b32 v48, a60
    v_mfma_f32_32x32x16_bf16 a[96:111], v[216:219], a[184:187], a[96:111]
    v_accvgpr_read_b32 v49, a61
    v_accvgpr_read_b32 v50, a62
    v_accvgpr_read_b32 v51, a63
    v_cvt_pk_bf16_f32 v52, v44, v45
    v_mfma_f32_32x32x16_bf16 a[112:127], v[248:251], a[184:187], a[112:127]
    v_cvt_pk_bf16_f32 v53, v46, v47
    v_cvt_pk_bf16_f32 v54, v48, v49
    v_cvt_pk_bf16_f32 v55, v50, v51
    s_add_u32 s56, s63, 3933184
    v_mfma_f32_32x32x16_bf16 a[64:79], v[156:159], a[188:191], a[64:79]
    buffer_store_dwordx4 v[52:55], v16, s[24:27], s56 offen sc1
    s_add_u32 s63, s63, 2048
    v_mfma_f32_32x32x16_bf16 a[80:95], v[188:191], a[188:191], a[80:95]
    v_mfma_f32_32x32x16_bf16 a[96:111], v[220:223], a[188:191], a[96:111]
    v_mfma_f32_32x32x16_bf16 a[112:127], v[252:255], a[188:191], a[112:127]
    buffer_load_dwordx4 a[160:163], v16, s[24:27], s62 offen offset:0
    buffer_load_dwordx4 a[164:167], v16, s[24:27], s62 offen offset:1024
    buffer_load_dwordx4 a[168:171], v16, s[24:27], s62 offen offset:2048
    buffer_load_dwordx4 a[172:175], v16, s[24:27], s62 offen offset:3072
    buffer_load_dwordx4 a[176:179], v17, s[24:27], s62 offen offset:0
    buffer_load_dwordx4 a[180:183], v17, s[24:27], s62 offen offset:1024
    buffer_load_dwordx4 a[184:187], v17, s[24:27], s62 offen offset:2048
    buffer_load_dwordx4 a[188:191], v17, s[24:27], s62 offen offset:3072
    s_add_u32 s62, s62, 8192
    s_waitcnt vmcnt(8)
    v_mfma_f32_32x32x16_bf16 a[0:15], v[128:131], a[128:131], 0
    s_nop 15
    v_accvgpr_read_b32 v32, a64
    v_accvgpr_read_b32 v33, a65
    v_accvgpr_read_b32 v34, a66
    v_mfma_f32_32x32x16_bf16 a[16:31], v[160:163], a[128:131], 0
    v_accvgpr_read_b32 v35, a67
    v_accvgpr_read_b32 v36, a68
    v_accvgpr_read_b32 v37, a69
    v_accvgpr_read_b32 v38, a70
    v_mfma_f32_32x32x16_bf16 a[32:47], v[192:195], a[128:131], 0
    v_accvgpr_read_b32 v39, a71
    v_cvt_pk_bf16_f32 v40, v32, v33
    v_cvt_pk_bf16_f32 v41, v34, v35
    v_cvt_pk_bf16_f32 v42, v36, v37
    v_mfma_f32_32x32x16_bf16 a[48:63], v[224:227], a[128:131], 0
    v_cvt_pk_bf16_f32 v43, v38, v39
    s_add_u32 s56, s63, 0
    buffer_store_dwordx4 v[40:43], v16, s[24:27], s56 offen sc1
    v_accvgpr_read_b32 v44, a72
    v_mfma_f32_32x32x16_bf16 a[0:15], v[132:135], a[132:135], a[0:15]
    v_accvgpr_read_b32 v45, a73
    v_accvgpr_read_b32 v46, a74
    v_accvgpr_read_b32 v47, a75
    v_accvgpr_read_b32 v48, a76
    v_mfma_f32_32x32x16_bf16 a[16:31], v[164:167], a[132:135], a[16:31]
    v_accvgpr_read_b32 v49, a77
    v_accvgpr_read_b32 v50, a78
    v_accvgpr_read_b32 v51, a79
    v_cvt_pk_bf16_f32 v52, v44, v45
    v_mfma_f32_32x32x16_bf16 a[32:47], v[196:199], a[132:135], a[32:47]
    v_cvt_pk_bf16_f32 v53, v46, v47
    v_cvt_pk_bf16_f32 v54, v48, v49
    v_cvt_pk_bf16_f32 v55, v50, v51
    s_add_u32 s56, s63, 1024
    v_mfma_f32_32x32x16_bf16 a[48:63], v[228:231], a[132:135], a[48:63]
    buffer_store_dwordx4 v[52:55], v16, s[24:27], s56 offen sc1
    v_accvgpr_read_b32 v32, a80
    v_accvgpr_read_b32 v33, a81
    v_accvgpr_read_b32 v34, a82
    v_mfma_f32_32x32x16_bf16 a[0:15], v[136:139], a[136:139], a[0:15]
    v_accvgpr_read_b32 v35, a83
    v_accvgpr_read_b32 v36, a84
    v_accvgpr_read_b32 v37, a85
    v_accvgpr_read_b32 v38, a86
    v_mfma_f32_32x32x16_bf16 a[16:31], v[168:171], a[136:139], a[16:31]
    v_accvgpr_read_b32 v39, a87
    v_cvt_pk_bf16_f32 v40, v32, v33
    v_cvt_pk_bf16_f32 v41, v34, v35
    v_cvt_pk_bf16_f32 v42, v36, v37
    v_mfma_f32_32x32x16_bf16 a[32:47], v[200:203], a[136:139], a[32:47]
    v_cvt_pk_bf16_f32 v43, v38, v39
    s_add_u32 s56, s63, 1310720
    buffer_store_dwordx4 v[40:43], v16, s[24:27], s56 offen sc1
    v_accvgpr_read_b32 v44, a88
    v_mfma_f32_32x32x16_bf16 a[48:63], v[232:235], a[136:139], a[48:63]
    v_accvgpr_read_b32 v45, a89
    v_accvgpr_read_b32 v46, a90
    v_accvgpr_read_b32 v47, a91
    v_accvgpr_read_b32 v48, a92
    v_mfma_f32_32x32x16_bf16 a[0:15], v[140:143], a[140:143], a[0:15]
    v_accvgpr_read_b32 v49, a93
    v_accvgpr_read_b32 v50, a94
    v_accvgpr_read_b32 v51, a95
    v_cvt_pk_bf16_f32 v52, v44, v45
    v_mfma_f32_32x32x16_bf16 a[16:31], v[172:175], a[140:143], a[16:31]
    v_cvt_pk_bf16_f32 v53, v46, v47
    v_cvt_pk_bf16_f32 v54, v48, v49
    v_cvt_pk_bf16_f32 v55, v50, v51
    s_add_u32 s56, s63, 1311744
    v_mfma_f32_32x32x16_bf16 a[32:47], v[204:207], a[140:143], a[32:47]
    buffer_store_dwordx4 v[52:55], v16, s[24:27], s56 offen sc1
    v_accvgpr_read_b32 v32, a96
    v_accvgpr_read_b32 v33, a97
    v_accvgpr_read_b32 v34, a98
    v_mfma_f32_32x32x16_bf16 a[48:63], v[236:239], a[140:143], a[48:63]
    v_accvgpr_read_b32 v35, a99
    v_accvgpr_read_b32 v36, a100
    v_accvgpr_read_b32 v37, a101
    v_accvgpr_read_b32 v38, a102
    v_mfma_f32_32x32x16_bf16 a[0:15], v[144:147], a[144:147], a[0:15]
    v_accvgpr_read_b32 v39, a103
    v_cvt_pk_bf16_f32 v40, v32, v33
    v_cvt_pk_bf16_f32 v41, v34, v35
    v_cvt_pk_bf16_f32 v42, v36, v37
    v_mfma_f32_32x32x16_bf16 a[16:31], v[176:179], a[144:147], a[16:31]
    v_cvt_pk_bf16_f32 v43, v38, v39
    s_add_u32 s56, s63, 2621440
    buffer_store_dwordx4 v[40:43], v16, s[24:27], s56 offen sc1
    v_accvgpr_read_b32 v44, a104
    v_mfma_f32_32x32x16_bf16 a[32:47], v[208:211], a[144:147], a[32:47]
    v_accvgpr_read_b32 v45, a105
    v_accvgpr_read_b32 v46, a106
    v_accvgpr_read_b32 v47, a107
    v_accvgpr_read_b32 v48, a108
    v_mfma_f32_32x32x16_bf16 a[48:63], v[240:243], a[144:147], a[48:63]
    v_accvgpr_read_b32 v49, a109
    v_accvgpr_read_b32 v50, a110
    v_accvgpr_read_b32 v51, a111
    v_cvt_pk_bf16_f32 v52, v44, v45
    v_mfma_f32_32x32x16_bf16 a[0:15], v[148:151], a[148:151], a[0:15]
    v_cvt_pk_bf16_f32 v53, v46, v47
    v_cvt_pk_bf16_f32 v54, v48, v49
    v_cvt_pk_bf16_f32 v55, v50, v51
    s_add_u32 s56, s63, 2622464
    v_mfma_f32_32x32x16_bf16 a[16:31], v[180:183], a[148:151], a[16:31]
    buffer_store_dwordx4 v[52:55], v16, s[24:27], s56 offen sc1
    v_accvgpr_read_b32 v32, a112
    v_accvgpr_read_b32 v33, a113
    v_accvgpr_read_b32 v34, a114
    v_mfma_f32_32x32x16_bf16 a[32:47], v[212:215], a[148:151], a[32:47]
    v_accvgpr_read_b32 v35, a115
    v_accvgpr_read_b32 v36, a116
    v_accvgpr_read_b32 v37, a117
    v_accvgpr_read_b32 v38, a118
    v_mfma_f32_32x32x16_bf16 a[48:63], v[244:247], a[148:151], a[48:63]
    v_accvgpr_read_b32 v39, a119
    v_cvt_pk_bf16_f32 v40, v32, v33
    v_cvt_pk_bf16_f32 v41, v34, v35
    v_cvt_pk_bf16_f32 v42, v36, v37
    v_mfma_f32_32x32x16_bf16 a[0:15], v[152:155], a[152:155], a[0:15]
    v_cvt_pk_bf16_f32 v43, v38, v39
    s_add_u32 s56, s63, 3932160
    buffer_store_dwordx4 v[40:43], v16, s[24:27], s56 offen sc1
    v_accvgpr_read_b32 v44, a120
    v_mfma_f32_32x32x16_bf16 a[16:31], v[184:187], a[152:155], a[16:31]
    v_accvgpr_read_b32 v45, a121
    v_accvgpr_read_b32 v46, a122
    v_accvgpr_read_b32 v47, a123
    v_accvgpr_read_b32 v48, a124
    v_mfma_f32_32x32x16_bf16 a[32:47], v[216:219], a[152:155], a[32:47]
    v_accvgpr_read_b32 v49, a125
    v_accvgpr_read_b32 v50, a126
    v_accvgpr_read_b32 v51, a127
    v_cvt_pk_bf16_f32 v52, v44, v45
    v_mfma_f32_32x32x16_bf16 a[48:63], v[248:251], a[152:155], a[48:63]
    v_cvt_pk_bf16_f32 v53, v46, v47
    v_cvt_pk_bf16_f32 v54, v48, v49
    v_cvt_pk_bf16_f32 v55, v50, v51
    s_add_u32 s56, s63, 3933184
    v_mfma_f32_32x32x16_bf16 a[0:15], v[156:159], a[156:159], a[0:15]
    buffer_store_dwordx4 v[52:55], v16, s[24:27], s56 offen sc1
    s_add_u32 s63, s63, 2048
    v_mfma_f32_32x32x16_bf16 a[16:31], v[188:191], a[156:159], a[16:31]
    v_mfma_f32_32x32x16_bf16 a[32:47], v[220:223], a[156:159], a[32:47]
    v_mfma_f32_32x32x16_bf16 a[48:63], v[252:255], a[156:159], a[48:63]
    buffer_load_dwordx4 a[128:131], v16, s[24:27], s62 offen offset:0
    buffer_load_dwordx4 a[132:135], v16, s[24:27], s62 offen offset:1024
    buffer_load_dwordx4 a[136:139], v16, s[24:27], s62 offen offset:2048
    buffer_load_dwordx4 a[140:143], v16, s[24:27], s62 offen offset:3072
    buffer_load_dwordx4 a[144:147], v17, s[24:27], s62 offen offset:0
    buffer_load_dwordx4 a[148:151], v17, s[24:27], s62 offen offset:1024
    buffer_load_dwordx4 a[152:155], v17, s[24:27], s62 offen offset:2048
    buffer_load_dwordx4 a[156:159], v17, s[24:27], s62 offen offset:3072
    s_add_u32 s62, s62, 8192
    s_waitcnt vmcnt(8)
    v_mfma_f32_32x32x16_bf16 a[64:79], v[128:131], a[160:163], 0
    s_nop 15
    v_accvgpr_read_b32 v32, a0
    v_accvgpr_read_b32 v33, a1
    v_accvgpr_read_b32 v34, a2
    v_mfma_f32_32x32x16_bf16 a[80:95], v[160:163], a[160:163], 0
    v_accvgpr_read_b32 v35, a3
    v_accvgpr_read_b32 v36, a4
    v_accvgpr_read_b32 v37, a5
    v_accvgpr_read_b32 v38, a6
    v_mfma_f32_32x32x16_bf16 a[96:111], v[192:195], a[160:163], 0
    v_accvgpr_read_b32 v39, a7
    v_cvt_pk_bf16_f32 v40, v32, v33
    v_cvt_pk_bf16_f32 v41, v34, v35
    v_cvt_pk_bf16_f32 v42, v36, v37
    v_mfma_f32_32x32x16_bf16 a[112:127], v[224:227], a[160:163], 0
    v_cvt_pk_bf16_f32 v43, v38, v39
    s_add_u32 s56, s63, 0
    buffer_store_dwordx4 v[40:43], v16, s[24:27], s56 offen sc1
    v_accvgpr_read_b32 v44, a8
    v_mfma_f32_32x32x16_bf16 a[64:79], v[132:135], a[164:167], a[64:79]
    v_accvgpr_read_b32 v45, a9
    v_accvgpr_read_b32 v46, a10
    v_accvgpr_read_b32 v47, a11
    v_accvgpr_read_b32 v48, a12
    v_mfma_f32_32x32x16_bf16 a[80:95], v[164:167], a[164:167], a[80:95]
    v_accvgpr_read_b32 v49, a13
    v_accvgpr_read_b32 v50, a14
    v_accvgpr_read_b32 v51, a15
    v_cvt_pk_bf16_f32 v52, v44, v45
    v_mfma_f32_32x32x16_bf16 a[96:111], v[196:199], a[164:167], a[96:111]
    v_cvt_pk_bf16_f32 v53, v46, v47
    v_cvt_pk_bf16_f32 v54, v48, v49
    v_cvt_pk_bf16_f32 v55, v50, v51
    s_add_u32 s56, s63, 1024
    v_mfma_f32_32x32x16_bf16 a[112:127], v[228:231], a[164:167], a[112:127]
    buffer_store_dwordx4 v[52:55], v16, s[24:27], s56 offen sc1
    v_accvgpr_read_b32 v32, a16
    v_accvgpr_read_b32 v33, a17
    v_accvgpr_read_b32 v34, a18
    v_mfma_f32_32x32x16_bf16 a[64:79], v[136:139], a[168:171], a[64:79]
    v_accvgpr_read_b32 v35, a19
    v_accvgpr_read_b32 v36, a20
    v_accvgpr_read_b32 v37, a21
    v_accvgpr_read_b32 v38, a22
    v_mfma_f32_32x32x16_bf16 a[80:95], v[168:171], a[168:171], a[80:95]
    v_accvgpr_read_b32 v39, a23
    v_cvt_pk_bf16_f32 v40, v32, v33
    v_cvt_pk_bf16_f32 v41, v34, v35
    v_cvt_pk_bf16_f32 v42, v36, v37
    v_mfma_f32_32x32x16_bf16 a[96:111], v[200:203], a[168:171], a[96:111]
    v_cvt_pk_bf16_f32 v43, v38, v39
    s_add_u32 s56, s63, 1310720
    buffer_store_dwordx4 v[40:43], v16, s[24:27], s56 offen sc1
    v_accvgpr_read_b32 v44, a24
    v_mfma_f32_32x32x16_bf16 a[112:127], v[232:235], a[168:171], a[112:127]
    v_accvgpr_read_b32 v45, a25
    v_accvgpr_read_b32 v46, a26
    v_accvgpr_read_b32 v47, a27
    v_accvgpr_read_b32 v48, a28
    v_mfma_f32_32x32x16_bf16 a[64:79], v[140:143], a[172:175], a[64:79]
    v_accvgpr_read_b32 v49, a29
    v_accvgpr_read_b32 v50, a30
    v_accvgpr_read_b32 v51, a31
    v_cvt_pk_bf16_f32 v52, v44, v45
    v_mfma_f32_32x32x16_bf16 a[80:95], v[172:175], a[172:175], a[80:95]
    v_cvt_pk_bf16_f32 v53, v46, v47
    v_cvt_pk_bf16_f32 v54, v48, v49
    v_cvt_pk_bf16_f32 v55, v50, v51
    s_add_u32 s56, s63, 1311744
    v_mfma_f32_32x32x16_bf16 a[96:111], v[204:207], a[172:175], a[96:111]
    buffer_store_dwordx4 v[52:55], v16, s[24:27], s56 offen sc1
    v_accvgpr_read_b32 v32, a32
    v_accvgpr_read_b32 v33, a33
    v_accvgpr_read_b32 v34, a34
    v_mfma_f32_32x32x16_bf16 a[112:127], v[236:239], a[172:175], a[112:127]
    v_accvgpr_read_b32 v35, a35
    v_accvgpr_read_b32 v36, a36
    v_accvgpr_read_b32 v37, a37
    v_accvgpr_read_b32 v38, a38
    v_mfma_f32_32x32x16_bf16 a[64:79], v[144:147], a[176:179], a[64:79]
    v_accvgpr_read_b32 v39, a39
    v_cvt_pk_bf16_f32 v40, v32, v33
    v_cvt_pk_bf16_f32 v41, v34, v35
    v_cvt_pk_bf16_f32 v42, v36, v37
    v_mfma_f32_32x32x16_bf16 a[80:95], v[176:179], a[176:179], a[80:95]
    v_cvt_pk_bf16_f32 v43, v38, v39
    s_add_u32 s56, s63, 2621440
    buffer_store_dwordx4 v[40:43], v16, s[24:27], s56 offen sc1
    v_accvgpr_read_b32 v44, a40
    v_mfma_f32_32x32x16_bf16 a[96:111], v[208:211], a[176:179], a[96:111]
    v_accvgpr_read_b32 v45, a41
    v_accvgpr_read_b32 v46, a42
    v_accvgpr_read_b32 v47, a43
    v_accvgpr_read_b32 v48, a44
    v_mfma_f32_32x32x16_bf16 a[112:127], v[240:243], a[176:179], a[112:127]
    v_accvgpr_read_b32 v49, a45
    v_accvgpr_read_b32 v50, a46
    v_accvgpr_read_b32 v51, a47
    v_cvt_pk_bf16_f32 v52, v44, v45
    v_mfma_f32_32x32x16_bf16 a[64:79], v[148:151], a[180:183], a[64:79]
    v_cvt_pk_bf16_f32 v53, v46, v47
    v_cvt_pk_bf16_f32 v54, v48, v49
    v_cvt_pk_bf16_f32 v55, v50, v51
    s_add_u32 s56, s63, 2622464
    v_mfma_f32_32x32x16_bf16 a[80:95], v[180:183], a[180:183], a[80:95]
    buffer_store_dwordx4 v[52:55], v16, s[24:27], s56 offen sc1
    v_accvgpr_read_b32 v32, a48
    v_accvgpr_read_b32 v33, a49
    v_accvgpr_read_b32 v34, a50
    v_mfma_f32_32x32x16_bf16 a[96:111], v[212:215], a[180:183], a[96:111]
    v_accvgpr_read_b32 v35, a51
    v_accvgpr_read_b32 v36, a52
    v_accvgpr_read_b32 v37, a53
    v_accvgpr_read_b32 v38, a54
    v_mfma_f32_32x32x16_bf16 a[112:127], v[244:247], a[180:183], a[112:127]
    v_accvgpr_read_b32 v39, a55
    v_cvt_pk_bf16_f32 v40, v32, v33
    v_cvt_pk_bf16_f32 v41, v34, v35
    v_cvt_pk_bf16_f32 v42, v36, v37
    v_mfma_f32_32x32x16_bf16 a[64:79], v[152:155], a[184:187], a[64:79]
    v_cvt_pk_bf16_f32 v43, v38, v39
    s_add_u32 s56, s63, 3932160
    buffer_store_dwordx4 v[40:43], v16, s[24:27], s56 offen sc1
    v_accvgpr_read_b32 v44, a56
    v_mfma_f32_32x32x16_bf16 a[80:95], v[184:187], a[184:187], a[80:95]
    v_accvgpr_read_b32 v45, a57
    v_accvgpr_read_b32 v46, a58
    v_accvgpr_read_b32 v47, a59
    v_accvgpr_read_b32 v48, a60
    v_mfma_f32_32x32x16_bf16 a[96:111], v[216:219], a[184:187], a[96:111]
    v_accvgpr_read_b32 v49, a61
    v_accvgpr_read_b32 v50, a62
    v_accvgpr_read_b32 v51, a63
    v_cvt_pk_bf16_f32 v52, v44, v45
    v_mfma_f32_32x32x16_bf16 a[112:127], v[248:251], a[184:187], a[112:127]
    v_cvt_pk_bf16_f32 v53, v46, v47
    v_cvt_pk_bf16_f32 v54, v48, v49
    v_cvt_pk_bf16_f32 v55, v50, v51
    s_add_u32 s56, s63, 3933184
    v_mfma_f32_32x32x16_bf16 a[64:79], v[156:159], a[188:191], a[64:79]
    buffer_store_dwordx4 v[52:55], v16, s[24:27], s56 offen sc1
    s_add_u32 s63, s63, 2048
    v_mfma_f32_32x32x16_bf16 a[80:95], v[188:191], a[188:191], a[80:95]
    v_mfma_f32_32x32x16_bf16 a[96:111], v[220:223], a[188:191], a[96:111]
    v_mfma_f32_32x32x16_bf16 a[112:127], v[252:255], a[188:191], a[112:127]
    buffer_load_dwordx4 a[160:163], v16, s[24:27], s62 offen offset:0
    buffer_load_dwordx4 a[164:167], v16, s[24:27], s62 offen offset:1024
    buffer_load_dwordx4 a[168:171], v16, s[24:27], s62 offen offset:2048
    buffer_load_dwordx4 a[172:175], v16, s[24:27], s62 offen offset:3072
    buffer_load_dwordx4 a[176:179], v17, s[24:27], s62 offen offset:0
    buffer_load_dwordx4 a[180:183], v17, s[24:27], s62 offen offset:1024
    buffer_load_dwordx4 a[184:187], v17, s[24:27], s62 offen offset:2048
    buffer_load_dwordx4 a[188:191], v17, s[24:27], s62 offen offset:3072
    s_add_u32 s62, s62, 8192
    s_waitcnt vmcnt(8)
    v_mfma_f32_32x32x16_bf16 a[0:15], v[128:131], a[128:131], 0
    s_nop 15
    v_accvgpr_read_b32 v32, a64
    v_accvgpr_read_b32 v33, a65
    v_accvgpr_read_b32 v34, a66
    v_mfma_f32_32x32x16_bf16 a[16:31], v[160:163], a[128:131], 0
    v_accvgpr_read_b32 v35, a67
    v_accvgpr_read_b32 v36, a68
    v_accvgpr_read_b32 v37, a69
    v_accvgpr_read_b32 v38, a70
    v_mfma_f32_32x32x16_bf16 a[32:47], v[192:195], a[128:131], 0
    v_accvgpr_read_b32 v39, a71
    v_cvt_pk_bf16_f32 v40, v32, v33
    v_cvt_pk_bf16_f32 v41, v34, v35
    v_cvt_pk_bf16_f32 v42, v36, v37
    v_mfma_f32_32x32x16_bf16 a[48:63], v[224:227], a[128:131], 0
    v_cvt_pk_bf16_f32 v43, v38, v39
    s_add_u32 s56, s63, 0
    buffer_store_dwordx4 v[40:43], v16, s[24:27], s56 offen sc1
    v_accvgpr_read_b32 v44, a72
    v_mfma_f32_32x32x16_bf16 a[0:15], v[132:135], a[132:135], a[0:15]
    v_accvgpr_read_b32 v45, a73
    v_accvgpr_read_b32 v46, a74
    v_accvgpr_read_b32 v47, a75
    v_accvgpr_read_b32 v48, a76
    v_mfma_f32_32x32x16_bf16 a[16:31], v[164:167], a[132:135], a[16:31]
    v_accvgpr_read_b32 v49, a77
    v_accvgpr_read_b32 v50, a78
    v_accvgpr_read_b32 v51, a79
    v_cvt_pk_bf16_f32 v52, v44, v45
    v_mfma_f32_32x32x16_bf16 a[32:47], v[196:199], a[132:135], a[32:47]
    v_cvt_pk_bf16_f32 v53, v46, v47
    v_cvt_pk_bf16_f32 v54, v48, v49
    v_cvt_pk_bf16_f32 v55, v50, v51
    s_add_u32 s56, s63, 1024
    v_mfma_f32_32x32x16_bf16 a[48:63], v[228:231], a[132:135], a[48:63]
    buffer_store_dwordx4 v[52:55], v16, s[24:27], s56 offen sc1
    v_accvgpr_read_b32 v32, a80
    v_accvgpr_read_b32 v33, a81
    v_accvgpr_read_b32 v34, a82
    v_mfma_f32_32x32x16_bf16 a[0:15], v[136:139], a[136:139], a[0:15]
    v_accvgpr_read_b32 v35, a83
    v_accvgpr_read_b32 v36, a84
    v_accvgpr_read_b32 v37, a85
    v_accvgpr_read_b32 v38, a86
    v_mfma_f32_32x32x16_bf16 a[16:31], v[168:171], a[136:139], a[16:31]
    v_accvgpr_read_b32 v39, a87
    v_cvt_pk_bf16_f32 v40, v32, v33
    v_cvt_pk_bf16_f32 v41, v34, v35
    v_cvt_pk_bf16_f32 v42, v36, v37
    v_mfma_f32_32x32x16_bf16 a[32:47], v[200:203], a[136:139], a[32:47]
    v_cvt_pk_bf16_f32 v43, v38, v39
    s_add_u32 s56, s63, 1310720
    buffer_store_dwordx4 v[40:43], v16, s[24:27], s56 offen sc1
    v_accvgpr_read_b32 v44, a88
    v_mfma_f32_32x32x16_bf16 a[48:63], v[232:235], a[136:139], a[48:63]
    v_accvgpr_read_b32 v45, a89
    v_accvgpr_read_b32 v46, a90
    v_accvgpr_read_b32 v47, a91
    v_accvgpr_read_b32 v48, a92
    v_mfma_f32_32x32x16_bf16 a[0:15], v[140:143], a[140:143], a[0:15]
    v_accvgpr_read_b32 v49, a93
    v_accvgpr_read_b32 v50, a94
    v_accvgpr_read_b32 v51, a95
    v_cvt_pk_bf16_f32 v52, v44, v45
    v_mfma_f32_32x32x16_bf16 a[16:31], v[172:175], a[140:143], a[16:31]
    v_cvt_pk_bf16_f32 v53, v46, v47
    v_cvt_pk_bf16_f32 v54, v48, v49
    v_cvt_pk_bf16_f32 v55, v50, v51
    s_add_u32 s56, s63, 1311744
    v_mfma_f32_32x32x16_bf16 a[32:47], v[204:207], a[140:143], a[32:47]
    buffer_store_dwordx4 v[52:55], v16, s[24:27], s56 offen sc1
    v_accvgpr_read_b32 v32, a96
    v_accvgpr_read_b32 v33, a97
    v_accvgpr_read_b32 v34, a98
    v_mfma_f32_32x32x16_bf16 a[48:63], v[236:239], a[140:143], a[48:63]
    v_accvgpr_read_b32 v35, a99
    v_accvgpr_read_b32 v36, a100
    v_accvgpr_read_b32 v37, a101
    v_accvgpr_read_b32 v38, a102
    v_mfma_f32_32x32x16_bf16 a[0:15], v[144:147], a[144:147], a[0:15]
    v_accvgpr_read_b32 v39, a103
    v_cvt_pk_bf16_f32 v40, v32, v33
    v_cvt_pk_bf16_f32 v41, v34, v35
    v_cvt_pk_bf16_f32 v42, v36, v37
    v_mfma_f32_32x32x16_bf16 a[16:31], v[176:179], a[144:147], a[16:31]
    v_cvt_pk_bf16_f32 v43, v38, v39
    s_add_u32 s56, s63, 2621440
    buffer_store_dwordx4 v[40:43], v16, s[24:27], s56 offen sc1
    v_accvgpr_read_b32 v44, a104
    v_mfma_f32_32x32x16_bf16 a[32:47], v[208:211], a[144:147], a[32:47]
    v_accvgpr_read_b32 v45, a105
    v_accvgpr_read_b32 v46, a106
    v_accvgpr_read_b32 v47, a107
    v_accvgpr_read_b32 v48, a108
    v_mfma_f32_32x32x16_bf16 a[48:63], v[240:243], a[144:147], a[48:63]
    v_accvgpr_read_b32 v49, a109
    v_accvgpr_read_b32 v50, a110
    v_accvgpr_read_b32 v51, a111
    v_cvt_pk_bf16_f32 v52, v44, v45
    v_mfma_f32_32x32x16_bf16 a[0:15], v[148:151], a[148:151], a[0:15]
    v_cvt_pk_bf16_f32 v53, v46, v47
    v_cvt_pk_bf16_f32 v54, v48, v49
    v_cvt_pk_bf16_f32 v55, v50, v51
    s_add_u32 s56, s63, 2622464
    v_mfma_f32_32x32x16_bf16 a[16:31], v[180:183], a[148:151], a[16:31]
    buffer_store_dwordx4 v[52:55], v16, s[24:27], s56 offen sc1
    v_accvgpr_read_b32 v32, a112
    v_accvgpr_read_b32 v33, a113
    v_accvgpr_read_b32 v34, a114
    v_mfma_f32_32x32x16_bf16 a[32:47], v[212:215], a[148:151], a[32:47]
    v_accvgpr_read_b32 v35, a115
    v_accvgpr_read_b32 v36, a116
    v_accvgpr_read_b32 v37, a117
    v_accvgpr_read_b32 v38, a118
    v_mfma_f32_32x32x16_bf16 a[48:63], v[244:247], a[148:151], a[48:63]
    v_accvgpr_read_b32 v39, a119
    v_cvt_pk_bf16_f32 v40, v32, v33
    v_cvt_pk_bf16_f32 v41, v34, v35
    v_cvt_pk_bf16_f32 v42, v36, v37
    v_mfma_f32_32x32x16_bf16 a[0:15], v[152:155], a[152:155], a[0:15]
    v_cvt_pk_bf16_f32 v43, v38, v39
    s_add_u32 s56, s63, 3932160
    buffer_store_dwordx4 v[40:43], v16, s[24:27], s56 offen sc1
    v_accvgpr_read_b32 v44, a120
    v_mfma_f32_32x32x16_bf16 a[16:31], v[184:187], a[152:155], a[16:31]
    v_accvgpr_read_b32 v45, a121
    v_accvgpr_read_b32 v46, a122
    v_accvgpr_read_b32 v47, a123
    v_accvgpr_read_b32 v48, a124
    v_mfma_f32_32x32x16_bf16 a[32:47], v[216:219], a[152:155], a[32:47]
    v_accvgpr_read_b32 v49, a125
    v_accvgpr_read_b32 v50, a126
    v_accvgpr_read_b32 v51, a127
    v_cvt_pk_bf16_f32 v52, v44, v45
    v_mfma_f32_32x32x16_bf16 a[48:63], v[248:251], a[152:155], a[48:63]
    v_cvt_pk_bf16_f32 v53, v46, v47
    v_cvt_pk_bf16_f32 v54, v48, v49
    v_cvt_pk_bf16_f32 v55, v50, v51
    s_add_u32 s56, s63, 3933184
    v_mfma_f32_32x32x16_bf16 a[0:15], v[156:159], a[156:159], a[0:15]
    buffer_store_dwordx4 v[52:55], v16, s[24:27], s56 offen sc1
    s_add_u32 s63, s63, 2048
    v_mfma_f32_32x32x16_bf16 a[16:31], v[188:191], a[156:159], a[16:31]
    v_mfma_f32_32x32x16_bf16 a[32:47], v[220:223], a[156:159], a[32:47]
    v_mfma_f32_32x32x16_bf16 a[48:63], v[252:255], a[156:159], a[48:63]
    buffer_load_dwordx4 a[128:131], v16, s[24:27], s62 offen offset:0
    buffer_load_dwordx4 a[132:135], v16, s[24:27], s62 offen offset:1024
    buffer_load_dwordx4 a[136:139], v16, s[24:27], s62 offen offset:2048
    buffer_load_dwordx4 a[140:143], v16, s[24:27], s62 offen offset:3072
    buffer_load_dwordx4 a[144:147], v17, s[24:27], s62 offen offset:0
    buffer_load_dwordx4 a[148:151], v17, s[24:27], s62 offen offset:1024
    buffer_load_dwordx4 a[152:155], v17, s[24:27], s62 offen offset:2048
    buffer_load_dwordx4 a[156:159], v17, s[24:27], s62 offen offset:3072
    s_add_u32 s62, s62, 8192
    s_waitcnt vmcnt(8)
    v_mfma_f32_32x32x16_bf16 a[64:79], v[128:131], a[160:163], 0
    s_nop 15
    v_accvgpr_read_b32 v32, a0
    v_accvgpr_read_b32 v33, a1
    v_accvgpr_read_b32 v34, a2
    v_mfma_f32_32x32x16_bf16 a[80:95], v[160:163], a[160:163], 0
    v_accvgpr_read_b32 v35, a3
    v_accvgpr_read_b32 v36, a4
    v_accvgpr_read_b32 v37, a5
    v_accvgpr_read_b32 v38, a6
    v_mfma_f32_32x32x16_bf16 a[96:111], v[192:195], a[160:163], 0
    v_accvgpr_read_b32 v39, a7
    v_cvt_pk_bf16_f32 v40, v32, v33
    v_cvt_pk_bf16_f32 v41, v34, v35
    v_cvt_pk_bf16_f32 v42, v36, v37
    v_mfma_f32_32x32x16_bf16 a[112:127], v[224:227], a[160:163], 0
    v_cvt_pk_bf16_f32 v43, v38, v39
    s_add_u32 s56, s63, 0
    buffer_store_dwordx4 v[40:43], v16, s[24:27], s56 offen sc1
    v_accvgpr_read_b32 v44, a8
    v_mfma_f32_32x32x16_bf16 a[64:79], v[132:135], a[164:167], a[64:79]
    v_accvgpr_read_b32 v45, a9
    v_accvgpr_read_b32 v46, a10
    v_accvgpr_read_b32 v47, a11
    v_accvgpr_read_b32 v48, a12
    v_mfma_f32_32x32x16_bf16 a[80:95], v[164:167], a[164:167], a[80:95]
    v_accvgpr_read_b32 v49, a13
    v_accvgpr_read_b32 v50, a14
    v_accvgpr_read_b32 v51, a15
    v_cvt_pk_bf16_f32 v52, v44, v45
    v_mfma_f32_32x32x16_bf16 a[96:111], v[196:199], a[164:167], a[96:111]
    v_cvt_pk_bf16_f32 v53, v46, v47
    v_cvt_pk_bf16_f32 v54, v48, v49
    v_cvt_pk_bf16_f32 v55, v50, v51
    s_add_u32 s56, s63, 1024
    v_mfma_f32_32x32x16_bf16 a[112:127], v[228:231], a[164:167], a[112:127]
    buffer_store_dwordx4 v[52:55], v16, s[24:27], s56 offen sc1
    v_accvgpr_read_b32 v32, a16
    v_accvgpr_read_b32 v33, a17
    v_accvgpr_read_b32 v34, a18
    v_mfma_f32_32x32x16_bf16 a[64:79], v[136:139], a[168:171], a[64:79]
    v_accvgpr_read_b32 v35, a19
    v_accvgpr_read_b32 v36, a20
    v_accvgpr_read_b32 v37, a21
    v_accvgpr_read_b32 v38, a22
    v_mfma_f32_32x32x16_bf16 a[80:95], v[168:171], a[168:171], a[80:95]
    v_accvgpr_read_b32 v39, a23
    v_cvt_pk_bf16_f32 v40, v32, v33
    v_cvt_pk_bf16_f32 v41, v34, v35
    v_cvt_pk_bf16_f32 v42, v36, v37
    v_mfma_f32_32x32x16_bf16 a[96:111], v[200:203], a[168:171], a[96:111]
    v_cvt_pk_bf16_f32 v43, v38, v39
    s_add_u32 s56, s63, 1310720
    buffer_store_dwordx4 v[40:43], v16, s[24:27], s56 offen sc1
    v_accvgpr_read_b32 v44, a24
    v_mfma_f32_32x32x16_bf16 a[112:127], v[232:235], a[168:171], a[112:127]
    v_accvgpr_read_b32 v45, a25
    v_accvgpr_read_b32 v46, a26
    v_accvgpr_read_b32 v47, a27
    v_accvgpr_read_b32 v48, a28
    v_mfma_f32_32x32x16_bf16 a[64:79], v[140:143], a[172:175], a[64:79]
    v_accvgpr_read_b32 v49, a29
    v_accvgpr_read_b32 v50, a30
    v_accvgpr_read_b32 v51, a31
    v_cvt_pk_bf16_f32 v52, v44, v45
    v_mfma_f32_32x32x16_bf16 a[80:95], v[172:175], a[172:175], a[80:95]
    v_cvt_pk_bf16_f32 v53, v46, v47
    v_cvt_pk_bf16_f32 v54, v48, v49
    v_cvt_pk_bf16_f32 v55, v50, v51
    s_add_u32 s56, s63, 1311744
    v_mfma_f32_32x32x16_bf16 a[96:111], v[204:207], a[172:175], a[96:111]
    buffer_store_dwordx4 v[52:55], v16, s[24:27], s56 offen sc1
    v_accvgpr_read_b32 v32, a32
    v_accvgpr_read_b32 v33, a33
    v_accvgpr_read_b32 v34, a34
    v_mfma_f32_32x32x16_bf16 a[112:127], v[236:239], a[172:175], a[112:127]
    v_accvgpr_read_b32 v35, a35
    v_accvgpr_read_b32 v36, a36
    v_accvgpr_read_b32 v37, a37
    v_accvgpr_read_b32 v38, a38
    v_mfma_f32_32x32x16_bf16 a[64:79], v[144:147], a[176:179], a[64:79]
    v_accvgpr_read_b32 v39, a39
    v_cvt_pk_bf16_f32 v40, v32, v33
    v_cvt_pk_bf16_f32 v41, v34, v35
    v_cvt_pk_bf16_f32 v42, v36, v37
    v_mfma_f32_32x32x16_bf16 a[80:95], v[176:179], a[176:179], a[80:95]
    v_cvt_pk_bf16_f32 v43, v38, v39
    s_add_u32 s56, s63, 2621440
    buffer_store_dwordx4 v[40:43], v16, s[24:27], s56 offen sc1
    v_accvgpr_read_b32 v44, a40
    v_mfma_f32_32x32x16_bf16 a[96:111], v[208:211], a[176:179], a[96:111]
    v_accvgpr_read_b32 v45, a41
    v_accvgpr_read_b32 v46, a42
    v_accvgpr_read_b32 v47, a43
    v_accvgpr_read_b32 v48, a44
    v_mfma_f32_32x32x16_bf16 a[112:127], v[240:243], a[176:179], a[112:127]
    v_accvgpr_read_b32 v49, a45
    v_accvgpr_read_b32 v50, a46
    v_accvgpr_read_b32 v51, a47
    v_cvt_pk_bf16_f32 v52, v44, v45
    v_mfma_f32_32x32x16_bf16 a[64:79], v[148:151], a[180:183], a[64:79]
    v_cvt_pk_bf16_f32 v53, v46, v47
    v_cvt_pk_bf16_f32 v54, v48, v49
    v_cvt_pk_bf16_f32 v55, v50, v51
    s_add_u32 s56, s63, 2622464
    v_mfma_f32_32x32x16_bf16 a[80:95], v[180:183], a[180:183], a[80:95]
    buffer_store_dwordx4 v[52:55], v16, s[24:27], s56 offen sc1
    v_accvgpr_read_b32 v32, a48
    v_accvgpr_read_b32 v33, a49
    v_accvgpr_read_b32 v34, a50
    v_mfma_f32_32x32x16_bf16 a[96:111], v[212:215], a[180:183], a[96:111]
    v_accvgpr_read_b32 v35, a51
    v_accvgpr_read_b32 v36, a52
    v_accvgpr_read_b32 v37, a53
    v_accvgpr_read_b32 v38, a54
    v_mfma_f32_32x32x16_bf16 a[112:127], v[244:247], a[180:183], a[112:127]
    v_accvgpr_read_b32 v39, a55
    v_cvt_pk_bf16_f32 v40, v32, v33
    v_cvt_pk_bf16_f32 v41, v34, v35
    v_cvt_pk_bf16_f32 v42, v36, v37
    v_mfma_f32_32x32x16_bf16 a[64:79], v[152:155], a[184:187], a[64:79]
    v_cvt_pk_bf16_f32 v43, v38, v39
    s_add_u32 s56, s63, 3932160
    buffer_store_dwordx4 v[40:43], v16, s[24:27], s56 offen sc1
    v_accvgpr_read_b32 v44, a56
    v_mfma_f32_32x32x16_bf16 a[80:95], v[184:187], a[184:187], a[80:95]
    v_accvgpr_read_b32 v45, a57
    v_accvgpr_read_b32 v46, a58
    v_accvgpr_read_b32 v47, a59
    v_accvgpr_read_b32 v48, a60
    v_mfma_f32_32x32x16_bf16 a[96:111], v[216:219], a[184:187], a[96:111]
    v_accvgpr_read_b32 v49, a61
    v_accvgpr_read_b32 v50, a62
    v_accvgpr_read_b32 v51, a63
    v_cvt_pk_bf16_f32 v52, v44, v45
    v_mfma_f32_32x32x16_bf16 a[112:127], v[248:251], a[184:187], a[112:127]
    v_cvt_pk_bf16_f32 v53, v46, v47
    v_cvt_pk_bf16_f32 v54, v48, v49
    v_cvt_pk_bf16_f32 v55, v50, v51
    s_add_u32 s56, s63, 3933184
    v_mfma_f32_32x32x16_bf16 a[64:79], v[156:159], a[188:191], a[64:79]
    buffer_store_dwordx4 v[52:55], v16, s[24:27], s56 offen sc1
    s_add_u32 s63, s63, 2048
    v_mfma_f32_32x32x16_bf16 a[80:95], v[188:191], a[188:191], a[80:95]
    v_mfma_f32_32x32x16_bf16 a[96:111], v[220:223], a[188:191], a[96:111]
    v_mfma_f32_32x32x16_bf16 a[112:127], v[252:255], a[188:191], a[112:127]
    buffer_load_dwordx4 a[160:163], v16, s[24:27], s62 offen offset:0
    buffer_load_dwordx4 a[164:167], v16, s[24:27], s62 offen offset:1024
    buffer_load_dwordx4 a[168:171], v16, s[24:27], s62 offen offset:2048
    buffer_load_dwordx4 a[172:175], v16, s[24:27], s62 offen offset:3072
    buffer_load_dwordx4 a[176:179], v17, s[24:27], s62 offen offset:0
    buffer_load_dwordx4 a[180:183], v17, s[24:27], s62 offen offset:1024
    buffer_load_dwordx4 a[184:187], v17, s[24:27], s62 offen offset:2048
    buffer_load_dwordx4 a[188:191], v17, s[24:27], s62 offen offset:3072
    s_add_u32 s62, s62, 8192
    s_waitcnt vmcnt(8)
    v_mfma_f32_32x32x16_bf16 a[0:15], v[128:131], a[128:131], 0
    s_nop 15
    v_accvgpr_read_b32 v32, a64
    v_accvgpr_read_b32 v33, a65
    v_accvgpr_read_b32 v34, a66
    v_mfma_f32_32x32x16_bf16 a[16:31], v[160:163], a[128:131], 0
    v_accvgpr_read_b32 v35, a67
    v_accvgpr_read_b32 v36, a68
    v_accvgpr_read_b32 v37, a69
    v_accvgpr_read_b32 v38, a70
    v_mfma_f32_32x32x16_bf16 a[32:47], v[192:195], a[128:131], 0
    v_accvgpr_read_b32 v39, a71
    v_cvt_pk_bf16_f32 v40, v32, v33
    v_cvt_pk_bf16_f32 v41, v34, v35
    v_cvt_pk_bf16_f32 v42, v36, v37
    v_mfma_f32_32x32x16_bf16 a[48:63], v[224:227], a[128:131], 0
    v_cvt_pk_bf16_f32 v43, v38, v39
    s_add_u32 s56, s63, 0
    buffer_store_dwordx4 v[40:43], v16, s[24:27], s56 offen sc1
    v_accvgpr_read_b32 v44, a72
    v_mfma_f32_32x32x16_bf16 a[0:15], v[132:135], a[132:135], a[0:15]
    v_accvgpr_read_b32 v45, a73
    v_accvgpr_read_b32 v46, a74
    v_accvgpr_read_b32 v47, a75
    v_accvgpr_read_b32 v48, a76
    v_mfma_f32_32x32x16_bf16 a[16:31], v[164:167], a[132:135], a[16:31]
    v_accvgpr_read_b32 v49, a77
    v_accvgpr_read_b32 v50, a78
    v_accvgpr_read_b32 v51, a79
    v_cvt_pk_bf16_f32 v52, v44, v45
    v_mfma_f32_32x32x16_bf16 a[32:47], v[196:199], a[132:135], a[32:47]
    v_cvt_pk_bf16_f32 v53, v46, v47
    v_cvt_pk_bf16_f32 v54, v48, v49
    v_cvt_pk_bf16_f32 v55, v50, v51
    s_add_u32 s56, s63, 1024
    v_mfma_f32_32x32x16_bf16 a[48:63], v[228:231], a[132:135], a[48:63]
    buffer_store_dwordx4 v[52:55], v16, s[24:27], s56 offen sc1
    v_accvgpr_read_b32 v32, a80
    v_accvgpr_read_b32 v33, a81
    v_accvgpr_read_b32 v34, a82
    v_mfma_f32_32x32x16_bf16 a[0:15], v[136:139], a[136:139], a[0:15]
    v_accvgpr_read_b32 v35, a83
    v_accvgpr_read_b32 v36, a84
    v_accvgpr_read_b32 v37, a85
    v_accvgpr_read_b32 v38, a86
    v_mfma_f32_32x32x16_bf16 a[16:31], v[168:171], a[136:139], a[16:31]
    v_accvgpr_read_b32 v39, a87
    v_cvt_pk_bf16_f32 v40, v32, v33
    v_cvt_pk_bf16_f32 v41, v34, v35
    v_cvt_pk_bf16_f32 v42, v36, v37
    v_mfma_f32_32x32x16_bf16 a[32:47], v[200:203], a[136:139], a[32:47]
    v_cvt_pk_bf16_f32 v43, v38, v39
    s_add_u32 s56, s63, 1310720
    buffer_store_dwordx4 v[40:43], v16, s[24:27], s56 offen sc1
    v_accvgpr_read_b32 v44, a88
    v_mfma_f32_32x32x16_bf16 a[48:63], v[232:235], a[136:139], a[48:63]
    v_accvgpr_read_b32 v45, a89
    v_accvgpr_read_b32 v46, a90
    v_accvgpr_read_b32 v47, a91
    v_accvgpr_read_b32 v48, a92
    v_mfma_f32_32x32x16_bf16 a[0:15], v[140:143], a[140:143], a[0:15]
    v_accvgpr_read_b32 v49, a93
    v_accvgpr_read_b32 v50, a94
    v_accvgpr_read_b32 v51, a95
    v_cvt_pk_bf16_f32 v52, v44, v45
    v_mfma_f32_32x32x16_bf16 a[16:31], v[172:175], a[140:143], a[16:31]
    v_cvt_pk_bf16_f32 v53, v46, v47
    v_cvt_pk_bf16_f32 v54, v48, v49
    v_cvt_pk_bf16_f32 v55, v50, v51
    s_add_u32 s56, s63, 1311744
    v_mfma_f32_32x32x16_bf16 a[32:47], v[204:207], a[140:143], a[32:47]
    buffer_store_dwordx4 v[52:55], v16, s[24:27], s56 offen sc1
    v_accvgpr_read_b32 v32, a96
    v_accvgpr_read_b32 v33, a97
    v_accvgpr_read_b32 v34, a98
    v_mfma_f32_32x32x16_bf16 a[48:63], v[236:239], a[140:143], a[48:63]
    v_accvgpr_read_b32 v35, a99
    v_accvgpr_read_b32 v36, a100
    v_accvgpr_read_b32 v37, a101
    v_accvgpr_read_b32 v38, a102
    v_mfma_f32_32x32x16_bf16 a[0:15], v[144:147], a[144:147], a[0:15]
    v_accvgpr_read_b32 v39, a103
    v_cvt_pk_bf16_f32 v40, v32, v33
    v_cvt_pk_bf16_f32 v41, v34, v35
    v_cvt_pk_bf16_f32 v42, v36, v37
    v_mfma_f32_32x32x16_bf16 a[16:31], v[176:179], a[144:147], a[16:31]
    v_cvt_pk_bf16_f32 v43, v38, v39
    s_add_u32 s56, s63, 2621440
    buffer_store_dwordx4 v[40:43], v16, s[24:27], s56 offen sc1
    v_accvgpr_read_b32 v44, a104
    v_mfma_f32_32x32x16_bf16 a[32:47], v[208:211], a[144:147], a[32:47]
    v_accvgpr_read_b32 v45, a105
    v_accvgpr_read_b32 v46, a106
    v_accvgpr_read_b32 v47, a107
    v_accvgpr_read_b32 v48, a108
    v_mfma_f32_32x32x16_bf16 a[48:63], v[240:243], a[144:147], a[48:63]
    v_accvgpr_read_b32 v49, a109
    v_accvgpr_read_b32 v50, a110
    v_accvgpr_read_b32 v51, a111
    v_cvt_pk_bf16_f32 v52, v44, v45
    v_mfma_f32_32x32x16_bf16 a[0:15], v[148:151], a[148:151], a[0:15]
    v_cvt_pk_bf16_f32 v53, v46, v47
    v_cvt_pk_bf16_f32 v54, v48, v49
    v_cvt_pk_bf16_f32 v55, v50, v51
    s_add_u32 s56, s63, 2622464
    v_mfma_f32_32x32x16_bf16 a[16:31], v[180:183], a[148:151], a[16:31]
    buffer_store_dwordx4 v[52:55], v16, s[24:27], s56 offen sc1
    v_accvgpr_read_b32 v32, a112
    v_accvgpr_read_b32 v33, a113
    v_accvgpr_read_b32 v34, a114
    v_mfma_f32_32x32x16_bf16 a[32:47], v[212:215], a[148:151], a[32:47]
    v_accvgpr_read_b32 v35, a115
    v_accvgpr_read_b32 v36, a116
    v_accvgpr_read_b32 v37, a117
    v_accvgpr_read_b32 v38, a118
    v_mfma_f32_32x32x16_bf16 a[48:63], v[244:247], a[148:151], a[48:63]
    v_accvgpr_read_b32 v39, a119
    v_cvt_pk_bf16_f32 v40, v32, v33
    v_cvt_pk_bf16_f32 v41, v34, v35
    v_cvt_pk_bf16_f32 v42, v36, v37
    v_mfma_f32_32x32x16_bf16 a[0:15], v[152:155], a[152:155], a[0:15]
    v_cvt_pk_bf16_f32 v43, v38, v39
    s_add_u32 s56, s63, 3932160
    buffer_store_dwordx4 v[40:43], v16, s[24:27], s56 offen sc1
    v_accvgpr_read_b32 v44, a120
    v_mfma_f32_32x32x16_bf16 a[16:31], v[184:187], a[152:155], a[16:31]
    v_accvgpr_read_b32 v45, a121
    v_accvgpr_read_b32 v46, a122
    v_accvgpr_read_b32 v47, a123
    v_accvgpr_read_b32 v48, a124
    v_mfma_f32_32x32x16_bf16 a[32:47], v[216:219], a[152:155], a[32:47]
    v_accvgpr_read_b32 v49, a125
    v_accvgpr_read_b32 v50, a126
    v_accvgpr_read_b32 v51, a127
    v_cvt_pk_bf16_f32 v52, v44, v45
    v_mfma_f32_32x32x16_bf16 a[48:63], v[248:251], a[152:155], a[48:63]
    v_cvt_pk_bf16_f32 v53, v46, v47
    v_cvt_pk_bf16_f32 v54, v48, v49
    v_cvt_pk_bf16_f32 v55, v50, v51
    s_add_u32 s56, s63, 3933184
    v_mfma_f32_32x32x16_bf16 a[0:15], v[156:159], a[156:159], a[0:15]
    buffer_store_dwordx4 v[52:55], v16, s[24:27], s56 offen sc1
    s_add_u32 s63, s63, 2048
    v_mfma_f32_32x32x16_bf16 a[16:31], v[188:191], a[156:159], a[16:31]
    v_mfma_f32_32x32x16_bf16 a[32:47], v[220:223], a[156:159], a[32:47]
    v_mfma_f32_32x32x16_bf16 a[48:63], v[252:255], a[156:159], a[48:63]
    buffer_load_dwordx4 a[128:131], v16, s[24:27], s62 offen offset:0
    buffer_load_dwordx4 a[132:135], v16, s[24:27], s62 offen offset:1024
    buffer_load_dwordx4 a[136:139], v16, s[24:27], s62 offen offset:2048
    buffer_load_dwordx4 a[140:143], v16, s[24:27], s62 offen offset:3072
    buffer_load_dwordx4 a[144:147], v17, s[24:27], s62 offen offset:0
    buffer_load_dwordx4 a[148:151], v17, s[24:27], s62 offen offset:1024
    buffer_load_dwordx4 a[152:155], v17, s[24:27], s62 offen offset:2048
    buffer_load_dwordx4 a[156:159], v17, s[24:27], s62 offen offset:3072
    s_add_u32 s62, s62, 8192
    s_waitcnt vmcnt(8)
    v_mfma_f32_32x32x16_bf16 a[64:79], v[128:131], a[160:163], 0
    s_nop 15
    v_accvgpr_read_b32 v32, a0
    v_accvgpr_read_b32 v33, a1
    v_accvgpr_read_b32 v34, a2
    v_mfma_f32_32x32x16_bf16 a[80:95], v[160:163], a[160:163], 0
    v_accvgpr_read_b32 v35, a3
    v_accvgpr_read_b32 v36, a4
    v_accvgpr_read_b32 v37, a5
    v_accvgpr_read_b32 v38, a6
    v_mfma_f32_32x32x16_bf16 a[96:111], v[192:195], a[160:163], 0
    v_accvgpr_read_b32 v39, a7
    v_cvt_pk_bf16_f32 v40, v32, v33
    v_cvt_pk_bf16_f32 v41, v34, v35
    v_cvt_pk_bf16_f32 v42, v36, v37
    v_mfma_f32_32x32x16_bf16 a[112:127], v[224:227], a[160:163], 0
    v_cvt_pk_bf16_f32 v43, v38, v39
    s_add_u32 s56, s63, 0
    buffer_store_dwordx4 v[40:43], v16, s[24:27], s56 offen sc1
    v_accvgpr_read_b32 v44, a8
    v_mfma_f32_32x32x16_bf16 a[64:79], v[132:135], a[164:167], a[64:79]
    v_accvgpr_read_b32 v45, a9
    v_accvgpr_read_b32 v46, a10
    v_accvgpr_read_b32 v47, a11
    v_accvgpr_read_b32 v48, a12
    v_mfma_f32_32x32x16_bf16 a[80:95], v[164:167], a[164:167], a[80:95]
    v_accvgpr_read_b32 v49, a13
    v_accvgpr_read_b32 v50, a14
    v_accvgpr_read_b32 v51, a15
    v_cvt_pk_bf16_f32 v52, v44, v45
    v_mfma_f32_32x32x16_bf16 a[96:111], v[196:199], a[164:167], a[96:111]
    v_cvt_pk_bf16_f32 v53, v46, v47
    v_cvt_pk_bf16_f32 v54, v48, v49
    v_cvt_pk_bf16_f32 v55, v50, v51
    s_add_u32 s56, s63, 1024
    v_mfma_f32_32x32x16_bf16 a[112:127], v[228:231], a[164:167], a[112:127]
    buffer_store_dwordx4 v[52:55], v16, s[24:27], s56 offen sc1
    v_accvgpr_read_b32 v32, a16
    v_accvgpr_read_b32 v33, a17
    v_accvgpr_read_b32 v34, a18
    v_mfma_f32_32x32x16_bf16 a[64:79], v[136:139], a[168:171], a[64:79]
    v_accvgpr_read_b32 v35, a19
    v_accvgpr_read_b32 v36, a20
    v_accvgpr_read_b32 v37, a21
    v_accvgpr_read_b32 v38, a22
    v_mfma_f32_32x32x16_bf16 a[80:95], v[168:171], a[168:171], a[80:95]
    v_accvgpr_read_b32 v39, a23
    v_cvt_pk_bf16_f32 v40, v32, v33
    v_cvt_pk_bf16_f32 v41, v34, v35
    v_cvt_pk_bf16_f32 v42, v36, v37
    v_mfma_f32_32x32x16_bf16 a[96:111], v[200:203], a[168:171], a[96:111]
    v_cvt_pk_bf16_f32 v43, v38, v39
    s_add_u32 s56, s63, 1310720
    buffer_store_dwordx4 v[40:43], v16, s[24:27], s56 offen sc1
    v_accvgpr_read_b32 v44, a24
    v_mfma_f32_32x32x16_bf16 a[112:127], v[232:235], a[168:171], a[112:127]
    v_accvgpr_read_b32 v45, a25
    v_accvgpr_read_b32 v46, a26
    v_accvgpr_read_b32 v47, a27
    v_accvgpr_read_b32 v48, a28
    v_mfma_f32_32x32x16_bf16 a[64:79], v[140:143], a[172:175], a[64:79]
    v_accvgpr_read_b32 v49, a29
    v_accvgpr_read_b32 v50, a30
    v_accvgpr_read_b32 v51, a31
    v_cvt_pk_bf16_f32 v52, v44, v45
    v_mfma_f32_32x32x16_bf16 a[80:95], v[172:175], a[172:175], a[80:95]
    v_cvt_pk_bf16_f32 v53, v46, v47
    v_cvt_pk_bf16_f32 v54, v48, v49
    v_cvt_pk_bf16_f32 v55, v50, v51
    s_add_u32 s56, s63, 1311744
    v_mfma_f32_32x32x16_bf16 a[96:111], v[204:207], a[172:175], a[96:111]
    buffer_store_dwordx4 v[52:55], v16, s[24:27], s56 offen sc1
    v_accvgpr_read_b32 v32, a32
    v_accvgpr_read_b32 v33, a33
    v_accvgpr_read_b32 v34, a34
    v_mfma_f32_32x32x16_bf16 a[112:127], v[236:239], a[172:175], a[112:127]
    v_accvgpr_read_b32 v35, a35
    v_accvgpr_read_b32 v36, a36
    v_accvgpr_read_b32 v37, a37
    v_accvgpr_read_b32 v38, a38
    v_mfma_f32_32x32x16_bf16 a[64:79], v[144:147], a[176:179], a[64:79]
    v_accvgpr_read_b32 v39, a39
    v_cvt_pk_bf16_f32 v40, v32, v33
    v_cvt_pk_bf16_f32 v41, v34, v35
    v_cvt_pk_bf16_f32 v42, v36, v37
    v_mfma_f32_32x32x16_bf16 a[80:95], v[176:179], a[176:179], a[80:95]
    v_cvt_pk_bf16_f32 v43, v38, v39
    s_add_u32 s56, s63, 2621440
    buffer_store_dwordx4 v[40:43], v16, s[24:27], s56 offen sc1
    v_accvgpr_read_b32 v44, a40
    v_mfma_f32_32x32x16_bf16 a[96:111], v[208:211], a[176:179], a[96:111]
    v_accvgpr_read_b32 v45, a41
    v_accvgpr_read_b32 v46, a42
    v_accvgpr_read_b32 v47, a43
    v_accvgpr_read_b32 v48, a44
    v_mfma_f32_32x32x16_bf16 a[112:127], v[240:243], a[176:179], a[112:127]
    v_accvgpr_read_b32 v49, a45
    v_accvgpr_read_b32 v50, a46
    v_accvgpr_read_b32 v51, a47
    v_cvt_pk_bf16_f32 v52, v44, v45
    v_mfma_f32_32x32x16_bf16 a[64:79], v[148:151], a[180:183], a[64:79]
    v_cvt_pk_bf16_f32 v53, v46, v47
    v_cvt_pk_bf16_f32 v54, v48, v49
    v_cvt_pk_bf16_f32 v55, v50, v51
    s_add_u32 s56, s63, 2622464
    v_mfma_f32_32x32x16_bf16 a[80:95], v[180:183], a[180:183], a[80:95]
    buffer_store_dwordx4 v[52:55], v16, s[24:27], s56 offen sc1
    v_accvgpr_read_b32 v32, a48
    v_accvgpr_read_b32 v33, a49
    v_accvgpr_read_b32 v34, a50
    v_mfma_f32_32x32x16_bf16 a[96:111], v[212:215], a[180:183], a[96:111]
    v_accvgpr_read_b32 v35, a51
    v_accvgpr_read_b32 v36, a52
    v_accvgpr_read_b32 v37, a53
    v_accvgpr_read_b32 v38, a54
    v_mfma_f32_32x32x16_bf16 a[112:127], v[244:247], a[180:183], a[112:127]
    v_accvgpr_read_b32 v39, a55
    v_cvt_pk_bf16_f32 v40, v32, v33
    v_cvt_pk_bf16_f32 v41, v34, v35
    v_cvt_pk_bf16_f32 v42, v36, v37
    v_mfma_f32_32x32x16_bf16 a[64:79], v[152:155], a[184:187], a[64:79]
    v_cvt_pk_bf16_f32 v43, v38, v39
    s_add_u32 s56, s63, 3932160
    buffer_store_dwordx4 v[40:43], v16, s[24:27], s56 offen sc1
    v_accvgpr_read_b32 v44, a56
    v_mfma_f32_32x32x16_bf16 a[80:95], v[184:187], a[184:187], a[80:95]
    v_accvgpr_read_b32 v45, a57
    v_accvgpr_read_b32 v46, a58
    v_accvgpr_read_b32 v47, a59
    v_accvgpr_read_b32 v48, a60
    v_mfma_f32_32x32x16_bf16 a[96:111], v[216:219], a[184:187], a[96:111]
    v_accvgpr_read_b32 v49, a61
    v_accvgpr_read_b32 v50, a62
    v_accvgpr_read_b32 v51, a63
    v_cvt_pk_bf16_f32 v52, v44, v45
    v_mfma_f32_32x32x16_bf16 a[112:127], v[248:251], a[184:187], a[112:127]
    v_cvt_pk_bf16_f32 v53, v46, v47
    v_cvt_pk_bf16_f32 v54, v48, v49
    v_cvt_pk_bf16_f32 v55, v50, v51
    s_add_u32 s56, s63, 3933184
    v_mfma_f32_32x32x16_bf16 a[64:79], v[156:159], a[188:191], a[64:79]
    buffer_store_dwordx4 v[52:55], v16, s[24:27], s56 offen sc1
    s_add_u32 s63, s63, 2048
    v_mfma_f32_32x32x16_bf16 a[80:95], v[188:191], a[188:191], a[80:95]
    v_mfma_f32_32x32x16_bf16 a[96:111], v[220:223], a[188:191], a[96:111]
    v_mfma_f32_32x32x16_bf16 a[112:127], v[252:255], a[188:191], a[112:127]
    buffer_load_dwordx4 a[160:163], v16, s[24:27], s62 offen offset:0
    buffer_load_dwordx4 a[164:167], v16, s[24:27], s62 offen offset:1024
    buffer_load_dwordx4 a[168:171], v16, s[24:27], s62 offen offset:2048
    buffer_load_dwordx4 a[172:175], v16, s[24:27], s62 offen offset:3072
    buffer_load_dwordx4 a[176:179], v17, s[24:27], s62 offen offset:0
    buffer_load_dwordx4 a[180:183], v17, s[24:27], s62 offen offset:1024
    buffer_load_dwordx4 a[184:187], v17, s[24:27], s62 offen offset:2048
    buffer_load_dwordx4 a[188:191], v17, s[24:27], s62 offen offset:3072
    s_add_u32 s62, s62, 8192
    s_waitcnt vmcnt(8)
    v_mfma_f32_32x32x16_bf16 a[0:15], v[128:131], a[128:131], 0
    s_nop 15
    v_accvgpr_read_b32 v32, a64
    v_accvgpr_read_b32 v33, a65
    v_accvgpr_read_b32 v34, a66
    v_mfma_f32_32x32x16_bf16 a[16:31], v[160:163], a[128:131], 0
    v_accvgpr_read_b32 v35, a67
    v_accvgpr_read_b32 v36, a68
    v_accvgpr_read_b32 v37, a69
    v_accvgpr_read_b32 v38, a70
    v_mfma_f32_32x32x16_bf16 a[32:47], v[192:195], a[128:131], 0
    v_accvgpr_read_b32 v39, a71
    v_cvt_pk_bf16_f32 v40, v32, v33
    v_cvt_pk_bf16_f32 v41, v34, v35
    v_cvt_pk_bf16_f32 v42, v36, v37
    v_mfma_f32_32x32x16_bf16 a[48:63], v[224:227], a[128:131], 0
    v_cvt_pk_bf16_f32 v43, v38, v39
    s_add_u32 s56, s63, 0
    buffer_store_dwordx4 v[40:43], v16, s[24:27], s56 offen sc1
    v_accvgpr_read_b32 v44, a72
    v_mfma_f32_32x32x16_bf16 a[0:15], v[132:135], a[132:135], a[0:15]
    v_accvgpr_read_b32 v45, a73
    v_accvgpr_read_b32 v46, a74
    v_accvgpr_read_b32 v47, a75
    v_accvgpr_read_b32 v48, a76
    v_mfma_f32_32x32x16_bf16 a[16:31], v[164:167], a[132:135], a[16:31]
    v_accvgpr_read_b32 v49, a77
    v_accvgpr_read_b32 v50, a78
    v_accvgpr_read_b32 v51, a79
    v_cvt_pk_bf16_f32 v52, v44, v45
    v_mfma_f32_32x32x16_bf16 a[32:47], v[196:199], a[132:135], a[32:47]
    v_cvt_pk_bf16_f32 v53, v46, v47
    v_cvt_pk_bf16_f32 v54, v48, v49
    v_cvt_pk_bf16_f32 v55, v50, v51
    s_add_u32 s56, s63, 1024
    v_mfma_f32_32x32x16_bf16 a[48:63], v[228:231], a[132:135], a[48:63]
    buffer_store_dwordx4 v[52:55], v16, s[24:27], s56 offen sc1
    v_accvgpr_read_b32 v32, a80
    v_accvgpr_read_b32 v33, a81
    v_accvgpr_read_b32 v34, a82
    v_mfma_f32_32x32x16_bf16 a[0:15], v[136:139], a[136:139], a[0:15]
    v_accvgpr_read_b32 v35, a83
    v_accvgpr_read_b32 v36, a84
    v_accvgpr_read_b32 v37, a85
    v_accvgpr_read_b32 v38, a86
    v_mfma_f32_32x32x16_bf16 a[16:31], v[168:171], a[136:139], a[16:31]
    v_accvgpr_read_b32 v39, a87
    v_cvt_pk_bf16_f32 v40, v32, v33
    v_cvt_pk_bf16_f32 v41, v34, v35
    v_cvt_pk_bf16_f32 v42, v36, v37
    v_mfma_f32_32x32x16_bf16 a[32:47], v[200:203], a[136:139], a[32:47]
    v_cvt_pk_bf16_f32 v43, v38, v39
    s_add_u32 s56, s63, 1310720
    buffer_store_dwordx4 v[40:43], v16, s[24:27], s56 offen sc1
    v_accvgpr_read_b32 v44, a88
    v_mfma_f32_32x32x16_bf16 a[48:63], v[232:235], a[136:139], a[48:63]
    v_accvgpr_read_b32 v45, a89
    v_accvgpr_read_b32 v46, a90
    v_accvgpr_read_b32 v47, a91
    v_accvgpr_read_b32 v48, a92
    v_mfma_f32_32x32x16_bf16 a[0:15], v[140:143], a[140:143], a[0:15]
    v_accvgpr_read_b32 v49, a93
    v_accvgpr_read_b32 v50, a94
    v_accvgpr_read_b32 v51, a95
    v_cvt_pk_bf16_f32 v52, v44, v45
    v_mfma_f32_32x32x16_bf16 a[16:31], v[172:175], a[140:143], a[16:31]
    v_cvt_pk_bf16_f32 v53, v46, v47
    v_cvt_pk_bf16_f32 v54, v48, v49
    v_cvt_pk_bf16_f32 v55, v50, v51
    s_add_u32 s56, s63, 1311744
    v_mfma_f32_32x32x16_bf16 a[32:47], v[204:207], a[140:143], a[32:47]
    buffer_store_dwordx4 v[52:55], v16, s[24:27], s56 offen sc1
    v_accvgpr_read_b32 v32, a96
    v_accvgpr_read_b32 v33, a97
    v_accvgpr_read_b32 v34, a98
    v_mfma_f32_32x32x16_bf16 a[48:63], v[236:239], a[140:143], a[48:63]
    v_accvgpr_read_b32 v35, a99
    v_accvgpr_read_b32 v36, a100
    v_accvgpr_read_b32 v37, a101
    v_accvgpr_read_b32 v38, a102
    v_mfma_f32_32x32x16_bf16 a[0:15], v[144:147], a[144:147], a[0:15]
    v_accvgpr_read_b32 v39, a103
    v_cvt_pk_bf16_f32 v40, v32, v33
    v_cvt_pk_bf16_f32 v41, v34, v35
    v_cvt_pk_bf16_f32 v42, v36, v37
    v_mfma_f32_32x32x16_bf16 a[16:31], v[176:179], a[144:147], a[16:31]
    v_cvt_pk_bf16_f32 v43, v38, v39
    s_add_u32 s56, s63, 2621440
    buffer_store_dwordx4 v[40:43], v16, s[24:27], s56 offen sc1
    v_accvgpr_read_b32 v44, a104
    v_mfma_f32_32x32x16_bf16 a[32:47], v[208:211], a[144:147], a[32:47]
    v_accvgpr_read_b32 v45, a105
    v_accvgpr_read_b32 v46, a106
    v_accvgpr_read_b32 v47, a107
    v_accvgpr_read_b32 v48, a108
    v_mfma_f32_32x32x16_bf16 a[48:63], v[240:243], a[144:147], a[48:63]
    v_accvgpr_read_b32 v49, a109
    v_accvgpr_read_b32 v50, a110
    v_accvgpr_read_b32 v51, a111
    v_cvt_pk_bf16_f32 v52, v44, v45
    v_mfma_f32_32x32x16_bf16 a[0:15], v[148:151], a[148:151], a[0:15]
    v_cvt_pk_bf16_f32 v53, v46, v47
    v_cvt_pk_bf16_f32 v54, v48, v49
    v_cvt_pk_bf16_f32 v55, v50, v51
    s_add_u32 s56, s63, 2622464
    v_mfma_f32_32x32x16_bf16 a[16:31], v[180:183], a[148:151], a[16:31]
    buffer_store_dwordx4 v[52:55], v16, s[24:27], s56 offen sc1
    v_accvgpr_read_b32 v32, a112
    v_accvgpr_read_b32 v33, a113
    v_accvgpr_read_b32 v34, a114
    v_mfma_f32_32x32x16_bf16 a[32:47], v[212:215], a[148:151], a[32:47]
    v_accvgpr_read_b32 v35, a115
    v_accvgpr_read_b32 v36, a116
    v_accvgpr_read_b32 v37, a117
    v_accvgpr_read_b32 v38, a118
    v_mfma_f32_32x32x16_bf16 a[48:63], v[244:247], a[148:151], a[48:63]
    v_accvgpr_read_b32 v39, a119
    v_cvt_pk_bf16_f32 v40, v32, v33
    v_cvt_pk_bf16_f32 v41, v34, v35
    v_cvt_pk_bf16_f32 v42, v36, v37
    v_mfma_f32_32x32x16_bf16 a[0:15], v[152:155], a[152:155], a[0:15]
    v_cvt_pk_bf16_f32 v43, v38, v39
    s_add_u32 s56, s63, 3932160
    buffer_store_dwordx4 v[40:43], v16, s[24:27], s56 offen sc1
    v_accvgpr_read_b32 v44, a120
    v_mfma_f32_32x32x16_bf16 a[16:31], v[184:187], a[152:155], a[16:31]
    v_accvgpr_read_b32 v45, a121
    v_accvgpr_read_b32 v46, a122
    v_accvgpr_read_b32 v47, a123
    v_accvgpr_read_b32 v48, a124
    v_mfma_f32_32x32x16_bf16 a[32:47], v[216:219], a[152:155], a[32:47]
    v_accvgpr_read_b32 v49, a125
    v_accvgpr_read_b32 v50, a126
    v_accvgpr_read_b32 v51, a127
    v_cvt_pk_bf16_f32 v52, v44, v45
    v_mfma_f32_32x32x16_bf16 a[48:63], v[248:251], a[152:155], a[48:63]
    v_cvt_pk_bf16_f32 v53, v46, v47
    v_cvt_pk_bf16_f32 v54, v48, v49
    v_cvt_pk_bf16_f32 v55, v50, v51
    s_add_u32 s56, s63, 3933184
    v_mfma_f32_32x32x16_bf16 a[0:15], v[156:159], a[156:159], a[0:15]
    buffer_store_dwordx4 v[52:55], v16, s[24:27], s56 offen sc1
    s_add_u32 s63, s63, 2048
    v_mfma_f32_32x32x16_bf16 a[16:31], v[188:191], a[156:159], a[16:31]
    v_mfma_f32_32x32x16_bf16 a[32:47], v[220:223], a[156:159], a[32:47]
    v_mfma_f32_32x32x16_bf16 a[48:63], v[252:255], a[156:159], a[48:63]
    buffer_load_dwordx4 a[128:131], v16, s[24:27], s62 offen offset:0
    buffer_load_dwordx4 a[132:135], v16, s[24:27], s62 offen offset:1024
    buffer_load_dwordx4 a[136:139], v16, s[24:27], s62 offen offset:2048
    buffer_load_dwordx4 a[140:143], v16, s[24:27], s62 offen offset:3072
    buffer_load_dwordx4 a[144:147], v17, s[24:27], s62 offen offset:0
    buffer_load_dwordx4 a[148:151], v17, s[24:27], s62 offen offset:1024
    buffer_load_dwordx4 a[152:155], v17, s[24:27], s62 offen offset:2048
    buffer_load_dwordx4 a[156:159], v17, s[24:27], s62 offen offset:3072
    s_add_u32 s62, s62, 8192
    s_waitcnt vmcnt(8)
    v_mfma_f32_32x32x16_bf16 a[64:79], v[128:131], a[160:163], 0
    s_nop 15
    v_accvgpr_read_b32 v32, a0
    v_accvgpr_read_b32 v33, a1
    v_accvgpr_read_b32 v34, a2
    v_mfma_f32_32x32x16_bf16 a[80:95], v[160:163], a[160:163], 0
    v_accvgpr_read_b32 v35, a3
    v_accvgpr_read_b32 v36, a4
    v_accvgpr_read_b32 v37, a5
    v_accvgpr_read_b32 v38, a6
    v_mfma_f32_32x32x16_bf16 a[96:111], v[192:195], a[160:163], 0
    v_accvgpr_read_b32 v39, a7
    v_cvt_pk_bf16_f32 v40, v32, v33
    v_cvt_pk_bf16_f32 v41, v34, v35
    v_cvt_pk_bf16_f32 v42, v36, v37
    v_mfma_f32_32x32x16_bf16 a[112:127], v[224:227], a[160:163], 0
    v_cvt_pk_bf16_f32 v43, v38, v39
    s_add_u32 s56, s63, 0
    buffer_store_dwordx4 v[40:43], v16, s[24:27], s56 offen sc1
    v_accvgpr_read_b32 v44, a8
    v_mfma_f32_32x32x16_bf16 a[64:79], v[132:135], a[164:167], a[64:79]
    v_accvgpr_read_b32 v45, a9
    v_accvgpr_read_b32 v46, a10
    v_accvgpr_read_b32 v47, a11
    v_accvgpr_read_b32 v48, a12
    v_mfma_f32_32x32x16_bf16 a[80:95], v[164:167], a[164:167], a[80:95]
    v_accvgpr_read_b32 v49, a13
    v_accvgpr_read_b32 v50, a14
    v_accvgpr_read_b32 v51, a15
    v_cvt_pk_bf16_f32 v52, v44, v45
    v_mfma_f32_32x32x16_bf16 a[96:111], v[196:199], a[164:167], a[96:111]
    v_cvt_pk_bf16_f32 v53, v46, v47
    v_cvt_pk_bf16_f32 v54, v48, v49
    v_cvt_pk_bf16_f32 v55, v50, v51
    s_add_u32 s56, s63, 1024
    v_mfma_f32_32x32x16_bf16 a[112:127], v[228:231], a[164:167], a[112:127]
    buffer_store_dwordx4 v[52:55], v16, s[24:27], s56 offen sc1
    v_accvgpr_read_b32 v32, a16
    v_accvgpr_read_b32 v33, a17
    v_accvgpr_read_b32 v34, a18
    v_mfma_f32_32x32x16_bf16 a[64:79], v[136:139], a[168:171], a[64:79]
    v_accvgpr_read_b32 v35, a19
    v_accvgpr_read_b32 v36, a20
    v_accvgpr_read_b32 v37, a21
    v_accvgpr_read_b32 v38, a22
    v_mfma_f32_32x32x16_bf16 a[80:95], v[168:171], a[168:171], a[80:95]
    v_accvgpr_read_b32 v39, a23
    v_cvt_pk_bf16_f32 v40, v32, v33
    v_cvt_pk_bf16_f32 v41, v34, v35
    v_cvt_pk_bf16_f32 v42, v36, v37
    v_mfma_f32_32x32x16_bf16 a[96:111], v[200:203], a[168:171], a[96:111]
    v_cvt_pk_bf16_f32 v43, v38, v39
    s_add_u32 s56, s63, 1310720
    buffer_store_dwordx4 v[40:43], v16, s[24:27], s56 offen sc1
    v_accvgpr_read_b32 v44, a24
    v_mfma_f32_32x32x16_bf16 a[112:127], v[232:235], a[168:171], a[112:127]
    v_accvgpr_read_b32 v45, a25
    v_accvgpr_read_b32 v46, a26
    v_accvgpr_read_b32 v47, a27
    v_accvgpr_read_b32 v48, a28
    v_mfma_f32_32x32x16_bf16 a[64:79], v[140:143], a[172:175], a[64:79]
    v_accvgpr_read_b32 v49, a29
    v_accvgpr_read_b32 v50, a30
    v_accvgpr_read_b32 v51, a31
    v_cvt_pk_bf16_f32 v52, v44, v45
    v_mfma_f32_32x32x16_bf16 a[80:95], v[172:175], a[172:175], a[80:95]
    v_cvt_pk_bf16_f32 v53, v46, v47
    v_cvt_pk_bf16_f32 v54, v48, v49
    v_cvt_pk_bf16_f32 v55, v50, v51
    s_add_u32 s56, s63, 1311744
    v_mfma_f32_32x32x16_bf16 a[96:111], v[204:207], a[172:175], a[96:111]
    buffer_store_dwordx4 v[52:55], v16, s[24:27], s56 offen sc1
    v_accvgpr_read_b32 v32, a32
    v_accvgpr_read_b32 v33, a33
    v_accvgpr_read_b32 v34, a34
    v_mfma_f32_32x32x16_bf16 a[112:127], v[236:239], a[172:175], a[112:127]
    v_accvgpr_read_b32 v35, a35
    v_accvgpr_read_b32 v36, a36
    v_accvgpr_read_b32 v37, a37
    v_accvgpr_read_b32 v38, a38
    v_mfma_f32_32x32x16_bf16 a[64:79], v[144:147], a[176:179], a[64:79]
    v_accvgpr_read_b32 v39, a39
    v_cvt_pk_bf16_f32 v40, v32, v33
    v_cvt_pk_bf16_f32 v41, v34, v35
    v_cvt_pk_bf16_f32 v42, v36, v37
    v_mfma_f32_32x32x16_bf16 a[80:95], v[176:179], a[176:179], a[80:95]
    v_cvt_pk_bf16_f32 v43, v38, v39
    s_add_u32 s56, s63, 2621440
    buffer_store_dwordx4 v[40:43], v16, s[24:27], s56 offen sc1
    v_accvgpr_read_b32 v44, a40
    v_mfma_f32_32x32x16_bf16 a[96:111], v[208:211], a[176:179], a[96:111]
    v_accvgpr_read_b32 v45, a41
    v_accvgpr_read_b32 v46, a42
    v_accvgpr_read_b32 v47, a43
    v_accvgpr_read_b32 v48, a44
    v_mfma_f32_32x32x16_bf16 a[112:127], v[240:243], a[176:179], a[112:127]
    v_accvgpr_read_b32 v49, a45
    v_accvgpr_read_b32 v50, a46
    v_accvgpr_read_b32 v51, a47
    v_cvt_pk_bf16_f32 v52, v44, v45
    v_mfma_f32_32x32x16_bf16 a[64:79], v[148:151], a[180:183], a[64:79]
    v_cvt_pk_bf16_f32 v53, v46, v47
    v_cvt_pk_bf16_f32 v54, v48, v49
    v_cvt_pk_bf16_f32 v55, v50, v51
    s_add_u32 s56, s63, 2622464
    v_mfma_f32_32x32x16_bf16 a[80:95], v[180:183], a[180:183], a[80:95]
    buffer_store_dwordx4 v[52:55], v16, s[24:27], s56 offen sc1
    v_accvgpr_read_b32 v32, a48
    v_accvgpr_read_b32 v33, a49
    v_accvgpr_read_b32 v34, a50
    v_mfma_f32_32x32x16_bf16 a[96:111], v[212:215], a[180:183], a[96:111]
    v_accvgpr_read_b32 v35, a51
    v_accvgpr_read_b32 v36, a52
    v_accvgpr_read_b32 v37, a53
    v_accvgpr_read_b32 v38, a54
    v_mfma_f32_32x32x16_bf16 a[112:127], v[244:247], a[180:183], a[112:127]
    v_accvgpr_read_b32 v39, a55
    v_cvt_pk_bf16_f32 v40, v32, v33
    v_cvt_pk_bf16_f32 v41, v34, v35
    v_cvt_pk_bf16_f32 v42, v36, v37
    v_mfma_f32_32x32x16_bf16 a[64:79], v[152:155], a[184:187], a[64:79]
    v_cvt_pk_bf16_f32 v43, v38, v39
    s_add_u32 s56, s63, 3932160
    buffer_store_dwordx4 v[40:43], v16, s[24:27], s56 offen sc1
    v_accvgpr_read_b32 v44, a56
    v_mfma_f32_32x32x16_bf16 a[80:95], v[184:187], a[184:187], a[80:95]
    v_accvgpr_read_b32 v45, a57
    v_accvgpr_read_b32 v46, a58
    v_accvgpr_read_b32 v47, a59
    v_accvgpr_read_b32 v48, a60
    v_mfma_f32_32x32x16_bf16 a[96:111], v[216:219], a[184:187], a[96:111]
    v_accvgpr_read_b32 v49, a61
    v_accvgpr_read_b32 v50, a62
    v_accvgpr_read_b32 v51, a63
    v_cvt_pk_bf16_f32 v52, v44, v45
    v_mfma_f32_32x32x16_bf16 a[112:127], v[248:251], a[184:187], a[112:127]
    v_cvt_pk_bf16_f32 v53, v46, v47
    v_cvt_pk_bf16_f32 v54, v48, v49
    v_cvt_pk_bf16_f32 v55, v50, v51
    s_add_u32 s56, s63, 3933184
    v_mfma_f32_32x32x16_bf16 a[64:79], v[156:159], a[188:191], a[64:79]
    buffer_store_dwordx4 v[52:55], v16, s[24:27], s56 offen sc1
    s_add_u32 s63, s63, 2048
    v_mfma_f32_32x32x16_bf16 a[80:95], v[188:191], a[188:191], a[80:95]
    v_mfma_f32_32x32x16_bf16 a[96:111], v[220:223], a[188:191], a[96:111]
    v_mfma_f32_32x32x16_bf16 a[112:127], v[252:255], a[188:191], a[112:127]
    buffer_load_dwordx4 a[160:163], v16, s[24:27], s62 offen offset:0
    buffer_load_dwordx4 a[164:167], v16, s[24:27], s62 offen offset:1024
    buffer_load_dwordx4 a[168:171], v16, s[24:27], s62 offen offset:2048
    buffer_load_dwordx4 a[172:175], v16, s[24:27], s62 offen offset:3072
    buffer_load_dwordx4 a[176:179], v17, s[24:27], s62 offen offset:0
    buffer_load_dwordx4 a[180:183], v17, s[24:27], s62 offen offset:1024
    buffer_load_dwordx4 a[184:187], v17, s[24:27], s62 offen offset:2048
    buffer_load_dwordx4 a[188:191], v17, s[24:27], s62 offen offset:3072
    s_add_u32 s62, s62, 8192
    s_waitcnt vmcnt(8)
    v_mfma_f32_32x32x16_bf16 a[0:15], v[128:131], a[128:131], 0
    s_nop 15
    v_accvgpr_read_b32 v32, a64
    v_accvgpr_read_b32 v33, a65
    v_accvgpr_read_b32 v34, a66
    v_mfma_f32_32x32x16_bf16 a[16:31], v[160:163], a[128:131], 0
    v_accvgpr_read_b32 v35, a67
    v_accvgpr_read_b32 v36, a68
    v_accvgpr_read_b32 v37, a69
    v_accvgpr_read_b32 v38, a70
    v_mfma_f32_32x32x16_bf16 a[32:47], v[192:195], a[128:131], 0
    v_accvgpr_read_b32 v39, a71
    v_cvt_pk_bf16_f32 v40, v32, v33
    v_cvt_pk_bf16_f32 v41, v34, v35
    v_cvt_pk_bf16_f32 v42, v36, v37
    v_mfma_f32_32x32x16_bf16 a[48:63], v[224:227], a[128:131], 0
    v_cvt_pk_bf16_f32 v43, v38, v39
    s_add_u32 s56, s63, 0
    buffer_store_dwordx4 v[40:43], v16, s[24:27], s56 offen sc1
    v_accvgpr_read_b32 v44, a72
    v_mfma_f32_32x32x16_bf16 a[0:15], v[132:135], a[132:135], a[0:15]
    v_accvgpr_read_b32 v45, a73
    v_accvgpr_read_b32 v46, a74
    v_accvgpr_read_b32 v47, a75
    v_accvgpr_read_b32 v48, a76
    v_mfma_f32_32x32x16_bf16 a[16:31], v[164:167], a[132:135], a[16:31]
    v_accvgpr_read_b32 v49, a77
    v_accvgpr_read_b32 v50, a78
    v_accvgpr_read_b32 v51, a79
    v_cvt_pk_bf16_f32 v52, v44, v45
    v_mfma_f32_32x32x16_bf16 a[32:47], v[196:199], a[132:135], a[32:47]
    v_cvt_pk_bf16_f32 v53, v46, v47
    v_cvt_pk_bf16_f32 v54, v48, v49
    v_cvt_pk_bf16_f32 v55, v50, v51
    s_add_u32 s56, s63, 1024
    v_mfma_f32_32x32x16_bf16 a[48:63], v[228:231], a[132:135], a[48:63]
    buffer_store_dwordx4 v[52:55], v16, s[24:27], s56 offen sc1
    v_accvgpr_read_b32 v32, a80
    v_accvgpr_read_b32 v33, a81
    v_accvgpr_read_b32 v34, a82
    v_mfma_f32_32x32x16_bf16 a[0:15], v[136:139], a[136:139], a[0:15]
    v_accvgpr_read_b32 v35, a83
    v_accvgpr_read_b32 v36, a84
    v_accvgpr_read_b32 v37, a85
    v_accvgpr_read_b32 v38, a86
    v_mfma_f32_32x32x16_bf16 a[16:31], v[168:171], a[136:139], a[16:31]
    v_accvgpr_read_b32 v39, a87
    v_cvt_pk_bf16_f32 v40, v32, v33
    v_cvt_pk_bf16_f32 v41, v34, v35
    v_cvt_pk_bf16_f32 v42, v36, v37
    v_mfma_f32_32x32x16_bf16 a[32:47], v[200:203], a[136:139], a[32:47]
    v_cvt_pk_bf16_f32 v43, v38, v39
    s_add_u32 s56, s63, 1310720
    buffer_store_dwordx4 v[40:43], v16, s[24:27], s56 offen sc1
    v_accvgpr_read_b32 v44, a88
    v_mfma_f32_32x32x16_bf16 a[48:63], v[232:235], a[136:139], a[48:63]
    v_accvgpr_read_b32 v45, a89
    v_accvgpr_read_b32 v46, a90
    v_accvgpr_read_b32 v47, a91
    v_accvgpr_read_b32 v48, a92
    v_mfma_f32_32x32x16_bf16 a[0:15], v[140:143], a[140:143], a[0:15]
    v_accvgpr_read_b32 v49, a93
    v_accvgpr_read_b32 v50, a94
    v_accvgpr_read_b32 v51, a95
    v_cvt_pk_bf16_f32 v52, v44, v45
    v_mfma_f32_32x32x16_bf16 a[16:31], v[172:175], a[140:143], a[16:31]
    v_cvt_pk_bf16_f32 v53, v46, v47
    v_cvt_pk_bf16_f32 v54, v48, v49
    v_cvt_pk_bf16_f32 v55, v50, v51
    s_add_u32 s56, s63, 1311744
    v_mfma_f32_32x32x16_bf16 a[32:47], v[204:207], a[140:143], a[32:47]
    buffer_store_dwordx4 v[52:55], v16, s[24:27], s56 offen sc1
    v_accvgpr_read_b32 v32, a96
    v_accvgpr_read_b32 v33, a97
    v_accvgpr_read_b32 v34, a98
    v_mfma_f32_32x32x16_bf16 a[48:63], v[236:239], a[140:143], a[48:63]
    v_accvgpr_read_b32 v35, a99
    v_accvgpr_read_b32 v36, a100
    v_accvgpr_read_b32 v37, a101
    v_accvgpr_read_b32 v38, a102
    v_mfma_f32_32x32x16_bf16 a[0:15], v[144:147], a[144:147], a[0:15]
    v_accvgpr_read_b32 v39, a103
    v_cvt_pk_bf16_f32 v40, v32, v33
    v_cvt_pk_bf16_f32 v41, v34, v35
    v_cvt_pk_bf16_f32 v42, v36, v37
    v_mfma_f32_32x32x16_bf16 a[16:31], v[176:179], a[144:147], a[16:31]
    v_cvt_pk_bf16_f32 v43, v38, v39
    s_add_u32 s56, s63, 2621440
    buffer_store_dwordx4 v[40:43], v16, s[24:27], s56 offen sc1
    v_accvgpr_read_b32 v44, a104
    v_mfma_f32_32x32x16_bf16 a[32:47], v[208:211], a[144:147], a[32:47]
    v_accvgpr_read_b32 v45, a105
    v_accvgpr_read_b32 v46, a106
    v_accvgpr_read_b32 v47, a107
    v_accvgpr_read_b32 v48, a108
    v_mfma_f32_32x32x16_bf16 a[48:63], v[240:243], a[144:147], a[48:63]
    v_accvgpr_read_b32 v49, a109
    v_accvgpr_read_b32 v50, a110
    v_accvgpr_read_b32 v51, a111
    v_cvt_pk_bf16_f32 v52, v44, v45
    v_mfma_f32_32x32x16_bf16 a[0:15], v[148:151], a[148:151], a[0:15]
    v_cvt_pk_bf16_f32 v53, v46, v47
    v_cvt_pk_bf16_f32 v54, v48, v49
    v_cvt_pk_bf16_f32 v55, v50, v51
    s_add_u32 s56, s63, 2622464
    v_mfma_f32_32x32x16_bf16 a[16:31], v[180:183], a[148:151], a[16:31]
    buffer_store_dwordx4 v[52:55], v16, s[24:27], s56 offen sc1
    v_accvgpr_read_b32 v32, a112
    v_accvgpr_read_b32 v33, a113
    v_accvgpr_read_b32 v34, a114
    v_mfma_f32_32x32x16_bf16 a[32:47], v[212:215], a[148:151], a[32:47]
    v_accvgpr_read_b32 v35, a115
    v_accvgpr_read_b32 v36, a116
    v_accvgpr_read_b32 v37, a117
    v_accvgpr_read_b32 v38, a118
    v_mfma_f32_32x32x16_bf16 a[48:63], v[244:247], a[148:151], a[48:63]
    v_accvgpr_read_b32 v39, a119
    v_cvt_pk_bf16_f32 v40, v32, v33
    v_cvt_pk_bf16_f32 v41, v34, v35
    v_cvt_pk_bf16_f32 v42, v36, v37
    v_mfma_f32_32x32x16_bf16 a[0:15], v[152:155], a[152:155], a[0:15]
    v_cvt_pk_bf16_f32 v43, v38, v39
    s_add_u32 s56, s63, 3932160
    buffer_store_dwordx4 v[40:43], v16, s[24:27], s56 offen sc1
    v_accvgpr_read_b32 v44, a120
    v_mfma_f32_32x32x16_bf16 a[16:31], v[184:187], a[152:155], a[16:31]
    v_accvgpr_read_b32 v45, a121
    v_accvgpr_read_b32 v46, a122
    v_accvgpr_read_b32 v47, a123
    v_accvgpr_read_b32 v48, a124
    v_mfma_f32_32x32x16_bf16 a[32:47], v[216:219], a[152:155], a[32:47]
    v_accvgpr_read_b32 v49, a125
    v_accvgpr_read_b32 v50, a126
    v_accvgpr_read_b32 v51, a127
    v_cvt_pk_bf16_f32 v52, v44, v45
    v_mfma_f32_32x32x16_bf16 a[48:63], v[248:251], a[152:155], a[48:63]
    v_cvt_pk_bf16_f32 v53, v46, v47
    v_cvt_pk_bf16_f32 v54, v48, v49
    v_cvt_pk_bf16_f32 v55, v50, v51
    s_add_u32 s56, s63, 3933184
    v_mfma_f32_32x32x16_bf16 a[0:15], v[156:159], a[156:159], a[0:15]
    buffer_store_dwordx4 v[52:55], v16, s[24:27], s56 offen sc1
    s_add_u32 s63, s63, 2048
    v_mfma_f32_32x32x16_bf16 a[16:31], v[188:191], a[156:159], a[16:31]
    v_mfma_f32_32x32x16_bf16 a[32:47], v[220:223], a[156:159], a[32:47]
    v_mfma_f32_32x32x16_bf16 a[48:63], v[252:255], a[156:159], a[48:63]
    buffer_load_dwordx4 a[128:131], v16, s[24:27], s62 offen offset:0
    buffer_load_dwordx4 a[132:135], v16, s[24:27], s62 offen offset:1024
    buffer_load_dwordx4 a[136:139], v16, s[24:27], s62 offen offset:2048
    buffer_load_dwordx4 a[140:143], v16, s[24:27], s62 offen offset:3072
    buffer_load_dwordx4 a[144:147], v17, s[24:27], s62 offen offset:0
    buffer_load_dwordx4 a[148:151], v17, s[24:27], s62 offen offset:1024
    buffer_load_dwordx4 a[152:155], v17, s[24:27], s62 offen offset:2048
    buffer_load_dwordx4 a[156:159], v17, s[24:27], s62 offen offset:3072
    s_add_u32 s62, s62, 8192
    s_waitcnt vmcnt(8)
    v_mfma_f32_32x32x16_bf16 a[64:79], v[128:131], a[160:163], 0
    s_nop 15
    v_accvgpr_read_b32 v32, a0
    v_accvgpr_read_b32 v33, a1
    v_accvgpr_read_b32 v34, a2
    v_mfma_f32_32x32x16_bf16 a[80:95], v[160:163], a[160:163], 0
    v_accvgpr_read_b32 v35, a3
    v_accvgpr_read_b32 v36, a4
    v_accvgpr_read_b32 v37, a5
    v_accvgpr_read_b32 v38, a6
    v_mfma_f32_32x32x16_bf16 a[96:111], v[192:195], a[160:163], 0
    v_accvgpr_read_b32 v39, a7
    v_cvt_pk_bf16_f32 v40, v32, v33
    v_cvt_pk_bf16_f32 v41, v34, v35
    v_cvt_pk_bf16_f32 v42, v36, v37
    v_mfma_f32_32x32x16_bf16 a[112:127], v[224:227], a[160:163], 0
    v_cvt_pk_bf16_f32 v43, v38, v39
    s_add_u32 s56, s63, 0
    buffer_store_dwordx4 v[40:43], v16, s[24:27], s56 offen sc1
    v_accvgpr_read_b32 v44, a8
    v_mfma_f32_32x32x16_bf16 a[64:79], v[132:135], a[164:167], a[64:79]
    v_accvgpr_read_b32 v45, a9
    v_accvgpr_read_b32 v46, a10
    v_accvgpr_read_b32 v47, a11
    v_accvgpr_read_b32 v48, a12
    v_mfma_f32_32x32x16_bf16 a[80:95], v[164:167], a[164:167], a[80:95]
    v_accvgpr_read_b32 v49, a13
    v_accvgpr_read_b32 v50, a14
    v_accvgpr_read_b32 v51, a15
    v_cvt_pk_bf16_f32 v52, v44, v45
    v_mfma_f32_32x32x16_bf16 a[96:111], v[196:199], a[164:167], a[96:111]
    v_cvt_pk_bf16_f32 v53, v46, v47
    v_cvt_pk_bf16_f32 v54, v48, v49
    v_cvt_pk_bf16_f32 v55, v50, v51
    s_add_u32 s56, s63, 1024
    v_mfma_f32_32x32x16_bf16 a[112:127], v[228:231], a[164:167], a[112:127]
    buffer_store_dwordx4 v[52:55], v16, s[24:27], s56 offen sc1
    v_accvgpr_read_b32 v32, a16
    v_accvgpr_read_b32 v33, a17
    v_accvgpr_read_b32 v34, a18
    v_mfma_f32_32x32x16_bf16 a[64:79], v[136:139], a[168:171], a[64:79]
    v_accvgpr_read_b32 v35, a19
    v_accvgpr_read_b32 v36, a20
    v_accvgpr_read_b32 v37, a21
    v_accvgpr_read_b32 v38, a22
    v_mfma_f32_32x32x16_bf16 a[80:95], v[168:171], a[168:171], a[80:95]
    v_accvgpr_read_b32 v39, a23
    v_cvt_pk_bf16_f32 v40, v32, v33
    v_cvt_pk_bf16_f32 v41, v34, v35
    v_cvt_pk_bf16_f32 v42, v36, v37
    v_mfma_f32_32x32x16_bf16 a[96:111], v[200:203], a[168:171], a[96:111]
    v_cvt_pk_bf16_f32 v43, v38, v39
    s_add_u32 s56, s63, 1310720
    buffer_store_dwordx4 v[40:43], v16, s[24:27], s56 offen sc1
    v_accvgpr_read_b32 v44, a24
    v_mfma_f32_32x32x16_bf16 a[112:127], v[232:235], a[168:171], a[112:127]
    v_accvgpr_read_b32 v45, a25
    v_accvgpr_read_b32 v46, a26
    v_accvgpr_read_b32 v47, a27
    v_accvgpr_read_b32 v48, a28
    v_mfma_f32_32x32x16_bf16 a[64:79], v[140:143], a[172:175], a[64:79]
    v_accvgpr_read_b32 v49, a29
    v_accvgpr_read_b32 v50, a30
    v_accvgpr_read_b32 v51, a31
    v_cvt_pk_bf16_f32 v52, v44, v45
    v_mfma_f32_32x32x16_bf16 a[80:95], v[172:175], a[172:175], a[80:95]
    v_cvt_pk_bf16_f32 v53, v46, v47
    v_cvt_pk_bf16_f32 v54, v48, v49
    v_cvt_pk_bf16_f32 v55, v50, v51
    s_add_u32 s56, s63, 1311744
    v_mfma_f32_32x32x16_bf16 a[96:111], v[204:207], a[172:175], a[96:111]
    buffer_store_dwordx4 v[52:55], v16, s[24:27], s56 offen sc1
    v_accvgpr_read_b32 v32, a32
    v_accvgpr_read_b32 v33, a33
    v_accvgpr_read_b32 v34, a34
    v_mfma_f32_32x32x16_bf16 a[112:127], v[236:239], a[172:175], a[112:127]
    v_accvgpr_read_b32 v35, a35
    v_accvgpr_read_b32 v36, a36
    v_accvgpr_read_b32 v37, a37
    v_accvgpr_read_b32 v38, a38
    v_mfma_f32_32x32x16_bf16 a[64:79], v[144:147], a[176:179], a[64:79]
    v_accvgpr_read_b32 v39, a39
    v_cvt_pk_bf16_f32 v40, v32, v33
    v_cvt_pk_bf16_f32 v41, v34, v35
    v_cvt_pk_bf16_f32 v42, v36, v37
    v_mfma_f32_32x32x16_bf16 a[80:95], v[176:179], a[176:179], a[80:95]
    v_cvt_pk_bf16_f32 v43, v38, v39
    s_add_u32 s56, s63, 2621440
    buffer_store_dwordx4 v[40:43], v16, s[24:27], s56 offen sc1
    v_accvgpr_read_b32 v44, a40
    v_mfma_f32_32x32x16_bf16 a[96:111], v[208:211], a[176:179], a[96:111]
    v_accvgpr_read_b32 v45, a41
    v_accvgpr_read_b32 v46, a42
    v_accvgpr_read_b32 v47, a43
    v_accvgpr_read_b32 v48, a44
    v_mfma_f32_32x32x16_bf16 a[112:127], v[240:243], a[176:179], a[112:127]
    v_accvgpr_read_b32 v49, a45
    v_accvgpr_read_b32 v50, a46
    v_accvgpr_read_b32 v51, a47
    v_cvt_pk_bf16_f32 v52, v44, v45
    v_mfma_f32_32x32x16_bf16 a[64:79], v[148:151], a[180:183], a[64:79]
    v_cvt_pk_bf16_f32 v53, v46, v47
    v_cvt_pk_bf16_f32 v54, v48, v49
    v_cvt_pk_bf16_f32 v55, v50, v51
    s_add_u32 s56, s63, 2622464
    v_mfma_f32_32x32x16_bf16 a[80:95], v[180:183], a[180:183], a[80:95]
    buffer_store_dwordx4 v[52:55], v16, s[24:27], s56 offen sc1
    v_accvgpr_read_b32 v32, a48
    v_accvgpr_read_b32 v33, a49
    v_accvgpr_read_b32 v34, a50
    v_mfma_f32_32x32x16_bf16 a[96:111], v[212:215], a[180:183], a[96:111]
    v_accvgpr_read_b32 v35, a51
    v_accvgpr_read_b32 v36, a52
    v_accvgpr_read_b32 v37, a53
    v_accvgpr_read_b32 v38, a54
    v_mfma_f32_32x32x16_bf16 a[112:127], v[244:247], a[180:183], a[112:127]
    v_accvgpr_read_b32 v39, a55
    v_cvt_pk_bf16_f32 v40, v32, v33
    v_cvt_pk_bf16_f32 v41, v34, v35
    v_cvt_pk_bf16_f32 v42, v36, v37
    v_mfma_f32_32x32x16_bf16 a[64:79], v[152:155], a[184:187], a[64:79]
    v_cvt_pk_bf16_f32 v43, v38, v39
    s_add_u32 s56, s63, 3932160
    buffer_store_dwordx4 v[40:43], v16, s[24:27], s56 offen sc1
    v_accvgpr_read_b32 v44, a56
    v_mfma_f32_32x32x16_bf16 a[80:95], v[184:187], a[184:187], a[80:95]
    v_accvgpr_read_b32 v45, a57
    v_accvgpr_read_b32 v46, a58
    v_accvgpr_read_b32 v47, a59
    v_accvgpr_read_b32 v48, a60
    v_mfma_f32_32x32x16_bf16 a[96:111], v[216:219], a[184:187], a[96:111]
    v_accvgpr_read_b32 v49, a61
    v_accvgpr_read_b32 v50, a62
    v_accvgpr_read_b32 v51, a63
    v_cvt_pk_bf16_f32 v52, v44, v45
    v_mfma_f32_32x32x16_bf16 a[112:127], v[248:251], a[184:187], a[112:127]
    v_cvt_pk_bf16_f32 v53, v46, v47
    v_cvt_pk_bf16_f32 v54, v48, v49
    v_cvt_pk_bf16_f32 v55, v50, v51
    s_add_u32 s56, s63, 3933184
    v_mfma_f32_32x32x16_bf16 a[64:79], v[156:159], a[188:191], a[64:79]
    buffer_store_dwordx4 v[52:55], v16, s[24:27], s56 offen sc1
    s_add_u32 s63, s63, 2048
    v_mfma_f32_32x32x16_bf16 a[80:95], v[188:191], a[188:191], a[80:95]
    v_mfma_f32_32x32x16_bf16 a[96:111], v[220:223], a[188:191], a[96:111]
    v_mfma_f32_32x32x16_bf16 a[112:127], v[252:255], a[188:191], a[112:127]
    buffer_load_dwordx4 a[160:163], v16, s[24:27], s62 offen offset:0
    buffer_load_dwordx4 a[164:167], v16, s[24:27], s62 offen offset:1024
    buffer_load_dwordx4 a[168:171], v16, s[24:27], s62 offen offset:2048
    buffer_load_dwordx4 a[172:175], v16, s[24:27], s62 offen offset:3072
    buffer_load_dwordx4 a[176:179], v17, s[24:27], s62 offen offset:0
    buffer_load_dwordx4 a[180:183], v17, s[24:27], s62 offen offset:1024
    buffer_load_dwordx4 a[184:187], v17, s[24:27], s62 offen offset:2048
    buffer_load_dwordx4 a[188:191], v17, s[24:27], s62 offen offset:3072
    s_add_u32 s62, s62, 8192
    s_waitcnt vmcnt(8)
    v_mfma_f32_32x32x16_bf16 a[0:15], v[128:131], a[128:131], 0
    s_nop 15
    v_accvgpr_read_b32 v32, a64
    v_accvgpr_read_b32 v33, a65
    v_accvgpr_read_b32 v34, a66
    v_mfma_f32_32x32x16_bf16 a[16:31], v[160:163], a[128:131], 0
    v_accvgpr_read_b32 v35, a67
    v_accvgpr_read_b32 v36, a68
    v_accvgpr_read_b32 v37, a69
    v_accvgpr_read_b32 v38, a70
    v_mfma_f32_32x32x16_bf16 a[32:47], v[192:195], a[128:131], 0
    v_accvgpr_read_b32 v39, a71
    v_cvt_pk_bf16_f32 v40, v32, v33
    v_cvt_pk_bf16_f32 v41, v34, v35
    v_cvt_pk_bf16_f32 v42, v36, v37
    v_mfma_f32_32x32x16_bf16 a[48:63], v[224:227], a[128:131], 0
    v_cvt_pk_bf16_f32 v43, v38, v39
    s_add_u32 s56, s63, 0
    buffer_store_dwordx4 v[40:43], v16, s[24:27], s56 offen sc1
    v_accvgpr_read_b32 v44, a72
    v_mfma_f32_32x32x16_bf16 a[0:15], v[132:135], a[132:135], a[0:15]
    v_accvgpr_read_b32 v45, a73
    v_accvgpr_read_b32 v46, a74
    v_accvgpr_read_b32 v47, a75
    v_accvgpr_read_b32 v48, a76
    v_mfma_f32_32x32x16_bf16 a[16:31], v[164:167], a[132:135], a[16:31]
    v_accvgpr_read_b32 v49, a77
    v_accvgpr_read_b32 v50, a78
    v_accvgpr_read_b32 v51, a79
    v_cvt_pk_bf16_f32 v52, v44, v45
    v_mfma_f32_32x32x16_bf16 a[32:47], v[196:199], a[132:135], a[32:47]
    v_cvt_pk_bf16_f32 v53, v46, v47
    v_cvt_pk_bf16_f32 v54, v48, v49
    v_cvt_pk_bf16_f32 v55, v50, v51
    s_add_u32 s56, s63, 1024
    v_mfma_f32_32x32x16_bf16 a[48:63], v[228:231], a[132:135], a[48:63]
    buffer_store_dwordx4 v[52:55], v16, s[24:27], s56 offen sc1
    v_accvgpr_read_b32 v32, a80
    v_accvgpr_read_b32 v33, a81
    v_accvgpr_read_b32 v34, a82
    v_mfma_f32_32x32x16_bf16 a[0:15], v[136:139], a[136:139], a[0:15]
    v_accvgpr_read_b32 v35, a83
    v_accvgpr_read_b32 v36, a84
    v_accvgpr_read_b32 v37, a85
    v_accvgpr_read_b32 v38, a86
    v_mfma_f32_32x32x16_bf16 a[16:31], v[168:171], a[136:139], a[16:31]
    v_accvgpr_read_b32 v39, a87
    v_cvt_pk_bf16_f32 v40, v32, v33
    v_cvt_pk_bf16_f32 v41, v34, v35
    v_cvt_pk_bf16_f32 v42, v36, v37
    v_mfma_f32_32x32x16_bf16 a[32:47], v[200:203], a[136:139], a[32:47]
    v_cvt_pk_bf16_f32 v43, v38, v39
    s_add_u32 s56, s63, 1310720
    buffer_store_dwordx4 v[40:43], v16, s[24:27], s56 offen sc1
    v_accvgpr_read_b32 v44, a88
    v_mfma_f32_32x32x16_bf16 a[48:63], v[232:235], a[136:139], a[48:63]
    v_accvgpr_read_b32 v45, a89
    v_accvgpr_read_b32 v46, a90
    v_accvgpr_read_b32 v47, a91
    v_accvgpr_read_b32 v48, a92
    v_mfma_f32_32x32x16_bf16 a[0:15], v[140:143], a[140:143], a[0:15]
    v_accvgpr_read_b32 v49, a93
    v_accvgpr_read_b32 v50, a94
    v_accvgpr_read_b32 v51, a95
    v_cvt_pk_bf16_f32 v52, v44, v45
    v_mfma_f32_32x32x16_bf16 a[16:31], v[172:175], a[140:143], a[16:31]
    v_cvt_pk_bf16_f32 v53, v46, v47
    v_cvt_pk_bf16_f32 v54, v48, v49
    v_cvt_pk_bf16_f32 v55, v50, v51
    s_add_u32 s56, s63, 1311744
    v_mfma_f32_32x32x16_bf16 a[32:47], v[204:207], a[140:143], a[32:47]
    buffer_store_dwordx4 v[52:55], v16, s[24:27], s56 offen sc1
    v_accvgpr_read_b32 v32, a96
    v_accvgpr_read_b32 v33, a97
    v_accvgpr_read_b32 v34, a98
    v_mfma_f32_32x32x16_bf16 a[48:63], v[236:239], a[140:143], a[48:63]
    v_accvgpr_read_b32 v35, a99
    v_accvgpr_read_b32 v36, a100
    v_accvgpr_read_b32 v37, a101
    v_accvgpr_read_b32 v38, a102
    v_mfma_f32_32x32x16_bf16 a[0:15], v[144:147], a[144:147], a[0:15]
    v_accvgpr_read_b32 v39, a103
    v_cvt_pk_bf16_f32 v40, v32, v33
    v_cvt_pk_bf16_f32 v41, v34, v35
    v_cvt_pk_bf16_f32 v42, v36, v37
    v_mfma_f32_32x32x16_bf16 a[16:31], v[176:179], a[144:147], a[16:31]
    v_cvt_pk_bf16_f32 v43, v38, v39
    s_add_u32 s56, s63, 2621440
    buffer_store_dwordx4 v[40:43], v16, s[24:27], s56 offen sc1
    v_accvgpr_read_b32 v44, a104
    v_mfma_f32_32x32x16_bf16 a[32:47], v[208:211], a[144:147], a[32:47]
    v_accvgpr_read_b32 v45, a105
    v_accvgpr_read_b32 v46, a106
    v_accvgpr_read_b32 v47, a107
    v_accvgpr_read_b32 v48, a108
    v_mfma_f32_32x32x16_bf16 a[48:63], v[240:243], a[144:147], a[48:63]
    v_accvgpr_read_b32 v49, a109
    v_accvgpr_read_b32 v50, a110
    v_accvgpr_read_b32 v51, a111
    v_cvt_pk_bf16_f32 v52, v44, v45
    v_mfma_f32_32x32x16_bf16 a[0:15], v[148:151], a[148:151], a[0:15]
    v_cvt_pk_bf16_f32 v53, v46, v47
    v_cvt_pk_bf16_f32 v54, v48, v49
    v_cvt_pk_bf16_f32 v55, v50, v51
    s_add_u32 s56, s63, 2622464
    v_mfma_f32_32x32x16_bf16 a[16:31], v[180:183], a[148:151], a[16:31]
    buffer_store_dwordx4 v[52:55], v16, s[24:27], s56 offen sc1
    v_accvgpr_read_b32 v32, a112
    v_accvgpr_read_b32 v33, a113
    v_accvgpr_read_b32 v34, a114
    v_mfma_f32_32x32x16_bf16 a[32:47], v[212:215], a[148:151], a[32:47]
    v_accvgpr_read_b32 v35, a115
    v_accvgpr_read_b32 v36, a116
    v_accvgpr_read_b32 v37, a117
    v_accvgpr_read_b32 v38, a118
    v_mfma_f32_32x32x16_bf16 a[48:63], v[244:247], a[148:151], a[48:63]
    v_accvgpr_read_b32 v39, a119
    v_cvt_pk_bf16_f32 v40, v32, v33
    v_cvt_pk_bf16_f32 v41, v34, v35
    v_cvt_pk_bf16_f32 v42, v36, v37
    v_mfma_f32_32x32x16_bf16 a[0:15], v[152:155], a[152:155], a[0:15]
    v_cvt_pk_bf16_f32 v43, v38, v39
    s_add_u32 s56, s63, 3932160
    buffer_store_dwordx4 v[40:43], v16, s[24:27], s56 offen sc1
    v_accvgpr_read_b32 v44, a120
    v_mfma_f32_32x32x16_bf16 a[16:31], v[184:187], a[152:155], a[16:31]
    v_accvgpr_read_b32 v45, a121
    v_accvgpr_read_b32 v46, a122
    v_accvgpr_read_b32 v47, a123
    v_accvgpr_read_b32 v48, a124
    v_mfma_f32_32x32x16_bf16 a[32:47], v[216:219], a[152:155], a[32:47]
    v_accvgpr_read_b32 v49, a125
    v_accvgpr_read_b32 v50, a126
    v_accvgpr_read_b32 v51, a127
    v_cvt_pk_bf16_f32 v52, v44, v45
    v_mfma_f32_32x32x16_bf16 a[48:63], v[248:251], a[152:155], a[48:63]
    v_cvt_pk_bf16_f32 v53, v46, v47
    v_cvt_pk_bf16_f32 v54, v48, v49
    v_cvt_pk_bf16_f32 v55, v50, v51
    s_add_u32 s56, s63, 3933184
    v_mfma_f32_32x32x16_bf16 a[0:15], v[156:159], a[156:159], a[0:15]
    buffer_store_dwordx4 v[52:55], v16, s[24:27], s56 offen sc1
    s_add_u32 s63, s63, 2048
    v_mfma_f32_32x32x16_bf16 a[16:31], v[188:191], a[156:159], a[16:31]
    v_mfma_f32_32x32x16_bf16 a[32:47], v[220:223], a[156:159], a[32:47]
    v_mfma_f32_32x32x16_bf16 a[48:63], v[252:255], a[156:159], a[48:63]
    buffer_load_dwordx4 a[128:131], v16, s[24:27], s62 offen offset:0
    buffer_load_dwordx4 a[132:135], v16, s[24:27], s62 offen offset:1024
    buffer_load_dwordx4 a[136:139], v16, s[24:27], s62 offen offset:2048
    buffer_load_dwordx4 a[140:143], v16, s[24:27], s62 offen offset:3072
    buffer_load_dwordx4 a[144:147], v17, s[24:27], s62 offen offset:0
    buffer_load_dwordx4 a[148:151], v17, s[24:27], s62 offen offset:1024
    buffer_load_dwordx4 a[152:155], v17, s[24:27], s62 offen offset:2048
    buffer_load_dwordx4 a[156:159], v17, s[24:27], s62 offen offset:3072
    s_add_u32 s62, s62, 8192
    s_waitcnt vmcnt(8)
    v_mfma_f32_32x32x16_bf16 a[64:79], v[128:131], a[160:163], 0
    s_nop 15
    v_accvgpr_read_b32 v32, a0
    v_accvgpr_read_b32 v33, a1
    v_accvgpr_read_b32 v34, a2
    v_mfma_f32_32x32x16_bf16 a[80:95], v[160:163], a[160:163], 0
    v_accvgpr_read_b32 v35, a3
    v_accvgpr_read_b32 v36, a4
    v_accvgpr_read_b32 v37, a5
    v_accvgpr_read_b32 v38, a6
    v_mfma_f32_32x32x16_bf16 a[96:111], v[192:195], a[160:163], 0
    v_accvgpr_read_b32 v39, a7
    v_cvt_pk_bf16_f32 v40, v32, v33
    v_cvt_pk_bf16_f32 v41, v34, v35
    v_cvt_pk_bf16_f32 v42, v36, v37
    v_mfma_f32_32x32x16_bf16 a[112:127], v[224:227], a[160:163], 0
    v_cvt_pk_bf16_f32 v43, v38, v39
    s_add_u32 s56, s63, 0
    buffer_store_dwordx4 v[40:43], v16, s[24:27], s56 offen sc1
    v_accvgpr_read_b32 v44, a8
    v_mfma_f32_32x32x16_bf16 a[64:79], v[132:135], a[164:167], a[64:79]
    v_accvgpr_read_b32 v45, a9
    v_accvgpr_read_b32 v46, a10
    v_accvgpr_read_b32 v47, a11
    v_accvgpr_read_b32 v48, a12
    v_mfma_f32_32x32x16_bf16 a[80:95], v[164:167], a[164:167], a[80:95]
    v_accvgpr_read_b32 v49, a13
    v_accvgpr_read_b32 v50, a14
    v_accvgpr_read_b32 v51, a15
    v_cvt_pk_bf16_f32 v52, v44, v45
    v_mfma_f32_32x32x16_bf16 a[96:111], v[196:199], a[164:167], a[96:111]
    v_cvt_pk_bf16_f32 v53, v46, v47
    v_cvt_pk_bf16_f32 v54, v48, v49
    v_cvt_pk_bf16_f32 v55, v50, v51
    s_add_u32 s56, s63, 1024
    v_mfma_f32_32x32x16_bf16 a[112:127], v[228:231], a[164:167], a[112:127]
    buffer_store_dwordx4 v[52:55], v16, s[24:27], s56 offen sc1
    v_accvgpr_read_b32 v32, a16
    v_accvgpr_read_b32 v33, a17
    v_accvgpr_read_b32 v34, a18
    v_mfma_f32_32x32x16_bf16 a[64:79], v[136:139], a[168:171], a[64:79]
    v_accvgpr_read_b32 v35, a19
    v_accvgpr_read_b32 v36, a20
    v_accvgpr_read_b32 v37, a21
    v_accvgpr_read_b32 v38, a22
    v_mfma_f32_32x32x16_bf16 a[80:95], v[168:171], a[168:171], a[80:95]
    v_accvgpr_read_b32 v39, a23
    v_cvt_pk_bf16_f32 v40, v32, v33
    v_cvt_pk_bf16_f32 v41, v34, v35
    v_cvt_pk_bf16_f32 v42, v36, v37
    v_mfma_f32_32x32x16_bf16 a[96:111], v[200:203], a[168:171], a[96:111]
    v_cvt_pk_bf16_f32 v43, v38, v39
    s_add_u32 s56, s63, 1310720
    buffer_store_dwordx4 v[40:43], v16, s[24:27], s56 offen sc1
    v_accvgpr_read_b32 v44, a24
    v_mfma_f32_32x32x16_bf16 a[112:127], v[232:235], a[168:171], a[112:127]
    v_accvgpr_read_b32 v45, a25
    v_accvgpr_read_b32 v46, a26
    v_accvgpr_read_b32 v47, a27
    v_accvgpr_read_b32 v48, a28
    v_mfma_f32_32x32x16_bf16 a[64:79], v[140:143], a[172:175], a[64:79]
    v_accvgpr_read_b32 v49, a29
    v_accvgpr_read_b32 v50, a30
    v_accvgpr_read_b32 v51, a31
    v_cvt_pk_bf16_f32 v52, v44, v45
    v_mfma_f32_32x32x16_bf16 a[80:95], v[172:175], a[172:175], a[80:95]
    v_cvt_pk_bf16_f32 v53, v46, v47
    v_cvt_pk_bf16_f32 v54, v48, v49
    v_cvt_pk_bf16_f32 v55, v50, v51
    s_add_u32 s56, s63, 1311744
    v_mfma_f32_32x32x16_bf16 a[96:111], v[204:207], a[172:175], a[96:111]
    buffer_store_dwordx4 v[52:55], v16, s[24:27], s56 offen sc1
    v_accvgpr_read_b32 v32, a32
    v_accvgpr_read_b32 v33, a33
    v_accvgpr_read_b32 v34, a34
    v_mfma_f32_32x32x16_bf16 a[112:127], v[236:239], a[172:175], a[112:127]
    v_accvgpr_read_b32 v35, a35
    v_accvgpr_read_b32 v36, a36
    v_accvgpr_read_b32 v37, a37
    v_accvgpr_read_b32 v38, a38
    v_mfma_f32_32x32x16_bf16 a[64:79], v[144:147], a[176:179], a[64:79]
    v_accvgpr_read_b32 v39, a39
    v_cvt_pk_bf16_f32 v40, v32, v33
    v_cvt_pk_bf16_f32 v41, v34, v35
    v_cvt_pk_bf16_f32 v42, v36, v37
    v_mfma_f32_32x32x16_bf16 a[80:95], v[176:179], a[176:179], a[80:95]
    v_cvt_pk_bf16_f32 v43, v38, v39
    s_add_u32 s56, s63, 2621440
    buffer_store_dwordx4 v[40:43], v16, s[24:27], s56 offen sc1
    v_accvgpr_read_b32 v44, a40
    v_mfma_f32_32x32x16_bf16 a[96:111], v[208:211], a[176:179], a[96:111]
    v_accvgpr_read_b32 v45, a41
    v_accvgpr_read_b32 v46, a42
    v_accvgpr_read_b32 v47, a43
    v_accvgpr_read_b32 v48, a44
    v_mfma_f32_32x32x16_bf16 a[112:127], v[240:243], a[176:179], a[112:127]
    v_accvgpr_read_b32 v49, a45
    v_accvgpr_read_b32 v50, a46
    v_accvgpr_read_b32 v51, a47
    v_cvt_pk_bf16_f32 v52, v44, v45
    v_mfma_f32_32x32x16_bf16 a[64:79], v[148:151], a[180:183], a[64:79]
    v_cvt_pk_bf16_f32 v53, v46, v47
    v_cvt_pk_bf16_f32 v54, v48, v49
    v_cvt_pk_bf16_f32 v55, v50, v51
    s_add_u32 s56, s63, 2622464
    v_mfma_f32_32x32x16_bf16 a[80:95], v[180:183], a[180:183], a[80:95]
    buffer_store_dwordx4 v[52:55], v16, s[24:27], s56 offen sc1
    v_accvgpr_read_b32 v32, a48
    v_accvgpr_read_b32 v33, a49
    v_accvgpr_read_b32 v34, a50
    v_mfma_f32_32x32x16_bf16 a[96:111], v[212:215], a[180:183], a[96:111]
    v_accvgpr_read_b32 v35, a51
    v_accvgpr_read_b32 v36, a52
    v_accvgpr_read_b32 v37, a53
    v_accvgpr_read_b32 v38, a54
    v_mfma_f32_32x32x16_bf16 a[112:127], v[244:247], a[180:183], a[112:127]
    v_accvgpr_read_b32 v39, a55
    v_cvt_pk_bf16_f32 v40, v32, v33
    v_cvt_pk_bf16_f32 v41, v34, v35
    v_cvt_pk_bf16_f32 v42, v36, v37
    v_mfma_f32_32x32x16_bf16 a[64:79], v[152:155], a[184:187], a[64:79]
    v_cvt_pk_bf16_f32 v43, v38, v39
    s_add_u32 s56, s63, 3932160
    buffer_store_dwordx4 v[40:43], v16, s[24:27], s56 offen sc1
    v_accvgpr_read_b32 v44, a56
    v_mfma_f32_32x32x16_bf16 a[80:95], v[184:187], a[184:187], a[80:95]
    v_accvgpr_read_b32 v45, a57
    v_accvgpr_read_b32 v46, a58
    v_accvgpr_read_b32 v47, a59
    v_accvgpr_read_b32 v48, a60
    v_mfma_f32_32x32x16_bf16 a[96:111], v[216:219], a[184:187], a[96:111]
    v_accvgpr_read_b32 v49, a61
    v_accvgpr_read_b32 v50, a62
    v_accvgpr_read_b32 v51, a63
    v_cvt_pk_bf16_f32 v52, v44, v45
    v_mfma_f32_32x32x16_bf16 a[112:127], v[248:251], a[184:187], a[112:127]
    v_cvt_pk_bf16_f32 v53, v46, v47
    v_cvt_pk_bf16_f32 v54, v48, v49
    v_cvt_pk_bf16_f32 v55, v50, v51
    s_add_u32 s56, s63, 3933184
    v_mfma_f32_32x32x16_bf16 a[64:79], v[156:159], a[188:191], a[64:79]
    buffer_store_dwordx4 v[52:55], v16, s[24:27], s56 offen sc1
    s_add_u32 s63, s63, 2048
    v_mfma_f32_32x32x16_bf16 a[80:95], v[188:191], a[188:191], a[80:95]
    v_mfma_f32_32x32x16_bf16 a[96:111], v[220:223], a[188:191], a[96:111]
    v_mfma_f32_32x32x16_bf16 a[112:127], v[252:255], a[188:191], a[112:127]
    buffer_load_dwordx4 a[160:163], v16, s[24:27], s62 offen offset:0
    buffer_load_dwordx4 a[164:167], v16, s[24:27], s62 offen offset:1024
    buffer_load_dwordx4 a[168:171], v16, s[24:27], s62 offen offset:2048
    buffer_load_dwordx4 a[172:175], v16, s[24:27], s62 offen offset:3072
    buffer_load_dwordx4 a[176:179], v17, s[24:27], s62 offen offset:0
    buffer_load_dwordx4 a[180:183], v17, s[24:27], s62 offen offset:1024
    buffer_load_dwordx4 a[184:187], v17, s[24:27], s62 offen offset:2048
    buffer_load_dwordx4 a[188:191], v17, s[24:27], s62 offen offset:3072
    s_add_u32 s62, s62, 8192
    s_waitcnt vmcnt(8)
    v_mfma_f32_32x32x16_bf16 a[0:15], v[128:131], a[128:131], 0
    s_nop 15
    v_accvgpr_read_b32 v32, a64
    v_accvgpr_read_b32 v33, a65
    v_accvgpr_read_b32 v34, a66
    v_mfma_f32_32x32x16_bf16 a[16:31], v[160:163], a[128:131], 0
    v_accvgpr_read_b32 v35, a67
    v_accvgpr_read_b32 v36, a68
    v_accvgpr_read_b32 v37, a69
    v_accvgpr_read_b32 v38, a70
    v_mfma_f32_32x32x16_bf16 a[32:47], v[192:195], a[128:131], 0
    v_accvgpr_read_b32 v39, a71
    v_cvt_pk_bf16_f32 v40, v32, v33
    v_cvt_pk_bf16_f32 v41, v34, v35
    v_cvt_pk_bf16_f32 v42, v36, v37
    v_mfma_f32_32x32x16_bf16 a[48:63], v[224:227], a[128:131], 0
    v_cvt_pk_bf16_f32 v43, v38, v39
    s_add_u32 s56, s63, 0
    buffer_store_dwordx4 v[40:43], v16, s[24:27], s56 offen sc1
    v_accvgpr_read_b32 v44, a72
    v_mfma_f32_32x32x16_bf16 a[0:15], v[132:135], a[132:135], a[0:15]
    v_accvgpr_read_b32 v45, a73
    v_accvgpr_read_b32 v46, a74
    v_accvgpr_read_b32 v47, a75
    v_accvgpr_read_b32 v48, a76
    v_mfma_f32_32x32x16_bf16 a[16:31], v[164:167], a[132:135], a[16:31]
    v_accvgpr_read_b32 v49, a77
    v_accvgpr_read_b32 v50, a78
    v_accvgpr_read_b32 v51, a79
    v_cvt_pk_bf16_f32 v52, v44, v45
    v_mfma_f32_32x32x16_bf16 a[32:47], v[196:199], a[132:135], a[32:47]
    v_cvt_pk_bf16_f32 v53, v46, v47
    v_cvt_pk_bf16_f32 v54, v48, v49
    v_cvt_pk_bf16_f32 v55, v50, v51
    s_add_u32 s56, s63, 1024
    v_mfma_f32_32x32x16_bf16 a[48:63], v[228:231], a[132:135], a[48:63]
    buffer_store_dwordx4 v[52:55], v16, s[24:27], s56 offen sc1
    v_accvgpr_read_b32 v32, a80
    v_accvgpr_read_b32 v33, a81
    v_accvgpr_read_b32 v34, a82
    v_mfma_f32_32x32x16_bf16 a[0:15], v[136:139], a[136:139], a[0:15]
    v_accvgpr_read_b32 v35, a83
    v_accvgpr_read_b32 v36, a84
    v_accvgpr_read_b32 v37, a85
    v_accvgpr_read_b32 v38, a86
    v_mfma_f32_32x32x16_bf16 a[16:31], v[168:171], a[136:139], a[16:31]
    v_accvgpr_read_b32 v39, a87
    v_cvt_pk_bf16_f32 v40, v32, v33
    v_cvt_pk_bf16_f32 v41, v34, v35
    v_cvt_pk_bf16_f32 v42, v36, v37
    v_mfma_f32_32x32x16_bf16 a[32:47], v[200:203], a[136:139], a[32:47]
    v_cvt_pk_bf16_f32 v43, v38, v39
    s_add_u32 s56, s63, 1310720
    buffer_store_dwordx4 v[40:43], v16, s[24:27], s56 offen sc1
    v_accvgpr_read_b32 v44, a88
    v_mfma_f32_32x32x16_bf16 a[48:63], v[232:235], a[136:139], a[48:63]
    v_accvgpr_read_b32 v45, a89
    v_accvgpr_read_b32 v46, a90
    v_accvgpr_read_b32 v47, a91
    v_accvgpr_read_b32 v48, a92
    v_mfma_f32_32x32x16_bf16 a[0:15], v[140:143], a[140:143], a[0:15]
    v_accvgpr_read_b32 v49, a93
    v_accvgpr_read_b32 v50, a94
    v_accvgpr_read_b32 v51, a95
    v_cvt_pk_bf16_f32 v52, v44, v45
    v_mfma_f32_32x32x16_bf16 a[16:31], v[172:175], a[140:143], a[16:31]
    v_cvt_pk_bf16_f32 v53, v46, v47
    v_cvt_pk_bf16_f32 v54, v48, v49
    v_cvt_pk_bf16_f32 v55, v50, v51
    s_add_u32 s56, s63, 1311744
    v_mfma_f32_32x32x16_bf16 a[32:47], v[204:207], a[140:143], a[32:47]
    buffer_store_dwordx4 v[52:55], v16, s[24:27], s56 offen sc1
    v_accvgpr_read_b32 v32, a96
    v_accvgpr_read_b32 v33, a97
    v_accvgpr_read_b32 v34, a98
    v_mfma_f32_32x32x16_bf16 a[48:63], v[236:239], a[140:143], a[48:63]
    v_accvgpr_read_b32 v35, a99
    v_accvgpr_read_b32 v36, a100
    v_accvgpr_read_b32 v37, a101
    v_accvgpr_read_b32 v38, a102
    v_mfma_f32_32x32x16_bf16 a[0:15], v[144:147], a[144:147], a[0:15]
    v_accvgpr_read_b32 v39, a103
    v_cvt_pk_bf16_f32 v40, v32, v33
    v_cvt_pk_bf16_f32 v41, v34, v35
    v_cvt_pk_bf16_f32 v42, v36, v37
    v_mfma_f32_32x32x16_bf16 a[16:31], v[176:179], a[144:147], a[16:31]
    v_cvt_pk_bf16_f32 v43, v38, v39
    s_add_u32 s56, s63, 2621440
    buffer_store_dwordx4 v[40:43], v16, s[24:27], s56 offen sc1
    v_accvgpr_read_b32 v44, a104
    v_mfma_f32_32x32x16_bf16 a[32:47], v[208:211], a[144:147], a[32:47]
    v_accvgpr_read_b32 v45, a105
    v_accvgpr_read_b32 v46, a106
    v_accvgpr_read_b32 v47, a107
    v_accvgpr_read_b32 v48, a108
    v_mfma_f32_32x32x16_bf16 a[48:63], v[240:243], a[144:147], a[48:63]
    v_accvgpr_read_b32 v49, a109
    v_accvgpr_read_b32 v50, a110
    v_accvgpr_read_b32 v51, a111
    v_cvt_pk_bf16_f32 v52, v44, v45
    v_mfma_f32_32x32x16_bf16 a[0:15], v[148:151], a[148:151], a[0:15]
    v_cvt_pk_bf16_f32 v53, v46, v47
    v_cvt_pk_bf16_f32 v54, v48, v49
    v_cvt_pk_bf16_f32 v55, v50, v51
    s_add_u32 s56, s63, 2622464
    v_mfma_f32_32x32x16_bf16 a[16:31], v[180:183], a[148:151], a[16:31]
    buffer_store_dwordx4 v[52:55], v16, s[24:27], s56 offen sc1
    v_accvgpr_read_b32 v32, a112
    v_accvgpr_read_b32 v33, a113
    v_accvgpr_read_b32 v34, a114
    v_mfma_f32_32x32x16_bf16 a[32:47], v[212:215], a[148:151], a[32:47]
    v_accvgpr_read_b32 v35, a115
    v_accvgpr_read_b32 v36, a116
    v_accvgpr_read_b32 v37, a117
    v_accvgpr_read_b32 v38, a118
    v_mfma_f32_32x32x16_bf16 a[48:63], v[244:247], a[148:151], a[48:63]
    v_accvgpr_read_b32 v39, a119
    v_cvt_pk_bf16_f32 v40, v32, v33
    v_cvt_pk_bf16_f32 v41, v34, v35
    v_cvt_pk_bf16_f32 v42, v36, v37
    v_mfma_f32_32x32x16_bf16 a[0:15], v[152:155], a[152:155], a[0:15]
    v_cvt_pk_bf16_f32 v43, v38, v39
    s_add_u32 s56, s63, 3932160
    buffer_store_dwordx4 v[40:43], v16, s[24:27], s56 offen sc1
    v_accvgpr_read_b32 v44, a120
    v_mfma_f32_32x32x16_bf16 a[16:31], v[184:187], a[152:155], a[16:31]
    v_accvgpr_read_b32 v45, a121
    v_accvgpr_read_b32 v46, a122
    v_accvgpr_read_b32 v47, a123
    v_accvgpr_read_b32 v48, a124
    v_mfma_f32_32x32x16_bf16 a[32:47], v[216:219], a[152:155], a[32:47]
    v_accvgpr_read_b32 v49, a125
    v_accvgpr_read_b32 v50, a126
    v_accvgpr_read_b32 v51, a127
    v_cvt_pk_bf16_f32 v52, v44, v45
    v_mfma_f32_32x32x16_bf16 a[48:63], v[248:251], a[152:155], a[48:63]
    v_cvt_pk_bf16_f32 v53, v46, v47
    v_cvt_pk_bf16_f32 v54, v48, v49
    v_cvt_pk_bf16_f32 v55, v50, v51
    s_add_u32 s56, s63, 3933184
    v_mfma_f32_32x32x16_bf16 a[0:15], v[156:159], a[156:159], a[0:15]
    buffer_store_dwordx4 v[52:55], v16, s[24:27], s56 offen sc1
    s_add_u32 s63, s63, 2048
    v_mfma_f32_32x32x16_bf16 a[16:31], v[188:191], a[156:159], a[16:31]
    v_mfma_f32_32x32x16_bf16 a[32:47], v[220:223], a[156:159], a[32:47]
    v_mfma_f32_32x32x16_bf16 a[48:63], v[252:255], a[156:159], a[48:63]
    buffer_load_dwordx4 a[128:131], v16, s[24:27], s62 offen offset:0
    buffer_load_dwordx4 a[132:135], v16, s[24:27], s62 offen offset:1024
    buffer_load_dwordx4 a[136:139], v16, s[24:27], s62 offen offset:2048
    buffer_load_dwordx4 a[140:143], v16, s[24:27], s62 offen offset:3072
    buffer_load_dwordx4 a[144:147], v17, s[24:27], s62 offen offset:0
    buffer_load_dwordx4 a[148:151], v17, s[24:27], s62 offen offset:1024
    buffer_load_dwordx4 a[152:155], v17, s[24:27], s62 offen offset:2048
    buffer_load_dwordx4 a[156:159], v17, s[24:27], s62 offen offset:3072
    s_add_u32 s62, s62, 8192
    s_waitcnt vmcnt(8)
    v_mfma_f32_32x32x16_bf16 a[64:79], v[128:131], a[160:163], 0
    s_nop 15
    v_accvgpr_read_b32 v32, a0
    v_accvgpr_read_b32 v33, a1
    v_accvgpr_read_b32 v34, a2
    v_mfma_f32_32x32x16_bf16 a[80:95], v[160:163], a[160:163], 0
    v_accvgpr_read_b32 v35, a3
    v_accvgpr_read_b32 v36, a4
    v_accvgpr_read_b32 v37, a5
    v_accvgpr_read_b32 v38, a6
    v_mfma_f32_32x32x16_bf16 a[96:111], v[192:195], a[160:163], 0
    v_accvgpr_read_b32 v39, a7
    v_cvt_pk_bf16_f32 v40, v32, v33
    v_cvt_pk_bf16_f32 v41, v34, v35
    v_cvt_pk_bf16_f32 v42, v36, v37
    v_mfma_f32_32x32x16_bf16 a[112:127], v[224:227], a[160:163], 0
    v_cvt_pk_bf16_f32 v43, v38, v39
    s_add_u32 s56, s63, 0
    buffer_store_dwordx4 v[40:43], v16, s[24:27], s56 offen sc1
    v_accvgpr_read_b32 v44, a8
    v_mfma_f32_32x32x16_bf16 a[64:79], v[132:135], a[164:167], a[64:79]
    v_accvgpr_read_b32 v45, a9
    v_accvgpr_read_b32 v46, a10
    v_accvgpr_read_b32 v47, a11
    v_accvgpr_read_b32 v48, a12
    v_mfma_f32_32x32x16_bf16 a[80:95], v[164:167], a[164:167], a[80:95]
    v_accvgpr_read_b32 v49, a13
    v_accvgpr_read_b32 v50, a14
    v_accvgpr_read_b32 v51, a15
    v_cvt_pk_bf16_f32 v52, v44, v45
    v_mfma_f32_32x32x16_bf16 a[96:111], v[196:199], a[164:167], a[96:111]
    v_cvt_pk_bf16_f32 v53, v46, v47
    v_cvt_pk_bf16_f32 v54, v48, v49
    v_cvt_pk_bf16_f32 v55, v50, v51
    s_add_u32 s56, s63, 1024
    v_mfma_f32_32x32x16_bf16 a[112:127], v[228:231], a[164:167], a[112:127]
    buffer_store_dwordx4 v[52:55], v16, s[24:27], s56 offen sc1
    v_accvgpr_read_b32 v32, a16
    v_accvgpr_read_b32 v33, a17
    v_accvgpr_read_b32 v34, a18
    v_mfma_f32_32x32x16_bf16 a[64:79], v[136:139], a[168:171], a[64:79]
    v_accvgpr_read_b32 v35, a19
    v_accvgpr_read_b32 v36, a20
    v_accvgpr_read_b32 v37, a21
    v_accvgpr_read_b32 v38, a22
    v_mfma_f32_32x32x16_bf16 a[80:95], v[168:171], a[168:171], a[80:95]
    v_accvgpr_read_b32 v39, a23
    v_cvt_pk_bf16_f32 v40, v32, v33
    v_cvt_pk_bf16_f32 v41, v34, v35
    v_cvt_pk_bf16_f32 v42, v36, v37
    v_mfma_f32_32x32x16_bf16 a[96:111], v[200:203], a[168:171], a[96:111]
    v_cvt_pk_bf16_f32 v43, v38, v39
    s_add_u32 s56, s63, 1310720
    buffer_store_dwordx4 v[40:43], v16, s[24:27], s56 offen sc1
    v_accvgpr_read_b32 v44, a24
    v_mfma_f32_32x32x16_bf16 a[112:127], v[232:235], a[168:171], a[112:127]
    v_accvgpr_read_b32 v45, a25
    v_accvgpr_read_b32 v46, a26
    v_accvgpr_read_b32 v47, a27
    v_accvgpr_read_b32 v48, a28
    v_mfma_f32_32x32x16_bf16 a[64:79], v[140:143], a[172:175], a[64:79]
    v_accvgpr_read_b32 v49, a29
    v_accvgpr_read_b32 v50, a30
    v_accvgpr_read_b32 v51, a31
    v_cvt_pk_bf16_f32 v52, v44, v45
    v_mfma_f32_32x32x16_bf16 a[80:95], v[172:175], a[172:175], a[80:95]
    v_cvt_pk_bf16_f32 v53, v46, v47
    v_cvt_pk_bf16_f32 v54, v48, v49
    v_cvt_pk_bf16_f32 v55, v50, v51
    s_add_u32 s56, s63, 1311744
    v_mfma_f32_32x32x16_bf16 a[96:111], v[204:207], a[172:175], a[96:111]
    buffer_store_dwordx4 v[52:55], v16, s[24:27], s56 offen sc1
    v_accvgpr_read_b32 v32, a32
    v_accvgpr_read_b32 v33, a33
    v_accvgpr_read_b32 v34, a34
    v_mfma_f32_32x32x16_bf16 a[112:127], v[236:239], a[172:175], a[112:127]
    v_accvgpr_read_b32 v35, a35
    v_accvgpr_read_b32 v36, a36
    v_accvgpr_read_b32 v37, a37
    v_accvgpr_read_b32 v38, a38
    v_mfma_f32_32x32x16_bf16 a[64:79], v[144:147], a[176:179], a[64:79]
    v_accvgpr_read_b32 v39, a39
    v_cvt_pk_bf16_f32 v40, v32, v33
    v_cvt_pk_bf16_f32 v41, v34, v35
    v_cvt_pk_bf16_f32 v42, v36, v37
    v_mfma_f32_32x32x16_bf16 a[80:95], v[176:179], a[176:179], a[80:95]
    v_cvt_pk_bf16_f32 v43, v38, v39
    s_add_u32 s56, s63, 2621440
    buffer_store_dwordx4 v[40:43], v16, s[24:27], s56 offen sc1
    v_accvgpr_read_b32 v44, a40
    v_mfma_f32_32x32x16_bf16 a[96:111], v[208:211], a[176:179], a[96:111]
    v_accvgpr_read_b32 v45, a41
    v_accvgpr_read_b32 v46, a42
    v_accvgpr_read_b32 v47, a43
    v_accvgpr_read_b32 v48, a44
    v_mfma_f32_32x32x16_bf16 a[112:127], v[240:243], a[176:179], a[112:127]
    v_accvgpr_read_b32 v49, a45
    v_accvgpr_read_b32 v50, a46
    v_accvgpr_read_b32 v51, a47
    v_cvt_pk_bf16_f32 v52, v44, v45
    v_mfma_f32_32x32x16_bf16 a[64:79], v[148:151], a[180:183], a[64:79]
    v_cvt_pk_bf16_f32 v53, v46, v47
    v_cvt_pk_bf16_f32 v54, v48, v49
    v_cvt_pk_bf16_f32 v55, v50, v51
    s_add_u32 s56, s63, 2622464
    v_mfma_f32_32x32x16_bf16 a[80:95], v[180:183], a[180:183], a[80:95]
    buffer_store_dwordx4 v[52:55], v16, s[24:27], s56 offen sc1
    v_accvgpr_read_b32 v32, a48
    v_accvgpr_read_b32 v33, a49
    v_accvgpr_read_b32 v34, a50
    v_mfma_f32_32x32x16_bf16 a[96:111], v[212:215], a[180:183], a[96:111]
    v_accvgpr_read_b32 v35, a51
    v_accvgpr_read_b32 v36, a52
    v_accvgpr_read_b32 v37, a53
    v_accvgpr_read_b32 v38, a54
    v_mfma_f32_32x32x16_bf16 a[112:127], v[244:247], a[180:183], a[112:127]
    v_accvgpr_read_b32 v39, a55
    v_cvt_pk_bf16_f32 v40, v32, v33
    v_cvt_pk_bf16_f32 v41, v34, v35
    v_cvt_pk_bf16_f32 v42, v36, v37
    v_mfma_f32_32x32x16_bf16 a[64:79], v[152:155], a[184:187], a[64:79]
    v_cvt_pk_bf16_f32 v43, v38, v39
    s_add_u32 s56, s63, 3932160
    buffer_store_dwordx4 v[40:43], v16, s[24:27], s56 offen sc1
    v_accvgpr_read_b32 v44, a56
    v_mfma_f32_32x32x16_bf16 a[80:95], v[184:187], a[184:187], a[80:95]
    v_accvgpr_read_b32 v45, a57
    v_accvgpr_read_b32 v46, a58
    v_accvgpr_read_b32 v47, a59
    v_accvgpr_read_b32 v48, a60
    v_mfma_f32_32x32x16_bf16 a[96:111], v[216:219], a[184:187], a[96:111]
    v_accvgpr_read_b32 v49, a61
    v_accvgpr_read_b32 v50, a62
    v_accvgpr_read_b32 v51, a63
    v_cvt_pk_bf16_f32 v52, v44, v45
    v_mfma_f32_32x32x16_bf16 a[112:127], v[248:251], a[184:187], a[112:127]
    v_cvt_pk_bf16_f32 v53, v46, v47
    v_cvt_pk_bf16_f32 v54, v48, v49
    v_cvt_pk_bf16_f32 v55, v50, v51
    s_add_u32 s56, s63, 3933184
    v_mfma_f32_32x32x16_bf16 a[64:79], v[156:159], a[188:191], a[64:79]
    buffer_store_dwordx4 v[52:55], v16, s[24:27], s56 offen sc1
    s_add_u32 s63, s63, 2048
    v_mfma_f32_32x32x16_bf16 a[80:95], v[188:191], a[188:191], a[80:95]
    v_mfma_f32_32x32x16_bf16 a[96:111], v[220:223], a[188:191], a[96:111]
    v_mfma_f32_32x32x16_bf16 a[112:127], v[252:255], a[188:191], a[112:127]
    buffer_load_dwordx4 a[160:163], v16, s[24:27], s62 offen offset:0
    buffer_load_dwordx4 a[164:167], v16, s[24:27], s62 offen offset:1024
    buffer_load_dwordx4 a[168:171], v16, s[24:27], s62 offen offset:2048
    buffer_load_dwordx4 a[172:175], v16, s[24:27], s62 offen offset:3072
    buffer_load_dwordx4 a[176:179], v17, s[24:27], s62 offen offset:0
    buffer_load_dwordx4 a[180:183], v17, s[24:27], s62 offen offset:1024
    buffer_load_dwordx4 a[184:187], v17, s[24:27], s62 offen offset:2048
    buffer_load_dwordx4 a[188:191], v17, s[24:27], s62 offen offset:3072
    s_add_u32 s62, s62, 8192
    s_waitcnt vmcnt(8)
    v_mfma_f32_32x32x16_bf16 a[0:15], v[128:131], a[128:131], 0
    s_nop 15
    v_accvgpr_read_b32 v32, a64
    v_accvgpr_read_b32 v33, a65
    v_accvgpr_read_b32 v34, a66
    v_mfma_f32_32x32x16_bf16 a[16:31], v[160:163], a[128:131], 0
    v_accvgpr_read_b32 v35, a67
    v_accvgpr_read_b32 v36, a68
    v_accvgpr_read_b32 v37, a69
    v_accvgpr_read_b32 v38, a70
    v_mfma_f32_32x32x16_bf16 a[32:47], v[192:195], a[128:131], 0
    v_accvgpr_read_b32 v39, a71
    v_cvt_pk_bf16_f32 v40, v32, v33
    v_cvt_pk_bf16_f32 v41, v34, v35
    v_cvt_pk_bf16_f32 v42, v36, v37
    v_mfma_f32_32x32x16_bf16 a[48:63], v[224:227], a[128:131], 0
    v_cvt_pk_bf16_f32 v43, v38, v39
    s_add_u32 s56, s63, 0
    buffer_store_dwordx4 v[40:43], v16, s[24:27], s56 offen sc1
    v_accvgpr_read_b32 v44, a72
    v_mfma_f32_32x32x16_bf16 a[0:15], v[132:135], a[132:135], a[0:15]
    v_accvgpr_read_b32 v45, a73
    v_accvgpr_read_b32 v46, a74
    v_accvgpr_read_b32 v47, a75
    v_accvgpr_read_b32 v48, a76
    v_mfma_f32_32x32x16_bf16 a[16:31], v[164:167], a[132:135], a[16:31]
    v_accvgpr_read_b32 v49, a77
    v_accvgpr_read_b32 v50, a78
    v_accvgpr_read_b32 v51, a79
    v_cvt_pk_bf16_f32 v52, v44, v45
    v_mfma_f32_32x32x16_bf16 a[32:47], v[196:199], a[132:135], a[32:47]
    v_cvt_pk_bf16_f32 v53, v46, v47
    v_cvt_pk_bf16_f32 v54, v48, v49
    v_cvt_pk_bf16_f32 v55, v50, v51
    s_add_u32 s56, s63, 1024
    v_mfma_f32_32x32x16_bf16 a[48:63], v[228:231], a[132:135], a[48:63]
    buffer_store_dwordx4 v[52:55], v16, s[24:27], s56 offen sc1
    v_accvgpr_read_b32 v32, a80
    v_accvgpr_read_b32 v33, a81
    v_accvgpr_read_b32 v34, a82
    v_mfma_f32_32x32x16_bf16 a[0:15], v[136:139], a[136:139], a[0:15]
    v_accvgpr_read_b32 v35, a83
    v_accvgpr_read_b32 v36, a84
    v_accvgpr_read_b32 v37, a85
    v_accvgpr_read_b32 v38, a86
    v_mfma_f32_32x32x16_bf16 a[16:31], v[168:171], a[136:139], a[16:31]
    v_accvgpr_read_b32 v39, a87
    v_cvt_pk_bf16_f32 v40, v32, v33
    v_cvt_pk_bf16_f32 v41, v34, v35
    v_cvt_pk_bf16_f32 v42, v36, v37
    v_mfma_f32_32x32x16_bf16 a[32:47], v[200:203], a[136:139], a[32:47]
    v_cvt_pk_bf16_f32 v43, v38, v39
    s_add_u32 s56, s63, 1310720
    buffer_store_dwordx4 v[40:43], v16, s[24:27], s56 offen sc1
    v_accvgpr_read_b32 v44, a88
    v_mfma_f32_32x32x16_bf16 a[48:63], v[232:235], a[136:139], a[48:63]
    v_accvgpr_read_b32 v45, a89
    v_accvgpr_read_b32 v46, a90
    v_accvgpr_read_b32 v47, a91
    v_accvgpr_read_b32 v48, a92
    v_mfma_f32_32x32x16_bf16 a[0:15], v[140:143], a[140:143], a[0:15]
    v_accvgpr_read_b32 v49, a93
    v_accvgpr_read_b32 v50, a94
    v_accvgpr_read_b32 v51, a95
    v_cvt_pk_bf16_f32 v52, v44, v45
    v_mfma_f32_32x32x16_bf16 a[16:31], v[172:175], a[140:143], a[16:31]
    v_cvt_pk_bf16_f32 v53, v46, v47
    v_cvt_pk_bf16_f32 v54, v48, v49
    v_cvt_pk_bf16_f32 v55, v50, v51
    s_add_u32 s56, s63, 1311744
    v_mfma_f32_32x32x16_bf16 a[32:47], v[204:207], a[140:143], a[32:47]
    buffer_store_dwordx4 v[52:55], v16, s[24:27], s56 offen sc1
    v_accvgpr_read_b32 v32, a96
    v_accvgpr_read_b32 v33, a97
    v_accvgpr_read_b32 v34, a98
    v_mfma_f32_32x32x16_bf16 a[48:63], v[236:239], a[140:143], a[48:63]
    v_accvgpr_read_b32 v35, a99
    v_accvgpr_read_b32 v36, a100
    v_accvgpr_read_b32 v37, a101
    v_accvgpr_read_b32 v38, a102
    v_mfma_f32_32x32x16_bf16 a[0:15], v[144:147], a[144:147], a[0:15]
    v_accvgpr_read_b32 v39, a103
    v_cvt_pk_bf16_f32 v40, v32, v33
    v_cvt_pk_bf16_f32 v41, v34, v35
    v_cvt_pk_bf16_f32 v42, v36, v37
    v_mfma_f32_32x32x16_bf16 a[16:31], v[176:179], a[144:147], a[16:31]
    v_cvt_pk_bf16_f32 v43, v38, v39
    s_add_u32 s56, s63, 2621440
    buffer_store_dwordx4 v[40:43], v16, s[24:27], s56 offen sc1
    v_accvgpr_read_b32 v44, a104
    v_mfma_f32_32x32x16_bf16 a[32:47], v[208:211], a[144:147], a[32:47]
    v_accvgpr_read_b32 v45, a105
    v_accvgpr_read_b32 v46, a106
    v_accvgpr_read_b32 v47, a107
    v_accvgpr_read_b32 v48, a108
    v_mfma_f32_32x32x16_bf16 a[48:63], v[240:243], a[144:147], a[48:63]
    v_accvgpr_read_b32 v49, a109
    v_accvgpr_read_b32 v50, a110
    v_accvgpr_read_b32 v51, a111
    v_cvt_pk_bf16_f32 v52, v44, v45
    v_mfma_f32_32x32x16_bf16 a[0:15], v[148:151], a[148:151], a[0:15]
    v_cvt_pk_bf16_f32 v53, v46, v47
    v_cvt_pk_bf16_f32 v54, v48, v49
    v_cvt_pk_bf16_f32 v55, v50, v51
    s_add_u32 s56, s63, 2622464
    v_mfma_f32_32x32x16_bf16 a[16:31], v[180:183], a[148:151], a[16:31]
    buffer_store_dwordx4 v[52:55], v16, s[24:27], s56 offen sc1
    v_accvgpr_read_b32 v32, a112
    v_accvgpr_read_b32 v33, a113
    v_accvgpr_read_b32 v34, a114
    v_mfma_f32_32x32x16_bf16 a[32:47], v[212:215], a[148:151], a[32:47]
    v_accvgpr_read_b32 v35, a115
    v_accvgpr_read_b32 v36, a116
    v_accvgpr_read_b32 v37, a117
    v_accvgpr_read_b32 v38, a118
    v_mfma_f32_32x32x16_bf16 a[48:63], v[244:247], a[148:151], a[48:63]
    v_accvgpr_read_b32 v39, a119
    v_cvt_pk_bf16_f32 v40, v32, v33
    v_cvt_pk_bf16_f32 v41, v34, v35
    v_cvt_pk_bf16_f32 v42, v36, v37
    v_mfma_f32_32x32x16_bf16 a[0:15], v[152:155], a[152:155], a[0:15]
    v_cvt_pk_bf16_f32 v43, v38, v39
    s_add_u32 s56, s63, 3932160
    buffer_store_dwordx4 v[40:43], v16, s[24:27], s56 offen sc1
    v_accvgpr_read_b32 v44, a120
    v_mfma_f32_32x32x16_bf16 a[16:31], v[184:187], a[152:155], a[16:31]
    v_accvgpr_read_b32 v45, a121
    v_accvgpr_read_b32 v46, a122
    v_accvgpr_read_b32 v47, a123
    v_accvgpr_read_b32 v48, a124
    v_mfma_f32_32x32x16_bf16 a[32:47], v[216:219], a[152:155], a[32:47]
    v_accvgpr_read_b32 v49, a125
    v_accvgpr_read_b32 v50, a126
    v_accvgpr_read_b32 v51, a127
    v_cvt_pk_bf16_f32 v52, v44, v45
    v_mfma_f32_32x32x16_bf16 a[48:63], v[248:251], a[152:155], a[48:63]
    v_cvt_pk_bf16_f32 v53, v46, v47
    v_cvt_pk_bf16_f32 v54, v48, v49
    v_cvt_pk_bf16_f32 v55, v50, v51
    s_add_u32 s56, s63, 3933184
    v_mfma_f32_32x32x16_bf16 a[0:15], v[156:159], a[156:159], a[0:15]
    buffer_store_dwordx4 v[52:55], v16, s[24:27], s56 offen sc1
    s_add_u32 s63, s63, 2048
    v_mfma_f32_32x32x16_bf16 a[16:31], v[188:191], a[156:159], a[16:31]
    v_mfma_f32_32x32x16_bf16 a[32:47], v[220:223], a[156:159], a[32:47]
    v_mfma_f32_32x32x16_bf16 a[48:63], v[252:255], a[156:159], a[48:63]
    s_waitcnt vmcnt(0)
    v_mfma_f32_32x32x16_bf16 a[64:79], v[128:131], a[160:163], 0
    s_nop 15
    v_accvgpr_read_b32 v32, a0
    v_accvgpr_read_b32 v33, a1
    v_accvgpr_read_b32 v34, a2
    v_mfma_f32_32x32x16_bf16 a[80:95], v[160:163], a[160:163], 0
    v_accvgpr_read_b32 v35, a3
    v_accvgpr_read_b32 v36, a4
    v_accvgpr_read_b32 v37, a5
    v_accvgpr_read_b32 v38, a6
    v_mfma_f32_32x32x16_bf16 a[96:111], v[192:195], a[160:163], 0
    v_accvgpr_read_b32 v39, a7
    v_cvt_pk_bf16_f32 v40, v32, v33
    v_cvt_pk_bf16_f32 v41, v34, v35
    v_cvt_pk_bf16_f32 v42, v36, v37
    v_mfma_f32_32x32x16_bf16 a[112:127], v[224:227], a[160:163], 0
    v_cvt_pk_bf16_f32 v43, v38, v39
    s_add_u32 s56, s63, 0
    buffer_store_dwordx4 v[40:43], v16, s[24:27], s56 offen sc1
    v_accvgpr_read_b32 v44, a8
    v_mfma_f32_32x32x16_bf16 a[64:79], v[132:135], a[164:167], a[64:79]
    v_accvgpr_read_b32 v45, a9
    v_accvgpr_read_b32 v46, a10
    v_accvgpr_read_b32 v47, a11
    v_accvgpr_read_b32 v48, a12
    v_mfma_f32_32x32x16_bf16 a[80:95], v[164:167], a[164:167], a[80:95]
    v_accvgpr_read_b32 v49, a13
    v_accvgpr_read_b32 v50, a14
    v_accvgpr_read_b32 v51, a15
    v_cvt_pk_bf16_f32 v52, v44, v45
    v_mfma_f32_32x32x16_bf16 a[96:111], v[196:199], a[164:167], a[96:111]
    v_cvt_pk_bf16_f32 v53, v46, v47
    v_cvt_pk_bf16_f32 v54, v48, v49
    v_cvt_pk_bf16_f32 v55, v50, v51
    s_add_u32 s56, s63, 1024
    v_mfma_f32_32x32x16_bf16 a[112:127], v[228:231], a[164:167], a[112:127]
    buffer_store_dwordx4 v[52:55], v16, s[24:27], s56 offen sc1
    v_accvgpr_read_b32 v32, a16
    v_accvgpr_read_b32 v33, a17
    v_accvgpr_read_b32 v34, a18
    v_mfma_f32_32x32x16_bf16 a[64:79], v[136:139], a[168:171], a[64:79]
    v_accvgpr_read_b32 v35, a19
    v_accvgpr_read_b32 v36, a20
    v_accvgpr_read_b32 v37, a21
    v_accvgpr_read_b32 v38, a22
    v_mfma_f32_32x32x16_bf16 a[80:95], v[168:171], a[168:171], a[80:95]
    v_accvgpr_read_b32 v39, a23
    v_cvt_pk_bf16_f32 v40, v32, v33
    v_cvt_pk_bf16_f32 v41, v34, v35
    v_cvt_pk_bf16_f32 v42, v36, v37
    v_mfma_f32_32x32x16_bf16 a[96:111], v[200:203], a[168:171], a[96:111]
    v_cvt_pk_bf16_f32 v43, v38, v39
    s_add_u32 s56, s63, 1310720
    buffer_store_dwordx4 v[40:43], v16, s[24:27], s56 offen sc1
    v_accvgpr_read_b32 v44, a24
    v_mfma_f32_32x32x16_bf16 a[112:127], v[232:235], a[168:171], a[112:127]
    v_accvgpr_read_b32 v45, a25
    v_accvgpr_read_b32 v46, a26
    v_accvgpr_read_b32 v47, a27
    v_accvgpr_read_b32 v48, a28
    v_mfma_f32_32x32x16_bf16 a[64:79], v[140:143], a[172:175], a[64:79]
    v_accvgpr_read_b32 v49, a29
    v_accvgpr_read_b32 v50, a30
    v_accvgpr_read_b32 v51, a31
    v_cvt_pk_bf16_f32 v52, v44, v45
    v_mfma_f32_32x32x16_bf16 a[80:95], v[172:175], a[172:175], a[80:95]
    v_cvt_pk_bf16_f32 v53, v46, v47
    v_cvt_pk_bf16_f32 v54, v48, v49
    v_cvt_pk_bf16_f32 v55, v50, v51
    s_add_u32 s56, s63, 1311744
    v_mfma_f32_32x32x16_bf16 a[96:111], v[204:207], a[172:175], a[96:111]
    buffer_store_dwordx4 v[52:55], v16, s[24:27], s56 offen sc1
    v_accvgpr_read_b32 v32, a32
    v_accvgpr_read_b32 v33, a33
    v_accvgpr_read_b32 v34, a34
    v_mfma_f32_32x32x16_bf16 a[112:127], v[236:239], a[172:175], a[112:127]
    v_accvgpr_read_b32 v35, a35
    v_accvgpr_read_b32 v36, a36
    v_accvgpr_read_b32 v37, a37
    v_accvgpr_read_b32 v38, a38
    v_mfma_f32_32x32x16_bf16 a[64:79], v[144:147], a[176:179], a[64:79]
    v_accvgpr_read_b32 v39, a39
    v_cvt_pk_bf16_f32 v40, v32, v33
    v_cvt_pk_bf16_f32 v41, v34, v35
    v_cvt_pk_bf16_f32 v42, v36, v37
    v_mfma_f32_32x32x16_bf16 a[80:95], v[176:179], a[176:179], a[80:95]
    v_cvt_pk_bf16_f32 v43, v38, v39
    s_add_u32 s56, s63, 2621440
    buffer_store_dwordx4 v[40:43], v16, s[24:27], s56 offen sc1
    v_accvgpr_read_b32 v44, a40
    v_mfma_f32_32x32x16_bf16 a[96:111], v[208:211], a[176:179], a[96:111]
    v_accvgpr_read_b32 v45, a41
    v_accvgpr_read_b32 v46, a42
    v_accvgpr_read_b32 v47, a43
    v_accvgpr_read_b32 v48, a44
    v_mfma_f32_32x32x16_bf16 a[112:127], v[240:243], a[176:179], a[112:127]
    v_accvgpr_read_b32 v49, a45
    v_accvgpr_read_b32 v50, a46
    v_accvgpr_read_b32 v51, a47
    v_cvt_pk_bf16_f32 v52, v44, v45
    v_mfma_f32_32x32x16_bf16 a[64:79], v[148:151], a[180:183], a[64:79]
    v_cvt_pk_bf16_f32 v53, v46, v47
    v_cvt_pk_bf16_f32 v54, v48, v49
    v_cvt_pk_bf16_f32 v55, v50, v51
    s_add_u32 s56, s63, 2622464
    v_mfma_f32_32x32x16_bf16 a[80:95], v[180:183], a[180:183], a[80:95]
    buffer_store_dwordx4 v[52:55], v16, s[24:27], s56 offen sc1
    v_accvgpr_read_b32 v32, a48
    v_accvgpr_read_b32 v33, a49
    v_accvgpr_read_b32 v34, a50
    v_mfma_f32_32x32x16_bf16 a[96:111], v[212:215], a[180:183], a[96:111]
    v_accvgpr_read_b32 v35, a51
    v_accvgpr_read_b32 v36, a52
    v_accvgpr_read_b32 v37, a53
    v_accvgpr_read_b32 v38, a54
    v_mfma_f32_32x32x16_bf16 a[112:127], v[244:247], a[180:183], a[112:127]
    v_accvgpr_read_b32 v39, a55
    v_cvt_pk_bf16_f32 v40, v32, v33
    v_cvt_pk_bf16_f32 v41, v34, v35
    v_cvt_pk_bf16_f32 v42, v36, v37
    v_mfma_f32_32x32x16_bf16 a[64:79], v[152:155], a[184:187], a[64:79]
    v_cvt_pk_bf16_f32 v43, v38, v39
    s_add_u32 s56, s63, 3932160
    buffer_store_dwordx4 v[40:43], v16, s[24:27], s56 offen sc1
    v_accvgpr_read_b32 v44, a56
    v_mfma_f32_32x32x16_bf16 a[80:95], v[184:187], a[184:187], a[80:95]
    v_accvgpr_read_b32 v45, a57
    v_accvgpr_read_b32 v46, a58
    v_accvgpr_read_b32 v47, a59
    v_accvgpr_read_b32 v48, a60
    v_mfma_f32_32x32x16_bf16 a[96:111], v[216:219], a[184:187], a[96:111]
    v_accvgpr_read_b32 v49, a61
    v_accvgpr_read_b32 v50, a62
    v_accvgpr_read_b32 v51, a63
    v_cvt_pk_bf16_f32 v52, v44, v45
    v_mfma_f32_32x32x16_bf16 a[112:127], v[248:251], a[184:187], a[112:127]
    v_cvt_pk_bf16_f32 v53, v46, v47
    v_cvt_pk_bf16_f32 v54, v48, v49
    v_cvt_pk_bf16_f32 v55, v50, v51
    s_add_u32 s56, s63, 3933184
    v_mfma_f32_32x32x16_bf16 a[64:79], v[156:159], a[188:191], a[64:79]
    buffer_store_dwordx4 v[52:55], v16, s[24:27], s56 offen sc1
    s_add_u32 s63, s63, 2048
    v_mfma_f32_32x32x16_bf16 a[80:95], v[188:191], a[188:191], a[80:95]
    v_mfma_f32_32x32x16_bf16 a[96:111], v[220:223], a[188:191], a[96:111]
    v_mfma_f32_32x32x16_bf16 a[112:127], v[252:255], a[188:191], a[112:127]
    s_nop 15
    v_accvgpr_read_b32 v32, a64
    v_accvgpr_read_b32 v33, a65
    v_accvgpr_read_b32 v34, a66
    v_accvgpr_read_b32 v35, a67
    v_accvgpr_read_b32 v36, a68
    v_accvgpr_read_b32 v37, a69
    v_accvgpr_read_b32 v38, a70
    v_accvgpr_read_b32 v39, a71
    v_cvt_pk_bf16_f32 v40, v32, v33
    v_cvt_pk_bf16_f32 v41, v34, v35
    v_cvt_pk_bf16_f32 v42, v36, v37
    v_cvt_pk_bf16_f32 v43, v38, v39
    s_add_u32 s56, s63, 0
    buffer_store_dwordx4 v[40:43], v16, s[24:27], s56 offen sc1
    v_accvgpr_read_b32 v44, a72
    v_accvgpr_read_b32 v45, a73
    v_accvgpr_read_b32 v46, a74
    v_accvgpr_read_b32 v47, a75
    v_accvgpr_read_b32 v48, a76
    v_accvgpr_read_b32 v49, a77
    v_accvgpr_read_b32 v50, a78
    v_accvgpr_read_b32 v51, a79
    v_cvt_pk_bf16_f32 v52, v44, v45
    v_cvt_pk_bf16_f32 v53, v46, v47
    v_cvt_pk_bf16_f32 v54, v48, v49
    v_cvt_pk_bf16_f32 v55, v50, v51
    s_add_u32 s56, s63, 1024
    buffer_store_dwordx4 v[52:55], v16, s[24:27], s56 offen sc1
    v_accvgpr_read_b32 v32, a80
    v_accvgpr_read_b32 v33, a81
    v_accvgpr_read_b32 v34, a82
    v_accvgpr_read_b32 v35, a83
    v_accvgpr_read_b32 v36, a84
    v_accvgpr_read_b32 v37, a85
    v_accvgpr_read_b32 v38, a86
    v_accvgpr_read_b32 v39, a87
    v_cvt_pk_bf16_f32 v40, v32, v33
    v_cvt_pk_bf16_f32 v41, v34, v35
    v_cvt_pk_bf16_f32 v42, v36, v37
    v_cvt_pk_bf16_f32 v43, v38, v39
    s_add_u32 s56, s63, 1310720
    buffer_store_dwordx4 v[40:43], v16, s[24:27], s56 offen sc1
    v_accvgpr_read_b32 v44, a88
    v_accvgpr_read_b32 v45, a89
    v_accvgpr_read_b32 v46, a90
    v_accvgpr_read_b32 v47, a91
    v_accvgpr_read_b32 v48, a92
    v_accvgpr_read_b32 v49, a93
    v_accvgpr_read_b32 v50, a94
    v_accvgpr_read_b32 v51, a95
    v_cvt_pk_bf16_f32 v52, v44, v45
    v_cvt_pk_bf16_f32 v53, v46, v47
    v_cvt_pk_bf16_f32 v54, v48, v49
    v_cvt_pk_bf16_f32 v55, v50, v51
    s_add_u32 s56, s63, 1311744
    buffer_store_dwordx4 v[52:55], v16, s[24:27], s56 offen sc1
    v_accvgpr_read_b32 v32, a96
    v_accvgpr_read_b32 v33, a97
    v_accvgpr_read_b32 v34, a98
    v_accvgpr_read_b32 v35, a99
    v_accvgpr_read_b32 v36, a100
    v_accvgpr_read_b32 v37, a101
    v_accvgpr_read_b32 v38, a102
    v_accvgpr_read_b32 v39, a103
    v_cvt_pk_bf16_f32 v40, v32, v33
    v_cvt_pk_bf16_f32 v41, v34, v35
    v_cvt_pk_bf16_f32 v42, v36, v37
    v_cvt_pk_bf16_f32 v43, v38, v39
    s_add_u32 s56, s63, 2621440
    buffer_store_dwordx4 v[40:43], v16, s[24:27], s56 offen sc1
    v_accvgpr_read_b32 v44, a104
    v_accvgpr_read_b32 v45, a105
    v_accvgpr_read_b32 v46, a106
    v_accvgpr_read_b32 v47, a107
    v_accvgpr_read_b32 v48, a108
    v_accvgpr_read_b32 v49, a109
    v_accvgpr_read_b32 v50, a110
    v_accvgpr_read_b32 v51, a111
    v_cvt_pk_bf16_f32 v52, v44, v45
    v_cvt_pk_bf16_f32 v53, v46, v47
    v_cvt_pk_bf16_f32 v54, v48, v49
    v_cvt_pk_bf16_f32 v55, v50, v51
    s_add_u32 s56, s63, 2622464
    buffer_store_dwordx4 v[52:55], v16, s[24:27], s56 offen sc1
    v_accvgpr_read_b32 v32, a112
    v_accvgpr_read_b32 v33, a113
    v_accvgpr_read_b32 v34, a114
    v_accvgpr_read_b32 v35, a115
    v_accvgpr_read_b32 v36, a116
    v_accvgpr_read_b32 v37, a117
    v_accvgpr_read_b32 v38, a118
    v_accvgpr_read_b32 v39, a119
    v_cvt_pk_bf16_f32 v40, v32, v33
    v_cvt_pk_bf16_f32 v41, v34, v35
    v_cvt_pk_bf16_f32 v42, v36, v37
    v_cvt_pk_bf16_f32 v43, v38, v39
    s_add_u32 s56, s63, 3932160
    buffer_store_dwordx4 v[40:43], v16, s[24:27], s56 offen sc1
    v_accvgpr_read_b32 v44, a120
    v_accvgpr_read_b32 v45, a121
    v_accvgpr_read_b32 v46, a122
    v_accvgpr_read_b32 v47, a123
    v_accvgpr_read_b32 v48, a124
    v_accvgpr_read_b32 v49, a125
    v_accvgpr_read_b32 v50, a126
    v_accvgpr_read_b32 v51, a127
    v_cvt_pk_bf16_f32 v52, v44, v45
    v_cvt_pk_bf16_f32 v53, v46, v47
    v_cvt_pk_bf16_f32 v54, v48, v49
    v_cvt_pk_bf16_f32 v55, v50, v51
    s_add_u32 s56, s63, 3933184
    buffer_store_dwordx4 v[52:55], v16, s[24:27], s56 offen sc1
    s_add_u32 s63, s63, 2048
    s_branch BGT_46
QKE_50:
    s_lshl_b32 s63, s16, 19
    s_lshl_b32 s13, s17, 13
    s_add_u32 s63, s63, s13
    s_add_u32 s63, s63, 0x1cd4000
    v_accvgpr_read_b32 v32, a0
    v_accvgpr_read_b32 v33, a1
    v_accvgpr_read_b32 v34, a2
    v_accvgpr_read_b32 v35, a3
    v_accvgpr_read_b32 v36, a4
    v_accvgpr_read_b32 v37, a5
    v_accvgpr_read_b32 v38, a6
    v_accvgpr_read_b32 v39, a7
    v_cvt_pk_bf16_f32 v40, v32, v33
    v_cvt_pk_bf16_f32 v41, v34, v35
    v_cvt_pk_bf16_f32 v42, v36, v37
    v_cvt_pk_bf16_f32 v43, v38, v39
    s_add_u32 s56, s63, 0
    buffer_store_dwordx4 v[40:43], v16, s[24:27], s56 offen sc1
    v_accvgpr_read_b32 v44, a8
    v_accvgpr_read_b32 v45, a9
    v_accvgpr_read_b32 v46, a10
    v_accvgpr_read_b32 v47, a11
    v_accvgpr_read_b32 v48, a12
    v_accvgpr_read_b32 v49, a13
    v_accvgpr_read_b32 v50, a14
    v_accvgpr_read_b32 v51, a15
    v_cvt_pk_bf16_f32 v52, v44, v45
    v_cvt_pk_bf16_f32 v53, v46, v47
    v_cvt_pk_bf16_f32 v54, v48, v49
    v_cvt_pk_bf16_f32 v55, v50, v51
    s_add_u32 s56, s63, 1024
    buffer_store_dwordx4 v[52:55], v16, s[24:27], s56 offen sc1
    v_accvgpr_read_b32 v32, a64
    v_accvgpr_read_b32 v33, a65
    v_accvgpr_read_b32 v34, a66
    v_accvgpr_read_b32 v35, a67
    v_accvgpr_read_b32 v36, a68
    v_accvgpr_read_b32 v37, a69
    v_accvgpr_read_b32 v38, a70
    v_accvgpr_read_b32 v39, a71
    v_cvt_pk_bf16_f32 v40, v32, v33
    v_cvt_pk_bf16_f32 v41, v34, v35
    v_cvt_pk_bf16_f32 v42, v36, v37
    v_cvt_pk_bf16_f32 v43, v38, v39
    s_add_u32 s56, s63, 2048
    buffer_store_dwordx4 v[40:43], v16, s[24:27], s56 offen sc1
    v_accvgpr_read_b32 v44, a72
    v_accvgpr_read_b32 v45, a73
    v_accvgpr_read_b32 v46, a74
    v_accvgpr_read_b32 v47, a75
    v_accvgpr_read_b32 v48, a76
    v_accvgpr_read_b32 v49, a77
    v_accvgpr_read_b32 v50, a78
    v_accvgpr_read_b32 v51, a79
    v_cvt_pk_bf16_f32 v52, v44, v45
    v_cvt_pk_bf16_f32 v53, v46, v47
    v_cvt_pk_bf16_f32 v54, v48, v49
    v_cvt_pk_bf16_f32 v55, v50, v51
    s_add_u32 s56, s63, 3072
    buffer_store_dwordx4 v[52:55], v16, s[24:27], s56 offen sc1
    v_accvgpr_read_b32 v32, a128
    v_accvgpr_read_b32 v33, a129
    v_accvgpr_read_b32 v34, a130
    v_accvgpr_read_b32 v35, a131
    v_accvgpr_read_b32 v36, a132
    v_accvgpr_read_b32 v37, a133
    v_accvgpr_read_b32 v38, a134
    v_accvgpr_read_b32 v39, a135
    v_cvt_pk_bf16_f32 v40, v32, v33
    v_cvt_pk_bf16_f32 v41, v34, v35
    v_cvt_pk_bf16_f32 v42, v36, v37
    v_cvt_pk_bf16_f32 v43, v38, v39
    s_add_u32 s56, s63, 4096
    buffer_store_dwordx4 v[40:43], v16, s[24:27], s56 offen sc1
    v_accvgpr_read_b32 v44, a136
    v_accvgpr_read_b32 v45, a137
    v_accvgpr_read_b32 v46, a138
    v_accvgpr_read_b32 v47, a139
    v_accvgpr_read_b32 v48, a140
    v_accvgpr_read_b32 v49, a141
    v_accvgpr_read_b32 v50, a142
    v_accvgpr_read_b32 v51, a143
    v_cvt_pk_bf16_f32 v52, v44, v45
    v_cvt_pk_bf16_f32 v53, v46, v47
    v_cvt_pk_bf16_f32 v54, v48, v49
    v_cvt_pk_bf16_f32 v55, v50, v51
    s_add_u32 s56, s63, 5120
    buffer_store_dwordx4 v[52:55], v16, s[24:27], s56 offen sc1
    v_accvgpr_read_b32 v32, a192
    v_accvgpr_read_b32 v33, a193
    v_accvgpr_read_b32 v34, a194
    v_accvgpr_read_b32 v35, a195
    v_accvgpr_read_b32 v36, a196
    v_accvgpr_read_b32 v37, a197
    v_accvgpr_read_b32 v38, a198
    v_accvgpr_read_b32 v39, a199
    v_cvt_pk_bf16_f32 v40, v32, v33
    v_cvt_pk_bf16_f32 v41, v34, v35
    v_cvt_pk_bf16_f32 v42, v36, v37
    v_cvt_pk_bf16_f32 v43, v38, v39
    s_add_u32 s56, s63, 6144
    buffer_store_dwordx4 v[40:43], v16, s[24:27], s56 offen sc1
    v_accvgpr_read_b32 v44, a200
    v_accvgpr_read_b32 v45, a201
    v_accvgpr_read_b32 v46, a202
    v_accvgpr_read_b32 v47, a203
    v_accvgpr_read_b32 v48, a204
    v_accvgpr_read_b32 v49, a205
    v_accvgpr_read_b32 v50, a206
    v_accvgpr_read_b32 v51, a207
    v_cvt_pk_bf16_f32 v52, v44, v45
    v_cvt_pk_bf16_f32 v53, v46, v47
    v_cvt_pk_bf16_f32 v54, v48, v49
    v_cvt_pk_bf16_f32 v55, v50, v51
    s_add_u32 s56, s63, 7168
    buffer_store_dwordx4 v[52:55], v16, s[24:27], s56 offen sc1
    v_accvgpr_read_b32 v32, a16
    v_accvgpr_read_b32 v33, a17
    v_accvgpr_read_b32 v34, a18
    v_accvgpr_read_b32 v35, a19
    v_accvgpr_read_b32 v36, a20
    v_accvgpr_read_b32 v37, a21
    v_accvgpr_read_b32 v38, a22
    v_accvgpr_read_b32 v39, a23
    v_cvt_pk_bf16_f32 v40, v32, v33
    v_cvt_pk_bf16_f32 v41, v34, v35
    v_cvt_pk_bf16_f32 v42, v36, v37
    v_cvt_pk_bf16_f32 v43, v38, v39
    s_add_u32 s56, s63, 8192
    buffer_store_dwordx4 v[40:43], v16, s[24:27], s56 offen sc1
    v_accvgpr_read_b32 v44, a24
    v_accvgpr_read_b32 v45, a25
    v_accvgpr_read_b32 v46, a26
    v_accvgpr_read_b32 v47, a27
    v_accvgpr_read_b32 v48, a28
    v_accvgpr_read_b32 v49, a29
    v_accvgpr_read_b32 v50, a30
    v_accvgpr_read_b32 v51, a31
    v_cvt_pk_bf16_f32 v52, v44, v45
    v_cvt_pk_bf16_f32 v53, v46, v47
    v_cvt_pk_bf16_f32 v54, v48, v49
    v_cvt_pk_bf16_f32 v55, v50, v51
    s_add_u32 s56, s63, 9216
    buffer_store_dwordx4 v[52:55], v16, s[24:27], s56 offen sc1
    v_accvgpr_read_b32 v32, a80
    v_accvgpr_read_b32 v33, a81
    v_accvgpr_read_b32 v34, a82
    v_accvgpr_read_b32 v35, a83
    v_accvgpr_read_b32 v36, a84
    v_accvgpr_read_b32 v37, a85
    v_accvgpr_read_b32 v38, a86
    v_accvgpr_read_b32 v39, a87
    v_cvt_pk_bf16_f32 v40, v32, v33
    v_cvt_pk_bf16_f32 v41, v34, v35
    v_cvt_pk_bf16_f32 v42, v36, v37
    v_cvt_pk_bf16_f32 v43, v38, v39
    s_add_u32 s56, s63, 10240
    buffer_store_dwordx4 v[40:43], v16, s[24:27], s56 offen sc1
    v_accvgpr_read_b32 v44, a88
    v_accvgpr_read_b32 v45, a89
    v_accvgpr_read_b32 v46, a90
    v_accvgpr_read_b32 v47, a91
    v_accvgpr_read_b32 v48, a92
    v_accvgpr_read_b32 v49, a93
    v_accvgpr_read_b32 v50, a94
    v_accvgpr_read_b32 v51, a95
    v_cvt_pk_bf16_f32 v52, v44, v45
    v_cvt_pk_bf16_f32 v53, v46, v47
    v_cvt_pk_bf16_f32 v54, v48, v49
    v_cvt_pk_bf16_f32 v55, v50, v51
    s_add_u32 s56, s63, 11264
    buffer_store_dwordx4 v[52:55], v16, s[24:27], s56 offen sc1
    v_accvgpr_read_b32 v32, a144
    v_accvgpr_read_b32 v33, a145
    v_accvgpr_read_b32 v34, a146
    v_accvgpr_read_b32 v35, a147
    v_accvgpr_read_b32 v36, a148
    v_accvgpr_read_b32 v37, a149
    v_accvgpr_read_b32 v38, a150
    v_accvgpr_read_b32 v39, a151
    v_cvt_pk_bf16_f32 v40, v32, v33
    v_cvt_pk_bf16_f32 v41, v34, v35
    v_cvt_pk_bf16_f32 v42, v36, v37
    v_cvt_pk_bf16_f32 v43, v38, v39
    s_add_u32 s56, s63, 12288
    buffer_store_dwordx4 v[40:43], v16, s[24:27], s56 offen sc1
    v_accvgpr_read_b32 v44, a152
    v_accvgpr_read_b32 v45, a153
    v_accvgpr_read_b32 v46, a154
    v_accvgpr_read_b32 v47, a155
    v_accvgpr_read_b32 v48, a156
    v_accvgpr_read_b32 v49, a157
    v_accvgpr_read_b32 v50, a158
    v_accvgpr_read_b32 v51, a159
    v_cvt_pk_bf16_f32 v52, v44, v45
    v_cvt_pk_bf16_f32 v53, v46, v47
    v_cvt_pk_bf16_f32 v54, v48, v49
    v_cvt_pk_bf16_f32 v55, v50, v51
    s_add_u32 s56, s63, 13312
    buffer_store_dwordx4 v[52:55], v16, s[24:27], s56 offen sc1
    v_accvgpr_read_b32 v32, a208
    v_accvgpr_read_b32 v33, a209
    v_accvgpr_read_b32 v34, a210
    v_accvgpr_read_b32 v35, a211
    v_accvgpr_read_b32 v36, a212
    v_accvgpr_read_b32 v37, a213
    v_accvgpr_read_b32 v38, a214
    v_accvgpr_read_b32 v39, a215
    v_cvt_pk_bf16_f32 v40, v32, v33
    v_cvt_pk_bf16_f32 v41, v34, v35
    v_cvt_pk_bf16_f32 v42, v36, v37
    v_cvt_pk_bf16_f32 v43, v38, v39
    s_add_u32 s56, s63, 14336
    buffer_store_dwordx4 v[40:43], v16, s[24:27], s56 offen sc1
    v_accvgpr_read_b32 v44, a216
    v_accvgpr_read_b32 v45, a217
    v_accvgpr_read_b32 v46, a218
    v_accvgpr_read_b32 v47, a219
    v_accvgpr_read_b32 v48, a220
    v_accvgpr_read_b32 v49, a221
    v_accvgpr_read_b32 v50, a222
    v_accvgpr_read_b32 v51, a223
    v_cvt_pk_bf16_f32 v52, v44, v45
    v_cvt_pk_bf16_f32 v53, v46, v47
    v_cvt_pk_bf16_f32 v54, v48, v49
    v_cvt_pk_bf16_f32 v55, v50, v51
    s_add_u32 s56, s63, 15360
    buffer_store_dwordx4 v[52:55], v16, s[24:27], s56 offen sc1
    v_accvgpr_read_b32 v32, a32
    v_accvgpr_read_b32 v33, a33
    v_accvgpr_read_b32 v34, a34
    v_accvgpr_read_b32 v35, a35
    v_accvgpr_read_b32 v36, a36
    v_accvgpr_read_b32 v37, a37
    v_accvgpr_read_b32 v38, a38
    v_accvgpr_read_b32 v39, a39
    v_cvt_pk_bf16_f32 v40, v32, v33
    v_cvt_pk_bf16_f32 v41, v34, v35
    v_cvt_pk_bf16_f32 v42, v36, v37
    v_cvt_pk_bf16_f32 v43, v38, v39
    s_add_u32 s56, s63, 16384
    buffer_store_dwordx4 v[40:43], v16, s[24:27], s56 offen sc1
    v_accvgpr_read_b32 v44, a40
    v_accvgpr_read_b32 v45, a41
    v_accvgpr_read_b32 v46, a42
    v_accvgpr_read_b32 v47, a43
    v_accvgpr_read_b32 v48, a44
    v_accvgpr_read_b32 v49, a45
    v_accvgpr_read_b32 v50, a46
    v_accvgpr_read_b32 v51, a47
    v_cvt_pk_bf16_f32 v52, v44, v45
    v_cvt_pk_bf16_f32 v53, v46, v47
    v_cvt_pk_bf16_f32 v54, v48, v49
    v_cvt_pk_bf16_f32 v55, v50, v51
    s_add_u32 s56, s63, 17408
    buffer_store_dwordx4 v[52:55], v16, s[24:27], s56 offen sc1
    v_accvgpr_read_b32 v32, a96
    v_accvgpr_read_b32 v33, a97
    v_accvgpr_read_b32 v34, a98
    v_accvgpr_read_b32 v35, a99
    v_accvgpr_read_b32 v36, a100
    v_accvgpr_read_b32 v37, a101
    v_accvgpr_read_b32 v38, a102
    v_accvgpr_read_b32 v39, a103
    v_cvt_pk_bf16_f32 v40, v32, v33
    v_cvt_pk_bf16_f32 v41, v34, v35
    v_cvt_pk_bf16_f32 v42, v36, v37
    v_cvt_pk_bf16_f32 v43, v38, v39
    s_add_u32 s56, s63, 18432
    buffer_store_dwordx4 v[40:43], v16, s[24:27], s56 offen sc1
    v_accvgpr_read_b32 v44, a104
    v_accvgpr_read_b32 v45, a105
    v_accvgpr_read_b32 v46, a106
    v_accvgpr_read_b32 v47, a107
    v_accvgpr_read_b32 v48, a108
    v_accvgpr_read_b32 v49, a109
    v_accvgpr_read_b32 v50, a110
    v_accvgpr_read_b32 v51, a111
    v_cvt_pk_bf16_f32 v52, v44, v45
    v_cvt_pk_bf16_f32 v53, v46, v47
    v_cvt_pk_bf16_f32 v54, v48, v49
    v_cvt_pk_bf16_f32 v55, v50, v51
    s_add_u32 s56, s63, 19456
    buffer_store_dwordx4 v[52:55], v16, s[24:27], s56 offen sc1
    v_accvgpr_read_b32 v32, a160
    v_accvgpr_read_b32 v33, a161
    v_accvgpr_read_b32 v34, a162
    v_accvgpr_read_b32 v35, a163
    v_accvgpr_read_b32 v36, a164
    v_accvgpr_read_b32 v37, a165
    v_accvgpr_read_b32 v38, a166
    v_accvgpr_read_b32 v39, a167
    v_cvt_pk_bf16_f32 v40, v32, v33
    v_cvt_pk_bf16_f32 v41, v34, v35
    v_cvt_pk_bf16_f32 v42, v36, v37
    v_cvt_pk_bf16_f32 v43, v38, v39
    s_add_u32 s56, s63, 20480
    buffer_store_dwordx4 v[40:43], v16, s[24:27], s56 offen sc1
    v_accvgpr_read_b32 v44, a168
    v_accvgpr_read_b32 v45, a169
    v_accvgpr_read_b32 v46, a170
    v_accvgpr_read_b32 v47, a171
    v_accvgpr_read_b32 v48, a172
    v_accvgpr_read_b32 v49, a173
    v_accvgpr_read_b32 v50, a174
    v_accvgpr_read_b32 v51, a175
    v_cvt_pk_bf16_f32 v52, v44, v45
    v_cvt_pk_bf16_f32 v53, v46, v47
    v_cvt_pk_bf16_f32 v54, v48, v49
    v_cvt_pk_bf16_f32 v55, v50, v51
    s_add_u32 s56, s63, 21504
    buffer_store_dwordx4 v[52:55], v16, s[24:27], s56 offen sc1
    v_accvgpr_read_b32 v32, a224
    v_accvgpr_read_b32 v33, a225
    v_accvgpr_read_b32 v34, a226
    v_accvgpr_read_b32 v35, a227
    v_accvgpr_read_b32 v36, a228
    v_accvgpr_read_b32 v37, a229
    v_accvgpr_read_b32 v38, a230
    v_accvgpr_read_b32 v39, a231
    v_cvt_pk_bf16_f32 v40, v32, v33
    v_cvt_pk_bf16_f32 v41, v34, v35
    v_cvt_pk_bf16_f32 v42, v36, v37
    v_cvt_pk_bf16_f32 v43, v38, v39
    s_add_u32 s56, s63, 22528
    buffer_store_dwordx4 v[40:43], v16, s[24:27], s56 offen sc1
    v_accvgpr_read_b32 v44, a232
    v_accvgpr_read_b32 v45, a233
    v_accvgpr_read_b32 v46, a234
    v_accvgpr_read_b32 v47, a235
    v_accvgpr_read_b32 v48, a236
    v_accvgpr_read_b32 v49, a237
    v_accvgpr_read_b32 v50, a238
    v_accvgpr_read_b32 v51, a239
    v_cvt_pk_bf16_f32 v52, v44, v45
    v_cvt_pk_bf16_f32 v53, v46, v47
    v_cvt_pk_bf16_f32 v54, v48, v49
    v_cvt_pk_bf16_f32 v55, v50, v51
    s_add_u32 s56, s63, 23552
    buffer_store_dwordx4 v[52:55], v16, s[24:27], s56 offen sc1
    v_accvgpr_read_b32 v32, a48
    v_accvgpr_read_b32 v33, a49
    v_accvgpr_read_b32 v34, a50
    v_accvgpr_read_b32 v35, a51
    v_accvgpr_read_b32 v36, a52
    v_accvgpr_read_b32 v37, a53
    v_accvgpr_read_b32 v38, a54
    v_accvgpr_read_b32 v39, a55
    v_cvt_pk_bf16_f32 v40, v32, v33
    v_cvt_pk_bf16_f32 v41, v34, v35
    v_cvt_pk_bf16_f32 v42, v36, v37
    v_cvt_pk_bf16_f32 v43, v38, v39
    s_add_u32 s56, s63, 24576
    buffer_store_dwordx4 v[40:43], v16, s[24:27], s56 offen sc1
    v_accvgpr_read_b32 v44, a56
    v_accvgpr_read_b32 v45, a57
    v_accvgpr_read_b32 v46, a58
    v_accvgpr_read_b32 v47, a59
    v_accvgpr_read_b32 v48, a60
    v_accvgpr_read_b32 v49, a61
    v_accvgpr_read_b32 v50, a62
    v_accvgpr_read_b32 v51, a63
    v_cvt_pk_bf16_f32 v52, v44, v45
    v_cvt_pk_bf16_f32 v53, v46, v47
    v_cvt_pk_bf16_f32 v54, v48, v49
    v_cvt_pk_bf16_f32 v55, v50, v51
    s_add_u32 s56, s63, 25600
    buffer_store_dwordx4 v[52:55], v16, s[24:27], s56 offen sc1
    v_accvgpr_read_b32 v32, a112
    v_accvgpr_read_b32 v33, a113
    v_accvgpr_read_b32 v34, a114
    v_accvgpr_read_b32 v35, a115
    v_accvgpr_read_b32 v36, a116
    v_accvgpr_read_b32 v37, a117
    v_accvgpr_read_b32 v38, a118
    v_accvgpr_read_b32 v39, a119
    v_cvt_pk_bf16_f32 v40, v32, v33
    v_cvt_pk_bf16_f32 v41, v34, v35
    v_cvt_pk_bf16_f32 v42, v36, v37
    v_cvt_pk_bf16_f32 v43, v38, v39
    s_add_u32 s56, s63, 26624
    buffer_store_dwordx4 v[40:43], v16, s[24:27], s56 offen sc1
    v_accvgpr_read_b32 v44, a120
    v_accvgpr_read_b32 v45, a121
    v_accvgpr_read_b32 v46, a122
    v_accvgpr_read_b32 v47, a123
    v_accvgpr_read_b32 v48, a124
    v_accvgpr_read_b32 v49, a125
    v_accvgpr_read_b32 v50, a126
    v_accvgpr_read_b32 v51, a127
    v_cvt_pk_bf16_f32 v52, v44, v45
    v_cvt_pk_bf16_f32 v53, v46, v47
    v_cvt_pk_bf16_f32 v54, v48, v49
    v_cvt_pk_bf16_f32 v55, v50, v51
    s_add_u32 s56, s63, 27648
    buffer_store_dwordx4 v[52:55], v16, s[24:27], s56 offen sc1
    v_accvgpr_read_b32 v32, a176
    v_accvgpr_read_b32 v33, a177
    v_accvgpr_read_b32 v34, a178
    v_accvgpr_read_b32 v35, a179
    v_accvgpr_read_b32 v36, a180
    v_accvgpr_read_b32 v37, a181
    v_accvgpr_read_b32 v38, a182
    v_accvgpr_read_b32 v39, a183
    v_cvt_pk_bf16_f32 v40, v32, v33
    v_cvt_pk_bf16_f32 v41, v34, v35
    v_cvt_pk_bf16_f32 v42, v36, v37
    v_cvt_pk_bf16_f32 v43, v38, v39
    s_add_u32 s56, s63, 28672
    buffer_store_dwordx4 v[40:43], v16, s[24:27], s56 offen sc1
    v_accvgpr_read_b32 v44, a184
    v_accvgpr_read_b32 v45, a185
    v_accvgpr_read_b32 v46, a186
    v_accvgpr_read_b32 v47, a187
    v_accvgpr_read_b32 v48, a188
    v_accvgpr_read_b32 v49, a189
    v_accvgpr_read_b32 v50, a190
    v_accvgpr_read_b32 v51, a191
    v_cvt_pk_bf16_f32 v52, v44, v45
    v_cvt_pk_bf16_f32 v53, v46, v47
    v_cvt_pk_bf16_f32 v54, v48, v49
    v_cvt_pk_bf16_f32 v55, v50, v51
    s_add_u32 s56, s63, 29696
    buffer_store_dwordx4 v[52:55], v16, s[24:27], s56 offen sc1
    v_accvgpr_read_b32 v32, a240
    v_accvgpr_read_b32 v33, a241
    v_accvgpr_read_b32 v34, a242
    v_accvgpr_read_b32 v35, a243
    v_accvgpr_read_b32 v36, a244
    v_accvgpr_read_b32 v37, a245
    v_accvgpr_read_b32 v38, a246
    v_accvgpr_read_b32 v39, a247
    v_cvt_pk_bf16_f32 v40, v32, v33
    v_cvt_pk_bf16_f32 v41, v34, v35
    v_cvt_pk_bf16_f32 v42, v36, v37
    v_cvt_pk_bf16_f32 v43, v38, v39
    s_add_u32 s56, s63, 30720
    buffer_store_dwordx4 v[40:43], v16, s[24:27], s56 offen sc1
    v_accvgpr_read_b32 v44, a248
    v_accvgpr_read_b32 v45, a249
    v_accvgpr_read_b32 v46, a250
    v_accvgpr_read_b32 v47, a251
    v_accvgpr_read_b32 v48, a252
    v_accvgpr_read_b32 v49, a253
    v_accvgpr_read_b32 v50, a254
    v_accvgpr_read_b32 v51, a255
    v_cvt_pk_bf16_f32 v52, v44, v45
    v_cvt_pk_bf16_f32 v53, v46, v47
    v_cvt_pk_bf16_f32 v54, v48, v49
    v_cvt_pk_bf16_f32 v55, v50, v51
    s_add_u32 s56, s63, 31744
    buffer_store_dwordx4 v[52:55], v16, s[24:27], s56 offen sc1
    s_branch BGT_46
BGT_46:
    s_waitcnt vmcnt(0) lgkmcnt(0)
    s_barrier
    s_cmp_lg_u32 s3, 0
    s_cbranch_scc1 BGN_47
    s_lshl_b32 s6, s96, 2
    s_add_u32 s6, s6, 0xad5e080
    v_mov_b32 v17, 0
    s_mov_b64 exec, 1
    buffer_store_dword v17, v17, s[24:27], s6 offen sc1
    s_mov_b64 exec, -1
BGN_47:
    s_add_u32 s96, s96, 144
    s_branch BGL_45
BPOST_48:
    s_lshl_b32 s69, s68, 2
    s_add_u32 s69, s69, s3
    s_add_u32 s69, s69, 2560
BPK_57:
    s_cmp_ge_u32 s69, 3370
    s_cbranch_scc1 BPKE_59
    s_mov_b32 s6, s69
    s_cmp_ge_u32 s6, 2830
    s_cbranch_scc1 PSEG_61
    s_load_dwordx2 s[8:9], s[0:1], 64
    s_sub_u32 s7, s6, 2560
    s_mov_b32 s10, 3456
    s_mov_b32 s14, 2211840
    s_mul_hi_u32 s11, s7, 0x1999999a
    s_mul_i32 s12, s11, 10
    s_sub_u32 s12, s7, s12
    s_mul_i32 s13, s11, 163840
    s_lshl_b32 s16, s12, 12
    s_add_u32 s13, s13, s16
    s_add_u32 s13, s13, 0x1400000
    s_mov_b32 s17, 81920
    s_mul_i32 s15, s12, 221184
    s_lshl_b32 s16, s11, 7
    s_add_u32 s15, s15, s16
    s_branch PGO_60
PSEG_61:
    s_cmp_ge_u32 s6, 3100
    s_cbranch_scc1 PSEG_62
    s_load_dwordx2 s[8:9], s[0:1], 72
    s_sub_u32 s7, s6, 2830
    s_mov_b32 s10, 3456
    s_mov_b32 s14, 2211840
    s_mul_hi_u32 s11, s7, 0x1999999a
    s_mul_i32 s12, s11, 10
    s_sub_u32 s12, s7, s12
    s_mul_i32 s13, s11, 163840
    s_lshl_b32 s16, s12, 12
    s_add_u32 s13, s13, s16
    s_add_u32 s13, s13, 0x140a000
    s_mov_b32 s17, 81920
    s_mul_i32 s15, s12, 221184
    s_lshl_b32 s16, s11, 7
    s_add_u32 s15, s15, s16
    s_branch PGO_60
PSEG_62:
    s_cmp_ge_u32 s6, 3370
    s_cbranch_scc1 PSEG_63
    s_load_dwordx2 s[8:9], s[0:1], 80
    s_sub_u32 s7, s6, 3100
    s_mov_b32 s10, 1280
    s_mov_b32 s14, 2211840
    s_mul_hi_u32 s11, s7, 0x97b425f
    s_mul_i32 s12, s11, 27
    s_sub_u32 s12, s7, s12
    s_mul_i32 s13, s11, 221184
    s_lshl_b32 s16, s12, 12
    s_add_u32 s13, s13, s16
    s_add_u32 s13, s13, 0x1838000
    s_mov_b32 s17, 110592
    s_mul_i32 s15, s12, 81920
    s_lshl_b32 s16, s11, 7
    s_add_u32 s15, s15, s16
    s_branch PGO_60
PSEG_63:
PGO_60:
    s_waitcnt lgkmcnt(0)
    s_mov_b32 s20, s8
    s_and_b32 s21, s9, 0xffff
    s_mov_b32 s22, s14
    s_mov_b32 s23, 0x00020000
    s_mov_b32 s24, s4
    s_and_b32 s25, s5, 0xffff
    s_mov_b32 s26, 0x10000000
    s_mov_b32 s27, 0x00020000
    v_and_b32 v3, 31, v2
    v_lshrrev_b32 v4, 5, v2
    v_mul_lo_u32 v5, v4, s10
    v_lshlrev_b32 v5, 2, v5
    v_lshl_add_u32 v5, v3, 2, v5
    v_lshrrev_b32 v6, 4, v3
    v_mul_lo_u32 v6, v6, s17
    v_lshlrev_b32 v7, 1, v3
    v_and_b32 v7, 31, v7
    v_lshl_add_u32 v7, v4, 5, v7
    v_lshl_add_u32 v6, v7, 4, v6
    s_mul_i32 s16, s10, 0
    s_add_u32 s16, s16, s15
    buffer_load_dword v16, v5, s[20:23], s16 offen
    s_mul_i32 s16, s10, 1
    s_add_u32 s16, s16, s15
    buffer_load_dword v17, v5, s[20:23], s16 offen
    s_mul_i32 s16, s10, 2
    s_add_u32 s16, s16, s15
    buffer_load_dword v18, v5, s[20:23], s16 offen
    s_mul_i32 s16, s10, 3
    s_add_u32 s16, s16, s15
    buffer_load_dword v19, v5, s[20:23], s16 offen
    s_mul_i32 s16, s10, 8
    s_add_u32 s16, s16, s15
    buffer_load_dword v20, v5, s[20:23], s16 offen
    s_mul_i32 s16, s10, 9
    s_add_u32 s16, s16, s15
    buffer_load_dword v21, v5, s[20:23], s16 offen
    s_mul_i32 s16, s10, 10
    s_add_u32 s16, s16, s15
    buffer_load_dword v22, v5, s[20:23], s16 offen
    s_mul_i32 s16, s10, 11
    s_add_u32 s16, s16, s15
    buffer_load_dword v23, v5, s[20:23], s16 offen
    s_mul_i32 s16, s10, 16
    s_add_u32 s16, s16, s15
    buffer_load_dword v24, v5, s[20:23], s16 offen
    s_mul_i32 s16, s10, 17
    s_add_u32 s16, s16, s15
    buffer_load_dword v25, v5, s[20:23], s16 offen
    s_mul_i32 s16, s10, 18
    s_add_u32 s16, s16, s15
    buffer_load_dword v26, v5, s[20:23], s16 offen
    s_mul_i32 s16, s10, 19
    s_add_u32 s16, s16, s15
    buffer_load_dword v27, v5, s[20:23], s16 offen
    s_mul_i32 s16, s10, 24
    s_add_u32 s16, s16, s15
    buffer_load_dword v28, v5, s[20:23], s16 offen
    s_mul_i32 s16, s10, 25
    s_add_u32 s16, s16, s15
    buffer_load_dword v29, v5, s[20:23], s16 offen
    s_mul_i32 s16, s10, 26
    s_add_u32 s16, s16, s15
    buffer_load_dword v30, v5, s[20:23], s16 offen
    s_mul_i32 s16, s10, 27
    s_add_u32 s16, s16, s15
    buffer_load_dword v31, v5, s[20:23], s16 offen
    s_mul_i32 s16, s10, 32
    s_add_u32 s16, s16, s15
    buffer_load_dword v32, v5, s[20:23], s16 offen
    s_mul_i32 s16, s10, 33
    s_add_u32 s16, s16, s15
    buffer_load_dword v33, v5, s[20:23], s16 offen
    s_mul_i32 s16, s10, 34
    s_add_u32 s16, s16, s15
    buffer_load_dword v34, v5, s[20:23], s16 offen
    s_mul_i32 s16, s10, 35
    s_add_u32 s16, s16, s15
    buffer_load_dword v35, v5, s[20:23], s16 offen
    s_mul_i32 s16, s10, 40
    s_add_u32 s16, s16, s15
    buffer_load_dword v36, v5, s[20:23], s16 offen
    s_mul_i32 s16, s10, 41
    s_add_u32 s16, s16, s15
    buffer_load_dword v37, v5, s[20:23], s16 offen
    s_mul_i32 s16, s10, 42
    s_add_u32 s16, s16, s15
    buffer_load_dword v38, v5, s[20:23], s16 offen
    s_mul_i32 s16, s10, 43
    s_add_u32 s16, s16, s15
    buffer_load_dword v39, v5, s[20:23], s16 offen
    s_mul_i32 s16, s10, 48
    s_add_u32 s16, s16, s15
    buffer_load_dword v40, v5, s[20:23], s16 offen
    s_mul_i32 s16, s10, 49
    s_add_u32 s16, s16, s15
    buffer_load_dword v41, v5, s[20:23], s16 offen
    s_mul_i32 s16, s10, 50
    s_add_u32 s16, s16, s15
    buffer_load_dword v42, v5, s[20:23], s16 offen
    s_mul_i32 s16, s10, 51
    s_add_u32 s16, s16, s15
    buffer_load_dword v43, v5, s[20:23], s16 offen
    s_mul_i32 s16, s10, 56
    s_add_u32 s16, s16, s15
    buffer_load_dword v44, v5, s[20:23], s16 offen
    s_mul_i32 s16, s10, 57
    s_add_u32 s16, s16, s15
    buffer_load_dword v45, v5, s[20:23], s16 offen
    s_mul_i32 s16, s10, 58
    s_add_u32 s16, s16, s15
    buffer_load_dword v46, v5, s[20:23], s16 offen
    s_mul_i32 s16, s10, 59
    s_add_u32 s16, s16, s15
    buffer_load_dword v47, v5, s[20:23], s16 offen
    s_mov_b32 s30, 0x05040100
    s_mov_b32 s31, 0x07060302
    s_waitcnt vmcnt(24)
    v_perm_b32 v48, v17, v16, s30
    v_perm_b32 v52, v17, v16, s31
    v_perm_b32 v49, v19, v18, s30
    v_perm_b32 v53, v19, v18, s31
    v_perm_b32 v50, v21, v20, s30
    v_perm_b32 v54, v21, v20, s31
    v_perm_b32 v51, v23, v22, s30
    v_perm_b32 v55, v23, v22, s31
    s_add_u32 s16, s13, 0
    buffer_store_dwordx4 v[48:51], v6, s[24:27], s16 offen
    buffer_store_dwordx4 v[52:55], v6, s[24:27], s16 offen offset:16
    s_nop 1
    s_waitcnt vmcnt(18)
    v_perm_b32 v48, v25, v24, s30
    v_perm_b32 v52, v25, v24, s31
    v_perm_b32 v49, v27, v26, s30
    v_perm_b32 v53, v27, v26, s31
    v_perm_b32 v50, v29, v28, s30
    v_perm_b32 v54, v29, v28, s31
    v_perm_b32 v51, v31, v30, s30
    v_perm_b32 v55, v31, v30, s31
    s_add_u32 s16, s13, 1024
    buffer_store_dwordx4 v[48:51], v6, s[24:27], s16 offen
    buffer_store_dwordx4 v[52:55], v6, s[24:27], s16 offen offset:16
    s_nop 1
    s_waitcnt vmcnt(12)
    v_perm_b32 v48, v33, v32, s30
    v_perm_b32 v52, v33, v32, s31
    v_perm_b32 v49, v35, v34, s30
    v_perm_b32 v53, v35, v34, s31
    v_perm_b32 v50, v37, v36, s30
    v_perm_b32 v54, v37, v36, s31
    v_perm_b32 v51, v39, v38, s30
    v_perm_b32 v55, v39, v38, s31
    s_add_u32 s16, s13, 2048
    buffer_store_dwordx4 v[48:51], v6, s[24:27], s16 offen
    buffer_store_dwordx4 v[52:55], v6, s[24:27], s16 offen offset:16
    s_nop 1
    s_waitcnt vmcnt(6)
    v_perm_b32 v48, v41, v40, s30
    v_perm_b32 v52, v41, v40, s31
    v_perm_b32 v49, v43, v42, s30
    v_perm_b32 v53, v43, v42, s31
    v_perm_b32 v50, v45, v44, s30
    v_perm_b32 v54, v45, v44, s31
    v_perm_b32 v51, v47, v46, s30
    v_perm_b32 v55, v47, v46, s31
    s_add_u32 s16, s13, 3072
    buffer_store_dwordx4 v[48:51], v6, s[24:27], s16 offen
    buffer_store_dwordx4 v[52:55], v6, s[24:27], s16 offen offset:16
    s_nop 1
    s_branch BPKN_58
BPKN_58:
    s_add_u32 s69, s69, 576
    s_branch BPK_57
BPKE_59:
    v_lshlrev_b32 v16, 4, v2
    s_mov_b32 s24, s4
    s_and_b32 s25, s5, 0xffff
    s_mov_b32 s26, 0x10000000
    s_mov_b32 s27, 0x00020000
    v_add_u32 v19, 0, v2
    v_min_u32 v19, 351, v19
    v_lshlrev_b32 v19, 2, v19
    s_mov_b32 s6, 0xad5e080
    s_cmp_lg_u32 s3, 0
    s_cbranch_scc1 BO_65
BW_64:
    buffer_load_dword v18, v19, s[24:27], s6 offen sc1
    s_waitcnt vmcnt(0)
    v_cmp_eq_u32 vcc, -1, v18
    s_cbranch_vccz BO_65
    s_add_u32 s36, s36, 1
    s_cmp_gt_u32 s36, 0x40000
    s_cbranch_scc1 END_44
    s_sleep 64
    s_branch BW_64
BO_65:
    s_barrier
    v_add_u32 v19, 64, v2
    v_min_u32 v19, 351, v19
    v_lshlrev_b32 v19, 2, v19
    s_mov_b32 s6, 0xad5e080
    s_cmp_lg_u32 s3, 0
    s_cbranch_scc1 BO_67
BW_66:
    buffer_load_dword v18, v19, s[24:27], s6 offen sc1
    s_waitcnt vmcnt(0)
    v_cmp_eq_u32 vcc, -1, v18
    s_cbranch_vccz BO_67
    s_add_u32 s36, s36, 1
    s_cmp_gt_u32 s36, 0x40000
    s_cbranch_scc1 END_44
    s_sleep 64
    s_branch BW_66
BO_67:
    s_barrier
    v_add_u32 v19, 128, v2
    v_min_u32 v19, 351, v19
    v_lshlrev_b32 v19, 2, v19
    s_mov_b32 s6, 0xad5e080
    s_cmp_lg_u32 s3, 0
    s_cbranch_scc1 BO_69
BW_68:
    buffer_load_dword v18, v19, s[24:27], s6 offen sc1
    s_waitcnt vmcnt(0)
    v_cmp_eq_u32 vcc, -1, v18
    s_cbranch_vccz BO_69
    s_add_u32 s36, s36, 1
    s_cmp_gt_u32 s36, 0x40000
    s_cbranch_scc1 END_44
    s_sleep 64
    s_branch BW_68
BO_69:
    s_barrier
    v_add_u32 v19, 192, v2
    v_min_u32 v19, 351, v19
    v_lshlrev_b32 v19, 2, v19
    s_mov_b32 s6, 0xad5e080
    s_cmp_lg_u32 s3, 0
    s_cbranch_scc1 BO_71
BW_70:
    buffer_load_dword v18, v19, s[24:27], s6 offen sc1
    s_waitcnt vmcnt(0)
    v_cmp_eq_u32 vcc, -1, v18
    s_cbranch_vccz BO_71
    s_add_u32 s36, s36, 1
    s_cmp_gt_u32 s36, 0x40000
    s_cbranch_scc1 END_44
    s_sleep 64
    s_branch BW_70
BO_71:
    s_barrier
    v_add_u32 v19, 256, v2
    v_min_u32 v19, 351, v19
    v_lshlrev_b32 v19, 2, v19
    s_mov_b32 s6, 0xad5e080
    s_cmp_lg_u32 s3, 0
    s_cbranch_scc1 BO_73
BW_72:
    buffer_load_dword v18, v19, s[24:27], s6 offen sc1
    s_waitcnt vmcnt(0)
    v_cmp_eq_u32 vcc, -1, v18
    s_cbranch_vccz BO_73
    s_add_u32 s36, s36, 1
    s_cmp_gt_u32 s36, 0x40000
    s_cbranch_scc1 END_44
    s_sleep 64
    s_branch BW_72
BO_73:
    s_barrier
    v_add_u32 v19, 320, v2
    v_min_u32 v19, 351, v19
    v_lshlrev_b32 v19, 2, v19
    s_mov_b32 s6, 0xad5e080
    s_cmp_lg_u32 s3, 0
    s_cbranch_scc1 BO_75
BW_74:
    buffer_load_dword v18, v19, s[24:27], s6 offen sc1
    s_waitcnt vmcnt(0)
    v_cmp_eq_u32 vcc, -1, v18
    s_cbranch_vccz BO_75
    s_add_u32 s36, s36, 1
    s_cmp_gt_u32 s36, 0x40000
    s_cbranch_scc1 END_44
    s_sleep 64
    s_branch BW_74
BO_75:
    s_barrier
BPL_76:
    s_cmp_ge_u32 s96, 1060
    s_cbranch_scc1 END_44
    s_sub_u32 s64, s96, 352
    s_mul_hi_u32 s65, s64, 0x15555556
    s_mul_i32 s66, s65, 12
    s_sub_u32 s66, s64, s66
    s_cmp_ge_u32 s66, 8
    s_cbranch_scc1 BUG_77
    s_cmp_ge_u32 s65, 58
    s_cbranch_scc1 BPN_78
    s_lshl_b32 s6, s65, 2
    s_add_u32 s6, s6, 0xad5e608
    v_mov_b32 v19, 0
    s_cmp_lg_u32 s3, 0
    s_cbranch_scc1 BO_81
BW_80:
    buffer_load_dword v18, v19, s[24:27], s6 offen sc1
    s_waitcnt vmcnt(0)
    v_cmp_eq_u32 vcc, -1, v18
    s_cbranch_vccz BO_81
    s_add_u32 s36, s36, 1
    s_cmp_gt_u32 s36, 0x40000
    s_cbranch_scc1 END_44
    s_sleep 64
    s_branch BW_80
BO_81:
    s_barrier
    s_lshl_b32 s2, s65, 3
    s_add_u32 s2, s2, s66
    s_mov_b32 s67, s2
    s_lshl_b32 s6, s2, 2
    s_add_u32 s6, s6, s3
    s_lshr_b32 s7, s6, 5
    s_and_b32 s8, s6, 31
    s_lshl_b32 s9, s8, 6
    s_add_u32 s9, s9, s7
    s_lshl_b32 s9, s9, 13
    s_add_u32 s10, s9, 0x1cd4000
    s_add_u32 s11, s9, 0x2cd4000
    s_lshl_b32 s12, s6, 11
    s_add_u32 s12, s12, 0xad5f000
    v_and_b32 v3, 7, v2
    v_lshrrev_b32 v4, 5, v2
    v_lshlrev_b32 v3, 4, v3
    v_lshl_add_u32 v3, v4, 7, v3
    v_add_u32 v17, 0x1000, v16
    buffer_load_dwordx4 v[32:35], v16, s[24:27], s10 offen offset:0
    buffer_load_dwordx4 v[64:67], v16, s[24:27], s11 offen offset:0
    buffer_load_dwordx4 v[96:99], v3, s[24:27], s12 offen offset:0
    buffer_load_dwordx4 v[36:39], v16, s[24:27], s10 offen offset:1024
    buffer_load_dwordx4 v[68:71], v16, s[24:27], s11 offen offset:1024
    buffer_load_dwordx4 v[100:103], v3, s[24:27], s12 offen offset:256
    buffer_load_dwordx4 v[40:43], v16, s[24:27], s10 offen offset:2048
    buffer_load_dwordx4 v[72:75], v16, s[24:27], s11 offen offset:2048
    buffer_load_dwordx4 v[104:107], v3, s[24:27], s12 offen offset:512
    buffer_load_dwordx4 v[44:47], v16, s[24:27], s10 offen offset:3072
    buffer_load_dwordx4 v[76:79], v16, s[24:27], s11 offen offset:3072
    buffer_load_dwordx4 v[108:111], v3, s[24:27], s12 offen offset:768
    buffer_load_dwordx4 v[48:51], v17, s[24:27], s10 offen offset:0
    buffer_load_dwordx4 v[80:83], v17, s[24:27], s11 offen offset:0
    buffer_load_dwordx4 v[112:115], v3, s[24:27], s12 offen offset:1024
    buffer_load_dwordx4 v[52:55], v17, s[24:27], s10 offen offset:1024
    buffer_load_dwordx4 v[84:87], v17, s[24:27], s11 offen offset:1024
    buffer_load_dwordx4 v[116:119], v3, s[24:27], s12 offen offset:1280
    buffer_load_dwordx4 v[56:59], v17, s[24:27], s10 offen offset:2048
    buffer_load_dwordx4 v[88:91], v17, s[24:27], s11 offen offset:2048
    buffer_load_dwordx4 v[120:123], v3, s[24:27], s12 offen offset:1536
    buffer_load_dwordx4 v[60:63], v17, s[24:27], s10 offen offset:3072
    buffer_load_dwordx4 v[92:95], v17, s[24:27], s11 offen offset:3072
    buffer_load_dwordx4 v[124:127], v3, s[24:27], s12 offen offset:1792
    s_waitcnt vmcnt(21)
    v_mfma_f32_32x32x16_bf16 v[128:143], v[64:67], v[32:35], 0
    v_mfma_f32_32x32x16_bf16 v[144:159], v[96:99], v[32:35], 0
    s_waitcnt vmcnt(18)
    v_mfma_f32_32x32x16_bf16 v[128:143], v[68:71], v[36:39], v[128:143]
    v_mfma_f32_32x32x16_bf16 v[144:159], v[100:103], v[36:39], v[144:159]
    s_waitcnt vmcnt(15)
    v_mfma_f32_32x32x16_bf16 v[128:143], v[72:75], v[40:43], v[128:143]
    v_mfma_f32_32x32x16_bf16 v[144:159], v[104:107], v[40:43], v[144:159]
    s_waitcnt vmcnt(12)
    v_mfma_f32_32x32x16_bf16 v[128:143], v[76:79], v[44:47], v[128:143]
    v_mfma_f32_32x32x16_bf16 v[144:159], v[108:111], v[44:47], v[144:159]
    s_waitcnt vmcnt(9)
    v_mfma_f32_32x32x16_bf16 v[128:143], v[80:83], v[48:51], v[128:143]
    v_mfma_f32_32x32x16_bf16 v[144:159], v[112:115], v[48:51], v[144:159]
    s_waitcnt vmcnt(6)
    v_mfma_f32_32x32x16_bf16 v[128:143], v[84:87], v[52:55], v[128:143]
    v_mfma_f32_32x32x16_bf16 v[144:159], v[116:119], v[52:55], v[144:159]
    s_waitcnt vmcnt(3)
    v_mfma_f32_32x32x16_bf16 v[128:143], v[88:91], v[56:59], v[128:143]
    v_mfma_f32_32x32x16_bf16 v[144:159], v[120:123], v[56:59], v[144:159]
    s_waitcnt vmcnt(0)
    v_mfma_f32_32x32x16_bf16 v[128:143], v[92:95], v[60:63], v[128:143]
    v_mfma_f32_32x32x16_bf16 v[144:159], v[124:127], v[60:63], v[144:159]
    v_and_b32 v5, 31, v2
    v_lshlrev_b32 v6, 2, v4
    v_sub_u32 v5, v5, v6
    v_mov_b32 v7, 0xff800000
    s_nop 7
    s_nop 3
    v_cmp_le_i32 vcc, 0, v5
    s_nop 1
    v_cndmask_b32 v128, v7, v128, vcc
    v_cmp_le_i32 vcc, 1, v5
    s_nop 1
    v_cndmask_b32 v129, v7, v129, vcc
    v_cmp_le_i32 vcc, 2, v5
    s_nop 1
    v_cndmask_b32 v130, v7, v130, vcc
    v_cmp_le_i32 vcc, 3, v5
    s_nop 1
    v_cndmask_b32 v131, v7, v131, vcc
    v_cmp_le_i32 vcc, 8, v5
    s_nop 1
    v_cndmask_b32 v132, v7, v132, vcc
    v_cmp_le_i32 vcc, 9, v5
    s_nop 1
    v_cndmask_b32 v133, v7, v133, vcc
    v_cmp_le_i32 vcc, 10, v5
    s_nop 1
    v_cndmask_b32 v134, v7, v134, vcc
    v_cmp_le_i32 vcc, 11, v5
    s_nop 1
    v_cndmask_b32 v135, v7, v135, vcc
    v_cmp_le_i32 vcc, 16, v5
    s_nop 1
    v_cndmask_b32 v136, v7, v136, vcc
    v_cmp_le_i32 vcc, 17, v5
    s_nop 1
    v_cndmask_b32 v137, v7, v137, vcc
    v_cmp_le_i32 vcc, 18, v5
    s_nop 1
    v_cndmask_b32 v138, v7, v138, vcc
    v_cmp_le_i32 vcc, 19, v5
    s_nop 1
    v_cndmask_b32 v139, v7, v139, vcc
    v_cmp_le_i32 vcc, 24, v5
    s_nop 1
    v_cndmask_b32 v140, v7, v140, vcc
    v_cmp_le_i32 vcc, 25, v5
    s_nop 1
    v_cndmask_b32 v141, v7, v141, vcc
    v_cmp_le_i32 vcc, 26, v5
    s_nop 1
    v_cndmask_b32 v142, v7, v142, vcc
    v_cmp_le_i32 vcc, 27, v5
    s_nop 1
    v_cndmask_b32 v143, v7, v143, vcc
    v_max3_f32 v8, v128, v129, v130
    v_max3_f32 v8, v8, v131, v132
    v_max3_f32 v8, v8, v133, v134
    v_max3_f32 v8, v8, v135, v136
    v_max3_f32 v8, v8, v137, v138
    v_max3_f32 v8, v8, v139, v140
    v_max3_f32 v8, v8, v141, v142
    v_max3_f32 v8, v8, v143, v144
    v_max3_f32 v8, v8, v145, v146
    v_max_f32 v8, v8, v147
    v_mov_b32 v9, v8
    s_nop 1
    v_permlane32_swap_b32 v9, v8
    s_nop 1
    v_max_f32 v8, v8, v9
    s_mov_b32 s13, 0x3e0293ee
    v_mul_f32 v8, s13, v8
    v_fma_f32 v128, v128, s13, -v8
    v_fma_f32 v129, v129, s13, -v8
    v_fma_f32 v130, v130, s13, -v8
    v_fma_f32 v131, v131, s13, -v8
    v_fma_f32 v132, v132, s13, -v8
    v_fma_f32 v133, v133, s13, -v8
    v_fma_f32 v134, v134, s13, -v8
    v_fma_f32 v135, v135, s13, -v8
    v_fma_f32 v136, v136, s13, -v8
    v_fma_f32 v137, v137, s13, -v8
    v_fma_f32 v138, v138, s13, -v8
    v_fma_f32 v139, v139, s13, -v8
    v_fma_f32 v140, v140, s13, -v8
    v_fma_f32 v141, v141, s13, -v8
    v_fma_f32 v142, v142, s13, -v8
    v_fma_f32 v143, v143, s13, -v8
    v_fma_f32 v144, v144, s13, -v8
    v_fma_f32 v145, v145, s13, -v8
    v_fma_f32 v146, v146, s13, -v8
    v_fma_f32 v147, v147, s13, -v8
    v_exp_f32 v128, v128
    v_exp_f32 v129, v129
    v_exp_f32 v130, v130
    v_exp_f32 v131, v131
    v_exp_f32 v132, v132
    v_exp_f32 v133, v133
    v_exp_f32 v134, v134
    v_exp_f32 v135, v135
    v_exp_f32 v136, v136
    v_exp_f32 v137, v137
    v_exp_f32 v138, v138
    v_exp_f32 v139, v139
    v_exp_f32 v140, v140
    v_exp_f32 v141, v141
    v_exp_f32 v142, v142
    v_exp_f32 v143, v143
    v_exp_f32 v144, v144
    v_exp_f32 v145, v145
    v_exp_f32 v146, v146
    v_exp_f32 v147, v147
    s_nop 0
    v_add_f32 v9, v128, v129
    v_add_f32 v9, v9, v130
    v_add_f32 v9, v9, v131
    v_add_f32 v9, v9, v132
    v_add_f32 v9, v9, v133
    v_add_f32 v9, v9, v134
    v_add_f32 v9, v9, v135
    v_add_f32 v9, v9, v136
    v_add_f32 v9, v9, v137
    v_add_f32 v9, v9, v138
    v_add_f32 v9, v9, v139
    v_add_f32 v9, v9, v140
    v_add_f32 v9, v9, v141
    v_add_f32 v9, v9, v142
    v_add_f32 v9, v9, v143
    v_add_f32 v9, v9, v144
    v_add_f32 v9, v9, v145
    v_add_f32 v9, v9, v146
    v_add_f32 v9, v9, v147
    v_mov_b32 v10, v9
    s_nop 1
    v_permlane32_swap_b32 v10, v9
    s_nop 1
    v_add_f32 v9, v9, v10
    v_rcp_f32 v9, v9
    s_nop 0
    v_mul_f32 v128, v128, v9
    v_mul_f32 v129, v129, v9
    v_mul_f32 v130, v130, v9
    v_mul_f32 v131, v131, v9
    v_mul_f32 v132, v132, v9
    v_mul_f32 v133, v133, v9
    v_mul_f32 v134, v134, v9
    v_mul_f32 v135, v135, v9
    v_mul_f32 v136, v136, v9
    v_mul_f32 v137, v137, v9
    v_mul_f32 v138, v138, v9
    v_mul_f32 v139, v139, v9
    v_mul_f32 v140, v140, v9
    v_mul_f32 v141, v141, v9
    v_mul_f32 v142, v142, v9
    v_mul_f32 v143, v143, v9
    v_mul_f32 v144, v144, v9
    v_mul_f32 v145, v145, v9
    v_mul_f32 v146, v146, v9
    v_mul_f32 v147, v147, v9
    v_cvt_pk_bf16_f32 v32, v128, v129
    v_cvt_pk_bf16_f32 v33, v130, v131
    v_cvt_pk_bf16_f32 v34, v132, v133
    v_cvt_pk_bf16_f32 v35, v134, v135
    v_cvt_pk_bf16_f32 v36, v136, v137
    v_cvt_pk_bf16_f32 v37, v138, v139
    v_cvt_pk_bf16_f32 v38, v140, v141
    v_cvt_pk_bf16_f32 v39, v142, v143
    v_cvt_pk_bf16_f32 v40, v144, v145
    v_cvt_pk_bf16_f32 v41, v146, v147
    v_mov_b32 v42, 0
    v_mov_b32 v43, 0
    s_mul_i32 s14, s6, 3072
    s_add_u32 s14, s14, 0xd3af000
    buffer_store_dwordx4 v[32:35], v16, s[24:27], s14 offen offset:0 sc1
    buffer_store_dwordx4 v[36:39], v16, s[24:27], s14 offen offset:1024 sc1
    buffer_store_dwordx4 v[40:43], v16, s[24:27], s14 offen offset:2048 sc1
    s_waitcnt vmcnt(0)
    s_barrier
    s_cmp_lg_u32 s3, 0
    s_cbranch_scc1 BPN_78
    s_lshl_b32 s6, s67, 2
    s_add_u32 s6, s6, 0xad5e800
    v_mov_b32 v17, 0
    s_mov_b64 exec, 1
    buffer_store_dword v17, v17, s[24:27], s6 offen sc1
    s_mov_b64 exec, -1
    s_branch BPN_78
BUG_77:
    s_cmp_eq_u32 s65, 0
    s_cbranch_scc1 BPN_78
    s_sub_u32 s65, s65, 1
    s_lshl_b32 s6, s65, 5
    s_add_u32 s6, s6, 0xad5e800
    v_and_b32 v19, 7, v2
    v_lshlrev_b32 v19, 2, v19
    s_cmp_lg_u32 s3, 0
    s_cbranch_scc1 BO_83
BW_82:
    buffer_load_dword v18, v19, s[24:27], s6 offen sc1
    s_waitcnt vmcnt(0)
    v_cmp_eq_u32 vcc, -1, v18
    s_cbranch_vccz BO_83
    s_add_u32 s36, s36, 1
    s_cmp_gt_u32 s36, 0x40000
    s_cbranch_scc1 END_44
    s_sleep 24
    s_branch BW_82
BO_83:
    s_barrier
    s_lshl_b32 s2, s65, 2
    s_add_u32 s2, s2, s66
    s_sub_u32 s2, s2, 8
    s_load_dwordx2 s[8:9], s[0:1], 0
    s_lshr_b32 s6, s2, 2
    s_and_b32 s7, s2, 3
    s_lshl_b32 s10, s6, 5
    s_lshl_b32 s11, s3, 3
    s_add_u32 s10, s10, s11
    s_mul_i32 s12, s10, 20
    s_mul_i32 s13, s7, 5
    s_add_u32 s12, s12, s13
    s_lshl_b32 s12, s12, 11
    s_add_u32 s12, s12, 0x3cd4000
    s_mul_i32 s14, s10, 10240
    s_mul_i32 s13, s7, 2560
    s_add_u32 s14, s14, s13
    s_add_u32 s14, s14, 0xb15f000
    v_and_b32 v3, 31, v2
    v_lshrrev_b32 v4, 5, v2
    v_lshlrev_b32 v5, 4, v3
    v_lshl_add_u32 v5, v4, 3, v5
    s_mul_i32 s15, s10, 3072
    s_add_u32 s15, s15, 0xd3af000
    v_mov_b32 v86, 0
    v_mov_b32 v87, 0
    v_mov_b32 v90, 0
    v_mov_b32 v91, 0
    v_mov_b32 v94, 0
    v_mov_b32 v95, 0
    v_mov_b32 v98, 0
    v_mov_b32 v99, 0
    v_mov_b32 v102, 0
    v_mov_b32 v103, 0
    v_mov_b32 v162, 0
    v_mov_b32 v163, 0
    v_mov_b32 v166, 0
    v_mov_b32 v167, 0
    v_mov_b32 v170, 0
    v_mov_b32 v171, 0
    v_mov_b32 v174, 0
    v_mov_b32 v175, 0
    v_mov_b32 v178, 0
    v_mov_b32 v179, 0
    buffer_load_dwordx4 v[32:35], v16, s[24:27], s15 offen offset:0
    buffer_load_dwordx4 v[36:39], v16, s[24:27], s15 offen offset:1024
    buffer_load_dwordx4 v[40:43], v16, s[24:27], s15 offen offset:2048
    s_add_u32 s16, s12, 0
    buffer_load_dwordx4 v[44:47], v16, s[24:27], s16 offen offset:0
    buffer_load_dwordx4 v[48:51], v16, s[24:27], s16 offen offset:1024
    buffer_load_dwordx2 v[84:85], v5, s[24:27], s14 offen offset:0
    s_add_u32 s16, s12, 2048
    buffer_load_dwordx4 v[52:55], v16, s[24:27], s16 offen offset:0
    buffer_load_dwordx4 v[56:59], v16, s[24:27], s16 offen offset:1024
    buffer_load_dwordx2 v[88:89], v5, s[24:27], s14 offen offset:512
    s_add_u32 s16, s12, 4096
    buffer_load_dwordx4 v[60:63], v16, s[24:27], s16 offen offset:0
    buffer_load_dwordx4 v[64:67], v16, s[24:27], s16 offen offset:1024
    buffer_load_dwordx2 v[92:93], v5, s[24:27], s14 offen offset:1024
    s_add_u32 s16, s12, 6144
    buffer_load_dwordx4 v[68:71], v16, s[24:27], s16 offen offset:0
    buffer_load_dwordx4 v[72:75], v16, s[24:27], s16 offen offset:1024
    buffer_load_dwordx2 v[96:97], v5, s[24:27], s14 offen offset:1536
    s_add_u32 s16, s12, 8192
    buffer_load_dwordx4 v[76:79], v16, s[24:27], s16 offen offset:0
    buffer_load_dwordx4 v[80:83], v16, s[24:27], s16 offen offset:1024
    buffer_load_dwordx2 v[100:101], v5, s[24:27], s14 offen offset:2048
    s_add_u32 s15, s15, 3072
    s_add_u32 s12, s12, 40960
    s_add_u32 s14, s14, 10240
    buffer_load_dwordx4 v[108:111], v16, s[24:27], s15 offen offset:0
    buffer_load_dwordx4 v[112:115], v16, s[24:27], s15 offen offset:1024
    buffer_load_dwordx4 v[116:119], v16, s[24:27], s15 offen offset:2048
    s_add_u32 s16, s12, 0
    buffer_load_dwordx4 v[120:123], v16, s[24:27], s16 offen offset:0
    buffer_load_dwordx4 v[124:127], v16, s[24:27], s16 offen offset:1024
    buffer_load_dwordx2 v[160:161], v5, s[24:27], s14 offen offset:0
    s_add_u32 s16, s12, 2048
    buffer_load_dwordx4 v[128:131], v16, s[24:27], s16 offen offset:0
    buffer_load_dwordx4 v[132:135], v16, s[24:27], s16 offen offset:1024
    buffer_load_dwordx2 v[164:165], v5, s[24:27], s14 offen offset:512
    s_add_u32 s16, s12, 4096
    buffer_load_dwordx4 v[136:139], v16, s[24:27], s16 offen offset:0
    buffer_load_dwordx4 v[140:143], v16, s[24:27], s16 offen offset:1024
    buffer_load_dwordx2 v[168:169], v5, s[24:27], s14 offen offset:1024
    s_add_u32 s16, s12, 6144
    buffer_load_dwordx4 v[144:147], v16, s[24:27], s16 offen offset:0
    buffer_load_dwordx4 v[148:151], v16, s[24:27], s16 offen offset:1024
    buffer_load_dwordx2 v[172:173], v5, s[24:27], s14 offen offset:1536
    s_add_u32 s16, s12, 8192
    buffer_load_dwordx4 v[152:155], v16, s[24:27], s16 offen offset:0
    buffer_load_dwordx4 v[156:159], v16, s[24:27], s16 offen offset:1024
    buffer_load_dwordx2 v[176:177], v5, s[24:27], s14 offen offset:2048
    s_add_u32 s15, s15, 3072
    s_add_u32 s12, s12, 40960
    s_add_u32 s14, s14, 10240
    s_waitcnt vmcnt(18)
    v_mfma_f32_32x32x16_bf16 a[0:15], v[44:47], v[32:35], 0
    v_mfma_f32_32x32x16_bf16 a[16:31], v[52:55], v[32:35], 0
    v_mfma_f32_32x32x16_bf16 a[32:47], v[60:63], v[32:35], 0
    v_mfma_f32_32x32x16_bf16 a[48:63], v[68:71], v[32:35], 0
    v_mfma_f32_32x32x16_bf16 a[64:79], v[76:79], v[32:35], 0
    v_mfma_f32_32x32x16_bf16 a[0:15], v[48:51], v[36:39], a[0:15]
    v_mfma_f32_32x32x16_bf16 a[16:31], v[56:59], v[36:39], a[16:31]
    v_mfma_f32_32x32x16_bf16 a[32:47], v[64:67], v[36:39], a[32:47]
    v_mfma_f32_32x32x16_bf16 a[48:63], v[72:75], v[36:39], a[48:63]
    v_mfma_f32_32x32x16_bf16 a[64:79], v[80:83], v[36:39], a[64:79]
    v_mfma_f32_32x32x16_bf16 a[0:15], v[84:87], v[40:43], a[0:15]
    v_mfma_f32_32x32x16_bf16 a[16:31], v[88:91], v[40:43], a[16:31]
    v_mfma_f32_32x32x16_bf16 a[32:47], v[92:95], v[40:43], a[32:47]
    v_mfma_f32_32x32x16_bf16 a[48:63], v[96:99], v[40:43], a[48:63]
    v_mfma_f32_32x32x16_bf16 a[64:79], v[100:103], v[40:43], a[64:79]
    buffer_load_dwordx4 v[32:35], v16, s[24:27], s15 offen offset:0
    buffer_load_dwordx4 v[36:39], v16, s[24:27], s15 offen offset:1024
    buffer_load_dwordx4 v[40:43], v16, s[24:27], s15 offen offset:2048
    s_add_u32 s16, s12, 0
    buffer_load_dwordx4 v[44:47], v16, s[24:27], s16 offen offset:0
    buffer_load_dwordx4 v[48:51], v16, s[24:27], s16 offen offset:1024
    buffer_load_dwordx2 v[84:85], v5, s[24:27], s14 offen offset:0
    s_add_u32 s16, s12, 2048
    buffer_load_dwordx4 v[52:55], v16, s[24:27], s16 offen offset:0
    buffer_load_dwordx4 v[56:59], v16, s[24:27], s16 offen offset:1024
    buffer_load_dwordx2 v[88:89], v5, s[24:27], s14 offen offset:512
    s_add_u32 s16, s12, 4096
    buffer_load_dwordx4 v[60:63], v16, s[24:27], s16 offen offset:0
    buffer_load_dwordx4 v[64:67], v16, s[24:27], s16 offen offset:1024
    buffer_load_dwordx2 v[92:93], v5, s[24:27], s14 offen offset:1024
    s_add_u32 s16, s12, 6144
    buffer_load_dwordx4 v[68:71], v16, s[24:27], s16 offen offset:0
    buffer_load_dwordx4 v[72:75], v16, s[24:27], s16 offen offset:1024
    buffer_load_dwordx2 v[96:97], v5, s[24:27], s14 offen offset:1536
    s_add_u32 s16, s12, 8192
    buffer_load_dwordx4 v[76:79], v16, s[24:27], s16 offen offset:0
    buffer_load_dwordx4 v[80:83], v16, s[24:27], s16 offen offset:1024
    buffer_load_dwordx2 v[100:101], v5, s[24:27], s14 offen offset:2048
    s_add_u32 s15, s15, 3072
    s_add_u32 s12, s12, 40960
    s_add_u32 s14, s14, 10240
    s_waitcnt vmcnt(18)
    v_mfma_f32_32x32x16_bf16 a[0:15], v[120:123], v[108:111], a[0:15]
    v_mfma_f32_32x32x16_bf16 a[16:31], v[128:131], v[108:111], a[16:31]
    v_mfma_f32_32x32x16_bf16 a[32:47], v[136:139], v[108:111], a[32:47]
    v_mfma_f32_32x32x16_bf16 a[48:63], v[144:147], v[108:111], a[48:63]
    v_mfma_f32_32x32x16_bf16 a[64:79], v[152:155], v[108:111], a[64:79]
    v_mfma_f32_32x32x16_bf16 a[0:15], v[124:127], v[112:115], a[0:15]
    v_mfma_f32_32x32x16_bf16 a[16:31], v[132:135], v[112:115], a[16:31]
    v_mfma_f32_32x32x16_bf16 a[32:47], v[140:143], v[112:115], a[32:47]
    v_mfma_f32_32x32x16_bf16 a[48:63], v[148:151], v[112:115], a[48:63]
    v_mfma_f32_32x32x16_bf16 a[64:79], v[156:159], v[112:115], a[64:79]
    v_mfma_f32_32x32x16_bf16 a[0:15], v[160:163], v[116:119], a[0:15]
    v_mfma_f32_32x32x16_bf16 a[16:31], v[164:167], v[116:119], a[16:31]
    v_mfma_f32_32x32x16_bf16 a[32:47], v[168:171], v[116:119], a[32:47]
    v_mfma_f32_32x32x16_bf16 a[48:63], v[172:175], v[116:119], a[48:63]
    v_mfma_f32_32x32x16_bf16 a[64:79], v[176:179], v[116:119], a[64:79]
    buffer_load_dwordx4 v[108:111], v16, s[24:27], s15 offen offset:0
    buffer_load_dwordx4 v[112:115], v16, s[24:27], s15 offen offset:1024
    buffer_load_dwordx4 v[116:119], v16, s[24:27], s15 offen offset:2048
    s_add_u32 s16, s12, 0
    buffer_load_dwordx4 v[120:123], v16, s[24:27], s16 offen offset:0
    buffer_load_dwordx4 v[124:127], v16, s[24:27], s16 offen offset:1024
    buffer_load_dwordx2 v[160:161], v5, s[24:27], s14 offen offset:0
    s_add_u32 s16, s12, 2048
    buffer_load_dwordx4 v[128:131], v16, s[24:27], s16 offen offset:0
    buffer_load_dwordx4 v[132:135], v16, s[24:27], s16 offen offset:1024
    buffer_load_dwordx2 v[164:165], v5, s[24:27], s14 offen offset:512
    s_add_u32 s16, s12, 4096
    buffer_load_dwordx4 v[136:139], v16, s[24:27], s16 offen offset:0
    buffer_load_dwordx4 v[140:143], v16, s[24:27], s16 offen offset:1024
    buffer_load_dwordx2 v[168:169], v5, s[24:27], s14 offen offset:1024
    s_add_u32 s16, s12, 6144
    buffer_load_dwordx4 v[144:147], v16, s[24:27], s16 offen offset:0
    buffer_load_dwordx4 v[148:151], v16, s[24:27], s16 offen offset:1024
    buffer_load_dwordx2 v[172:173], v5, s[24:27], s14 offen offset:1536
    s_add_u32 s16, s12, 8192
    buffer_load_dwordx4 v[152:155], v16, s[24:27], s16 offen offset:0
    buffer_load_dwordx4 v[156:159], v16, s[24:27], s16 offen offset:1024
    buffer_load_dwordx2 v[176:177], v5, s[24:27], s14 offen offset:2048
    s_add_u32 s15, s15, 3072
    s_add_u32 s12, s12, 40960
    s_add_u32 s14, s14, 10240
    s_waitcnt vmcnt(18)
    v_mfma_f32_32x32x16_bf16 a[0:15], v[44:47], v[32:35], a[0:15]
    v_mfma_f32_32x32x16_bf16 a[16:31], v[52:55], v[32:35], a[16:31]
    v_mfma_f32_32x32x16_bf16 a[32:47], v[60:63], v[32:35], a[32:47]
    v_mfma_f32_32x32x16_bf16 a[48:63], v[68:71], v[32:35], a[48:63]
    v_mfma_f32_32x32x16_bf16 a[64:79], v[76:79], v[32:35], a[64:79]
    v_mfma_f32_32x32x16_bf16 a[0:15], v[48:51], v[36:39], a[0:15]
    v_mfma_f32_32x32x16_bf16 a[16:31], v[56:59], v[36:39], a[16:31]
    v_mfma_f32_32x32x16_bf16 a[32:47], v[64:67], v[36:39], a[32:47]
    v_mfma_f32_32x32x16_bf16 a[48:63], v[72:75], v[36:39], a[48:63]
    v_mfma_f32_32x32x16_bf16 a[64:79], v[80:83], v[36:39], a[64:79]
    v_mfma_f32_32x32x16_bf16 a[0:15], v[84:87], v[40:43], a[0:15]
    v_mfma_f32_32x32x16_bf16 a[16:31], v[88:91], v[40:43], a[16:31]
    v_mfma_f32_32x32x16_bf16 a[32:47], v[92:95], v[40:43], a[32:47]
    v_mfma_f32_32x32x16_bf16 a[48:63], v[96:99], v[40:43], a[48:63]
    v_mfma_f32_32x32x16_bf16 a[64:79], v[100:103], v[40:43], a[64:79]
    buffer_load_dwordx4 v[32:35], v16, s[24:27], s15 offen offset:0
    buffer_load_dwordx4 v[36:39], v16, s[24:27], s15 offen offset:1024
    buffer_load_dwordx4 v[40:43], v16, s[24:27], s15 offen offset:2048
    s_add_u32 s16, s12, 0
    buffer_load_dwordx4 v[44:47], v16, s[24:27], s16 offen offset:0
    buffer_load_dwordx4 v[48:51], v16, s[24:27], s16 offen offset:1024
    buffer_load_dwordx2 v[84:85], v5, s[24:27], s14 offen offset:0
    s_add_u32 s16, s12, 2048
    buffer_load_dwordx4 v[52:55], v16, s[24:27], s16 offen offset:0
    buffer_load_dwordx4 v[56:59], v16, s[24:27], s16 offen offset:1024
    buffer_load_dwordx2 v[88:89], v5, s[24:27], s14 offen offset:512
    s_add_u32 s16, s12, 4096
    buffer_load_dwordx4 v[60:63], v16, s[24:27], s16 offen offset:0
    buffer_load_dwordx4 v[64:67], v16, s[24:27], s16 offen offset:1024
    buffer_load_dwordx2 v[92:93], v5, s[24:27], s14 offen offset:1024
    s_add_u32 s16, s12, 6144
    buffer_load_dwordx4 v[68:71], v16, s[24:27], s16 offen offset:0
    buffer_load_dwordx4 v[72:75], v16, s[24:27], s16 offen offset:1024
    buffer_load_dwordx2 v[96:97], v5, s[24:27], s14 offen offset:1536
    s_add_u32 s16, s12, 8192
    buffer_load_dwordx4 v[76:79], v16, s[24:27], s16 offen offset:0
    buffer_load_dwordx4 v[80:83], v16, s[24:27], s16 offen offset:1024
    buffer_load_dwordx2 v[100:101], v5, s[24:27], s14 offen offset:2048
    s_add_u32 s15, s15, 3072
    s_add_u32 s12, s12, 40960
    s_add_u32 s14, s14, 10240
    s_waitcnt vmcnt(18)
    v_mfma_f32_32x32x16_bf16 a[0:15], v[120:123], v[108:111], a[0:15]
    v_mfma_f32_32x32x16_bf16 a[16:31], v[128:131], v[108:111], a[16:31]
    v_mfma_f32_32x32x16_bf16 a[32:47], v[136:139], v[108:111], a[32:47]
    v_mfma_f32_32x32x16_bf16 a[48:63], v[144:147], v[108:111], a[48:63]
    v_mfma_f32_32x32x16_bf16 a[64:79], v[152:155], v[108:111], a[64:79]
    v_mfma_f32_32x32x16_bf16 a[0:15], v[124:127], v[112:115], a[0:15]
    v_mfma_f32_32x32x16_bf16 a[16:31], v[132:135], v[112:115], a[16:31]
    v_mfma_f32_32x32x16_bf16 a[32:47], v[140:143], v[112:115], a[32:47]
    v_mfma_f32_32x32x16_bf16 a[48:63], v[148:151], v[112:115], a[48:63]
    v_mfma_f32_32x32x16_bf16 a[64:79], v[156:159], v[112:115], a[64:79]
    v_mfma_f32_32x32x16_bf16 a[0:15], v[160:163], v[116:119], a[0:15]
    v_mfma_f32_32x32x16_bf16 a[16:31], v[164:167], v[116:119], a[16:31]
    v_mfma_f32_32x32x16_bf16 a[32:47], v[168:171], v[116:119], a[32:47]
    v_mfma_f32_32x32x16_bf16 a[48:63], v[172:175], v[116:119], a[48:63]
    v_mfma_f32_32x32x16_bf16 a[64:79], v[176:179], v[116:119], a[64:79]
    buffer_load_dwordx4 v[108:111], v16, s[24:27], s15 offen offset:0
    buffer_load_dwordx4 v[112:115], v16, s[24:27], s15 offen offset:1024
    buffer_load_dwordx4 v[116:119], v16, s[24:27], s15 offen offset:2048
    s_add_u32 s16, s12, 0
    buffer_load_dwordx4 v[120:123], v16, s[24:27], s16 offen offset:0
    buffer_load_dwordx4 v[124:127], v16, s[24:27], s16 offen offset:1024
    buffer_load_dwordx2 v[160:161], v5, s[24:27], s14 offen offset:0
    s_add_u32 s16, s12, 2048
    buffer_load_dwordx4 v[128:131], v16, s[24:27], s16 offen offset:0
    buffer_load_dwordx4 v[132:135], v16, s[24:27], s16 offen offset:1024
    buffer_load_dwordx2 v[164:165], v5, s[24:27], s14 offen offset:512
    s_add_u32 s16, s12, 4096
    buffer_load_dwordx4 v[136:139], v16, s[24:27], s16 offen offset:0
    buffer_load_dwordx4 v[140:143], v16, s[24:27], s16 offen offset:1024
    buffer_load_dwordx2 v[168:169], v5, s[24:27], s14 offen offset:1024
    s_add_u32 s16, s12, 6144
    buffer_load_dwordx4 v[144:147], v16, s[24:27], s16 offen offset:0
    buffer_load_dwordx4 v[148:151], v16, s[24:27], s16 offen offset:1024
    buffer_load_dwordx2 v[172:173], v5, s[24:27], s14 offen offset:1536
    s_add_u32 s16, s12, 8192
    buffer_load_dwordx4 v[152:155], v16, s[24:27], s16 offen offset:0
    buffer_load_dwordx4 v[156:159], v16, s[24:27], s16 offen offset:1024
    buffer_load_dwordx2 v[176:177], v5, s[24:27], s14 offen offset:2048
    s_add_u32 s15, s15, 3072
    s_add_u32 s12, s12, 40960
    s_add_u32 s14, s14, 10240
    s_waitcnt vmcnt(18)
    v_mfma_f32_32x32x16_bf16 a[0:15], v[44:47], v[32:35], a[0:15]
    v_mfma_f32_32x32x16_bf16 a[16:31], v[52:55], v[32:35], a[16:31]
    v_mfma_f32_32x32x16_bf16 a[32:47], v[60:63], v[32:35], a[32:47]
    v_mfma_f32_32x32x16_bf16 a[48:63], v[68:71], v[32:35], a[48:63]
    v_mfma_f32_32x32x16_bf16 a[64:79], v[76:79], v[32:35], a[64:79]
    v_mfma_f32_32x32x16_bf16 a[0:15], v[48:51], v[36:39], a[0:15]
    v_mfma_f32_32x32x16_bf16 a[16:31], v[56:59], v[36:39], a[16:31]
    v_mfma_f32_32x32x16_bf16 a[32:47], v[64:67], v[36:39], a[32:47]
    v_mfma_f32_32x32x16_bf16 a[48:63], v[72:75], v[36:39], a[48:63]
    v_mfma_f32_32x32x16_bf16 a[64:79], v[80:83], v[36:39], a[64:79]
    v_mfma_f32_32x32x16_bf16 a[0:15], v[84:87], v[40:43], a[0:15]
    v_mfma_f32_32x32x16_bf16 a[16:31], v[88:91], v[40:43], a[16:31]
    v_mfma_f32_32x32x16_bf16 a[32:47], v[92:95], v[40:43], a[32:47]
    v_mfma_f32_32x32x16_bf16 a[48:63], v[96:99], v[40:43], a[48:63]
    v_mfma_f32_32x32x16_bf16 a[64:79], v[100:103], v[40:43], a[64:79]
    buffer_load_dwordx4 v[32:35], v16, s[24:27], s15 offen offset:0
    buffer_load_dwordx4 v[36:39], v16, s[24:27], s15 offen offset:1024
    buffer_load_dwordx4 v[40:43], v16, s[24:27], s15 offen offset:2048
    s_add_u32 s16, s12, 0
    buffer_load_dwordx4 v[44:47], v16, s[24:27], s16 offen offset:0
    buffer_load_dwordx4 v[48:51], v16, s[24:27], s16 offen offset:1024
    buffer_load_dwordx2 v[84:85], v5, s[24:27], s14 offen offset:0
    s_add_u32 s16, s12, 2048
    buffer_load_dwordx4 v[52:55], v16, s[24:27], s16 offen offset:0
    buffer_load_dwordx4 v[56:59], v16, s[24:27], s16 offen offset:1024
    buffer_load_dwordx2 v[88:89], v5, s[24:27], s14 offen offset:512
    s_add_u32 s16, s12, 4096
    buffer_load_dwordx4 v[60:63], v16, s[24:27], s16 offen offset:0
    buffer_load_dwordx4 v[64:67], v16, s[24:27], s16 offen offset:1024
    buffer_load_dwordx2 v[92:93], v5, s[24:27], s14 offen offset:1024
    s_add_u32 s16, s12, 6144
    buffer_load_dwordx4 v[68:71], v16, s[24:27], s16 offen offset:0
    buffer_load_dwordx4 v[72:75], v16, s[24:27], s16 offen offset:1024
    buffer_load_dwordx2 v[96:97], v5, s[24:27], s14 offen offset:1536
    s_add_u32 s16, s12, 8192
    buffer_load_dwordx4 v[76:79], v16, s[24:27], s16 offen offset:0
    buffer_load_dwordx4 v[80:83], v16, s[24:27], s16 offen offset:1024
    buffer_load_dwordx2 v[100:101], v5, s[24:27], s14 offen offset:2048
    s_add_u32 s15, s15, 3072
    s_add_u32 s12, s12, 40960
    s_add_u32 s14, s14, 10240
    s_waitcnt vmcnt(18)
    v_mfma_f32_32x32x16_bf16 a[0:15], v[120:123], v[108:111], a[0:15]
    v_mfma_f32_32x32x16_bf16 a[16:31], v[128:131], v[108:111], a[16:31]
    v_mfma_f32_32x32x16_bf16 a[32:47], v[136:139], v[108:111], a[32:47]
    v_mfma_f32_32x32x16_bf16 a[48:63], v[144:147], v[108:111], a[48:63]
    v_mfma_f32_32x32x16_bf16 a[64:79], v[152:155], v[108:111], a[64:79]
    v_mfma_f32_32x32x16_bf16 a[0:15], v[124:127], v[112:115], a[0:15]
    v_mfma_f32_32x32x16_bf16 a[16:31], v[132:135], v[112:115], a[16:31]
    v_mfma_f32_32x32x16_bf16 a[32:47], v[140:143], v[112:115], a[32:47]
    v_mfma_f32_32x32x16_bf16 a[48:63], v[148:151], v[112:115], a[48:63]
    v_mfma_f32_32x32x16_bf16 a[64:79], v[156:159], v[112:115], a[64:79]
    v_mfma_f32_32x32x16_bf16 a[0:15], v[160:163], v[116:119], a[0:15]
    v_mfma_f32_32x32x16_bf16 a[16:31], v[164:167], v[116:119], a[16:31]
    v_mfma_f32_32x32x16_bf16 a[32:47], v[168:171], v[116:119], a[32:47]
    v_mfma_f32_32x32x16_bf16 a[48:63], v[172:175], v[116:119], a[48:63]
    v_mfma_f32_32x32x16_bf16 a[64:79], v[176:179], v[116:119], a[64:79]
    buffer_load_dwordx4 v[108:111], v16, s[24:27], s15 offen offset:0
    buffer_load_dwordx4 v[112:115], v16, s[24:27], s15 offen offset:1024
    buffer_load_dwordx4 v[116:119], v16, s[24:27], s15 offen offset:2048
    s_add_u32 s16, s12, 0
    buffer_load_dwordx4 v[120:123], v16, s[24:27], s16 offen offset:0
    buffer_load_dwordx4 v[124:127], v16, s[24:27], s16 offen offset:1024
    buffer_load_dwordx2 v[160:161], v5, s[24:27], s14 offen offset:0
    s_add_u32 s16, s12, 2048
    buffer_load_dwordx4 v[128:131], v16, s[24:27], s16 offen offset:0
    buffer_load_dwordx4 v[132:135], v16, s[24:27], s16 offen offset:1024
    buffer_load_dwordx2 v[164:165], v5, s[24:27], s14 offen offset:512
    s_add_u32 s16, s12, 4096
    buffer_load_dwordx4 v[136:139], v16, s[24:27], s16 offen offset:0
    buffer_load_dwordx4 v[140:143], v16, s[24:27], s16 offen offset:1024
    buffer_load_dwordx2 v[168:169], v5, s[24:27], s14 offen offset:1024
    s_add_u32 s16, s12, 6144
    buffer_load_dwordx4 v[144:147], v16, s[24:27], s16 offen offset:0
    buffer_load_dwordx4 v[148:151], v16, s[24:27], s16 offen offset:1024
    buffer_load_dwordx2 v[172:173], v5, s[24:27], s14 offen offset:1536
    s_add_u32 s16, s12, 8192
    buffer_load_dwordx4 v[152:155], v16, s[24:27], s16 offen offset:0
    buffer_load_dwordx4 v[156:159], v16, s[24:27], s16 offen offset:1024
    buffer_load_dwordx2 v[176:177], v5, s[24:27], s14 offen offset:2048
    s_add_u32 s15, s15, 3072
    s_add_u32 s12, s12, 40960
    s_add_u32 s14, s14, 10240
    s_waitcnt vmcnt(18)
    v_mfma_f32_32x32x16_bf16 a[0:15], v[44:47], v[32:35], a[0:15]
    v_mfma_f32_32x32x16_bf16 a[16:31], v[52:55], v[32:35], a[16:31]
    v_mfma_f32_32x32x16_bf16 a[32:47], v[60:63], v[32:35], a[32:47]
    v_mfma_f32_32x32x16_bf16 a[48:63], v[68:71], v[32:35], a[48:63]
    v_mfma_f32_32x32x16_bf16 a[64:79], v[76:79], v[32:35], a[64:79]
    v_mfma_f32_32x32x16_bf16 a[0:15], v[48:51], v[36:39], a[0:15]
    v_mfma_f32_32x32x16_bf16 a[16:31], v[56:59], v[36:39], a[16:31]
    v_mfma_f32_32x32x16_bf16 a[32:47], v[64:67], v[36:39], a[32:47]
    v_mfma_f32_32x32x16_bf16 a[48:63], v[72:75], v[36:39], a[48:63]
    v_mfma_f32_32x32x16_bf16 a[64:79], v[80:83], v[36:39], a[64:79]
    v_mfma_f32_32x32x16_bf16 a[0:15], v[84:87], v[40:43], a[0:15]
    v_mfma_f32_32x32x16_bf16 a[16:31], v[88:91], v[40:43], a[16:31]
    v_mfma_f32_32x32x16_bf16 a[32:47], v[92:95], v[40:43], a[32:47]
    v_mfma_f32_32x32x16_bf16 a[48:63], v[96:99], v[40:43], a[48:63]
    v_mfma_f32_32x32x16_bf16 a[64:79], v[100:103], v[40:43], a[64:79]
    s_waitcnt vmcnt(0)
    v_mfma_f32_32x32x16_bf16 a[0:15], v[120:123], v[108:111], a[0:15]
    v_mfma_f32_32x32x16_bf16 a[16:31], v[128:131], v[108:111], a[16:31]
    v_mfma_f32_32x32x16_bf16 a[32:47], v[136:139], v[108:111], a[32:47]
    v_mfma_f32_32x32x16_bf16 a[48:63], v[144:147], v[108:111], a[48:63]
    v_mfma_f32_32x32x16_bf16 a[64:79], v[152:155], v[108:111], a[64:79]
    v_mfma_f32_32x32x16_bf16 a[0:15], v[124:127], v[112:115], a[0:15]
    v_mfma_f32_32x32x16_bf16 a[16:31], v[132:135], v[112:115], a[16:31]
    v_mfma_f32_32x32x16_bf16 a[32:47], v[140:143], v[112:115], a[32:47]
    v_mfma_f32_32x32x16_bf16 a[48:63], v[148:151], v[112:115], a[48:63]
    v_mfma_f32_32x32x16_bf16 a[64:79], v[156:159], v[112:115], a[64:79]
    v_mfma_f32_32x32x16_bf16 a[0:15], v[160:163], v[116:119], a[0:15]
    v_mfma_f32_32x32x16_bf16 a[16:31], v[164:167], v[116:119], a[16:31]
    v_mfma_f32_32x32x16_bf16 a[32:47], v[168:171], v[116:119], a[32:47]
    v_mfma_f32_32x32x16_bf16 a[48:63], v[172:175], v[116:119], a[48:63]
    v_mfma_f32_32x32x16_bf16 a[64:79], v[176:179], v[116:119], a[64:79]
    s_nop 15
    s_mul_i32 s16, s3, 20480
    v_add_u32 v6, s16, v16
    v_accvgpr_read_b32 v32, a0
    v_accvgpr_read_b32 v33, a1
    v_accvgpr_read_b32 v34, a2
    v_accvgpr_read_b32 v35, a3
    ds_write_b128 v6, v[32:35] offset:0
    v_accvgpr_read_b32 v36, a4
    v_accvgpr_read_b32 v37, a5
    v_accvgpr_read_b32 v38, a6
    v_accvgpr_read_b32 v39, a7
    ds_write_b128 v6, v[36:39] offset:1024
    v_accvgpr_read_b32 v32, a8
    v_accvgpr_read_b32 v33, a9
    v_accvgpr_read_b32 v34, a10
    v_accvgpr_read_b32 v35, a11
    ds_write_b128 v6, v[32:35] offset:2048
    v_accvgpr_read_b32 v36, a12
    v_accvgpr_read_b32 v37, a13
    v_accvgpr_read_b32 v38, a14
    v_accvgpr_read_b32 v39, a15
    ds_write_b128 v6, v[36:39] offset:3072
    v_accvgpr_read_b32 v32, a16
    v_accvgpr_read_b32 v33, a17
    v_accvgpr_read_b32 v34, a18
    v_accvgpr_read_b32 v35, a19
    ds_write_b128 v6, v[32:35] offset:4096
    v_accvgpr_read_b32 v36, a20
    v_accvgpr_read_b32 v37, a21
    v_accvgpr_read_b32 v38, a22
    v_accvgpr_read_b32 v39, a23
    ds_write_b128 v6, v[36:39] offset:5120
    v_accvgpr_read_b32 v32, a24
    v_accvgpr_read_b32 v33, a25
    v_accvgpr_read_b32 v34, a26
    v_accvgpr_read_b32 v35, a27
    ds_write_b128 v6, v[32:35] offset:6144
    v_accvgpr_read_b32 v36, a28
    v_accvgpr_read_b32 v37, a29
    v_accvgpr_read_b32 v38, a30
    v_accvgpr_read_b32 v39, a31
    ds_write_b128 v6, v[36:39] offset:7168
    v_accvgpr_read_b32 v32, a32
    v_accvgpr_read_b32 v33, a33
    v_accvgpr_read_b32 v34, a34
    v_accvgpr_read_b32 v35, a35
    ds_write_b128 v6, v[32:35] offset:8192
    v_accvgpr_read_b32 v36, a36
    v_accvgpr_read_b32 v37, a37
    v_accvgpr_read_b32 v38, a38
    v_accvgpr_read_b32 v39, a39
    ds_write_b128 v6, v[36:39] offset:9216
    v_accvgpr_read_b32 v32, a40
    v_accvgpr_read_b32 v33, a41
    v_accvgpr_read_b32 v34, a42
    v_accvgpr_read_b32 v35, a43
    ds_write_b128 v6, v[32:35] offset:10240
    v_accvgpr_read_b32 v36, a44
    v_accvgpr_read_b32 v37, a45
    v_accvgpr_read_b32 v38, a46
    v_accvgpr_read_b32 v39, a47
    ds_write_b128 v6, v[36:39] offset:11264
    v_accvgpr_read_b32 v32, a48
    v_accvgpr_read_b32 v33, a49
    v_accvgpr_read_b32 v34, a50
    v_accvgpr_read_b32 v35, a51
    ds_write_b128 v6, v[32:35] offset:12288
    v_accvgpr_read_b32 v36, a52
    v_accvgpr_read_b32 v37, a53
    v_accvgpr_read_b32 v38, a54
    v_accvgpr_read_b32 v39, a55
    ds_write_b128 v6, v[36:39] offset:13312
    v_accvgpr_read_b32 v32, a56
    v_accvgpr_read_b32 v33, a57
    v_accvgpr_read_b32 v34, a58
    v_accvgpr_read_b32 v35, a59
    ds_write_b128 v6, v[32:35] offset:14336
    v_accvgpr_read_b32 v36, a60
    v_accvgpr_read_b32 v37, a61
    v_accvgpr_read_b32 v38, a62
    v_accvgpr_read_b32 v39, a63
    ds_write_b128 v6, v[36:39] offset:15360
    v_accvgpr_read_b32 v32, a64
    v_accvgpr_read_b32 v33, a65
    v_accvgpr_read_b32 v34, a66
    v_accvgpr_read_b32 v35, a67
    ds_write_b128 v6, v[32:35] offset:16384
    v_accvgpr_read_b32 v36, a68
    v_accvgpr_read_b32 v37, a69
    v_accvgpr_read_b32 v38, a70
    v_accvgpr_read_b32 v39, a71
    ds_write_b128 v6, v[36:39] offset:17408
    v_accvgpr_read_b32 v32, a72
    v_accvgpr_read_b32 v33, a73
    v_accvgpr_read_b32 v34, a74
    v_accvgpr_read_b32 v35, a75
    ds_write_b128 v6, v[32:35] offset:18432
    v_accvgpr_read_b32 v36, a76
    v_accvgpr_read_b32 v37, a77
    v_accvgpr_read_b32 v38, a78
    v_accvgpr_read_b32 v39, a79
    ds_write_b128 v6, v[36:39] offset:19456
    s_waitcnt lgkmcnt(0)
    s_barrier
    s_waitcnt lgkmcnt(0)
    s_mov_b32 s28, s8
    s_and_b32 s29, s9, 0xffff
    s_mov_b32 s30, 0x280000
    s_mov_b32 s31, 0x00020000
    v_mul_u32_u24 v7, 1280, v3
    v_lshl_add_u32 v7, v4, 3, v7
    s_mul_i32 s17, s6, 40960
    s_mul_i32 s18, s7, 320
    s_add_u32 s17, s17, s18
    s_lshl_b32 s18, s3, 4
    s_add_u32 s17, s17, s18
    s_add_u32 s19, s17, 0xc55f000
    s_lshl_b32 s16, s3, 10
    v_add_u32 v6, s16, v16
    buffer_load_dwordx2 v[100:101], v7, s[28:31], s17 offen offset:0
    buffer_load_dwordx2 v[102:103], v7, s[28:31], s17 offen offset:64
    buffer_load_dwordx2 v[104:105], v7, s[28:31], s17 offen offset:128
    buffer_load_dwordx2 v[106:107], v7, s[28:31], s17 offen offset:192
    buffer_load_dwordx2 v[108:109], v7, s[28:31], s17 offen offset:256
    ds_read_b128 v[32:35], v6 offset:0
    v_add_u32 v8, 0xf000, v6
    ds_read_b128 v[36:39], v6 offset:20480
    ds_read_b128 v[40:43], v6 offset:40960
    ds_read_b128 v[44:47], v6 offset:61440
    s_waitcnt lgkmcnt(0)
    v_add_f32 v32, v32, v36
    v_add_f32 v40, v40, v44
    v_add_f32 v32, v32, v40
    v_add_f32 v33, v33, v37
    v_add_f32 v41, v41, v45
    v_add_f32 v33, v33, v41
    v_add_f32 v34, v34, v38
    v_add_f32 v42, v42, v46
    v_add_f32 v34, v34, v42
    v_add_f32 v35, v35, v39
    v_add_f32 v43, v43, v47
    v_add_f32 v35, v35, v43
    v_cvt_pk_bf16_f32 v48, v32, v33
    v_cvt_pk_bf16_f32 v49, v34, v35
    s_waitcnt vmcnt(4)

    v_lshlrev_b32 v32, 16, v48
    v_and_b32 v33, 0xffff0000, v48
    v_lshlrev_b32 v34, 16, v49
    v_and_b32 v35, 0xffff0000, v49
    v_lshlrev_b32 v36, 16, v100
    v_and_b32 v37, 0xffff0000, v100
    v_lshlrev_b32 v38, 16, v101
    v_and_b32 v39, 0xffff0000, v101
    v_add_f32 v32, v32, v36
    v_add_f32 v33, v33, v37
    v_add_f32 v34, v34, v38
    v_add_f32 v35, v35, v39
    v_cvt_pk_bf16_f32 v50, v32, v33
    v_cvt_pk_bf16_f32 v51, v34, v35
    buffer_store_dwordx2 v[50:51], v7, s[24:27], s19 offen offset:0
    ds_read_b128 v[32:35], v6 offset:4096
    ds_read_b128 v[36:39], v6 offset:24576
    ds_read_b128 v[40:43], v6 offset:45056
    ds_read_b128 v[44:47], v8 offset:4096
    s_waitcnt lgkmcnt(0)
    v_add_f32 v32, v32, v36
    v_add_f32 v40, v40, v44
    v_add_f32 v32, v32, v40
    v_add_f32 v33, v33, v37
    v_add_f32 v41, v41, v45
    v_add_f32 v33, v33, v41
    v_add_f32 v34, v34, v38
    v_add_f32 v42, v42, v46
    v_add_f32 v34, v34, v42
    v_add_f32 v35, v35, v39
    v_add_f32 v43, v43, v47
    v_add_f32 v35, v35, v43
    v_cvt_pk_bf16_f32 v48, v32, v33
    v_cvt_pk_bf16_f32 v49, v34, v35
    s_waitcnt vmcnt(4)

    v_lshlrev_b32 v32, 16, v48
    v_and_b32 v33, 0xffff0000, v48
    v_lshlrev_b32 v34, 16, v49
    v_and_b32 v35, 0xffff0000, v49
    v_lshlrev_b32 v36, 16, v102
    v_and_b32 v37, 0xffff0000, v102
    v_lshlrev_b32 v38, 16, v103
    v_and_b32 v39, 0xffff0000, v103
    v_add_f32 v32, v32, v36
    v_add_f32 v33, v33, v37
    v_add_f32 v34, v34, v38
    v_add_f32 v35, v35, v39
    v_cvt_pk_bf16_f32 v52, v32, v33
    v_cvt_pk_bf16_f32 v53, v34, v35
    buffer_store_dwordx2 v[52:53], v7, s[24:27], s19 offen offset:64
    ds_read_b128 v[32:35], v6 offset:8192
    ds_read_b128 v[36:39], v6 offset:28672
    ds_read_b128 v[40:43], v6 offset:49152
    ds_read_b128 v[44:47], v8 offset:8192
    s_waitcnt lgkmcnt(0)
    v_add_f32 v32, v32, v36
    v_add_f32 v40, v40, v44
    v_add_f32 v32, v32, v40
    v_add_f32 v33, v33, v37
    v_add_f32 v41, v41, v45
    v_add_f32 v33, v33, v41
    v_add_f32 v34, v34, v38
    v_add_f32 v42, v42, v46
    v_add_f32 v34, v34, v42
    v_add_f32 v35, v35, v39
    v_add_f32 v43, v43, v47
    v_add_f32 v35, v35, v43
    v_cvt_pk_bf16_f32 v48, v32, v33
    v_cvt_pk_bf16_f32 v49, v34, v35
    s_waitcnt vmcnt(4)

    v_lshlrev_b32 v32, 16, v48
    v_and_b32 v33, 0xffff0000, v48
    v_lshlrev_b32 v34, 16, v49
    v_and_b32 v35, 0xffff0000, v49
    v_lshlrev_b32 v36, 16, v104
    v_and_b32 v37, 0xffff0000, v104
    v_lshlrev_b32 v38, 16, v105
    v_and_b32 v39, 0xffff0000, v105
    v_add_f32 v32, v32, v36
    v_add_f32 v33, v33, v37
    v_add_f32 v34, v34, v38
    v_add_f32 v35, v35, v39
    v_cvt_pk_bf16_f32 v50, v32, v33
    v_cvt_pk_bf16_f32 v51, v34, v35
    buffer_store_dwordx2 v[50:51], v7, s[24:27], s19 offen offset:128
    ds_read_b128 v[32:35], v6 offset:12288
    ds_read_b128 v[36:39], v6 offset:32768
    ds_read_b128 v[40:43], v6 offset:53248
    ds_read_b128 v[44:47], v8 offset:12288
    s_waitcnt lgkmcnt(0)
    v_add_f32 v32, v32, v36
    v_add_f32 v40, v40, v44
    v_add_f32 v32, v32, v40
    v_add_f32 v33, v33, v37
    v_add_f32 v41, v41, v45
    v_add_f32 v33, v33, v41
    v_add_f32 v34, v34, v38
    v_add_f32 v42, v42, v46
    v_add_f32 v34, v34, v42
    v_add_f32 v35, v35, v39
    v_add_f32 v43, v43, v47
    v_add_f32 v35, v35, v43
    v_cvt_pk_bf16_f32 v48, v32, v33
    v_cvt_pk_bf16_f32 v49, v34, v35
    s_waitcnt vmcnt(4)

    v_lshlrev_b32 v32, 16, v48
    v_and_b32 v33, 0xffff0000, v48
    v_lshlrev_b32 v34, 16, v49
    v_and_b32 v35, 0xffff0000, v49
    v_lshlrev_b32 v36, 16, v106
    v_and_b32 v37, 0xffff0000, v106
    v_lshlrev_b32 v38, 16, v107
    v_and_b32 v39, 0xffff0000, v107
    v_add_f32 v32, v32, v36
    v_add_f32 v33, v33, v37
    v_add_f32 v34, v34, v38
    v_add_f32 v35, v35, v39
    v_cvt_pk_bf16_f32 v52, v32, v33
    v_cvt_pk_bf16_f32 v53, v34, v35
    buffer_store_dwordx2 v[52:53], v7, s[24:27], s19 offen offset:192
    ds_read_b128 v[32:35], v6 offset:16384
    ds_read_b128 v[36:39], v6 offset:36864
    ds_read_b128 v[40:43], v6 offset:57344
    ds_read_b128 v[44:47], v8 offset:16384
    s_waitcnt lgkmcnt(0)
    v_add_f32 v32, v32, v36
    v_add_f32 v40, v40, v44
    v_add_f32 v32, v32, v40
    v_add_f32 v33, v33, v37
    v_add_f32 v41, v41, v45
    v_add_f32 v33, v33, v41
    v_add_f32 v34, v34, v38
    v_add_f32 v42, v42, v46
    v_add_f32 v34, v34, v42
    v_add_f32 v35, v35, v39
    v_add_f32 v43, v43, v47
    v_add_f32 v35, v35, v43
    v_cvt_pk_bf16_f32 v48, v32, v33
    v_cvt_pk_bf16_f32 v49, v34, v35
    s_waitcnt vmcnt(4)

    v_lshlrev_b32 v32, 16, v48
    v_and_b32 v33, 0xffff0000, v48
    v_lshlrev_b32 v34, 16, v49
    v_and_b32 v35, 0xffff0000, v49
    v_lshlrev_b32 v36, 16, v108
    v_and_b32 v37, 0xffff0000, v108
    v_lshlrev_b32 v38, 16, v109
    v_and_b32 v39, 0xffff0000, v109
    v_add_f32 v32, v32, v36
    v_add_f32 v33, v33, v37
    v_add_f32 v34, v34, v38
    v_add_f32 v35, v35, v39
    v_cvt_pk_bf16_f32 v50, v32, v33
    v_cvt_pk_bf16_f32 v51, v34, v35
    buffer_store_dwordx2 v[50:51], v7, s[24:27], s19 offen offset:256
    s_waitcnt vmcnt(0) lgkmcnt(0)
    s_barrier
BPN_78:
    s_add_u32 s96, s96, 144
    s_branch BPL_76
END_44:
    s_endpgm
.globl tail_kernel
.p2align 8
.type tail_kernel,@function
tail_kernel:
    s_load_dwordx2 s[4:5], s[0:1], 104
    v_lshrrev_b32 v1, 6, v0
    v_and_b32 v2, 63, v0
    v_readfirstlane_b32 s3, v1
    v_lshlrev_b32 v16, 4, v2
    s_cmp_ge_u32 s2, 584
    s_cbranch_scc1 END_84
    s_waitcnt lgkmcnt(0)
    s_mov_b32 s24, s4
    s_and_b32 s25, s5, 0xffff
    s_mov_b32 s26, 0x10000000
    s_mov_b32 s27, 0x00020000
    s_mov_b32 s36, 0
    s_cmp_ge_u32 s2, 48
    s_cbranch_scc1 TU_85
    s_add_u32 s2, s2, 464
    s_mov_b32 s67, s2
    s_lshl_b32 s6, s2, 2
    s_add_u32 s6, s6, s3
    s_lshr_b32 s7, s6, 5
    s_and_b32 s8, s6, 31
    s_lshl_b32 s9, s8, 6
    s_add_u32 s9, s9, s7
    s_lshl_b32 s9, s9, 13
    s_add_u32 s10, s9, 0x1cd4000
    s_add_u32 s11, s9, 0x2cd4000
    s_lshl_b32 s12, s6, 11
    s_add_u32 s12, s12, 0xad5f000
    v_and_b32 v3, 7, v2
    v_lshrrev_b32 v4, 5, v2
    v_lshlrev_b32 v3, 4, v3
    v_lshl_add_u32 v3, v4, 7, v3
    v_add_u32 v17, 0x1000, v16
    buffer_load_dwordx4 v[32:35], v16, s[24:27], s10 offen offset:0
    buffer_load_dwordx4 v[64:67], v16, s[24:27], s11 offen offset:0
    buffer_load_dwordx4 v[96:99], v3, s[24:27], s12 offen offset:0
    buffer_load_dwordx4 v[36:39], v16, s[24:27], s10 offen offset:1024
    buffer_load_dwordx4 v[68:71], v16, s[24:27], s11 offen offset:1024
    buffer_load_dwordx4 v[100:103], v3, s[24:27], s12 offen offset:256
    buffer_load_dwordx4 v[40:43], v16, s[24:27], s10 offen offset:2048
    buffer_load_dwordx4 v[72:75], v16, s[24:27], s11 offen offset:2048
    buffer_load_dwordx4 v[104:107], v3, s[24:27], s12 offen offset:512
    buffer_load_dwordx4 v[44:47], v16, s[24:27], s10 offen offset:3072
    buffer_load_dwordx4 v[76:79], v16, s[24:27], s11 offen offset:3072
    buffer_load_dwordx4 v[108:111], v3, s[24:27], s12 offen offset:768
    buffer_load_dwordx4 v[48:51], v17, s[24:27], s10 offen offset:0
    buffer_load_dwordx4 v[80:83], v17, s[24:27], s11 offen offset:0
    buffer_load_dwordx4 v[112:115], v3, s[24:27], s12 offen offset:1024
    buffer_load_dwordx4 v[52:55], v17, s[24:27], s10 offen offset:1024
    buffer_load_dwordx4 v[84:87], v17, s[24:27], s11 offen offset:1024
    buffer_load_dwordx4 v[116:119], v3, s[24:27], s12 offen offset:1280
    buffer_load_dwordx4 v[56:59], v17, s[24:27], s10 offen offset:2048
    buffer_load_dwordx4 v[88:91], v17, s[24:27], s11 offen offset:2048
    buffer_load_dwordx4 v[120:123], v3, s[24:27], s12 offen offset:1536
    buffer_load_dwordx4 v[60:63], v17, s[24:27], s10 offen offset:3072
    buffer_load_dwordx4 v[92:95], v17, s[24:27], s11 offen offset:3072
    buffer_load_dwordx4 v[124:127], v3, s[24:27], s12 offen offset:1792
    s_waitcnt vmcnt(21)
    v_mfma_f32_32x32x16_bf16 v[128:143], v[64:67], v[32:35], 0
    v_mfma_f32_32x32x16_bf16 v[144:159], v[96:99], v[32:35], 0
    s_waitcnt vmcnt(18)
    v_mfma_f32_32x32x16_bf16 v[128:143], v[68:71], v[36:39], v[128:143]
    v_mfma_f32_32x32x16_bf16 v[144:159], v[100:103], v[36:39], v[144:159]
    s_waitcnt vmcnt(15)
    v_mfma_f32_32x32x16_bf16 v[128:143], v[72:75], v[40:43], v[128:143]
    v_mfma_f32_32x32x16_bf16 v[144:159], v[104:107], v[40:43], v[144:159]
    s_waitcnt vmcnt(12)
    v_mfma_f32_32x32x16_bf16 v[128:143], v[76:79], v[44:47], v[128:143]
    v_mfma_f32_32x32x16_bf16 v[144:159], v[108:111], v[44:47], v[144:159]
    s_waitcnt vmcnt(9)
    v_mfma_f32_32x32x16_bf16 v[128:143], v[80:83], v[48:51], v[128:143]
    v_mfma_f32_32x32x16_bf16 v[144:159], v[112:115], v[48:51], v[144:159]
    s_waitcnt vmcnt(6)
    v_mfma_f32_32x32x16_bf16 v[128:143], v[84:87], v[52:55], v[128:143]
    v_mfma_f32_32x32x16_bf16 v[144:159], v[116:119], v[52:55], v[144:159]
    s_waitcnt vmcnt(3)
    v_mfma_f32_32x32x16_bf16 v[128:143], v[88:91], v[56:59], v[128:143]
    v_mfma_f32_32x32x16_bf16 v[144:159], v[120:123], v[56:59], v[144:159]
    s_waitcnt vmcnt(0)
    v_mfma_f32_32x32x16_bf16 v[128:143], v[92:95], v[60:63], v[128:143]
    v_mfma_f32_32x32x16_bf16 v[144:159], v[124:127], v[60:63], v[144:159]
    v_and_b32 v5, 31, v2
    v_lshlrev_b32 v6, 2, v4
    v_sub_u32 v5, v5, v6
    v_mov_b32 v7, 0xff800000
    s_nop 7
    s_nop 3
    v_cmp_le_i32 vcc, 0, v5
    s_nop 1
    v_cndmask_b32 v128, v7, v128, vcc
    v_cmp_le_i32 vcc, 1, v5
    s_nop 1
    v_cndmask_b32 v129, v7, v129, vcc
    v_cmp_le_i32 vcc, 2, v5
    s_nop 1
    v_cndmask_b32 v130, v7, v130, vcc
    v_cmp_le_i32 vcc, 3, v5
    s_nop 1
    v_cndmask_b32 v131, v7, v131, vcc
    v_cmp_le_i32 vcc, 8, v5
    s_nop 1
    v_cndmask_b32 v132, v7, v132, vcc
    v_cmp_le_i32 vcc, 9, v5
    s_nop 1
    v_cndmask_b32 v133, v7, v133, vcc
    v_cmp_le_i32 vcc, 10, v5
    s_nop 1
    v_cndmask_b32 v134, v7, v134, vcc
    v_cmp_le_i32 vcc, 11, v5
    s_nop 1
    v_cndmask_b32 v135, v7, v135, vcc
    v_cmp_le_i32 vcc, 16, v5
    s_nop 1
    v_cndmask_b32 v136, v7, v136, vcc
    v_cmp_le_i32 vcc, 17, v5
    s_nop 1
    v_cndmask_b32 v137, v7, v137, vcc
    v_cmp_le_i32 vcc, 18, v5
    s_nop 1
    v_cndmask_b32 v138, v7, v138, vcc
    v_cmp_le_i32 vcc, 19, v5
    s_nop 1
    v_cndmask_b32 v139, v7, v139, vcc
    v_cmp_le_i32 vcc, 24, v5
    s_nop 1
    v_cndmask_b32 v140, v7, v140, vcc
    v_cmp_le_i32 vcc, 25, v5
    s_nop 1
    v_cndmask_b32 v141, v7, v141, vcc
    v_cmp_le_i32 vcc, 26, v5
    s_nop 1
    v_cndmask_b32 v142, v7, v142, vcc
    v_cmp_le_i32 vcc, 27, v5
    s_nop 1
    v_cndmask_b32 v143, v7, v143, vcc
    v_max3_f32 v8, v128, v129, v130
    v_max3_f32 v8, v8, v131, v132
    v_max3_f32 v8, v8, v133, v134
    v_max3_f32 v8, v8, v135, v136
    v_max3_f32 v8, v8, v137, v138
    v_max3_f32 v8, v8, v139, v140
    v_max3_f32 v8, v8, v141, v142
    v_max3_f32 v8, v8, v143, v144
    v_max3_f32 v8, v8, v145, v146
    v_max_f32 v8, v8, v147
    v_mov_b32 v9, v8
    s_nop 1
    v_permlane32_swap_b32 v9, v8
    s_nop 1
    v_max_f32 v8, v8, v9
    s_mov_b32 s13, 0x3e0293ee
    v_mul_f32 v8, s13, v8
    v_fma_f32 v128, v128, s13, -v8
    v_fma_f32 v129, v129, s13, -v8
    v_fma_f32 v130, v130, s13, -v8
    v_fma_f32 v131, v131, s13, -v8
    v_fma_f32 v132, v132, s13, -v8
    v_fma_f32 v133, v133, s13, -v8
    v_fma_f32 v134, v134, s13, -v8
    v_fma_f32 v135, v135, s13, -v8
    v_fma_f32 v136, v136, s13, -v8
    v_fma_f32 v137, v137, s13, -v8
    v_fma_f32 v138, v138, s13, -v8
    v_fma_f32 v139, v139, s13, -v8
    v_fma_f32 v140, v140, s13, -v8
    v_fma_f32 v141, v141, s13, -v8
    v_fma_f32 v142, v142, s13, -v8
    v_fma_f32 v143, v143, s13, -v8
    v_fma_f32 v144, v144, s13, -v8
    v_fma_f32 v145, v145, s13, -v8
    v_fma_f32 v146, v146, s13, -v8
    v_fma_f32 v147, v147, s13, -v8
    v_exp_f32 v128, v128
    v_exp_f32 v129, v129
    v_exp_f32 v130, v130
    v_exp_f32 v131, v131
    v_exp_f32 v132, v132
    v_exp_f32 v133, v133
    v_exp_f32 v134, v134
    v_exp_f32 v135, v135
    v_exp_f32 v136, v136
    v_exp_f32 v137, v137
    v_exp_f32 v138, v138
    v_exp_f32 v139, v139
    v_exp_f32 v140, v140
    v_exp_f32 v141, v141
    v_exp_f32 v142, v142
    v_exp_f32 v143, v143
    v_exp_f32 v144, v144
    v_exp_f32 v145, v145
    v_exp_f32 v146, v146
    v_exp_f32 v147, v147
    s_nop 0
    v_add_f32 v9, v128, v129
    v_add_f32 v9, v9, v130
    v_add_f32 v9, v9, v131
    v_add_f32 v9, v9, v132
    v_add_f32 v9, v9, v133
    v_add_f32 v9, v9, v134
    v_add_f32 v9, v9, v135
    v_add_f32 v9, v9, v136
    v_add_f32 v9, v9, v137
    v_add_f32 v9, v9, v138
    v_add_f32 v9, v9, v139
    v_add_f32 v9, v9, v140
    v_add_f32 v9, v9, v141
    v_add_f32 v9, v9, v142
    v_add_f32 v9, v9, v143
    v_add_f32 v9, v9, v144
    v_add_f32 v9, v9, v145
    v_add_f32 v9, v9, v146
    v_add_f32 v9, v9, v147
    v_mov_b32 v10, v9
    s_nop 1
    v_permlane32_swap_b32 v10, v9
    s_nop 1
    v_add_f32 v9, v9, v10
    v_rcp_f32 v9, v9
    s_nop 0
    v_mul_f32 v128, v128, v9
    v_mul_f32 v129, v129, v9
    v_mul_f32 v130, v130, v9
    v_mul_f32 v131, v131, v9
    v_mul_f32 v132, v132, v9
    v_mul_f32 v133, v133, v9
    v_mul_f32 v134, v134, v9
    v_mul_f32 v135, v135, v9
    v_mul_f32 v136, v136, v9
    v_mul_f32 v137, v137, v9
    v_mul_f32 v138, v138, v9
    v_mul_f32 v139, v139, v9
    v_mul_f32 v140, v140, v9
    v_mul_f32 v141, v141, v9
    v_mul_f32 v142, v142, v9
    v_mul_f32 v143, v143, v9
    v_mul_f32 v144, v144, v9
    v_mul_f32 v145, v145, v9
    v_mul_f32 v146, v146, v9
    v_mul_f32 v147, v147, v9
    v_cvt_pk_bf16_f32 v32, v128, v129
    v_cvt_pk_bf16_f32 v33, v130, v131
    v_cvt_pk_bf16_f32 v34, v132, v133
    v_cvt_pk_bf16_f32 v35, v134, v135
    v_cvt_pk_bf16_f32 v36, v136, v137
    v_cvt_pk_bf16_f32 v37, v138, v139
    v_cvt_pk_bf16_f32 v38, v140, v141
    v_cvt_pk_bf16_f32 v39, v142, v143
    v_cvt_pk_bf16_f32 v40, v144, v145
    v_cvt_pk_bf16_f32 v41, v146, v147
    v_mov_b32 v42, 0
    v_mov_b32 v43, 0
    s_mul_i32 s14, s6, 3072
    s_add_u32 s14, s14, 0xd3af000
    buffer_store_dwordx4 v[32:35], v16, s[24:27], s14 offen offset:0 sc1
    buffer_store_dwordx4 v[36:39], v16, s[24:27], s14 offen offset:1024 sc1
    buffer_store_dwordx4 v[40:43], v16, s[24:27], s14 offen offset:2048 sc1
    s_waitcnt vmcnt(0)
    s_barrier
    s_cmp_lg_u32 s3, 0
    s_cbranch_scc1 END_84
    s_lshl_b32 s6, s67, 2
    s_add_u32 s6, s6, 0xad5e800
    v_mov_b32 v17, 0
    s_mov_b64 exec, 1
    buffer_store_dword v17, v17, s[24:27], s6 offen sc1
    s_branch END_84
TU_85:
    s_cmp_ge_u32 s2, 72
    s_cbranch_scc1 TL_86
    s_sub_u32 s67, s2, 48
    s_add_u32 s2, s67, 232
    s_lshr_b32 s69, s2, 2
    s_lshl_b32 s69, s69, 5
    s_add_u32 s69, s69, 0xad5e800
    v_and_b32 v19, 7, v2
    v_lshlrev_b32 v19, 2, v19
    s_load_dwordx2 s[8:9], s[0:1], 0
    s_lshr_b32 s6, s2, 2
    s_and_b32 s7, s2, 3
    s_lshl_b32 s10, s6, 5
    s_lshl_b32 s11, s3, 3
    s_add_u32 s10, s10, s11
    s_mul_i32 s12, s10, 20
    s_mul_i32 s13, s7, 5
    s_add_u32 s12, s12, s13
    s_lshl_b32 s12, s12, 11
    s_add_u32 s12, s12, 0x3cd4000
    s_mul_i32 s14, s10, 10240
    s_mul_i32 s13, s7, 2560
    s_add_u32 s14, s14, s13
    s_add_u32 s14, s14, 0xb15f000
    v_and_b32 v3, 31, v2
    v_lshrrev_b32 v4, 5, v2
    v_lshlrev_b32 v5, 4, v3
    v_lshl_add_u32 v5, v4, 3, v5
    s_mul_i32 s15, s10, 3072
    s_add_u32 s15, s15, 0xd3af000
    s_cmp_lg_u32 s3, 0
    s_cbranch_scc1 TO_89
TW_88:
    buffer_load_dword v18, v19, s[24:27], s69 offen sc1
    s_waitcnt vmcnt(0)
    v_cmp_eq_u32 vcc, -1, v18
    s_cbranch_vccz TO_89
    s_add_u32 s36, s36, 1
    s_cmp_gt_u32 s36, 0x40000
    s_cbranch_scc1 END_84
    s_sleep 2
    s_branch TW_88
TO_89:
    s_barrier
    s_waitcnt vmcnt(0)
    v_mov_b32 v86, 0
    v_mov_b32 v87, 0
    v_mov_b32 v90, 0
    v_mov_b32 v91, 0
    v_mov_b32 v94, 0
    v_mov_b32 v95, 0
    v_mov_b32 v98, 0
    v_mov_b32 v99, 0
    v_mov_b32 v102, 0
    v_mov_b32 v103, 0
    v_mov_b32 v162, 0
    v_mov_b32 v163, 0
    v_mov_b32 v166, 0
    v_mov_b32 v167, 0
    v_mov_b32 v170, 0
    v_mov_b32 v171, 0
    v_mov_b32 v174, 0
    v_mov_b32 v175, 0
    v_mov_b32 v178, 0
    v_mov_b32 v179, 0
    buffer_load_dwordx4 v[32:35], v16, s[24:27], s15 offen offset:0
    buffer_load_dwordx4 v[36:39], v16, s[24:27], s15 offen offset:1024
    buffer_load_dwordx4 v[40:43], v16, s[24:27], s15 offen offset:2048
    s_add_u32 s16, s12, 0
    buffer_load_dwordx4 v[44:47], v16, s[24:27], s16 offen offset:0
    buffer_load_dwordx4 v[48:51], v16, s[24:27], s16 offen offset:1024
    buffer_load_dwordx2 v[84:85], v5, s[24:27], s14 offen offset:0
    s_add_u32 s16, s12, 2048
    buffer_load_dwordx4 v[52:55], v16, s[24:27], s16 offen offset:0
    buffer_load_dwordx4 v[56:59], v16, s[24:27], s16 offen offset:1024
    buffer_load_dwordx2 v[88:89], v5, s[24:27], s14 offen offset:512
    s_add_u32 s16, s12, 4096
    buffer_load_dwordx4 v[60:63], v16, s[24:27], s16 offen offset:0
    buffer_load_dwordx4 v[64:67], v16, s[24:27], s16 offen offset:1024
    buffer_load_dwordx2 v[92:93], v5, s[24:27], s14 offen offset:1024
    s_add_u32 s16, s12, 6144
    buffer_load_dwordx4 v[68:71], v16, s[24:27], s16 offen offset:0
    buffer_load_dwordx4 v[72:75], v16, s[24:27], s16 offen offset:1024
    buffer_load_dwordx2 v[96:97], v5, s[24:27], s14 offen offset:1536
    s_add_u32 s16, s12, 8192
    buffer_load_dwordx4 v[76:79], v16, s[24:27], s16 offen offset:0
    buffer_load_dwordx4 v[80:83], v16, s[24:27], s16 offen offset:1024
    buffer_load_dwordx2 v[100:101], v5, s[24:27], s14 offen offset:2048
    s_add_u32 s15, s15, 3072
    s_add_u32 s12, s12, 40960
    s_add_u32 s14, s14, 10240
    buffer_load_dwordx4 v[108:111], v16, s[24:27], s15 offen offset:0
    buffer_load_dwordx4 v[112:115], v16, s[24:27], s15 offen offset:1024
    buffer_load_dwordx4 v[116:119], v16, s[24:27], s15 offen offset:2048
    s_add_u32 s16, s12, 0
    buffer_load_dwordx4 v[120:123], v16, s[24:27], s16 offen offset:0
    buffer_load_dwordx4 v[124:127], v16, s[24:27], s16 offen offset:1024
    buffer_load_dwordx2 v[160:161], v5, s[24:27], s14 offen offset:0
    s_add_u32 s16, s12, 2048
    buffer_load_dwordx4 v[128:131], v16, s[24:27], s16 offen offset:0
    buffer_load_dwordx4 v[132:135], v16, s[24:27], s16 offen offset:1024
    buffer_load_dwordx2 v[164:165], v5, s[24:27], s14 offen offset:512
    s_add_u32 s16, s12, 4096
    buffer_load_dwordx4 v[136:139], v16, s[24:27], s16 offen offset:0
    buffer_load_dwordx4 v[140:143], v16, s[24:27], s16 offen offset:1024
    buffer_load_dwordx2 v[168:169], v5, s[24:27], s14 offen offset:1024
    s_add_u32 s16, s12, 6144
    buffer_load_dwordx4 v[144:147], v16, s[24:27], s16 offen offset:0
    buffer_load_dwordx4 v[148:151], v16, s[24:27], s16 offen offset:1024
    buffer_load_dwordx2 v[172:173], v5, s[24:27], s14 offen offset:1536
    s_add_u32 s16, s12, 8192
    buffer_load_dwordx4 v[152:155], v16, s[24:27], s16 offen offset:0
    buffer_load_dwordx4 v[156:159], v16, s[24:27], s16 offen offset:1024
    buffer_load_dwordx2 v[176:177], v5, s[24:27], s14 offen offset:2048
    s_add_u32 s15, s15, 3072
    s_add_u32 s12, s12, 40960
    s_add_u32 s14, s14, 10240
    s_waitcnt vmcnt(18)
    v_mfma_f32_32x32x16_bf16 a[0:15], v[44:47], v[32:35], 0
    v_mfma_f32_32x32x16_bf16 a[16:31], v[52:55], v[32:35], 0
    v_mfma_f32_32x32x16_bf16 a[32:47], v[60:63], v[32:35], 0
    v_mfma_f32_32x32x16_bf16 a[48:63], v[68:71], v[32:35], 0
    v_mfma_f32_32x32x16_bf16 a[64:79], v[76:79], v[32:35], 0
    v_mfma_f32_32x32x16_bf16 a[0:15], v[48:51], v[36:39], a[0:15]
    v_mfma_f32_32x32x16_bf16 a[16:31], v[56:59], v[36:39], a[16:31]
    v_mfma_f32_32x32x16_bf16 a[32:47], v[64:67], v[36:39], a[32:47]
    v_mfma_f32_32x32x16_bf16 a[48:63], v[72:75], v[36:39], a[48:63]
    v_mfma_f32_32x32x16_bf16 a[64:79], v[80:83], v[36:39], a[64:79]
    v_mfma_f32_32x32x16_bf16 a[0:15], v[84:87], v[40:43], a[0:15]
    v_mfma_f32_32x32x16_bf16 a[16:31], v[88:91], v[40:43], a[16:31]
    v_mfma_f32_32x32x16_bf16 a[32:47], v[92:95], v[40:43], a[32:47]
    v_mfma_f32_32x32x16_bf16 a[48:63], v[96:99], v[40:43], a[48:63]
    v_mfma_f32_32x32x16_bf16 a[64:79], v[100:103], v[40:43], a[64:79]
    buffer_load_dwordx4 v[32:35], v16, s[24:27], s15 offen offset:0
    buffer_load_dwordx4 v[36:39], v16, s[24:27], s15 offen offset:1024
    buffer_load_dwordx4 v[40:43], v16, s[24:27], s15 offen offset:2048
    s_add_u32 s16, s12, 0
    buffer_load_dwordx4 v[44:47], v16, s[24:27], s16 offen offset:0
    buffer_load_dwordx4 v[48:51], v16, s[24:27], s16 offen offset:1024
    buffer_load_dwordx2 v[84:85], v5, s[24:27], s14 offen offset:0
    s_add_u32 s16, s12, 2048
    buffer_load_dwordx4 v[52:55], v16, s[24:27], s16 offen offset:0
    buffer_load_dwordx4 v[56:59], v16, s[24:27], s16 offen offset:1024
    buffer_load_dwordx2 v[88:89], v5, s[24:27], s14 offen offset:512
    s_add_u32 s16, s12, 4096
    buffer_load_dwordx4 v[60:63], v16, s[24:27], s16 offen offset:0
    buffer_load_dwordx4 v[64:67], v16, s[24:27], s16 offen offset:1024
    buffer_load_dwordx2 v[92:93], v5, s[24:27], s14 offen offset:1024
    s_add_u32 s16, s12, 6144
    buffer_load_dwordx4 v[68:71], v16, s[24:27], s16 offen offset:0
    buffer_load_dwordx4 v[72:75], v16, s[24:27], s16 offen offset:1024
    buffer_load_dwordx2 v[96:97], v5, s[24:27], s14 offen offset:1536
    s_add_u32 s16, s12, 8192
    buffer_load_dwordx4 v[76:79], v16, s[24:27], s16 offen offset:0
    buffer_load_dwordx4 v[80:83], v16, s[24:27], s16 offen offset:1024
    buffer_load_dwordx2 v[100:101], v5, s[24:27], s14 offen offset:2048
    s_add_u32 s15, s15, 3072
    s_add_u32 s12, s12, 40960
    s_add_u32 s14, s14, 10240
    s_waitcnt vmcnt(18)
    v_mfma_f32_32x32x16_bf16 a[0:15], v[120:123], v[108:111], a[0:15]
    v_mfma_f32_32x32x16_bf16 a[16:31], v[128:131], v[108:111], a[16:31]
    v_mfma_f32_32x32x16_bf16 a[32:47], v[136:139], v[108:111], a[32:47]
    v_mfma_f32_32x32x16_bf16 a[48:63], v[144:147], v[108:111], a[48:63]
    v_mfma_f32_32x32x16_bf16 a[64:79], v[152:155], v[108:111], a[64:79]
    v_mfma_f32_32x32x16_bf16 a[0:15], v[124:127], v[112:115], a[0:15]
    v_mfma_f32_32x32x16_bf16 a[16:31], v[132:135], v[112:115], a[16:31]
    v_mfma_f32_32x32x16_bf16 a[32:47], v[140:143], v[112:115], a[32:47]
    v_mfma_f32_32x32x16_bf16 a[48:63], v[148:151], v[112:115], a[48:63]
    v_mfma_f32_32x32x16_bf16 a[64:79], v[156:159], v[112:115], a[64:79]
    v_mfma_f32_32x32x16_bf16 a[0:15], v[160:163], v[116:119], a[0:15]
    v_mfma_f32_32x32x16_bf16 a[16:31], v[164:167], v[116:119], a[16:31]
    v_mfma_f32_32x32x16_bf16 a[32:47], v[168:171], v[116:119], a[32:47]
    v_mfma_f32_32x32x16_bf16 a[48:63], v[172:175], v[116:119], a[48:63]
    v_mfma_f32_32x32x16_bf16 a[64:79], v[176:179], v[116:119], a[64:79]
    buffer_load_dwordx4 v[108:111], v16, s[24:27], s15 offen offset:0
    buffer_load_dwordx4 v[112:115], v16, s[24:27], s15 offen offset:1024
    buffer_load_dwordx4 v[116:119], v16, s[24:27], s15 offen offset:2048
    s_add_u32 s16, s12, 0
    buffer_load_dwordx4 v[120:123], v16, s[24:27], s16 offen offset:0
    buffer_load_dwordx4 v[124:127], v16, s[24:27], s16 offen offset:1024
    buffer_load_dwordx2 v[160:161], v5, s[24:27], s14 offen offset:0
    s_add_u32 s16, s12, 2048
    buffer_load_dwordx4 v[128:131], v16, s[24:27], s16 offen offset:0
    buffer_load_dwordx4 v[132:135], v16, s[24:27], s16 offen offset:1024
    buffer_load_dwordx2 v[164:165], v5, s[24:27], s14 offen offset:512
    s_add_u32 s16, s12, 4096
    buffer_load_dwordx4 v[136:139], v16, s[24:27], s16 offen offset:0
    buffer_load_dwordx4 v[140:143], v16, s[24:27], s16 offen offset:1024
    buffer_load_dwordx2 v[168:169], v5, s[24:27], s14 offen offset:1024
    s_add_u32 s16, s12, 6144
    buffer_load_dwordx4 v[144:147], v16, s[24:27], s16 offen offset:0
    buffer_load_dwordx4 v[148:151], v16, s[24:27], s16 offen offset:1024
    buffer_load_dwordx2 v[172:173], v5, s[24:27], s14 offen offset:1536
    s_add_u32 s16, s12, 8192
    buffer_load_dwordx4 v[152:155], v16, s[24:27], s16 offen offset:0
    buffer_load_dwordx4 v[156:159], v16, s[24:27], s16 offen offset:1024
    buffer_load_dwordx2 v[176:177], v5, s[24:27], s14 offen offset:2048
    s_add_u32 s15, s15, 3072
    s_add_u32 s12, s12, 40960
    s_add_u32 s14, s14, 10240
    s_waitcnt vmcnt(18)
    v_mfma_f32_32x32x16_bf16 a[0:15], v[44:47], v[32:35], a[0:15]
    v_mfma_f32_32x32x16_bf16 a[16:31], v[52:55], v[32:35], a[16:31]
    v_mfma_f32_32x32x16_bf16 a[32:47], v[60:63], v[32:35], a[32:47]
    v_mfma_f32_32x32x16_bf16 a[48:63], v[68:71], v[32:35], a[48:63]
    v_mfma_f32_32x32x16_bf16 a[64:79], v[76:79], v[32:35], a[64:79]
    v_mfma_f32_32x32x16_bf16 a[0:15], v[48:51], v[36:39], a[0:15]
    v_mfma_f32_32x32x16_bf16 a[16:31], v[56:59], v[36:39], a[16:31]
    v_mfma_f32_32x32x16_bf16 a[32:47], v[64:67], v[36:39], a[32:47]
    v_mfma_f32_32x32x16_bf16 a[48:63], v[72:75], v[36:39], a[48:63]
    v_mfma_f32_32x32x16_bf16 a[64:79], v[80:83], v[36:39], a[64:79]
    v_mfma_f32_32x32x16_bf16 a[0:15], v[84:87], v[40:43], a[0:15]
    v_mfma_f32_32x32x16_bf16 a[16:31], v[88:91], v[40:43], a[16:31]
    v_mfma_f32_32x32x16_bf16 a[32:47], v[92:95], v[40:43], a[32:47]
    v_mfma_f32_32x32x16_bf16 a[48:63], v[96:99], v[40:43], a[48:63]
    v_mfma_f32_32x32x16_bf16 a[64:79], v[100:103], v[40:43], a[64:79]
    buffer_load_dwordx4 v[32:35], v16, s[24:27], s15 offen offset:0
    buffer_load_dwordx4 v[36:39], v16, s[24:27], s15 offen offset:1024
    buffer_load_dwordx4 v[40:43], v16, s[24:27], s15 offen offset:2048
    s_add_u32 s16, s12, 0
    buffer_load_dwordx4 v[44:47], v16, s[24:27], s16 offen offset:0
    buffer_load_dwordx4 v[48:51], v16, s[24:27], s16 offen offset:1024
    buffer_load_dwordx2 v[84:85], v5, s[24:27], s14 offen offset:0
    s_add_u32 s16, s12, 2048
    buffer_load_dwordx4 v[52:55], v16, s[24:27], s16 offen offset:0
    buffer_load_dwordx4 v[56:59], v16, s[24:27], s16 offen offset:1024
    buffer_load_dwordx2 v[88:89], v5, s[24:27], s14 offen offset:512
    s_add_u32 s16, s12, 4096
    buffer_load_dwordx4 v[60:63], v16, s[24:27], s16 offen offset:0
    buffer_load_dwordx4 v[64:67], v16, s[24:27], s16 offen offset:1024
    buffer_load_dwordx2 v[92:93], v5, s[24:27], s14 offen offset:1024
    s_add_u32 s16, s12, 6144
    buffer_load_dwordx4 v[68:71], v16, s[24:27], s16 offen offset:0
    buffer_load_dwordx4 v[72:75], v16, s[24:27], s16 offen offset:1024
    buffer_load_dwordx2 v[96:97], v5, s[24:27], s14 offen offset:1536
    s_add_u32 s16, s12, 8192
    buffer_load_dwordx4 v[76:79], v16, s[24:27], s16 offen offset:0
    buffer_load_dwordx4 v[80:83], v16, s[24:27], s16 offen offset:1024
    buffer_load_dwordx2 v[100:101], v5, s[24:27], s14 offen offset:2048
    s_add_u32 s15, s15, 3072
    s_add_u32 s12, s12, 40960
    s_add_u32 s14, s14, 10240
    s_waitcnt vmcnt(18)
    v_mfma_f32_32x32x16_bf16 a[0:15], v[120:123], v[108:111], a[0:15]
    v_mfma_f32_32x32x16_bf16 a[16:31], v[128:131], v[108:111], a[16:31]
    v_mfma_f32_32x32x16_bf16 a[32:47], v[136:139], v[108:111], a[32:47]
    v_mfma_f32_32x32x16_bf16 a[48:63], v[144:147], v[108:111], a[48:63]
    v_mfma_f32_32x32x16_bf16 a[64:79], v[152:155], v[108:111], a[64:79]
    v_mfma_f32_32x32x16_bf16 a[0:15], v[124:127], v[112:115], a[0:15]
    v_mfma_f32_32x32x16_bf16 a[16:31], v[132:135], v[112:115], a[16:31]
    v_mfma_f32_32x32x16_bf16 a[32:47], v[140:143], v[112:115], a[32:47]
    v_mfma_f32_32x32x16_bf16 a[48:63], v[148:151], v[112:115], a[48:63]
    v_mfma_f32_32x32x16_bf16 a[64:79], v[156:159], v[112:115], a[64:79]
    v_mfma_f32_32x32x16_bf16 a[0:15], v[160:163], v[116:119], a[0:15]
    v_mfma_f32_32x32x16_bf16 a[16:31], v[164:167], v[116:119], a[16:31]
    v_mfma_f32_32x32x16_bf16 a[32:47], v[168:171], v[116:119], a[32:47]
    v_mfma_f32_32x32x16_bf16 a[48:63], v[172:175], v[116:119], a[48:63]
    v_mfma_f32_32x32x16_bf16 a[64:79], v[176:179], v[116:119], a[64:79]
    buffer_load_dwordx4 v[108:111], v16, s[24:27], s15 offen offset:0
    buffer_load_dwordx4 v[112:115], v16, s[24:27], s15 offen offset:1024
    buffer_load_dwordx4 v[116:119], v16, s[24:27], s15 offen offset:2048
    s_add_u32 s16, s12, 0
    buffer_load_dwordx4 v[120:123], v16, s[24:27], s16 offen offset:0
    buffer_load_dwordx4 v[124:127], v16, s[24:27], s16 offen offset:1024
    buffer_load_dwordx2 v[160:161], v5, s[24:27], s14 offen offset:0
    s_add_u32 s16, s12, 2048
    buffer_load_dwordx4 v[128:131], v16, s[24:27], s16 offen offset:0
    buffer_load_dwordx4 v[132:135], v16, s[24:27], s16 offen offset:1024
    buffer_load_dwordx2 v[164:165], v5, s[24:27], s14 offen offset:512
    s_add_u32 s16, s12, 4096
    buffer_load_dwordx4 v[136:139], v16, s[24:27], s16 offen offset:0
    buffer_load_dwordx4 v[140:143], v16, s[24:27], s16 offen offset:1024
    buffer_load_dwordx2 v[168:169], v5, s[24:27], s14 offen offset:1024
    s_add_u32 s16, s12, 6144
    buffer_load_dwordx4 v[144:147], v16, s[24:27], s16 offen offset:0
    buffer_load_dwordx4 v[148:151], v16, s[24:27], s16 offen offset:1024
    buffer_load_dwordx2 v[172:173], v5, s[24:27], s14 offen offset:1536
    s_add_u32 s16, s12, 8192
    buffer_load_dwordx4 v[152:155], v16, s[24:27], s16 offen offset:0
    buffer_load_dwordx4 v[156:159], v16, s[24:27], s16 offen offset:1024
    buffer_load_dwordx2 v[176:177], v5, s[24:27], s14 offen offset:2048
    s_add_u32 s15, s15, 3072
    s_add_u32 s12, s12, 40960
    s_add_u32 s14, s14, 10240
    s_waitcnt vmcnt(18)
    v_mfma_f32_32x32x16_bf16 a[0:15], v[44:47], v[32:35], a[0:15]
    v_mfma_f32_32x32x16_bf16 a[16:31], v[52:55], v[32:35], a[16:31]
    v_mfma_f32_32x32x16_bf16 a[32:47], v[60:63], v[32:35], a[32:47]
    v_mfma_f32_32x32x16_bf16 a[48:63], v[68:71], v[32:35], a[48:63]
    v_mfma_f32_32x32x16_bf16 a[64:79], v[76:79], v[32:35], a[64:79]
    v_mfma_f32_32x32x16_bf16 a[0:15], v[48:51], v[36:39], a[0:15]
    v_mfma_f32_32x32x16_bf16 a[16:31], v[56:59], v[36:39], a[16:31]
    v_mfma_f32_32x32x16_bf16 a[32:47], v[64:67], v[36:39], a[32:47]
    v_mfma_f32_32x32x16_bf16 a[48:63], v[72:75], v[36:39], a[48:63]
    v_mfma_f32_32x32x16_bf16 a[64:79], v[80:83], v[36:39], a[64:79]
    v_mfma_f32_32x32x16_bf16 a[0:15], v[84:87], v[40:43], a[0:15]
    v_mfma_f32_32x32x16_bf16 a[16:31], v[88:91], v[40:43], a[16:31]
    v_mfma_f32_32x32x16_bf16 a[32:47], v[92:95], v[40:43], a[32:47]
    v_mfma_f32_32x32x16_bf16 a[48:63], v[96:99], v[40:43], a[48:63]
    v_mfma_f32_32x32x16_bf16 a[64:79], v[100:103], v[40:43], a[64:79]
    buffer_load_dwordx4 v[32:35], v16, s[24:27], s15 offen offset:0
    buffer_load_dwordx4 v[36:39], v16, s[24:27], s15 offen offset:1024
    buffer_load_dwordx4 v[40:43], v16, s[24:27], s15 offen offset:2048
    s_add_u32 s16, s12, 0
    buffer_load_dwordx4 v[44:47], v16, s[24:27], s16 offen offset:0
    buffer_load_dwordx4 v[48:51], v16, s[24:27], s16 offen offset:1024
    buffer_load_dwordx2 v[84:85], v5, s[24:27], s14 offen offset:0
    s_add_u32 s16, s12, 2048
    buffer_load_dwordx4 v[52:55], v16, s[24:27], s16 offen offset:0
    buffer_load_dwordx4 v[56:59], v16, s[24:27], s16 offen offset:1024
    buffer_load_dwordx2 v[88:89], v5, s[24:27], s14 offen offset:512
    s_add_u32 s16, s12, 4096
    buffer_load_dwordx4 v[60:63], v16, s[24:27], s16 offen offset:0
    buffer_load_dwordx4 v[64:67], v16, s[24:27], s16 offen offset:1024
    buffer_load_dwordx2 v[92:93], v5, s[24:27], s14 offen offset:1024
    s_add_u32 s16, s12, 6144
    buffer_load_dwordx4 v[68:71], v16, s[24:27], s16 offen offset:0
    buffer_load_dwordx4 v[72:75], v16, s[24:27], s16 offen offset:1024
    buffer_load_dwordx2 v[96:97], v5, s[24:27], s14 offen offset:1536
    s_add_u32 s16, s12, 8192
    buffer_load_dwordx4 v[76:79], v16, s[24:27], s16 offen offset:0
    buffer_load_dwordx4 v[80:83], v16, s[24:27], s16 offen offset:1024
    buffer_load_dwordx2 v[100:101], v5, s[24:27], s14 offen offset:2048
    s_add_u32 s15, s15, 3072
    s_add_u32 s12, s12, 40960
    s_add_u32 s14, s14, 10240
    s_waitcnt vmcnt(18)
    v_mfma_f32_32x32x16_bf16 a[0:15], v[120:123], v[108:111], a[0:15]
    v_mfma_f32_32x32x16_bf16 a[16:31], v[128:131], v[108:111], a[16:31]
    v_mfma_f32_32x32x16_bf16 a[32:47], v[136:139], v[108:111], a[32:47]
    v_mfma_f32_32x32x16_bf16 a[48:63], v[144:147], v[108:111], a[48:63]
    v_mfma_f32_32x32x16_bf16 a[64:79], v[152:155], v[108:111], a[64:79]
    v_mfma_f32_32x32x16_bf16 a[0:15], v[124:127], v[112:115], a[0:15]
    v_mfma_f32_32x32x16_bf16 a[16:31], v[132:135], v[112:115], a[16:31]
    v_mfma_f32_32x32x16_bf16 a[32:47], v[140:143], v[112:115], a[32:47]
    v_mfma_f32_32x32x16_bf16 a[48:63], v[148:151], v[112:115], a[48:63]
    v_mfma_f32_32x32x16_bf16 a[64:79], v[156:159], v[112:115], a[64:79]
    v_mfma_f32_32x32x16_bf16 a[0:15], v[160:163], v[116:119], a[0:15]
    v_mfma_f32_32x32x16_bf16 a[16:31], v[164:167], v[116:119], a[16:31]
    v_mfma_f32_32x32x16_bf16 a[32:47], v[168:171], v[116:119], a[32:47]
    v_mfma_f32_32x32x16_bf16 a[48:63], v[172:175], v[116:119], a[48:63]
    v_mfma_f32_32x32x16_bf16 a[64:79], v[176:179], v[116:119], a[64:79]
    buffer_load_dwordx4 v[108:111], v16, s[24:27], s15 offen offset:0
    buffer_load_dwordx4 v[112:115], v16, s[24:27], s15 offen offset:1024
    buffer_load_dwordx4 v[116:119], v16, s[24:27], s15 offen offset:2048
    s_add_u32 s16, s12, 0
    buffer_load_dwordx4 v[120:123], v16, s[24:27], s16 offen offset:0
    buffer_load_dwordx4 v[124:127], v16, s[24:27], s16 offen offset:1024
    buffer_load_dwordx2 v[160:161], v5, s[24:27], s14 offen offset:0
    s_add_u32 s16, s12, 2048
    buffer_load_dwordx4 v[128:131], v16, s[24:27], s16 offen offset:0
    buffer_load_dwordx4 v[132:135], v16, s[24:27], s16 offen offset:1024
    buffer_load_dwordx2 v[164:165], v5, s[24:27], s14 offen offset:512
    s_add_u32 s16, s12, 4096
    buffer_load_dwordx4 v[136:139], v16, s[24:27], s16 offen offset:0
    buffer_load_dwordx4 v[140:143], v16, s[24:27], s16 offen offset:1024
    buffer_load_dwordx2 v[168:169], v5, s[24:27], s14 offen offset:1024
    s_add_u32 s16, s12, 6144
    buffer_load_dwordx4 v[144:147], v16, s[24:27], s16 offen offset:0
    buffer_load_dwordx4 v[148:151], v16, s[24:27], s16 offen offset:1024
    buffer_load_dwordx2 v[172:173], v5, s[24:27], s14 offen offset:1536
    s_add_u32 s16, s12, 8192
    buffer_load_dwordx4 v[152:155], v16, s[24:27], s16 offen offset:0
    buffer_load_dwordx4 v[156:159], v16, s[24:27], s16 offen offset:1024
    buffer_load_dwordx2 v[176:177], v5, s[24:27], s14 offen offset:2048
    s_add_u32 s15, s15, 3072
    s_add_u32 s12, s12, 40960
    s_add_u32 s14, s14, 10240
    s_waitcnt vmcnt(18)
    v_mfma_f32_32x32x16_bf16 a[0:15], v[44:47], v[32:35], a[0:15]
    v_mfma_f32_32x32x16_bf16 a[16:31], v[52:55], v[32:35], a[16:31]
    v_mfma_f32_32x32x16_bf16 a[32:47], v[60:63], v[32:35], a[32:47]
    v_mfma_f32_32x32x16_bf16 a[48:63], v[68:71], v[32:35], a[48:63]
    v_mfma_f32_32x32x16_bf16 a[64:79], v[76:79], v[32:35], a[64:79]
    v_mfma_f32_32x32x16_bf16 a[0:15], v[48:51], v[36:39], a[0:15]
    v_mfma_f32_32x32x16_bf16 a[16:31], v[56:59], v[36:39], a[16:31]
    v_mfma_f32_32x32x16_bf16 a[32:47], v[64:67], v[36:39], a[32:47]
    v_mfma_f32_32x32x16_bf16 a[48:63], v[72:75], v[36:39], a[48:63]
    v_mfma_f32_32x32x16_bf16 a[64:79], v[80:83], v[36:39], a[64:79]
    v_mfma_f32_32x32x16_bf16 a[0:15], v[84:87], v[40:43], a[0:15]
    v_mfma_f32_32x32x16_bf16 a[16:31], v[88:91], v[40:43], a[16:31]
    v_mfma_f32_32x32x16_bf16 a[32:47], v[92:95], v[40:43], a[32:47]
    v_mfma_f32_32x32x16_bf16 a[48:63], v[96:99], v[40:43], a[48:63]
    v_mfma_f32_32x32x16_bf16 a[64:79], v[100:103], v[40:43], a[64:79]
    s_waitcnt vmcnt(0)
    v_mfma_f32_32x32x16_bf16 a[0:15], v[120:123], v[108:111], a[0:15]
    v_mfma_f32_32x32x16_bf16 a[16:31], v[128:131], v[108:111], a[16:31]
    v_mfma_f32_32x32x16_bf16 a[32:47], v[136:139], v[108:111], a[32:47]
    v_mfma_f32_32x32x16_bf16 a[48:63], v[144:147], v[108:111], a[48:63]
    v_mfma_f32_32x32x16_bf16 a[64:79], v[152:155], v[108:111], a[64:79]
    v_mfma_f32_32x32x16_bf16 a[0:15], v[124:127], v[112:115], a[0:15]
    v_mfma_f32_32x32x16_bf16 a[16:31], v[132:135], v[112:115], a[16:31]
    v_mfma_f32_32x32x16_bf16 a[32:47], v[140:143], v[112:115], a[32:47]
    v_mfma_f32_32x32x16_bf16 a[48:63], v[148:151], v[112:115], a[48:63]
    v_mfma_f32_32x32x16_bf16 a[64:79], v[156:159], v[112:115], a[64:79]
    v_mfma_f32_32x32x16_bf16 a[0:15], v[160:163], v[116:119], a[0:15]
    v_mfma_f32_32x32x16_bf16 a[16:31], v[164:167], v[116:119], a[16:31]
    v_mfma_f32_32x32x16_bf16 a[32:47], v[168:171], v[116:119], a[32:47]
    v_mfma_f32_32x32x16_bf16 a[48:63], v[172:175], v[116:119], a[48:63]
    v_mfma_f32_32x32x16_bf16 a[64:79], v[176:179], v[116:119], a[64:79]
    s_nop 15
    s_mul_i32 s16, s3, 20480
    v_add_u32 v6, s16, v16
    v_accvgpr_read_b32 v32, a0
    v_accvgpr_read_b32 v33, a1
    v_accvgpr_read_b32 v34, a2
    v_accvgpr_read_b32 v35, a3
    ds_write_b128 v6, v[32:35] offset:0
    v_accvgpr_read_b32 v36, a4
    v_accvgpr_read_b32 v37, a5
    v_accvgpr_read_b32 v38, a6
    v_accvgpr_read_b32 v39, a7
    ds_write_b128 v6, v[36:39] offset:1024
    v_accvgpr_read_b32 v32, a8
    v_accvgpr_read_b32 v33, a9
    v_accvgpr_read_b32 v34, a10
    v_accvgpr_read_b32 v35, a11
    ds_write_b128 v6, v[32:35] offset:2048
    v_accvgpr_read_b32 v36, a12
    v_accvgpr_read_b32 v37, a13
    v_accvgpr_read_b32 v38, a14
    v_accvgpr_read_b32 v39, a15
    ds_write_b128 v6, v[36:39] offset:3072
    v_accvgpr_read_b32 v32, a16
    v_accvgpr_read_b32 v33, a17
    v_accvgpr_read_b32 v34, a18
    v_accvgpr_read_b32 v35, a19
    ds_write_b128 v6, v[32:35] offset:4096
    v_accvgpr_read_b32 v36, a20
    v_accvgpr_read_b32 v37, a21
    v_accvgpr_read_b32 v38, a22
    v_accvgpr_read_b32 v39, a23
    ds_write_b128 v6, v[36:39] offset:5120
    v_accvgpr_read_b32 v32, a24
    v_accvgpr_read_b32 v33, a25
    v_accvgpr_read_b32 v34, a26
    v_accvgpr_read_b32 v35, a27
    ds_write_b128 v6, v[32:35] offset:6144
    v_accvgpr_read_b32 v36, a28
    v_accvgpr_read_b32 v37, a29
    v_accvgpr_read_b32 v38, a30
    v_accvgpr_read_b32 v39, a31
    ds_write_b128 v6, v[36:39] offset:7168
    v_accvgpr_read_b32 v32, a32
    v_accvgpr_read_b32 v33, a33
    v_accvgpr_read_b32 v34, a34
    v_accvgpr_read_b32 v35, a35
    ds_write_b128 v6, v[32:35] offset:8192
    v_accvgpr_read_b32 v36, a36
    v_accvgpr_read_b32 v37, a37
    v_accvgpr_read_b32 v38, a38
    v_accvgpr_read_b32 v39, a39
    ds_write_b128 v6, v[36:39] offset:9216
    v_accvgpr_read_b32 v32, a40
    v_accvgpr_read_b32 v33, a41
    v_accvgpr_read_b32 v34, a42
    v_accvgpr_read_b32 v35, a43
    ds_write_b128 v6, v[32:35] offset:10240
    v_accvgpr_read_b32 v36, a44
    v_accvgpr_read_b32 v37, a45
    v_accvgpr_read_b32 v38, a46
    v_accvgpr_read_b32 v39, a47
    ds_write_b128 v6, v[36:39] offset:11264
    v_accvgpr_read_b32 v32, a48
    v_accvgpr_read_b32 v33, a49
    v_accvgpr_read_b32 v34, a50
    v_accvgpr_read_b32 v35, a51
    ds_write_b128 v6, v[32:35] offset:12288
    v_accvgpr_read_b32 v36, a52
    v_accvgpr_read_b32 v37, a53
    v_accvgpr_read_b32 v38, a54
    v_accvgpr_read_b32 v39, a55
    ds_write_b128 v6, v[36:39] offset:13312
    v_accvgpr_read_b32 v32, a56
    v_accvgpr_read_b32 v33, a57
    v_accvgpr_read_b32 v34, a58
    v_accvgpr_read_b32 v35, a59
    ds_write_b128 v6, v[32:35] offset:14336
    v_accvgpr_read_b32 v36, a60
    v_accvgpr_read_b32 v37, a61
    v_accvgpr_read_b32 v38, a62
    v_accvgpr_read_b32 v39, a63
    ds_write_b128 v6, v[36:39] offset:15360
    v_accvgpr_read_b32 v32, a64
    v_accvgpr_read_b32 v33, a65
    v_accvgpr_read_b32 v34, a66
    v_accvgpr_read_b32 v35, a67
    ds_write_b128 v6, v[32:35] offset:16384
    v_accvgpr_read_b32 v36, a68
    v_accvgpr_read_b32 v37, a69
    v_accvgpr_read_b32 v38, a70
    v_accvgpr_read_b32 v39, a71
    ds_write_b128 v6, v[36:39] offset:17408
    v_accvgpr_read_b32 v32, a72
    v_accvgpr_read_b32 v33, a73
    v_accvgpr_read_b32 v34, a74
    v_accvgpr_read_b32 v35, a75
    ds_write_b128 v6, v[32:35] offset:18432
    v_accvgpr_read_b32 v36, a76
    v_accvgpr_read_b32 v37, a77
    v_accvgpr_read_b32 v38, a78
    v_accvgpr_read_b32 v39, a79
    ds_write_b128 v6, v[36:39] offset:19456
    s_waitcnt lgkmcnt(0)
    s_barrier
    s_waitcnt lgkmcnt(0)
    s_mov_b32 s28, s8
    s_and_b32 s29, s9, 0xffff
    s_mov_b32 s30, 0x280000
    s_mov_b32 s31, 0x00020000
    v_mul_u32_u24 v7, 1280, v3
    v_lshl_add_u32 v7, v4, 3, v7
    s_mul_i32 s17, s6, 40960
    s_mul_i32 s18, s7, 320
    s_add_u32 s17, s17, s18
    s_lshl_b32 s18, s3, 4
    s_add_u32 s17, s17, s18
    s_add_u32 s19, s17, 0xc55f000
    s_lshl_b32 s16, s3, 10
    v_add_u32 v6, s16, v16
    buffer_load_dwordx2 v[100:101], v7, s[28:31], s17 offen offset:0
    buffer_load_dwordx2 v[102:103], v7, s[28:31], s17 offen offset:64
    buffer_load_dwordx2 v[104:105], v7, s[28:31], s17 offen offset:128
    buffer_load_dwordx2 v[106:107], v7, s[28:31], s17 offen offset:192
    buffer_load_dwordx2 v[108:109], v7, s[28:31], s17 offen offset:256
    ds_read_b128 v[32:35], v6 offset:0
    v_add_u32 v8, 0xf000, v6
    ds_read_b128 v[36:39], v6 offset:20480
    ds_read_b128 v[40:43], v6 offset:40960
    ds_read_b128 v[44:47], v6 offset:61440
    s_waitcnt lgkmcnt(0)
    v_add_f32 v32, v32, v36
    v_add_f32 v40, v40, v44
    v_add_f32 v32, v32, v40
    v_add_f32 v33, v33, v37
    v_add_f32 v41, v41, v45
    v_add_f32 v33, v33, v41
    v_add_f32 v34, v34, v38
    v_add_f32 v42, v42, v46
    v_add_f32 v34, v34, v42
    v_add_f32 v35, v35, v39
    v_add_f32 v43, v43, v47
    v_add_f32 v35, v35, v43
    v_cvt_pk_bf16_f32 v48, v32, v33
    v_cvt_pk_bf16_f32 v49, v34, v35
    s_waitcnt vmcnt(4)

    v_lshlrev_b32 v32, 16, v48
    v_and_b32 v33, 0xffff0000, v48
    v_lshlrev_b32 v34, 16, v49
    v_and_b32 v35, 0xffff0000, v49
    v_lshlrev_b32 v36, 16, v100
    v_and_b32 v37, 0xffff0000, v100
    v_lshlrev_b32 v38, 16, v101
    v_and_b32 v39, 0xffff0000, v101
    v_add_f32 v32, v32, v36
    v_add_f32 v33, v33, v37
    v_add_f32 v34, v34, v38
    v_add_f32 v35, v35, v39
    v_cvt_pk_bf16_f32 v50, v32, v33
    v_cvt_pk_bf16_f32 v51, v34, v35
    buffer_store_dwordx2 v[50:51], v7, s[24:27], s19 offen offset:0 sc1
    ds_read_b128 v[32:35], v6 offset:4096
    ds_read_b128 v[36:39], v6 offset:24576
    ds_read_b128 v[40:43], v6 offset:45056
    ds_read_b128 v[44:47], v8 offset:4096
    s_waitcnt lgkmcnt(0)
    v_add_f32 v32, v32, v36
    v_add_f32 v40, v40, v44
    v_add_f32 v32, v32, v40
    v_add_f32 v33, v33, v37
    v_add_f32 v41, v41, v45
    v_add_f32 v33, v33, v41
    v_add_f32 v34, v34, v38
    v_add_f32 v42, v42, v46
    v_add_f32 v34, v34, v42
    v_add_f32 v35, v35, v39
    v_add_f32 v43, v43, v47
    v_add_f32 v35, v35, v43
    v_cvt_pk_bf16_f32 v48, v32, v33
    v_cvt_pk_bf16_f32 v49, v34, v35
    s_waitcnt vmcnt(4)

    v_lshlrev_b32 v32, 16, v48
    v_and_b32 v33, 0xffff0000, v48
    v_lshlrev_b32 v34, 16, v49
    v_and_b32 v35, 0xffff0000, v49
    v_lshlrev_b32 v36, 16, v102
    v_and_b32 v37, 0xffff0000, v102
    v_lshlrev_b32 v38, 16, v103
    v_and_b32 v39, 0xffff0000, v103
    v_add_f32 v32, v32, v36
    v_add_f32 v33, v33, v37
    v_add_f32 v34, v34, v38
    v_add_f32 v35, v35, v39
    v_cvt_pk_bf16_f32 v52, v32, v33
    v_cvt_pk_bf16_f32 v53, v34, v35
    buffer_store_dwordx2 v[52:53], v7, s[24:27], s19 offen offset:64 sc1
    ds_read_b128 v[32:35], v6 offset:8192
    ds_read_b128 v[36:39], v6 offset:28672
    ds_read_b128 v[40:43], v6 offset:49152
    ds_read_b128 v[44:47], v8 offset:8192
    s_waitcnt lgkmcnt(0)
    v_add_f32 v32, v32, v36
    v_add_f32 v40, v40, v44
    v_add_f32 v32, v32, v40
    v_add_f32 v33, v33, v37
    v_add_f32 v41, v41, v45
    v_add_f32 v33, v33, v41
    v_add_f32 v34, v34, v38
    v_add_f32 v42, v42, v46
    v_add_f32 v34, v34, v42
    v_add_f32 v35, v35, v39
    v_add_f32 v43, v43, v47
    v_add_f32 v35, v35, v43
    v_cvt_pk_bf16_f32 v48, v32, v33
    v_cvt_pk_bf16_f32 v49, v34, v35
    s_waitcnt vmcnt(4)

    v_lshlrev_b32 v32, 16, v48
    v_and_b32 v33, 0xffff0000, v48
    v_lshlrev_b32 v34, 16, v49
    v_and_b32 v35, 0xffff0000, v49
    v_lshlrev_b32 v36, 16, v104
    v_and_b32 v37, 0xffff0000, v104
    v_lshlrev_b32 v38, 16, v105
    v_and_b32 v39, 0xffff0000, v105
    v_add_f32 v32, v32, v36
    v_add_f32 v33, v33, v37
    v_add_f32 v34, v34, v38
    v_add_f32 v35, v35, v39
    v_cvt_pk_bf16_f32 v50, v32, v33
    v_cvt_pk_bf16_f32 v51, v34, v35
    buffer_store_dwordx2 v[50:51], v7, s[24:27], s19 offen offset:128 sc1
    ds_read_b128 v[32:35], v6 offset:12288
    ds_read_b128 v[36:39], v6 offset:32768
    ds_read_b128 v[40:43], v6 offset:53248
    ds_read_b128 v[44:47], v8 offset:12288
    s_waitcnt lgkmcnt(0)
    v_add_f32 v32, v32, v36
    v_add_f32 v40, v40, v44
    v_add_f32 v32, v32, v40
    v_add_f32 v33, v33, v37
    v_add_f32 v41, v41, v45
    v_add_f32 v33, v33, v41
    v_add_f32 v34, v34, v38
    v_add_f32 v42, v42, v46
    v_add_f32 v34, v34, v42
    v_add_f32 v35, v35, v39
    v_add_f32 v43, v43, v47
    v_add_f32 v35, v35, v43
    v_cvt_pk_bf16_f32 v48, v32, v33
    v_cvt_pk_bf16_f32 v49, v34, v35
    s_waitcnt vmcnt(4)

    v_lshlrev_b32 v32, 16, v48
    v_and_b32 v33, 0xffff0000, v48
    v_lshlrev_b32 v34, 16, v49
    v_and_b32 v35, 0xffff0000, v49
    v_lshlrev_b32 v36, 16, v106
    v_and_b32 v37, 0xffff0000, v106
    v_lshlrev_b32 v38, 16, v107
    v_and_b32 v39, 0xffff0000, v107
    v_add_f32 v32, v32, v36
    v_add_f32 v33, v33, v37
    v_add_f32 v34, v34, v38
    v_add_f32 v35, v35, v39
    v_cvt_pk_bf16_f32 v52, v32, v33
    v_cvt_pk_bf16_f32 v53, v34, v35
    buffer_store_dwordx2 v[52:53], v7, s[24:27], s19 offen offset:192 sc1
    ds_read_b128 v[32:35], v6 offset:16384
    ds_read_b128 v[36:39], v6 offset:36864
    ds_read_b128 v[40:43], v6 offset:57344
    ds_read_b128 v[44:47], v8 offset:16384
    s_waitcnt lgkmcnt(0)
    v_add_f32 v32, v32, v36
    v_add_f32 v40, v40, v44
    v_add_f32 v32, v32, v40
    v_add_f32 v33, v33, v37
    v_add_f32 v41, v41, v45
    v_add_f32 v33, v33, v41
    v_add_f32 v34, v34, v38
    v_add_f32 v42, v42, v46
    v_add_f32 v34, v34, v42
    v_add_f32 v35, v35, v39
    v_add_f32 v43, v43, v47
    v_add_f32 v35, v35, v43
    v_cvt_pk_bf16_f32 v48, v32, v33
    v_cvt_pk_bf16_f32 v49, v34, v35
    s_waitcnt vmcnt(4)

    v_lshlrev_b32 v32, 16, v48
    v_and_b32 v33, 0xffff0000, v48
    v_lshlrev_b32 v34, 16, v49
    v_and_b32 v35, 0xffff0000, v49
    v_lshlrev_b32 v36, 16, v108
    v_and_b32 v37, 0xffff0000, v108
    v_lshlrev_b32 v38, 16, v109
    v_and_b32 v39, 0xffff0000, v109
    v_add_f32 v32, v32, v36
    v_add_f32 v33, v33, v37
    v_add_f32 v34, v34, v38
    v_add_f32 v35, v35, v39
    v_cvt_pk_bf16_f32 v50, v32, v33
    v_cvt_pk_bf16_f32 v51, v34, v35
    buffer_store_dwordx2 v[50:51], v7, s[24:27], s19 offen offset:256 sc1
    s_waitcnt vmcnt(0)
    s_barrier
    s_cmp_lg_u32 s3, 0
    s_cbranch_scc1 END_84
    s_lshl_b32 s6, s67, 2
    s_add_u32 s6, s6, 0xad5e700
    v_mov_b32 v17, 0
    s_mov_b64 exec, 1
    buffer_store_dword v17, v17, s[24:27], s6 offen sc1
    s_branch END_84
TL_86:
    s_sub_u32 s2, s2, 72
    s_lshr_b32 s6, s2, 3
    s_cmp_lt_u32 s6, 58
    s_cbranch_scc1 TG_87
    s_sub_u32 s6, s6, 58
    s_lshl_b32 s6, s6, 4
    s_add_u32 s6, s6, 0xad5e700
    v_and_b32 v19, 3, v2
    v_lshlrev_b32 v19, 2, v19
    s_cmp_lg_u32 s3, 0
    s_cbranch_scc1 TO_91
TW_90:
    buffer_load_dword v18, v19, s[24:27], s6 offen sc1
    s_waitcnt vmcnt(0)
    v_cmp_eq_u32 vcc, -1, v18
    s_cbranch_vccz TO_91
    s_add_u32 s36, s36, 1
    s_cmp_gt_u32 s36, 0x40000
    s_cbranch_scc1 END_84
    s_sleep 2
    s_branch TW_90
TO_91:
    s_barrier
TG_87:
    s_lshl_b32 s7, s2, 2
    s_add_u32 s7, s7, s3
    s_add_u32 s8, s4, 0xc55f000
    s_addc_u32 s9, s5, 0
    s_mov_b32 s20, s8
    s_and_b32 s21, s9, 0xffff
    s_mov_b32 s22, 0x280000
    s_mov_b32 s23, 0x00020000
    v_cmp_gt_u32 vcc, 40, v2
    s_mul_i32 s44, s7, 1280
    v_lshlrev_b32 v3, 5, v2
    v_mov_b32 v8, 0
    v_mov_b32 v9, 0
    v_mov_b32 v10, 0
    v_mov_b32 v11, 0
    v_mov_b32 v12, 0
    v_mov_b32 v13, 0
    v_mov_b32 v14, 0
    v_mov_b32 v15, 0
    s_and_saveexec_b64 s[46:47], vcc
    buffer_load_dwordx4 v[8:11], v3, s[20:23], s44 offen
    buffer_load_dwordx4 v[12:15], v3, s[20:23], s44 offen offset:16
    s_mov_b64 exec, s[46:47]
    s_waitcnt vmcnt(0)
    v_lshlrev_b32 v16, 16, v8
    v_and_b32 v17, 0xffff0000, v8
    v_lshlrev_b32 v18, 16, v9
    v_and_b32 v19, 0xffff0000, v9
    v_lshlrev_b32 v20, 16, v10
    v_and_b32 v21, 0xffff0000, v10
    v_lshlrev_b32 v22, 16, v11
    v_and_b32 v23, 0xffff0000, v11
    v_lshlrev_b32 v24, 16, v12
    v_and_b32 v25, 0xffff0000, v12
    v_lshlrev_b32 v26, 16, v13
    v_and_b32 v27, 0xffff0000, v13
    v_lshlrev_b32 v28, 16, v14
    v_and_b32 v29, 0xffff0000, v14
    v_lshlrev_b32 v30, 16, v15
    v_and_b32 v31, 0xffff0000, v15
    v_add_f32 v32, v16, v17
    v_add_f32 v32, v32, v18
    v_add_f32 v32, v32, v19
    v_add_f32 v32, v32, v20
    v_add_f32 v32, v32, v21
    v_add_f32 v32, v32, v22
    v_add_f32 v32, v32, v23
    v_add_f32 v32, v32, v24
    v_add_f32 v32, v32, v25
    v_add_f32 v32, v32, v26
    v_add_f32 v32, v32, v27
    v_add_f32 v32, v32, v28
    v_add_f32 v32, v32, v29
    v_add_f32 v32, v32, v30
    v_add_f32 v32, v32, v31
    s_nop 1
    v_add_f32_dpp v32, v32, v32 row_ror:1 row_mask:0xf bank_mask:0xf
    s_nop 1
    v_add_f32_dpp v32, v32, v32 row_ror:2 row_mask:0xf bank_mask:0xf
    s_nop 1
    v_add_f32_dpp v32, v32, v32 row_ror:4 row_mask:0xf bank_mask:0xf
    s_nop 1
    v_add_f32_dpp v32, v32, v32 row_ror:8 row_mask:0xf bank_mask:0xf
    s_nop 1
    v_readlane_b32 s40, v32, 0
    v_readlane_b32 s41, v32, 16
    v_readlane_b32 s42, v32, 32
    v_readlane_b32 s43, v32, 48
    s_nop 1
    v_mov_b32 v32, s40
    v_add_f32 v32, s41, v32
    v_add_f32 v32, s42, v32
    v_add_f32 v32, s43, v32
    v_mul_f32 v32, 0x3acccccd, v32
    v_sub_f32 v33, v16, v32
    v_mul_f32 v34, v33, v33
    v_sub_f32 v33, v17, v32
    v_fmac_f32 v34, v33, v33
    v_sub_f32 v33, v18, v32
    v_fmac_f32 v34, v33, v33
    v_sub_f32 v33, v19, v32
    v_fmac_f32 v34, v33, v33
    v_sub_f32 v33, v20, v32
    v_fmac_f32 v34, v33, v33
    v_sub_f32 v33, v21, v32
    v_fmac_f32 v34, v33, v33
    v_sub_f32 v33, v22, v32
    v_fmac_f32 v34, v33, v33
    v_sub_f32 v33, v23, v32
    v_fmac_f32 v34, v33, v33
    v_sub_f32 v33, v24, v32
    v_fmac_f32 v34, v33, v33
    v_sub_f32 v33, v25, v32
    v_fmac_f32 v34, v33, v33
    v_sub_f32 v33, v26, v32
    v_fmac_f32 v34, v33, v33
    v_sub_f32 v33, v27, v32
    v_fmac_f32 v34, v33, v33
    v_sub_f32 v33, v28, v32
    v_fmac_f32 v34, v33, v33
    v_sub_f32 v33, v29, v32
    v_fmac_f32 v34, v33, v33
    v_sub_f32 v33, v30, v32
    v_fmac_f32 v34, v33, v33
    v_sub_f32 v33, v31, v32
    v_fmac_f32 v34, v33, v33
    v_cmp_gt_u32 vcc, 40, v2
    s_nop 1
    v_cndmask_b32 v34, 0, v34, vcc
    s_nop 1
    v_add_f32_dpp v34, v34, v34 row_ror:1 row_mask:0xf bank_mask:0xf
    s_nop 1
    v_add_f32_dpp v34, v34, v34 row_ror:2 row_mask:0xf bank_mask:0xf
    s_nop 1
    v_add_f32_dpp v34, v34, v34 row_ror:4 row_mask:0xf bank_mask:0xf
    s_nop 1
    v_add_f32_dpp v34, v34, v34 row_ror:8 row_mask:0xf bank_mask:0xf
    s_nop 1
    v_readlane_b32 s40, v34, 0
    v_readlane_b32 s41, v34, 16
    v_readlane_b32 s42, v34, 32
    v_readlane_b32 s43, v34, 48
    s_nop 1
    v_mov_b32 v34, s40
    v_add_f32 v34, s41, v34
    v_add_f32 v34, s42, v34
    v_add_f32 v34, s43, v34
    v_mul_f32 v34, 0x3acccccd, v34
    v_cvt_pk_bf16_f32 v34, v34, v34
    v_lshlrev_b32 v34, 16, v34
    v_add_f32 v34, 0x3727c5ac, v34
    v_cvt_pk_bf16_f32 v34, v34, v34
    v_lshlrev_b32 v34, 16, v34
    v_sqrt_f32 v34, v34
    s_nop 0
    v_cvt_pk_bf16_f32 v34, v34, v34
    v_lshlrev_b32 v34, 16, v34
    v_rcp_f32 v35, v34
    v_cvt_pk_bf16_f32 v32, v32, v32
    v_lshlrev_b32 v32, 16, v32
    v_sub_f32 v16, v16, v32
    v_sub_f32 v17, v17, v32
    v_sub_f32 v18, v18, v32
    v_sub_f32 v19, v19, v32
    v_sub_f32 v20, v20, v32
    v_sub_f32 v21, v21, v32
    v_sub_f32 v22, v22, v32
    v_sub_f32 v23, v23, v32
    v_sub_f32 v24, v24, v32
    v_sub_f32 v25, v25, v32
    v_sub_f32 v26, v26, v32
    v_sub_f32 v27, v27, v32
    v_sub_f32 v28, v28, v32
    v_sub_f32 v29, v29, v32
    v_sub_f32 v30, v30, v32
    v_sub_f32 v31, v31, v32
    v_cvt_pk_bf16_f32 v36, v16, v17
    v_lshlrev_b32 v16, 16, v36
    v_and_b32 v17, 0xffff0000, v36
    v_cvt_pk_bf16_f32 v36, v18, v19
    v_lshlrev_b32 v18, 16, v36
    v_and_b32 v19, 0xffff0000, v36
    v_cvt_pk_bf16_f32 v36, v20, v21
    v_lshlrev_b32 v20, 16, v36
    v_and_b32 v21, 0xffff0000, v36
    v_cvt_pk_bf16_f32 v36, v22, v23
    v_lshlrev_b32 v22, 16, v36
    v_and_b32 v23, 0xffff0000, v36
    v_cvt_pk_bf16_f32 v36, v24, v25
    v_lshlrev_b32 v24, 16, v36
    v_and_b32 v25, 0xffff0000, v36
    v_cvt_pk_bf16_f32 v36, v26, v27
    v_lshlrev_b32 v26, 16, v36
    v_and_b32 v27, 0xffff0000, v36
    v_cvt_pk_bf16_f32 v36, v28, v29
    v_lshlrev_b32 v28, 16, v36
    v_and_b32 v29, 0xffff0000, v36
    v_cvt_pk_bf16_f32 v36, v30, v31
    v_lshlrev_b32 v30, 16, v36
    v_and_b32 v31, 0xffff0000, v36
    v_mul_f32 v36, v16, v35
    v_fma_f32 v37, -v36, v34, v16
    v_fma_f32 v16, v37, v35, v36
    v_mul_f32 v36, v17, v35
    v_fma_f32 v37, -v36, v34, v17
    v_fma_f32 v17, v37, v35, v36
    v_mul_f32 v36, v18, v35
    v_fma_f32 v37, -v36, v34, v18
    v_fma_f32 v18, v37, v35, v36
    v_mul_f32 v36, v19, v35
    v_fma_f32 v37, -v36, v34, v19
    v_fma_f32 v19, v37, v35, v36
    v_mul_f32 v36, v20, v35
    v_fma_f32 v37, -v36, v34, v20
    v_fma_f32 v20, v37, v35, v36
    v_mul_f32 v36, v21, v35
    v_fma_f32 v37, -v36, v34, v21
    v_fma_f32 v21, v37, v35, v36
    v_mul_f32 v36, v22, v35
    v_fma_f32 v37, -v36, v34, v22
    v_fma_f32 v22, v37, v35, v36
    v_mul_f32 v36, v23, v35
    v_fma_f32 v37, -v36, v34, v23
    v_fma_f32 v23, v37, v35, v36
    v_mul_f32 v36, v24, v35
    v_fma_f32 v37, -v36, v34, v24
    v_fma_f32 v24, v37, v35, v36
    v_mul_f32 v36, v25, v35
    v_fma_f32 v37, -v36, v34, v25
    v_fma_f32 v25, v37, v35, v36
    v_mul_f32 v36, v26, v35
    v_fma_f32 v37, -v36, v34, v26
    v_fma_f32 v26, v37, v35, v36
    v_mul_f32 v36, v27, v35
    v_fma_f32 v37, -v36, v34, v27
    v_fma_f32 v27, v37, v35, v36
    v_mul_f32 v36, v28, v35
    v_fma_f32 v37, -v36, v34, v28
    v_fma_f32 v28, v37, v35, v36
    v_mul_f32 v36, v29, v35
    v_fma_f32 v37, -v36, v34, v29
    v_fma_f32 v29, v37, v35, v36
    v_mul_f32 v36, v30, v35
    v_fma_f32 v37, -v36, v34, v30
    v_fma_f32 v30, v37, v35, v36
    v_mul_f32 v36, v31, v35
    v_fma_f32 v37, -v36, v34, v31
    v_fma_f32 v31, v37, v35, v36
    v_cvt_pk_bf16_f32 v40, v16, v17
    v_cvt_pk_bf16_f32 v41, v18, v19
    v_cvt_pk_bf16_f32 v42, v24, v25
    v_cvt_pk_bf16_f32 v43, v26, v27
    v_cvt_pk_bf16_f32 v44, v20, v21
    v_cvt_pk_bf16_f32 v45, v22, v23
    v_cvt_pk_bf16_f32 v46, v28, v29
    v_cvt_pk_bf16_f32 v47, v30, v31
    s_lshr_b32 s44, s7, 5
    s_mul_i32 s44, s44, 40960
    s_and_b32 s45, s7, 31
    s_lshl_b32 s45, s45, 4
    s_add_u32 s44, s44, s45
    s_add_u32 s44, s44, 0xd9af000
    v_lshlrev_b32 v3, 10, v2
    v_cmp_gt_u32 vcc, 40, v2
    s_and_saveexec_b64 s[46:47], vcc
    buffer_store_dwordx4 v[40:43], v3, s[24:27], s44 offen
    buffer_store_dwordx4 v[44:47], v3, s[24:27], s44 offen offset:512
    s_mov_b64 exec, s[46:47]
END_84:
    s_endpgm
.globl up_kernel
.p2align 8
.type up_kernel,@function
up_kernel:
    s_load_dwordx2 s[4:5], s[0:1], 104
    v_lshrrev_b32 v1, 6, v0
    v_and_b32 v2, 63, v0
    v_readfirstlane_b32 s3, v1
    v_lshlrev_b32 v16, 4, v2
    s_cmp_ge_u32 s2, 432
    s_cbranch_scc1 END_92
    s_waitcnt lgkmcnt(0)
    s_mov_b32 s24, s4
    s_and_b32 s25, s5, 0xffff
    s_mov_b32 s26, 0x10000000
    s_mov_b32 s27, 0x00020000
    s_and_b32 s98, s2, 7
    s_mul_i32 s98, s98, 54
    s_lshr_b32 s2, s2, 3
    s_add_u32 s2, s2, s98
    s_lshr_b32 s11, s2, 4
    s_and_b32 s12, s2, 15
    s_mul_i32 s60, s11, 163840
    s_add_u32 s60, s60, 0x1400000
    s_mul_i32 s61, s12, 163840
    s_add_u32 s61, s61, 0xd9af000
    v_accvgpr_write_b32 a0, 0
    v_accvgpr_write_b32 a1, 0
    v_accvgpr_write_b32 a2, 0
    v_accvgpr_write_b32 a3, 0
    v_accvgpr_write_b32 a4, 0
    v_accvgpr_write_b32 a5, 0
    v_accvgpr_write_b32 a6, 0
    v_accvgpr_write_b32 a7, 0
    v_accvgpr_write_b32 a8, 0
    v_accvgpr_write_b32 a9, 0
    v_accvgpr_write_b32 a10, 0
    v_accvgpr_write_b32 a11, 0
    v_accvgpr_write_b32 a12, 0
    v_accvgpr_write_b32 a13, 0
    v_accvgpr_write_b32 a14, 0
    v_accvgpr_write_b32 a15, 0
    v_accvgpr_write_b32 a16, 0
    v_accvgpr_write_b32 a17, 0
    v_accvgpr_write_b32 a18, 0
    v_accvgpr_write_b32 a19, 0
    v_accvgpr_write_b32 a20, 0
    v_accvgpr_write_b32 a21, 0
    v_accvgpr_write_b32 a22, 0
    v_accvgpr_write_b32 a23, 0
    v_accvgpr_write_b32 a24, 0
    v_accvgpr_write_b32 a25, 0
    v_accvgpr_write_b32 a26, 0
    v_accvgpr_write_b32 a27, 0
    v_accvgpr_write_b32 a28, 0
    v_accvgpr_write_b32 a29, 0
    v_accvgpr_write_b32 a30, 0
    v_accvgpr_write_b32 a31, 0
    v_accvgpr_write_b32 a32, 0
    v_accvgpr_write_b32 a33, 0
    v_accvgpr_write_b32 a34, 0
    v_accvgpr_write_b32 a35, 0
    v_accvgpr_write_b32 a36, 0
    v_accvgpr_write_b32 a37, 0
    v_accvgpr_write_b32 a38, 0
    v_accvgpr_write_b32 a39, 0
    v_accvgpr_write_b32 a40, 0
    v_accvgpr_write_b32 a41, 0
    v_accvgpr_write_b32 a42, 0
    v_accvgpr_write_b32 a43, 0
    v_accvgpr_write_b32 a44, 0
    v_accvgpr_write_b32 a45, 0
    v_accvgpr_write_b32 a46, 0
    v_accvgpr_write_b32 a47, 0
    v_accvgpr_write_b32 a48, 0
    v_accvgpr_write_b32 a49, 0
    v_accvgpr_write_b32 a50, 0
    v_accvgpr_write_b32 a51, 0
    v_accvgpr_write_b32 a52, 0
    v_accvgpr_write_b32 a53, 0
    v_accvgpr_write_b32 a54, 0
    v_accvgpr_write_b32 a55, 0
    v_accvgpr_write_b32 a56, 0
    v_accvgpr_write_b32 a57, 0
    v_accvgpr_write_b32 a58, 0
    v_accvgpr_write_b32 a59, 0
    v_accvgpr_write_b32 a60, 0
    v_accvgpr_write_b32 a61, 0
    v_accvgpr_write_b32 a62, 0
    v_accvgpr_write_b32 a63, 0
    s_lshr_b32 s50, s3, 1
    s_and_b32 s51, s3, 1
    s_mul_i32 s50, s50, 4096
    s_mul_i32 s51, s51, 4096
    s_add_u32 s51, s51, 8192
    v_add_u32 v15, s51, v16
    v_add_u32 v14, s50, v16
    s_mul_i32 s52, s3, 4
    s_add_u32 s54, s52, 0
    s_lshr_b32 s55, s54, 1
    s_and_b32 s56, s54, 1
    s_lshl_b32 s56, s56, 10
    s_mul_i32 s57, s55, 40960
    s_add_u32 s57, s57, s60
    s_sub_u32 s58, s55, 4
    s_mul_i32 s58, s58, 40960
    s_add_u32 s58, s58, s61
    s_cmp_lt_u32 s55, 4
    s_cselect_b32 s57, s57, s58
    s_add_u32 s80, s57, s56
    s_add_u32 s54, s52, 1
    s_lshr_b32 s55, s54, 1
    s_and_b32 s56, s54, 1
    s_lshl_b32 s56, s56, 10
    s_mul_i32 s57, s55, 40960
    s_add_u32 s57, s57, s60
    s_sub_u32 s58, s55, 4
    s_mul_i32 s58, s58, 40960
    s_add_u32 s58, s58, s61
    s_cmp_lt_u32 s55, 4
    s_cselect_b32 s57, s57, s58
    s_add_u32 s81, s57, s56
    s_add_u32 s54, s52, 2
    s_lshr_b32 s55, s54, 1
    s_and_b32 s56, s54, 1
    s_lshl_b32 s56, s56, 10
    s_mul_i32 s57, s55, 40960
    s_add_u32 s57, s57, s60
    s_sub_u32 s58, s55, 4
    s_mul_i32 s58, s58, 40960
    s_add_u32 s58, s58, s61
    s_cmp_lt_u32 s55, 4
    s_cselect_b32 s57, s57, s58
    s_add_u32 s82, s57, s56
    s_add_u32 s54, s52, 3
    s_lshr_b32 s55, s54, 1
    s_and_b32 s56, s54, 1
    s_lshl_b32 s56, s56, 10
    s_mul_i32 s57, s55, 40960
    s_add_u32 s57, s57, s60
    s_sub_u32 s58, s55, 4
    s_mul_i32 s58, s58, 40960
    s_add_u32 s58, s58, s61
    s_cmp_lt_u32 s55, 4
    s_cselect_b32 s57, s57, s58
    s_add_u32 s83, s57, s56
    s_lshl_b32 s52, s52, 10
    s_mov_b32 s53, 0
    s_add_u32 s54, s53, s52
    s_mov_b32 m0, s54
    s_add_u32 s54, s54, 1024
    buffer_load_dwordx4 v16, s[24:27], s80 offen lds
    s_add_u32 s80, s80, 2048
    s_mov_b32 m0, s54
    s_add_u32 s54, s54, 1024
    buffer_load_dwordx4 v16, s[24:27], s81 offen lds
    s_add_u32 s81, s81, 2048
    s_mov_b32 m0, s54
    s_add_u32 s54, s54, 1024
    buffer_load_dwordx4 v16, s[24:27], s82 offen lds
    s_add_u32 s82, s82, 2048
    s_mov_b32 m0, s54
    s_add_u32 s54, s54, 1024
    buffer_load_dwordx4 v16, s[24:27], s83 offen lds
    s_add_u32 s83, s83, 2048
    s_add_u32 s53, s53, 16384
    s_cmp_ge_u32 s53, 81920
    s_cselect_b32 s53, 0, s53
    s_add_u32 s54, s53, s52
    s_mov_b32 m0, s54
    s_add_u32 s54, s54, 1024
    buffer_load_dwordx4 v16, s[24:27], s80 offen lds
    s_add_u32 s80, s80, 2048
    s_mov_b32 m0, s54
    s_add_u32 s54, s54, 1024
    buffer_load_dwordx4 v16, s[24:27], s81 offen lds
    s_add_u32 s81, s81, 2048
    s_mov_b32 m0, s54
    s_add_u32 s54, s54, 1024
    buffer_load_dwordx4 v16, s[24:27], s82 offen lds
    s_add_u32 s82, s82, 2048
    s_mov_b32 m0, s54
    s_add_u32 s54, s54, 1024
    buffer_load_dwordx4 v16, s[24:27], s83 offen lds
    s_add_u32 s83, s83, 2048
    s_add_u32 s53, s53, 16384
    s_cmp_ge_u32 s53, 81920
    s_cselect_b32 s53, 0, s53
    s_add_u32 s54, s53, s52
    s_mov_b32 m0, s54
    s_add_u32 s54, s54, 1024
    buffer_load_dwordx4 v16, s[24:27], s80 offen lds
    s_add_u32 s80, s80, 2048
    s_mov_b32 m0, s54
    s_add_u32 s54, s54, 1024
    buffer_load_dwordx4 v16, s[24:27], s81 offen lds
    s_add_u32 s81, s81, 2048
    s_mov_b32 m0, s54
    s_add_u32 s54, s54, 1024
    buffer_load_dwordx4 v16, s[24:27], s82 offen lds
    s_add_u32 s82, s82, 2048
    s_mov_b32 m0, s54
    s_add_u32 s54, s54, 1024
    buffer_load_dwordx4 v16, s[24:27], s83 offen lds
    s_add_u32 s83, s83, 2048
    s_add_u32 s53, s53, 16384
    s_cmp_ge_u32 s53, 81920
    s_cselect_b32 s53, 0, s53
    s_add_u32 s54, s53, s52
    s_mov_b32 m0, s54
    s_add_u32 s54, s54, 1024
    buffer_load_dwordx4 v16, s[24:27], s80 offen lds
    s_add_u32 s80, s80, 2048
    s_mov_b32 m0, s54
    s_add_u32 s54, s54, 1024
    buffer_load_dwordx4 v16, s[24:27], s81 offen lds
    s_add_u32 s81, s81, 2048
    s_mov_b32 m0, s54
    s_add_u32 s54, s54, 1024
    buffer_load_dwordx4 v16, s[24:27], s82 offen lds
    s_add_u32 s82, s82, 2048
    s_mov_b32 m0, s54
    s_add_u32 s54, s54, 1024
    buffer_load_dwordx4 v16, s[24:27], s83 offen lds
    s_add_u32 s83, s83, 2048
    s_add_u32 s53, s53, 16384
    s_cmp_ge_u32 s53, 81920
    s_cselect_b32 s53, 0, s53
    s_waitcnt vmcnt(12)
    s_barrier
    ds_read_b128 v[64:67], v14 offset:0
    ds_read_b128 v[68:71], v14 offset:2048
    ds_read_b128 v[80:83], v15 offset:0
    ds_read_b128 v[84:87], v15 offset:2048
    s_mov_b32 s59, 0
    s_mov_b32 s49, 0
    s_mov_b32 s47, 16384
GL_93:
    ds_read_b128 v[96:99], v14 offset:1024
    ds_read_b128 v[100:103], v14 offset:3072
    ds_read_b128 v[112:115], v15 offset:1024
    ds_read_b128 v[116:119], v15 offset:3072
    s_waitcnt lgkmcnt(4)
    v_mfma_f32_32x32x16_bf16 a[0:15], v[64:67], v[80:83], a[0:15]
    v_mfma_f32_32x32x16_bf16 a[16:31], v[64:67], v[84:87], a[16:31]
    v_mfma_f32_32x32x16_bf16 a[32:47], v[68:71], v[80:83], a[32:47]
    v_mfma_f32_32x32x16_bf16 a[48:63], v[68:71], v[84:87], a[48:63]
    s_add_u32 s49, s49, 16384
    s_cmp_ge_u32 s49, 81920
    s_cselect_b32 s48, 4294901760, s47
    s_cselect_b32 s49, 0, s49
    v_add_u32 v14, s48, v14
    v_add_u32 v15, s48, v15
    s_cmp_ge_u32 s59, 16
    s_cbranch_scc1 GL_94
    s_waitcnt vmcnt(8)
    s_barrier
    s_waitcnt lgkmcnt(0)
    ds_read_b128 v[64:67], v14 offset:0
    ds_read_b128 v[68:71], v14 offset:2048
    ds_read_b128 v[80:83], v15 offset:0
    ds_read_b128 v[84:87], v15 offset:2048
    s_add_u32 s54, s53, s52
    v_mfma_f32_32x32x16_bf16 a[0:15], v[96:99], v[112:115], a[0:15]
    s_mov_b32 m0, s54
    s_add_u32 s54, s54, 1024
    buffer_load_dwordx4 v16, s[24:27], s80 offen lds
    s_add_u32 s80, s80, 2048
    v_mfma_f32_32x32x16_bf16 a[16:31], v[96:99], v[116:119], a[16:31]
    s_mov_b32 m0, s54
    s_add_u32 s54, s54, 1024
    buffer_load_dwordx4 v16, s[24:27], s81 offen lds
    s_add_u32 s81, s81, 2048
    v_mfma_f32_32x32x16_bf16 a[32:47], v[100:103], v[112:115], a[32:47]
    s_mov_b32 m0, s54
    s_add_u32 s54, s54, 1024
    buffer_load_dwordx4 v16, s[24:27], s82 offen lds
    s_add_u32 s82, s82, 2048
    v_mfma_f32_32x32x16_bf16 a[48:63], v[100:103], v[116:119], a[48:63]
    s_mov_b32 m0, s54
    s_add_u32 s54, s54, 1024
    buffer_load_dwordx4 v16, s[24:27], s83 offen lds
    s_add_u32 s83, s83, 2048
    s_add_u32 s53, s53, 16384
    s_cmp_ge_u32 s53, 81920
    s_cselect_b32 s53, 0, s53
    s_branch GL_96
GL_94:
    s_cmp_lg_u32 s59, 16
    s_cbranch_scc1 GK_98
    s_waitcnt vmcnt(8)
    s_branch GL_95
GK_98:
    s_cmp_lg_u32 s59, 17
    s_cbranch_scc1 GK_99
    s_waitcnt vmcnt(4)
    s_branch GL_95
GK_99:
    s_waitcnt vmcnt(0)
GL_95:
    s_barrier
    s_waitcnt lgkmcnt(0)
    ds_read_b128 v[64:67], v14 offset:0
    ds_read_b128 v[68:71], v14 offset:2048
    ds_read_b128 v[80:83], v15 offset:0
    ds_read_b128 v[84:87], v15 offset:2048
    v_mfma_f32_32x32x16_bf16 a[0:15], v[96:99], v[112:115], a[0:15]
    v_mfma_f32_32x32x16_bf16 a[16:31], v[96:99], v[116:119], a[16:31]
    v_mfma_f32_32x32x16_bf16 a[32:47], v[100:103], v[112:115], a[32:47]
    v_mfma_f32_32x32x16_bf16 a[48:63], v[100:103], v[116:119], a[48:63]
GL_96:
    s_add_u32 s59, s59, 1
    s_cmp_lt_u32 s59, 20
    s_cbranch_scc1 GL_93
    s_waitcnt lgkmcnt(0)
    s_nop 15
    s_lshr_b32 s14, s3, 1
    s_and_b32 s15, s3, 1
    s_lshl_b32 s16, s11, 1
    s_add_u32 s16, s16, s14
    s_lshl_b32 s17, s12, 2
    s_lshl_b32 s18, s15, 1
    s_add_u32 s17, s17, s18
    s_mul_i32 s18, s17, 110592
    s_lshl_b32 s19, s16, 11
    s_add_u32 s18, s18, s19
    s_add_u32 s18, s18, 0xc7df000
    s_mov_b32 s20, 0xbfb8aa3b
    v_accvgpr_read_b32 v32, a0
    v_accvgpr_read_b32 v40, a32
    v_accvgpr_read_b32 v33, a1
    v_accvgpr_read_b32 v41, a33
    v_accvgpr_read_b32 v34, a2
    v_accvgpr_read_b32 v42, a34
    v_accvgpr_read_b32 v35, a3
    v_accvgpr_read_b32 v43, a35
    v_accvgpr_read_b32 v36, a4
    v_accvgpr_read_b32 v44, a36
    v_accvgpr_read_b32 v37, a5
    v_accvgpr_read_b32 v45, a37
    v_accvgpr_read_b32 v38, a6
    v_accvgpr_read_b32 v46, a38
    v_accvgpr_read_b32 v39, a7
    v_accvgpr_read_b32 v47, a39
    v_cvt_pk_bf16_f32 v48, v32, v33
    v_lshlrev_b32 v32, 16, v48
    v_and_b32 v33, 0xffff0000, v48
    v_cvt_pk_bf16_f32 v48, v40, v41
    v_lshlrev_b32 v40, 16, v48
    v_and_b32 v41, 0xffff0000, v48
    v_cvt_pk_bf16_f32 v48, v34, v35
    v_lshlrev_b32 v34, 16, v48
    v_and_b32 v35, 0xffff0000, v48
    v_cvt_pk_bf16_f32 v48, v42, v43
    v_lshlrev_b32 v42, 16, v48
    v_and_b32 v43, 0xffff0000, v48
    v_cvt_pk_bf16_f32 v48, v36, v37
    v_lshlrev_b32 v36, 16, v48
    v_and_b32 v37, 0xffff0000, v48
    v_cvt_pk_bf16_f32 v48, v44, v45
    v_lshlrev_b32 v44, 16, v48
    v_and_b32 v45, 0xffff0000, v48
    v_cvt_pk_bf16_f32 v48, v38, v39
    v_lshlrev_b32 v38, 16, v48
    v_and_b32 v39, 0xffff0000, v48
    v_cvt_pk_bf16_f32 v48, v46, v47
    v_lshlrev_b32 v46, 16, v48
    v_and_b32 v47, 0xffff0000, v48
    v_mul_f32 v48, s20, v32
    v_mul_f32 v49, s20, v33
    v_mul_f32 v50, s20, v34
    v_mul_f32 v51, s20, v35
    v_mul_f32 v52, s20, v36
    v_mul_f32 v53, s20, v37
    v_mul_f32 v54, s20, v38
    v_mul_f32 v55, s20, v39
    v_exp_f32 v48, v48
    v_exp_f32 v49, v49
    v_exp_f32 v50, v50
    v_exp_f32 v51, v51
    v_exp_f32 v52, v52
    v_exp_f32 v53, v53
    v_exp_f32 v54, v54
    v_exp_f32 v55, v55
    v_add_f32 v48, 1.0, v48
    v_add_f32 v49, 1.0, v49
    v_add_f32 v50, 1.0, v50
    v_add_f32 v51, 1.0, v51
    v_add_f32 v52, 1.0, v52
    v_add_f32 v53, 1.0, v53
    v_add_f32 v54, 1.0, v54
    v_add_f32 v55, 1.0, v55
    v_rcp_f32 v48, v48
    v_rcp_f32 v49, v49
    v_rcp_f32 v50, v50
    v_rcp_f32 v51, v51
    v_rcp_f32 v52, v52
    v_rcp_f32 v53, v53
    v_rcp_f32 v54, v54
    v_rcp_f32 v55, v55
    v_mul_f32 v32, v32, v48
    v_mul_f32 v33, v33, v49
    v_mul_f32 v34, v34, v50
    v_mul_f32 v35, v35, v51
    v_mul_f32 v36, v36, v52
    v_mul_f32 v37, v37, v53
    v_mul_f32 v38, v38, v54
    v_mul_f32 v39, v39, v55
    v_cvt_pk_bf16_f32 v48, v32, v33
    v_lshlrev_b32 v32, 16, v48
    v_and_b32 v33, 0xffff0000, v48
    v_cvt_pk_bf16_f32 v48, v34, v35
    v_lshlrev_b32 v34, 16, v48
    v_and_b32 v35, 0xffff0000, v48
    v_cvt_pk_bf16_f32 v48, v36, v37
    v_lshlrev_b32 v36, 16, v48
    v_and_b32 v37, 0xffff0000, v48
    v_cvt_pk_bf16_f32 v48, v38, v39
    v_lshlrev_b32 v38, 16, v48
    v_and_b32 v39, 0xffff0000, v48
    v_mul_f32 v32, v32, v40
    v_mul_f32 v33, v33, v41
    v_mul_f32 v34, v34, v42
    v_mul_f32 v35, v35, v43
    v_mul_f32 v36, v36, v44
    v_mul_f32 v37, v37, v45
    v_mul_f32 v38, v38, v46
    v_mul_f32 v39, v39, v47
    v_cvt_pk_bf16_f32 v56, v32, v33
    v_cvt_pk_bf16_f32 v57, v34, v35
    v_cvt_pk_bf16_f32 v58, v36, v37
    v_cvt_pk_bf16_f32 v59, v38, v39
    s_add_u32 s21, s18, 0
    buffer_store_dwordx4 v[56:59], v16, s[24:27], s21 offen
    v_accvgpr_read_b32 v32, a8
    v_accvgpr_read_b32 v40, a40
    v_accvgpr_read_b32 v33, a9
    v_accvgpr_read_b32 v41, a41
    v_accvgpr_read_b32 v34, a10
    v_accvgpr_read_b32 v42, a42
    v_accvgpr_read_b32 v35, a11
    v_accvgpr_read_b32 v43, a43
    v_accvgpr_read_b32 v36, a12
    v_accvgpr_read_b32 v44, a44
    v_accvgpr_read_b32 v37, a13
    v_accvgpr_read_b32 v45, a45
    v_accvgpr_read_b32 v38, a14
    v_accvgpr_read_b32 v46, a46
    v_accvgpr_read_b32 v39, a15
    v_accvgpr_read_b32 v47, a47
    v_cvt_pk_bf16_f32 v48, v32, v33
    v_lshlrev_b32 v32, 16, v48
    v_and_b32 v33, 0xffff0000, v48
    v_cvt_pk_bf16_f32 v48, v40, v41
    v_lshlrev_b32 v40, 16, v48
    v_and_b32 v41, 0xffff0000, v48
    v_cvt_pk_bf16_f32 v48, v34, v35
    v_lshlrev_b32 v34, 16, v48
    v_and_b32 v35, 0xffff0000, v48
    v_cvt_pk_bf16_f32 v48, v42, v43
    v_lshlrev_b32 v42, 16, v48
    v_and_b32 v43, 0xffff0000, v48
    v_cvt_pk_bf16_f32 v48, v36, v37
    v_lshlrev_b32 v36, 16, v48
    v_and_b32 v37, 0xffff0000, v48
    v_cvt_pk_bf16_f32 v48, v44, v45
    v_lshlrev_b32 v44, 16, v48
    v_and_b32 v45, 0xffff0000, v48
    v_cvt_pk_bf16_f32 v48, v38, v39
    v_lshlrev_b32 v38, 16, v48
    v_and_b32 v39, 0xffff0000, v48
    v_cvt_pk_bf16_f32 v48, v46, v47
    v_lshlrev_b32 v46, 16, v48
    v_and_b32 v47, 0xffff0000, v48
    v_mul_f32 v48, s20, v32
    v_mul_f32 v49, s20, v33
    v_mul_f32 v50, s20, v34
    v_mul_f32 v51, s20, v35
    v_mul_f32 v52, s20, v36
    v_mul_f32 v53, s20, v37
    v_mul_f32 v54, s20, v38
    v_mul_f32 v55, s20, v39
    v_exp_f32 v48, v48
    v_exp_f32 v49, v49
    v_exp_f32 v50, v50
    v_exp_f32 v51, v51
    v_exp_f32 v52, v52
    v_exp_f32 v53, v53
    v_exp_f32 v54, v54
    v_exp_f32 v55, v55
    v_add_f32 v48, 1.0, v48
    v_add_f32 v49, 1.0, v49
    v_add_f32 v50, 1.0, v50
    v_add_f32 v51, 1.0, v51
    v_add_f32 v52, 1.0, v52
    v_add_f32 v53, 1.0, v53
    v_add_f32 v54, 1.0, v54
    v_add_f32 v55, 1.0, v55
    v_rcp_f32 v48, v48
    v_rcp_f32 v49, v49
    v_rcp_f32 v50, v50
    v_rcp_f32 v51, v51
    v_rcp_f32 v52, v52
    v_rcp_f32 v53, v53
    v_rcp_f32 v54, v54
    v_rcp_f32 v55, v55
    v_mul_f32 v32, v32, v48
    v_mul_f32 v33, v33, v49
    v_mul_f32 v34, v34, v50
    v_mul_f32 v35, v35, v51
    v_mul_f32 v36, v36, v52
    v_mul_f32 v37, v37, v53
    v_mul_f32 v38, v38, v54
    v_mul_f32 v39, v39, v55
    v_cvt_pk_bf16_f32 v48, v32, v33
    v_lshlrev_b32 v32, 16, v48
    v_and_b32 v33, 0xffff0000, v48
    v_cvt_pk_bf16_f32 v48, v34, v35
    v_lshlrev_b32 v34, 16, v48
    v_and_b32 v35, 0xffff0000, v48
    v_cvt_pk_bf16_f32 v48, v36, v37
    v_lshlrev_b32 v36, 16, v48
    v_and_b32 v37, 0xffff0000, v48
    v_cvt_pk_bf16_f32 v48, v38, v39
    v_lshlrev_b32 v38, 16, v48
    v_and_b32 v39, 0xffff0000, v48
    v_mul_f32 v32, v32, v40
    v_mul_f32 v33, v33, v41
    v_mul_f32 v34, v34, v42
    v_mul_f32 v35, v35, v43
    v_mul_f32 v36, v36, v44
    v_mul_f32 v37, v37, v45
    v_mul_f32 v38, v38, v46
    v_mul_f32 v39, v39, v47
    v_cvt_pk_bf16_f32 v60, v32, v33
    v_cvt_pk_bf16_f32 v61, v34, v35
    v_cvt_pk_bf16_f32 v62, v36, v37
    v_cvt_pk_bf16_f32 v63, v38, v39
    s_add_u32 s21, s18, 1024
    buffer_store_dwordx4 v[60:63], v16, s[24:27], s21 offen
    v_accvgpr_read_b32 v32, a16
    v_accvgpr_read_b32 v40, a48
    v_accvgpr_read_b32 v33, a17
    v_accvgpr_read_b32 v41, a49
    v_accvgpr_read_b32 v34, a18
    v_accvgpr_read_b32 v42, a50
    v_accvgpr_read_b32 v35, a19
    v_accvgpr_read_b32 v43, a51
    v_accvgpr_read_b32 v36, a20
    v_accvgpr_read_b32 v44, a52
    v_accvgpr_read_b32 v37, a21
    v_accvgpr_read_b32 v45, a53
    v_accvgpr_read_b32 v38, a22
    v_accvgpr_read_b32 v46, a54
    v_accvgpr_read_b32 v39, a23
    v_accvgpr_read_b32 v47, a55
    v_cvt_pk_bf16_f32 v48, v32, v33
    v_lshlrev_b32 v32, 16, v48
    v_and_b32 v33, 0xffff0000, v48
    v_cvt_pk_bf16_f32 v48, v40, v41
    v_lshlrev_b32 v40, 16, v48
    v_and_b32 v41, 0xffff0000, v48
    v_cvt_pk_bf16_f32 v48, v34, v35
    v_lshlrev_b32 v34, 16, v48
    v_and_b32 v35, 0xffff0000, v48
    v_cvt_pk_bf16_f32 v48, v42, v43
    v_lshlrev_b32 v42, 16, v48
    v_and_b32 v43, 0xffff0000, v48
    v_cvt_pk_bf16_f32 v48, v36, v37
    v_lshlrev_b32 v36, 16, v48
    v_and_b32 v37, 0xffff0000, v48
    v_cvt_pk_bf16_f32 v48, v44, v45
    v_lshlrev_b32 v44, 16, v48
    v_and_b32 v45, 0xffff0000, v48
    v_cvt_pk_bf16_f32 v48, v38, v39
    v_lshlrev_b32 v38, 16, v48
    v_and_b32 v39, 0xffff0000, v48
    v_cvt_pk_bf16_f32 v48, v46, v47
    v_lshlrev_b32 v46, 16, v48
    v_and_b32 v47, 0xffff0000, v48
    v_mul_f32 v48, s20, v32
    v_mul_f32 v49, s20, v33
    v_mul_f32 v50, s20, v34
    v_mul_f32 v51, s20, v35
    v_mul_f32 v52, s20, v36
    v_mul_f32 v53, s20, v37
    v_mul_f32 v54, s20, v38
    v_mul_f32 v55, s20, v39
    v_exp_f32 v48, v48
    v_exp_f32 v49, v49
    v_exp_f32 v50, v50
    v_exp_f32 v51, v51
    v_exp_f32 v52, v52
    v_exp_f32 v53, v53
    v_exp_f32 v54, v54
    v_exp_f32 v55, v55
    v_add_f32 v48, 1.0, v48
    v_add_f32 v49, 1.0, v49
    v_add_f32 v50, 1.0, v50
    v_add_f32 v51, 1.0, v51
    v_add_f32 v52, 1.0, v52
    v_add_f32 v53, 1.0, v53
    v_add_f32 v54, 1.0, v54
    v_add_f32 v55, 1.0, v55
    v_rcp_f32 v48, v48
    v_rcp_f32 v49, v49
    v_rcp_f32 v50, v50
    v_rcp_f32 v51, v51
    v_rcp_f32 v52, v52
    v_rcp_f32 v53, v53
    v_rcp_f32 v54, v54
    v_rcp_f32 v55, v55
    v_mul_f32 v32, v32, v48
    v_mul_f32 v33, v33, v49
    v_mul_f32 v34, v34, v50
    v_mul_f32 v35, v35, v51
    v_mul_f32 v36, v36, v52
    v_mul_f32 v37, v37, v53
    v_mul_f32 v38, v38, v54
    v_mul_f32 v39, v39, v55
    v_cvt_pk_bf16_f32 v48, v32, v33
    v_lshlrev_b32 v32, 16, v48
    v_and_b32 v33, 0xffff0000, v48
    v_cvt_pk_bf16_f32 v48, v34, v35
    v_lshlrev_b32 v34, 16, v48
    v_and_b32 v35, 0xffff0000, v48
    v_cvt_pk_bf16_f32 v48, v36, v37
    v_lshlrev_b32 v36, 16, v48
    v_and_b32 v37, 0xffff0000, v48
    v_cvt_pk_bf16_f32 v48, v38, v39
    v_lshlrev_b32 v38, 16, v48
    v_and_b32 v39, 0xffff0000, v48
    v_mul_f32 v32, v32, v40
    v_mul_f32 v33, v33, v41
    v_mul_f32 v34, v34, v42
    v_mul_f32 v35, v35, v43
    v_mul_f32 v36, v36, v44
    v_mul_f32 v37, v37, v45
    v_mul_f32 v38, v38, v46
    v_mul_f32 v39, v39, v47
    v_cvt_pk_bf16_f32 v56, v32, v33
    v_cvt_pk_bf16_f32 v57, v34, v35
    v_cvt_pk_bf16_f32 v58, v36, v37
    v_cvt_pk_bf16_f32 v59, v38, v39
    s_add_u32 s21, s18, 110592
    buffer_store_dwordx4 v[56:59], v16, s[24:27], s21 offen
    v_accvgpr_read_b32 v32, a24
    v_accvgpr_read_b32 v40, a56
    v_accvgpr_read_b32 v33, a25
    v_accvgpr_read_b32 v41, a57
    v_accvgpr_read_b32 v34, a26
    v_accvgpr_read_b32 v42, a58
    v_accvgpr_read_b32 v35, a27
    v_accvgpr_read_b32 v43, a59
    v_accvgpr_read_b32 v36, a28
    v_accvgpr_read_b32 v44, a60
    v_accvgpr_read_b32 v37, a29
    v_accvgpr_read_b32 v45, a61
    v_accvgpr_read_b32 v38, a30
    v_accvgpr_read_b32 v46, a62
    v_accvgpr_read_b32 v39, a31
    v_accvgpr_read_b32 v47, a63
    v_cvt_pk_bf16_f32 v48, v32, v33
    v_lshlrev_b32 v32, 16, v48
    v_and_b32 v33, 0xffff0000, v48
    v_cvt_pk_bf16_f32 v48, v40, v41
    v_lshlrev_b32 v40, 16, v48
    v_and_b32 v41, 0xffff0000, v48
    v_cvt_pk_bf16_f32 v48, v34, v35
    v_lshlrev_b32 v34, 16, v48
    v_and_b32 v35, 0xffff0000, v48
    v_cvt_pk_bf16_f32 v48, v42, v43
    v_lshlrev_b32 v42, 16, v48
    v_and_b32 v43, 0xffff0000, v48
    v_cvt_pk_bf16_f32 v48, v36, v37
    v_lshlrev_b32 v36, 16, v48
    v_and_b32 v37, 0xffff0000, v48
    v_cvt_pk_bf16_f32 v48, v44, v45
    v_lshlrev_b32 v44, 16, v48
    v_and_b32 v45, 0xffff0000, v48
    v_cvt_pk_bf16_f32 v48, v38, v39
    v_lshlrev_b32 v38, 16, v48
    v_and_b32 v39, 0xffff0000, v48
    v_cvt_pk_bf16_f32 v48, v46, v47
    v_lshlrev_b32 v46, 16, v48
    v_and_b32 v47, 0xffff0000, v48
    v_mul_f32 v48, s20, v32
    v_mul_f32 v49, s20, v33
    v_mul_f32 v50, s20, v34
    v_mul_f32 v51, s20, v35
    v_mul_f32 v52, s20, v36
    v_mul_f32 v53, s20, v37
    v_mul_f32 v54, s20, v38
    v_mul_f32 v55, s20, v39
    v_exp_f32 v48, v48
    v_exp_f32 v49, v49
    v_exp_f32 v50, v50
    v_exp_f32 v51, v51
    v_exp_f32 v52, v52
    v_exp_f32 v53, v53
    v_exp_f32 v54, v54
    v_exp_f32 v55, v55
    v_add_f32 v48, 1.0, v48
    v_add_f32 v49, 1.0, v49
    v_add_f32 v50, 1.0, v50
    v_add_f32 v51, 1.0, v51
    v_add_f32 v52, 1.0, v52
    v_add_f32 v53, 1.0, v53
    v_add_f32 v54, 1.0, v54
    v_add_f32 v55, 1.0, v55
    v_rcp_f32 v48, v48
    v_rcp_f32 v49, v49
    v_rcp_f32 v50, v50
    v_rcp_f32 v51, v51
    v_rcp_f32 v52, v52
    v_rcp_f32 v53, v53
    v_rcp_f32 v54, v54
    v_rcp_f32 v55, v55
    v_mul_f32 v32, v32, v48
    v_mul_f32 v33, v33, v49
    v_mul_f32 v34, v34, v50
    v_mul_f32 v35, v35, v51
    v_mul_f32 v36, v36, v52
    v_mul_f32 v37, v37, v53
    v_mul_f32 v38, v38, v54
    v_mul_f32 v39, v39, v55
    v_cvt_pk_bf16_f32 v48, v32, v33
    v_lshlrev_b32 v32, 16, v48
    v_and_b32 v33, 0xffff0000, v48
    v_cvt_pk_bf16_f32 v48, v34, v35
    v_lshlrev_b32 v34, 16, v48
    v_and_b32 v35, 0xffff0000, v48
    v_cvt_pk_bf16_f32 v48, v36, v37
    v_lshlrev_b32 v36, 16, v48
    v_and_b32 v37, 0xffff0000, v48
    v_cvt_pk_bf16_f32 v48, v38, v39
    v_lshlrev_b32 v38, 16, v48
    v_and_b32 v39, 0xffff0000, v48
    v_mul_f32 v32, v32, v40
    v_mul_f32 v33, v33, v41
    v_mul_f32 v34, v34, v42
    v_mul_f32 v35, v35, v43
    v_mul_f32 v36, v36, v44
    v_mul_f32 v37, v37, v45
    v_mul_f32 v38, v38, v46
    v_mul_f32 v39, v39, v47
    v_cvt_pk_bf16_f32 v60, v32, v33
    v_cvt_pk_bf16_f32 v61, v34, v35
    v_cvt_pk_bf16_f32 v62, v36, v37
    v_cvt_pk_bf16_f32 v63, v38, v39
    s_add_u32 s21, s18, 111616
    buffer_store_dwordx4 v[60:63], v16, s[24:27], s21 offen
END_92:
    s_endpgm
.globl down_kernel
.p2align 8
.type down_kernel,@function
down_kernel:
    s_load_dwordx2 s[4:5], s[0:1], 104
    v_lshrrev_b32 v1, 6, v0
    v_and_b32 v2, 63, v0
    v_readfirstlane_b32 s3, v1
    v_lshlrev_b32 v16, 4, v2
    s_cmp_ge_u32 s2, 160
    s_cbranch_scc1 END_100
    s_waitcnt lgkmcnt(0)
    s_mov_b32 s24, s4
    s_and_b32 s25, s5, 0xffff
    s_mov_b32 s26, 0x10000000
    s_mov_b32 s27, 0x00020000
    s_load_dwordx2 s[8:9], s[0:1], 88
    s_and_b32 s98, s2, 7
    s_mul_i32 s98, s98, 20
    s_lshr_b32 s2, s2, 3
    s_add_u32 s2, s2, s98
    s_mul_hi_u32 s12, s2, 0x33333334
    s_mul_i32 s11, s12, 5
    s_sub_u32 s11, s2, s11
    s_mul_i32 s60, s11, 442368
    s_add_u32 s60, s60, 0x1838000
    s_mul_i32 s61, s12, 221184
    s_add_u32 s61, s61, 0xc7df000
    v_accvgpr_write_b32 a0, 0
    v_accvgpr_write_b32 a1, 0
    v_accvgpr_write_b32 a2, 0
    v_accvgpr_write_b32 a3, 0
    v_accvgpr_write_b32 a4, 0
    v_accvgpr_write_b32 a5, 0
    v_accvgpr_write_b32 a6, 0
    v_accvgpr_write_b32 a7, 0
    v_accvgpr_write_b32 a8, 0
    v_accvgpr_write_b32 a9, 0
    v_accvgpr_write_b32 a10, 0
    v_accvgpr_write_b32 a11, 0
    v_accvgpr_write_b32 a12, 0
    v_accvgpr_write_b32 a13, 0
    v_accvgpr_write_b32 a14, 0
    v_accvgpr_write_b32 a15, 0
    v_accvgpr_write_b32 a16, 0
    v_accvgpr_write_b32 a17, 0
    v_accvgpr_write_b32 a18, 0
    v_accvgpr_write_b32 a19, 0
    v_accvgpr_write_b32 a20, 0
    v_accvgpr_write_b32 a21, 0
    v_accvgpr_write_b32 a22, 0
    v_accvgpr_write_b32 a23, 0
    v_accvgpr_write_b32 a24, 0
    v_accvgpr_write_b32 a25, 0
    v_accvgpr_write_b32 a26, 0
    v_accvgpr_write_b32 a27, 0
    v_accvgpr_write_b32 a28, 0
    v_accvgpr_write_b32 a29, 0
    v_accvgpr_write_b32 a30, 0
    v_accvgpr_write_b32 a31, 0
    s_lshr_b32 s50, s3, 1
    s_and_b32 s51, s3, 1
    s_mul_i32 s50, s50, 4096
    s_mul_i32 s51, s51, 2048
    s_add_u32 s51, s51, 8192
    v_add_u32 v15, s51, v16
    v_add_u32 v14, s50, v16
    s_mul_i32 s52, s3, 3
    s_add_u32 s54, s52, 0
    s_lshr_b32 s55, s54, 1
    s_and_b32 s56, s54, 1
    s_lshl_b32 s56, s56, 10
    s_mul_i32 s57, s55, 110592
    s_add_u32 s57, s57, s60
    s_sub_u32 s58, s55, 4
    s_mul_i32 s58, s58, 110592
    s_add_u32 s58, s58, s61
    s_cmp_lt_u32 s55, 4
    s_cselect_b32 s57, s57, s58
    s_add_u32 s80, s57, s56
    s_add_u32 s54, s52, 1
    s_lshr_b32 s55, s54, 1
    s_and_b32 s56, s54, 1
    s_lshl_b32 s56, s56, 10
    s_mul_i32 s57, s55, 110592
    s_add_u32 s57, s57, s60
    s_sub_u32 s58, s55, 4
    s_mul_i32 s58, s58, 110592
    s_add_u32 s58, s58, s61
    s_cmp_lt_u32 s55, 4
    s_cselect_b32 s57, s57, s58
    s_add_u32 s81, s57, s56
    s_add_u32 s54, s52, 2
    s_lshr_b32 s55, s54, 1
    s_and_b32 s56, s54, 1
    s_lshl_b32 s56, s56, 10
    s_mul_i32 s57, s55, 110592
    s_add_u32 s57, s57, s60
    s_sub_u32 s58, s55, 4
    s_mul_i32 s58, s58, 110592
    s_add_u32 s58, s58, s61
    s_cmp_lt_u32 s55, 4
    s_cselect_b32 s57, s57, s58
    s_add_u32 s82, s57, s56
    s_lshl_b32 s52, s52, 10
    s_mov_b32 s53, 0
    s_add_u32 s54, s53, s52
    s_mov_b32 m0, s54
    s_add_u32 s54, s54, 1024
    buffer_load_dwordx4 v16, s[24:27], s80 offen lds
    s_add_u32 s80, s80, 2048
    s_mov_b32 m0, s54
    s_add_u32 s54, s54, 1024
    buffer_load_dwordx4 v16, s[24:27], s81 offen lds
    s_add_u32 s81, s81, 2048
    s_mov_b32 m0, s54
    s_add_u32 s54, s54, 1024
    buffer_load_dwordx4 v16, s[24:27], s82 offen lds
    s_add_u32 s82, s82, 2048
    s_add_u32 s53, s53, 12288
    s_cmp_ge_u32 s53, 98304
    s_cselect_b32 s53, 0, s53
    s_add_u32 s54, s53, s52
    s_mov_b32 m0, s54
    s_add_u32 s54, s54, 1024
    buffer_load_dwordx4 v16, s[24:27], s80 offen lds
    s_add_u32 s80, s80, 2048
    s_mov_b32 m0, s54
    s_add_u32 s54, s54, 1024
    buffer_load_dwordx4 v16, s[24:27], s81 offen lds
    s_add_u32 s81, s81, 2048
    s_mov_b32 m0, s54
    s_add_u32 s54, s54, 1024
    buffer_load_dwordx4 v16, s[24:27], s82 offen lds
    s_add_u32 s82, s82, 2048
    s_add_u32 s53, s53, 12288
    s_cmp_ge_u32 s53, 98304
    s_cselect_b32 s53, 0, s53
    s_add_u32 s54, s53, s52
    s_mov_b32 m0, s54
    s_add_u32 s54, s54, 1024
    buffer_load_dwordx4 v16, s[24:27], s80 offen lds
    s_add_u32 s80, s80, 2048
    s_mov_b32 m0, s54
    s_add_u32 s54, s54, 1024
    buffer_load_dwordx4 v16, s[24:27], s81 offen lds
    s_add_u32 s81, s81, 2048
    s_mov_b32 m0, s54
    s_add_u32 s54, s54, 1024
    buffer_load_dwordx4 v16, s[24:27], s82 offen lds
    s_add_u32 s82, s82, 2048
    s_add_u32 s53, s53, 12288
    s_cmp_ge_u32 s53, 98304
    s_cselect_b32 s53, 0, s53
    s_add_u32 s54, s53, s52
    s_mov_b32 m0, s54
    s_add_u32 s54, s54, 1024
    buffer_load_dwordx4 v16, s[24:27], s80 offen lds
    s_add_u32 s80, s80, 2048
    s_mov_b32 m0, s54
    s_add_u32 s54, s54, 1024
    buffer_load_dwordx4 v16, s[24:27], s81 offen lds
    s_add_u32 s81, s81, 2048
    s_mov_b32 m0, s54
    s_add_u32 s54, s54, 1024
    buffer_load_dwordx4 v16, s[24:27], s82 offen lds
    s_add_u32 s82, s82, 2048
    s_add_u32 s53, s53, 12288
    s_cmp_ge_u32 s53, 98304
    s_cselect_b32 s53, 0, s53
    s_add_u32 s54, s53, s52
    s_mov_b32 m0, s54
    s_add_u32 s54, s54, 1024
    buffer_load_dwordx4 v16, s[24:27], s80 offen lds
    s_add_u32 s80, s80, 2048
    s_mov_b32 m0, s54
    s_add_u32 s54, s54, 1024
    buffer_load_dwordx4 v16, s[24:27], s81 offen lds
    s_add_u32 s81, s81, 2048
    s_mov_b32 m0, s54
    s_add_u32 s54, s54, 1024
    buffer_load_dwordx4 v16, s[24:27], s82 offen lds
    s_add_u32 s82, s82, 2048
    s_add_u32 s53, s53, 12288
    s_cmp_ge_u32 s53, 98304
    s_cselect_b32 s53, 0, s53
    s_add_u32 s54, s53, s52
    s_mov_b32 m0, s54
    s_add_u32 s54, s54, 1024
    buffer_load_dwordx4 v16, s[24:27], s80 offen lds
    s_add_u32 s80, s80, 2048
    s_mov_b32 m0, s54
    s_add_u32 s54, s54, 1024
    buffer_load_dwordx4 v16, s[24:27], s81 offen lds
    s_add_u32 s81, s81, 2048
    s_mov_b32 m0, s54
    s_add_u32 s54, s54, 1024
    buffer_load_dwordx4 v16, s[24:27], s82 offen lds
    s_add_u32 s82, s82, 2048
    s_add_u32 s53, s53, 12288
    s_cmp_ge_u32 s53, 98304
    s_cselect_b32 s53, 0, s53
    s_add_u32 s54, s53, s52
    s_mov_b32 m0, s54
    s_add_u32 s54, s54, 1024
    buffer_load_dwordx4 v16, s[24:27], s80 offen lds
    s_add_u32 s80, s80, 2048
    s_mov_b32 m0, s54
    s_add_u32 s54, s54, 1024
    buffer_load_dwordx4 v16, s[24:27], s81 offen lds
    s_add_u32 s81, s81, 2048
    s_mov_b32 m0, s54
    s_add_u32 s54, s54, 1024
    buffer_load_dwordx4 v16, s[24:27], s82 offen lds
    s_add_u32 s82, s82, 2048
    s_add_u32 s53, s53, 12288
    s_cmp_ge_u32 s53, 98304
    s_cselect_b32 s53, 0, s53
    s_waitcnt vmcnt(18)
    s_barrier
    ds_read_b128 v[64:67], v14 offset:0
    ds_read_b128 v[68:71], v14 offset:2048
    ds_read_b128 v[80:83], v15 offset:0
    s_mov_b32 s59, 0
    s_mov_b32 s49, 0
    s_mov_b32 s47, 12288
GL_101:
    ds_read_b128 v[96:99], v14 offset:1024
    ds_read_b128 v[100:103], v14 offset:3072
    ds_read_b128 v[112:115], v15 offset:1024
    s_waitcnt lgkmcnt(3)
    v_mfma_f32_32x32x16_bf16 a[0:15], v[64:67], v[80:83], a[0:15]
    v_mfma_f32_32x32x16_bf16 a[16:31], v[68:71], v[80:83], a[16:31]
    s_add_u32 s49, s49, 12288
    s_cmp_ge_u32 s49, 98304
    s_cselect_b32 s48, 4294881280, s47
    s_cselect_b32 s49, 0, s49
    v_add_u32 v14, s48, v14
    v_add_u32 v15, s48, v15
    s_cmp_ge_u32 s59, 47
    s_cbranch_scc1 GL_102
    s_waitcnt vmcnt(15)
    s_barrier
    s_waitcnt lgkmcnt(0)
    ds_read_b128 v[64:67], v14 offset:0
    ds_read_b128 v[68:71], v14 offset:2048
    ds_read_b128 v[80:83], v15 offset:0
    s_add_u32 s54, s53, s52
    v_mfma_f32_32x32x16_bf16 a[0:15], v[96:99], v[112:115], a[0:15]
    s_mov_b32 m0, s54
    s_add_u32 s54, s54, 1024
    buffer_load_dwordx4 v16, s[24:27], s80 offen lds
    s_add_u32 s80, s80, 2048
    v_mfma_f32_32x32x16_bf16 a[16:31], v[100:103], v[112:115], a[16:31]
    s_mov_b32 m0, s54
    s_add_u32 s54, s54, 1024
    buffer_load_dwordx4 v16, s[24:27], s81 offen lds
    s_add_u32 s81, s81, 2048
    s_mov_b32 m0, s54
    s_add_u32 s54, s54, 1024
    buffer_load_dwordx4 v16, s[24:27], s82 offen lds
    s_add_u32 s82, s82, 2048
    s_add_u32 s53, s53, 12288
    s_cmp_ge_u32 s53, 98304
    s_cselect_b32 s53, 0, s53
    s_branch GL_104
GL_102:
    s_cmp_lg_u32 s59, 47
    s_cbranch_scc1 GK_106
    s_waitcnt vmcnt(15)
    s_branch GL_103
GK_106:
    s_cmp_lg_u32 s59, 48
    s_cbranch_scc1 GK_107
    s_waitcnt vmcnt(12)
    s_branch GL_103
GK_107:
    s_cmp_lg_u32 s59, 49
    s_cbranch_scc1 GK_108
    s_waitcnt vmcnt(9)
    s_branch GL_103
GK_108:
    s_cmp_lg_u32 s59, 50
    s_cbranch_scc1 GK_109
    s_waitcnt vmcnt(6)
    s_branch GL_103
GK_109:
    s_cmp_lg_u32 s59, 51
    s_cbranch_scc1 GK_110
    s_waitcnt vmcnt(3)
    s_branch GL_103
GK_110:
    s_waitcnt vmcnt(0)
GL_103:
    s_barrier
    s_waitcnt lgkmcnt(0)
    ds_read_b128 v[64:67], v14 offset:0
    ds_read_b128 v[68:71], v14 offset:2048
    ds_read_b128 v[80:83], v15 offset:0
    v_mfma_f32_32x32x16_bf16 a[0:15], v[96:99], v[112:115], a[0:15]
    v_mfma_f32_32x32x16_bf16 a[16:31], v[100:103], v[112:115], a[16:31]
GL_104:
    s_add_u32 s59, s59, 1
    s_cmp_lt_u32 s59, 54
    s_cbranch_scc1 GL_101
    s_waitcnt lgkmcnt(0)
    s_nop 15
    s_mov_b32 s28, s8
    s_and_b32 s29, s9, 0xffff
    s_mov_b32 s30, 0x280000
    s_mov_b32 s31, 0x00020000
    s_lshr_b32 s14, s3, 1
    s_and_b32 s15, s3, 1
    s_lshl_b32 s16, s11, 2
    s_lshl_b32 s17, s14, 1
    s_add_u32 s16, s16, s17
    s_lshl_b32 s17, s12, 1
    s_add_u32 s17, s17, s15
    s_mul_i32 s18, s17, 40960
    s_lshl_b32 s19, s16, 6
    s_add_u32 s18, s18, s19
    s_add_u32 s19, s18, 0xc55f000
    v_and_b32 v3, 31, v2
    v_lshrrev_b32 v4, 5, v2
    v_mul_u32_u24 v7, 1280, v3
    v_lshl_add_u32 v7, v4, 3, v7
    buffer_load_dwordx2 v[100:101], v7, s[24:27], s19 offen offset:0
    buffer_load_dwordx2 v[102:103], v7, s[24:27], s19 offen offset:16
    buffer_load_dwordx2 v[104:105], v7, s[24:27], s19 offen offset:32
    buffer_load_dwordx2 v[106:107], v7, s[24:27], s19 offen offset:48
    buffer_load_dwordx2 v[108:109], v7, s[24:27], s19 offen offset:64
    buffer_load_dwordx2 v[110:111], v7, s[24:27], s19 offen offset:80
    buffer_load_dwordx2 v[112:113], v7, s[24:27], s19 offen offset:96
    buffer_load_dwordx2 v[114:115], v7, s[24:27], s19 offen offset:112
    s_waitcnt vmcnt(0)
    v_accvgpr_read_b32 v32, a0
    v_accvgpr_read_b32 v33, a1
    v_accvgpr_read_b32 v34, a2
    v_accvgpr_read_b32 v35, a3
    v_cvt_pk_bf16_f32 v48, v32, v33
    v_cvt_pk_bf16_f32 v49, v34, v35
    v_lshlrev_b32 v32, 16, v48
    v_and_b32 v33, 0xffff0000, v48
    v_lshlrev_b32 v34, 16, v49
    v_and_b32 v35, 0xffff0000, v49
    v_lshlrev_b32 v36, 16, v100
    v_and_b32 v37, 0xffff0000, v100
    v_lshlrev_b32 v38, 16, v101
    v_and_b32 v39, 0xffff0000, v101
    v_add_f32 v32, v32, v36
    v_add_f32 v33, v33, v37
    v_add_f32 v34, v34, v38
    v_add_f32 v35, v35, v39
    v_cvt_pk_bf16_f32 v50, v32, v33
    v_cvt_pk_bf16_f32 v51, v34, v35
    buffer_store_dwordx2 v[50:51], v7, s[28:31], s18 offen offset:0
    v_accvgpr_read_b32 v32, a4
    v_accvgpr_read_b32 v33, a5
    v_accvgpr_read_b32 v34, a6
    v_accvgpr_read_b32 v35, a7
    v_cvt_pk_bf16_f32 v48, v32, v33
    v_cvt_pk_bf16_f32 v49, v34, v35
    v_lshlrev_b32 v32, 16, v48
    v_and_b32 v33, 0xffff0000, v48
    v_lshlrev_b32 v34, 16, v49
    v_and_b32 v35, 0xffff0000, v49
    v_lshlrev_b32 v36, 16, v102
    v_and_b32 v37, 0xffff0000, v102
    v_lshlrev_b32 v38, 16, v103
    v_and_b32 v39, 0xffff0000, v103
    v_add_f32 v32, v32, v36
    v_add_f32 v33, v33, v37
    v_add_f32 v34, v34, v38
    v_add_f32 v35, v35, v39
    v_cvt_pk_bf16_f32 v52, v32, v33
    v_cvt_pk_bf16_f32 v53, v34, v35
    buffer_store_dwordx2 v[52:53], v7, s[28:31], s18 offen offset:16
    v_accvgpr_read_b32 v32, a8
    v_accvgpr_read_b32 v33, a9
    v_accvgpr_read_b32 v34, a10
    v_accvgpr_read_b32 v35, a11
    v_cvt_pk_bf16_f32 v48, v32, v33
    v_cvt_pk_bf16_f32 v49, v34, v35
    v_lshlrev_b32 v32, 16, v48
    v_and_b32 v33, 0xffff0000, v48
    v_lshlrev_b32 v34, 16, v49
    v_and_b32 v35, 0xffff0000, v49
    v_lshlrev_b32 v36, 16, v104
    v_and_b32 v37, 0xffff0000, v104
    v_lshlrev_b32 v38, 16, v105
    v_and_b32 v39, 0xffff0000, v105
    v_add_f32 v32, v32, v36
    v_add_f32 v33, v33, v37
    v_add_f32 v34, v34, v38
    v_add_f32 v35, v35, v39
    v_cvt_pk_bf16_f32 v50, v32, v33
    v_cvt_pk_bf16_f32 v51, v34, v35
    buffer_store_dwordx2 v[50:51], v7, s[28:31], s18 offen offset:32
    v_accvgpr_read_b32 v32, a12
    v_accvgpr_read_b32 v33, a13
    v_accvgpr_read_b32 v34, a14
    v_accvgpr_read_b32 v35, a15
    v_cvt_pk_bf16_f32 v48, v32, v33
    v_cvt_pk_bf16_f32 v49, v34, v35
    v_lshlrev_b32 v32, 16, v48
    v_and_b32 v33, 0xffff0000, v48
    v_lshlrev_b32 v34, 16, v49
    v_and_b32 v35, 0xffff0000, v49
    v_lshlrev_b32 v36, 16, v106
    v_and_b32 v37, 0xffff0000, v106
    v_lshlrev_b32 v38, 16, v107
    v_and_b32 v39, 0xffff0000, v107
    v_add_f32 v32, v32, v36
    v_add_f32 v33, v33, v37
    v_add_f32 v34, v34, v38
    v_add_f32 v35, v35, v39
    v_cvt_pk_bf16_f32 v52, v32, v33
    v_cvt_pk_bf16_f32 v53, v34, v35
    buffer_store_dwordx2 v[52:53], v7, s[28:31], s18 offen offset:48
    v_accvgpr_read_b32 v32, a16
    v_accvgpr_read_b32 v33, a17
    v_accvgpr_read_b32 v34, a18
    v_accvgpr_read_b32 v35, a19
    v_cvt_pk_bf16_f32 v48, v32, v33
    v_cvt_pk_bf16_f32 v49, v34, v35
    v_lshlrev_b32 v32, 16, v48
    v_and_b32 v33, 0xffff0000, v48
    v_lshlrev_b32 v34, 16, v49
    v_and_b32 v35, 0xffff0000, v49
    v_lshlrev_b32 v36, 16, v108
    v_and_b32 v37, 0xffff0000, v108
    v_lshlrev_b32 v38, 16, v109
    v_and_b32 v39, 0xffff0000, v109
    v_add_f32 v32, v32, v36
    v_add_f32 v33, v33, v37
    v_add_f32 v34, v34, v38
    v_add_f32 v35, v35, v39
    v_cvt_pk_bf16_f32 v50, v32, v33
    v_cvt_pk_bf16_f32 v51, v34, v35
    buffer_store_dwordx2 v[50:51], v7, s[28:31], s18 offen offset:64
    v_accvgpr_read_b32 v32, a20
    v_accvgpr_read_b32 v33, a21
    v_accvgpr_read_b32 v34, a22
    v_accvgpr_read_b32 v35, a23
    v_cvt_pk_bf16_f32 v48, v32, v33
    v_cvt_pk_bf16_f32 v49, v34, v35
    v_lshlrev_b32 v32, 16, v48
    v_and_b32 v33, 0xffff0000, v48
    v_lshlrev_b32 v34, 16, v49
    v_and_b32 v35, 0xffff0000, v49
    v_lshlrev_b32 v36, 16, v110
    v_and_b32 v37, 0xffff0000, v110
    v_lshlrev_b32 v38, 16, v111
    v_and_b32 v39, 0xffff0000, v111
    v_add_f32 v32, v32, v36
    v_add_f32 v33, v33, v37
    v_add_f32 v34, v34, v38
    v_add_f32 v35, v35, v39
    v_cvt_pk_bf16_f32 v52, v32, v33
    v_cvt_pk_bf16_f32 v53, v34, v35
    buffer_store_dwordx2 v[52:53], v7, s[28:31], s18 offen offset:80
    v_accvgpr_read_b32 v32, a24
    v_accvgpr_read_b32 v33, a25
    v_accvgpr_read_b32 v34, a26
    v_accvgpr_read_b32 v35, a27
    v_cvt_pk_bf16_f32 v48, v32, v33
    v_cvt_pk_bf16_f32 v49, v34, v35
    v_lshlrev_b32 v32, 16, v48
    v_and_b32 v33, 0xffff0000, v48
    v_lshlrev_b32 v34, 16, v49
    v_and_b32 v35, 0xffff0000, v49
    v_lshlrev_b32 v36, 16, v112
    v_and_b32 v37, 0xffff0000, v112
    v_lshlrev_b32 v38, 16, v113
    v_and_b32 v39, 0xffff0000, v113
    v_add_f32 v32, v32, v36
    v_add_f32 v33, v33, v37
    v_add_f32 v34, v34, v38
    v_add_f32 v35, v35, v39
    v_cvt_pk_bf16_f32 v50, v32, v33
    v_cvt_pk_bf16_f32 v51, v34, v35
    buffer_store_dwordx2 v[50:51], v7, s[28:31], s18 offen offset:96
    v_accvgpr_read_b32 v32, a28
    v_accvgpr_read_b32 v33, a29
    v_accvgpr_read_b32 v34, a30
    v_accvgpr_read_b32 v35, a31
    v_cvt_pk_bf16_f32 v48, v32, v33
    v_cvt_pk_bf16_f32 v49, v34, v35
    v_lshlrev_b32 v32, 16, v48
    v_and_b32 v33, 0xffff0000, v48
    v_lshlrev_b32 v34, 16, v49
    v_and_b32 v35, 0xffff0000, v49
    v_lshlrev_b32 v36, 16, v114
    v_and_b32 v37, 0xffff0000, v114
    v_lshlrev_b32 v38, 16, v115
    v_and_b32 v39, 0xffff0000, v115
    v_add_f32 v32, v32, v36
    v_add_f32 v33, v33, v37
    v_add_f32 v34, v34, v38
    v_add_f32 v35, v35, v39
    v_cvt_pk_bf16_f32 v52, v32, v33
    v_cvt_pk_bf16_f32 v53, v34, v35
    buffer_store_dwordx2 v[52:53], v7, s[28:31], s18 offen offset:112
END_100:
    s_endpgm
.section .rodata,"a"

.p2align 6
.amdhsa_kernel prep_kernel
  .amdhsa_next_free_vgpr 64
  .amdhsa_next_free_sgpr 102
  .amdhsa_accum_offset 64
  .amdhsa_group_segment_fixed_size 0
  .amdhsa_kernarg_size 112
  .amdhsa_user_sgpr_count 2
  .amdhsa_user_sgpr_kernarg_segment_ptr 1
  .amdhsa_system_sgpr_workgroup_id_x 1
.end_amdhsa_kernel

.p2align 6
.amdhsa_kernel gemm1_kernel
  .amdhsa_next_free_vgpr 512
  .amdhsa_next_free_sgpr 102
  .amdhsa_accum_offset 256
  .amdhsa_group_segment_fixed_size 0
  .amdhsa_kernarg_size 112
  .amdhsa_user_sgpr_count 2
  .amdhsa_user_sgpr_kernarg_segment_ptr 1
  .amdhsa_system_sgpr_workgroup_id_x 1
.end_amdhsa_kernel

.p2align 6
.amdhsa_kernel rec_kernel
  .amdhsa_next_free_vgpr 512
  .amdhsa_next_free_sgpr 102
  .amdhsa_accum_offset 256
  .amdhsa_group_segment_fixed_size 0
  .amdhsa_kernarg_size 112
  .amdhsa_user_sgpr_count 2
  .amdhsa_user_sgpr_kernarg_segment_ptr 1
  .amdhsa_system_sgpr_workgroup_id_x 1
.end_amdhsa_kernel

.p2align 6
.amdhsa_kernel tail_kernel
  .amdhsa_next_free_vgpr 272
  .amdhsa_next_free_sgpr 102
  .amdhsa_accum_offset 192
  .amdhsa_group_segment_fixed_size 0
  .amdhsa_kernarg_size 112
  .amdhsa_user_sgpr_count 2
  .amdhsa_user_sgpr_kernarg_segment_ptr 1
  .amdhsa_system_sgpr_workgroup_id_x 1
.end_amdhsa_kernel

.p2align 6
.amdhsa_kernel up_kernel
  .amdhsa_next_free_vgpr 192
  .amdhsa_next_free_sgpr 102
  .amdhsa_accum_offset 128
  .amdhsa_group_segment_fixed_size 0
  .amdhsa_kernarg_size 112
  .amdhsa_user_sgpr_count 2
  .amdhsa_user_sgpr_kernarg_segment_ptr 1
  .amdhsa_system_sgpr_workgroup_id_x 1
.end_amdhsa_kernel

.p2align 6
.amdhsa_kernel down_kernel
  .amdhsa_next_free_vgpr 160
  .amdhsa_next_free_sgpr 102
  .amdhsa_accum_offset 128
  .amdhsa_group_segment_fixed_size 0
  .amdhsa_kernarg_size 112
  .amdhsa_user_sgpr_count 2
  .amdhsa_user_sgpr_kernarg_segment_ptr 1
  .amdhsa_system_sgpr_workgroup_id_x 1
.end_amdhsa_kernel
```
